```python
import torch

def _softmax(x, axis=-1):
    return torch.softmax(x, dim=axis)
def _gelu(x):
    return torch.nn.functional.gelu(x, approximate="tanh")
def _silu(x):
    return torch.nn.functional.silu(x)
def _sigmoid(x):
    return torch.sigmoid(x)
def _layernorm(x, axis=-1, eps=1e-5):
    m = x.mean(dim=axis, keepdim=True)
    v = x.var(dim=axis, keepdim=True, unbiased=False)
    return (x - m) / torch.sqrt(v + eps)
def _scatter_add(tgt, idx, src, axis=0):
    return tgt.clone().index_add_(axis, idx, src)
def _segment_sum(src, seg, n):
    out = torch.zeros((n,) + src.shape[1:], dtype=src.dtype)
    return out.index_add_(0, seg, src)
def _pad(x, pw):
    flat = tuple(v for pair in reversed(pw) for v in pair)
    return torch.nn.functional.pad(x, flat)

kernel_name = 'concat_heads__softmax_full_mha__compressed_kv_cla__prompt'

def setup_inputs():

    _w = (lambda a: (lambda t: t.to(torch.bfloat16) if t.is_floating_point() else t)(torch.as_tensor(a)))
    def _A_setup():
        B, S, D = 1, 2048, 448
        return {
            "x": _w((lambda *s: torch.randn(*s, dtype=torch.bfloat16) * 0.4)(B, S, D)),
            "wqkv": _w((lambda *s: torch.randn(*s, dtype=torch.bfloat16) * 0.4)(D, 3 * D)),
            "wo": _w((lambda *s: torch.randn(*s, dtype=torch.bfloat16) * 0.05)(D, D)),
        }
    _A_in = _A_setup()

    def _B_setup():
        B, H, Sq, Sk, D, M = 1, 16, 2048, 2048, 256, 448
        Dc = 4 * D
        return {
            "x": _w((lambda *s: torch.randn(*s, dtype=torch.bfloat16) * 0.2)(B, Sq, M)),
            "c_kv": _w((lambda *s: torch.randn(*s, dtype=torch.bfloat16) * 1.6)(B, Sk, Dc)),
            "w_q": _w((lambda *s: torch.randn(*s, dtype=torch.bfloat16) * 3.2)(M, H, D) * (M ** -0.5)),
            "w_uk": _w((lambda *s: torch.randn(*s, dtype=torch.bfloat16) * 3.2)(Dc, H, D) * (Dc ** -0.5)),
            "w_uv": _w((lambda *s: torch.randn(*s, dtype=torch.bfloat16) * 1.6)(Dc, H, D) * (Dc ** -0.5)),
            "w_o": _w((lambda *s: torch.randn(*s, dtype=torch.bfloat16) * 1.6)(H, D, M) * ((H * D) ** -0.5)),
        }
    _B_in = _B_setup()

    return {
        "A_x": _A_in["x"],
        "A_wqkv": _A_in["wqkv"],
        "A_wo": _A_in["wo"],
        "B_x": _B_in["x"],
        "B_c_kv": _B_in["c_kv"],
        "B_w_q": _B_in["w_q"],
        "B_w_uk": _B_in["w_uk"],
        "B_w_uv": _B_in["w_uv"],
        "B_w_o": _B_in["w_o"],
    }

def reference(A_x, A_wqkv, A_wo, B_x, B_c_kv, B_w_q, B_w_uk, B_w_uv, B_w_o):
    def _A_ref(x, wqkv, wo):
        B, S, D = x.shape
        H = 16; Dh = D // H
        qkv = (lambda x, *d: x.permute(*d))((x @ wqkv).reshape(B, S, 3, H, Dh), 2, 0, 3, 1, 4)
        q, k, v = qkv[0], qkv[1], qkv[2]
        scale = Dh ** -0.5
        scores = torch.einsum("bhqd,bhkd->bhqk", q, k) * scale
        p = _softmax(scores, axis=-1)
        o = torch.einsum("bhqk,bhkd->bhqd", p, v)
        return (lambda x, *d: x.permute(*d))(o, 0, 2, 1, 3).reshape(B, S, D) @ wo

    def _B_ref(x, c_kv, w_q, w_uk, w_uv, w_o):
        B, Sq, M = x.shape[0], x.shape[1], x.shape[2]
        Sk = c_kv.shape[1]
        H, D = w_q.shape[1], w_q.shape[2]
        q = torch.einsum("bqm,mhd->bhqd", x, w_q)
        k = torch.einsum("bkc,chd->bhkd", c_kv, w_uk)
        v = torch.einsum("bkc,chd->bhkd", c_kv, w_uv)
        scores = torch.einsum("bhqd,bhkd->bhqk", q, k) * (D ** -0.5)
        off = Sk - Sq
        qi = torch.arange(Sq)[:, None]
        kj = torch.arange(Sk)[None, :]
        cmask = kj <= (qi + off)
        scores = torch.where(cmask[None, None], scores, -1e9)
        p = _softmax(scores, axis=-1)
        ctx = torch.einsum("bhqk,bhkd->bhqd", p, v)
        return torch.einsum("bhqd,hdm->bqm", ctx, w_o)

    a = _A_ref(A_x, A_wqkv, A_wo)
    b = _B_ref(B_x, B_c_kv, B_w_q, B_w_uk, B_w_uv, B_w_o)
    return torch.concatenate([a, b], axis=-1)
```

```asm
; @launch grid=(256,1,1) block=(256,1,1) lds=163840
.amdgcn_target "amdgcn-amd-amdhsa--gfx950"
.text
.globl concat_heads__softmax_full_mha__compressed_kv_cla__prompt_kernel
.p2align 8
.type concat_heads__softmax_full_mha__compressed_kv_cla__prompt_kernel,@function
concat_heads__softmax_full_mha__compressed_kv_cla__prompt_kernel:
s_cmp_lt_u32 s2, 256
s_cbranch_scc1 LM_go
s_endpgm
LM_go:
s_load_dwordx16 s[76:91], s[0:1], 0
s_load_dwordx4 s[92:95], s[0:1], 80
v_lshrrev_b32 v14, 6, v0
v_and_b32 v0, 63, v0
s_nop 0
v_readfirstlane_b32 s48, v14
s_and_b32 s53, s2, 7
s_lshr_b32 s54, s2, 3
s_and_b32 s55, s54, 1
s_and_b32 s56, s54, 2
s_lshl_b32 s56, s56, 1
s_add_u32 s55, s55, s56
s_cmp_lt_u32 s54, 16
s_cselect_b32 s56, 0, 2
s_add_u32 s55, s55, s56
s_lshl_b32 s57, s54, 1
s_and_b32 s57, s57, 8
s_add_u32 s57, s57, s53
s_lshr_b32 s64, s54, 3
s_and_b32 s64, s64, 1
s_and_b32 s100, s54, 1
s_lshl_b32 s100, s100, 3
s_add_u32 s100, s100, s53
s_lshr_b32 s101, s54, 1
s_and_b32 s101, s101, 7
s_add_u32 s101, s101, 8
v_lshrrev_b32 v14, 3, v0
v_and_b32 v15, 7, v0
s_and_b32 s58, s48, 1
s_lshl_b32 s59, s58, 2
v_lshrrev_b32 v8, 1, v14
v_add_u32 v8, s59, v8
v_xor_b32 v8, v15, v8
v_lshlrev_b32 v8, 4, v8
s_lshl_b32 s59, s48, 3
v_add_u32 v14, s59, v14
v_mul_u32_u24 v10, 896, v14
v_add_u32 v10, v10, v8
v_lshl_add_u32 v8, v14, 11, v8
v_bfe_u32 v9, v0, 4, 1
s_lshl_b32 s59, s58, 1
v_or_b32 v9, s59, v9
v_lshrrev_b32 v12, 1, v15
v_xor_b32 v9, v12, v9
v_and_b32 v15, 1, v15
v_lshlrev_b32 v15, 4, v15
v_lshrrev_b32 v13, 1, v9
v_mul_u32_u24 v13, 56, v13
v_and_b32 v12, 1, v9
v_lshl_add_u32 v13, v12, 5, v13
v_add_u32 v13, v13, v15
v_mul_u32_u24 v12, 2688, v14
v_add_u32 v13, v13, v12
v_lshl_add_u32 v9, v9, 5, v15
v_lshl_add_u32 v9, v14, 13, v9
s_lshl_b32 s24, s55, 19
s_add_u32 s24, s24, 0
s_lshl_b32 s25, s55, 19
s_add_u32 s25, s25, 65536
s_lshl_b32 s26, s55, 19
s_add_u32 s26, s26, 131072
s_lshl_b32 s27, s55, 19
s_add_u32 s27, s27, 196608
s_lshl_b32 s28, s55, 19
s_add_u32 s28, s28, 262144
s_lshl_b32 s29, s55, 19
s_add_u32 s29, s29, 327680
s_lshl_b32 s30, s55, 19
s_add_u32 s30, s30, 393216
s_lshl_b32 s31, s55, 19
s_add_u32 s31, s31, 458752
s_lshl_b32 s40, s57, 9
s_add_u32 s40, s40, 0
s_lshl_b32 s41, s57, 9
s_add_u32 s41, s41, 128
s_lshl_b32 s42, s57, 9
s_add_u32 s42, s42, 256
s_lshl_b32 s43, s57, 9
s_add_u32 s43, s43, 384
s_lshl_b32 s51, s48, 10
v_mov_b32 v11, v9
s_mov_b32 s66, 262144
s_waitcnt lgkmcnt(0)
s_mov_b32 s4, s84
s_mov_b32 s5, s85
s_mov_b32 s6, 4194304
s_mov_b32 s7, 0x20000
s_cmp_eq_u32 s64, 0
s_cselect_b32 s8, s88, s90
s_cselect_b32 s9, s89, s91
s_mov_b32 s10, 8388608
s_mov_b32 s11, 0x20000
s_mov_b32 s12, s76
s_mov_b32 s13, s77
s_mov_b32 s14, 1835008
s_mov_b32 s15, 0x20000
s_mov_b32 s16, s78
s_mov_b32 s17, s79
s_mov_b32 s18, 1204224
s_mov_b32 s19, 0x20000
s_cmp_ge_u32 s54, 16
s_cbranch_scc1 LM_pb
s_add_u32 m0, s51, 0
s_nop 0
buffer_load_dwordx4 v9, s[8:11], s40 offen lds
s_add_u32 m0, s51, 4096
s_nop 0
buffer_load_dwordx4 v9, s[8:11], s41 offen lds
s_add_u32 m0, s51, 8192
s_nop 0
buffer_load_dwordx4 v9, s[8:11], s42 offen lds
s_add_u32 m0, s51, 12288
s_nop 0
buffer_load_dwordx4 v9, s[8:11], s43 offen lds
v_add_u32 v9, 262144, v9
s_add_u32 s50, s51, 65536
s_add_u32 m0, s50, 0
s_nop 0
buffer_load_dwordx4 v8, s[4:7], s24 offen lds
s_add_u32 m0, s50, 4096
s_nop 0
buffer_load_dwordx4 v8, s[4:7], s25 offen lds
s_add_u32 m0, s50, 8192
s_nop 0
buffer_load_dwordx4 v8, s[4:7], s26 offen lds
s_add_u32 m0, s50, 12288
s_nop 0
buffer_load_dwordx4 v8, s[4:7], s27 offen lds
s_add_u32 m0, s50, 16384
s_nop 0
buffer_load_dwordx4 v8, s[4:7], s28 offen lds
s_add_u32 m0, s50, 20480
s_nop 0
buffer_load_dwordx4 v8, s[4:7], s29 offen lds
s_add_u32 m0, s50, 24576
s_nop 0
buffer_load_dwordx4 v8, s[4:7], s30 offen lds
s_add_u32 m0, s50, 28672
s_nop 0
buffer_load_dwordx4 v8, s[4:7], s31 offen lds
v_add_u32 v8, 128, v8
s_mov_b32 s65, 2
s_branch LM_pc
LM_pb:
s_and_b32 s63, s53, 1
s_lshl_b32 s63, s63, 2
s_and_b32 s59, s54, 3
s_add_u32 s63, s63, s59
s_lshr_b32 s56, s53, 1
s_lshl_b32 s56, s56, 2
s_lshr_b32 s59, s54, 2
s_and_b32 s59, s59, 3
s_add_u32 s56, s56, s59
s_lshl_b32 s3, s56, 3
s_add_u32 s3, s3, s63
s_lshl_b32 s3, s3, 2
s_add_u32 s3, s3, 109096960
s_mul_i32 s32, s63, 229376
s_add_u32 s32, s32, 0
s_mul_i32 s33, s63, 229376
s_add_u32 s33, s33, 28672
s_mul_i32 s34, s63, 229376
s_add_u32 s34, s34, 57344
s_mul_i32 s35, s63, 229376
s_add_u32 s35, s35, 86016
s_mul_i32 s36, s63, 229376
s_add_u32 s36, s36, 114688
s_mul_i32 s37, s63, 229376
s_add_u32 s37, s37, 143360
s_mul_i32 s38, s63, 229376
s_add_u32 s38, s38, 172032
s_mul_i32 s39, s63, 229376
s_add_u32 s39, s39, 200704
s_lshr_b32 s65, s56, 3
s_mul_i32 s44, s56, 112
s_add_u32 s44, s44, 896
s_mul_i32 s45, s56, 56
s_mov_b32 s66, 86016
v_mov_b32 v11, v13
s_add_u32 m0, s51, 32768
s_nop 0
buffer_load_dwordx4 v11, s[16:19], s44 offen lds
s_add_u32 m0, s51, 36864
s_nop 0
buffer_load_dwordx4 v11, s[16:19], s45 offen lds
v_add_u32 v11, s66, v11
s_add_u32 s50, s51, 65536
s_add_u32 m0, s50, 0
s_nop 0
buffer_load_dwordx4 v10, s[12:15], s32 offen lds
s_add_u32 m0, s50, 4096
s_nop 0
buffer_load_dwordx4 v10, s[12:15], s33 offen lds
s_add_u32 m0, s50, 8192
s_nop 0
buffer_load_dwordx4 v10, s[12:15], s34 offen lds
s_add_u32 m0, s50, 12288
s_nop 0
buffer_load_dwordx4 v10, s[12:15], s35 offen lds
s_add_u32 m0, s50, 16384
s_nop 0
buffer_load_dwordx4 v10, s[12:15], s36 offen lds
s_add_u32 m0, s50, 20480
s_nop 0
buffer_load_dwordx4 v10, s[12:15], s37 offen lds
s_add_u32 m0, s50, 24576
s_nop 0
buffer_load_dwordx4 v10, s[12:15], s38 offen lds
s_add_u32 m0, s50, 28672
s_nop 0
buffer_load_dwordx4 v10, s[12:15], s39 offen lds
v_add_u32 v10, 128, v10
s_lshl_b32 s59, s63, 2
s_add_u32 s59, s59, s48
s_lshl_b32 s63, s56, 17
s_lshl_b32 s68, s59, 12
s_add_u32 s63, s63, s68
s_add_u32 s63, s63, 67108864
s_and_b32 s62, s56, 7
s_lshl_b32 s62, s62, 19
s_lshl_b32 s68, s59, 13
s_add_u32 s62, s62, s68
s_lshl_b32 s68, s65, 11
s_add_u32 s62, s62, s68
s_add_u32 s62, s62, 69206016
LM_pc:
s_getpc_b64 s[88:89]
Lpc_km:
s_sub_u32 s88, s88, Lpc_km-concat_heads__softmax_full_mha__compressed_kv_cla__prompt_kernel
s_subb_u32 s89, s89, 0
s_mov_b32 s90, L_text_end-concat_heads__softmax_full_mha__compressed_kv_cla__prompt_kernel
s_mov_b32 s91, 0x20000
v_lshlrev_b32 v1, 6, v0
v_lshlrev_b32 v1, 4, v0
s_lshl_b32 s59, s54, 12
s_add_u32 s59, s59, s51
buffer_load_dwordx4 a[140:143], v1, s[88:91], s59 offen
s_mov_b32 s76, s92
s_mov_b32 s77, s93
s_mov_b32 s78, 256
s_mov_b32 s79, 0x20000
s_or_b32 s59, s2, s48
s_cmp_lg_u32 s59, 0
s_cbranch_scc1 LM_notag
s_memrealtime s[96:97]
v_mov_b32 v1, 0
s_waitcnt lgkmcnt(0)
s_or_b32 s96, s96, 1
v_mov_b32 v2, s96
s_mov_b64 exec, 1
buffer_store_dword v2, v1, s[76:79], 0 offen sc0 sc1
s_mov_b64 exec, -1
LM_notag:
s_mov_b32 s49, 65536
v_and_b32 v14, 15, v0
v_lshrrev_b32 v15, 4, v0
v_lshrrev_b32 v1, 1, v14
v_xor_b32 v1, v15, v1
v_lshlrev_b32 v1, 4, v1
v_lshl_add_u32 v1, v14, 7, v1
s_lshr_b32 s75, s48, 1
s_lshl_b32 s75, s75, 13
v_add_u32 v1, s75, v1
s_lshl_b32 s98, s48, 13
s_sub_u32 s98, s98, s75
s_sub_u32 s98, s98, s75
v_lshrrev_b32 v3, 3, v14
v_and_b32 v4, 1, v15
v_lshl_or_b32 v3, v4, 1, v3
v_lshrrev_b32 v4, 2, v14
v_lshlrev_b32 v4, 7, v4
v_lshl_add_u32 v4, v15, 10, v4
v_and_b32 v12, 3, v14
v_lshl_add_u32 v4, v12, 3, v4
s_lshl_b32 s74, s58, 13
v_add_u32 v12, s74, v4
v_xor_b32 v7, 3, v3
v_lshl_add_u32 v7, v7, 5, v12
v_xor_b32 v6, 2, v3
v_lshl_add_u32 v6, v6, 5, v12
v_xor_b32 v5, 1, v3
v_lshl_add_u32 v5, v5, 5, v12
v_xor_b32 v4, 0, v3
v_lshl_add_u32 v4, v4, 5, v12
s_mov_b32 s20, s94
s_mov_b32 s21, s95
s_mov_b32 s22, 117440512
s_mov_b32 s23, 0x20000
s_lshr_b32 s59, s48, 1
s_lshl_b32 s59, s59, 2
s_lshl_b32 s60, s55, 3
s_add_u32 s60, s60, s59
s_lshl_b32 s60, s60, 15
s_lshl_b32 s59, s57, 21
s_add_u32 s60, s60, s59
s_lshl_b32 s59, s58, 12
s_add_u32 s68, s74, 16384
s_cmp_eq_u32 s64, 0
s_cselect_b32 s59, s59, s68
s_add_u32 s60, s60, s59
s_cmp_eq_u32 s64, 0
s_mov_b32 s61, 4096
s_cmov_b32 s61, 8192
s_add_u32 s61, s61, s60
s_lshl_b32 s67, s64, 3
s_add_u32 s67, s67, s55
s_lshl_b32 s67, s67, 2
s_lshl_b32 s59, s57, 7
s_add_u32 s67, s67, s59
s_add_u32 s67, s67, 109084672
s_lshl_b32 s99, s100, 7
s_add_u32 s99, s99, 109084672
v_lshlrev_b32 v13, 4, v14
v_lshl_add_u32 v13, v15, 9, v13
v_lshlrev_b32 v12, 4, v0
v_cmp_eq_u32 s[70:71], 12, v14
v_cmp_eq_u32 s[72:73], 3, v15
v_add_u32 v1, s75, v1
s_cmp_eq_u32 s65, 2
s_cbranch_scc1 LM_pa2
v_add_u32 v1, s98, v1
v_add_u32 v2, s49, v1
v_xor_b32 v3, 64, v2
v_subrev_u32 v4, s74, v4
v_subrev_u32 v5, s74, v5
v_subrev_u32 v6, s74, v6
v_subrev_u32 v7, s74, v7
s_add_u32 m0, s51, 49152
s_nop 0
buffer_load_dwordx4 v11, s[16:19], s44 offen lds
s_add_u32 m0, s51, 53248
s_nop 0
buffer_load_dwordx4 v11, s[16:19], s45 offen lds
v_add_u32 v11, s66, v11
s_add_u32 s50, s51, 98304
s_add_u32 m0, s50, 0
s_nop 0
buffer_load_dwordx4 v10, s[12:15], s32 offen lds
s_add_u32 m0, s50, 4096
s_nop 0
buffer_load_dwordx4 v10, s[12:15], s33 offen lds
s_add_u32 m0, s50, 8192
s_nop 0
buffer_load_dwordx4 v10, s[12:15], s34 offen lds
s_add_u32 m0, s50, 12288
s_nop 0
buffer_load_dwordx4 v10, s[12:15], s35 offen lds
s_add_u32 m0, s50, 16384
s_nop 0
buffer_load_dwordx4 v10, s[12:15], s36 offen lds
s_add_u32 m0, s50, 20480
s_nop 0
buffer_load_dwordx4 v10, s[12:15], s37 offen lds
s_add_u32 m0, s50, 24576
s_nop 0
buffer_load_dwordx4 v10, s[12:15], s38 offen lds
s_add_u32 m0, s50, 28672
s_nop 0
buffer_load_dwordx4 v10, s[12:15], s39 offen lds
v_add_u32 v10, 128, v10
s_add_u32 m0, s51, 0
s_nop 0
buffer_load_dwordx4 v11, s[16:19], s44 offen lds
s_add_u32 m0, s51, 4096
s_nop 0
buffer_load_dwordx4 v11, s[16:19], s45 offen lds
v_add_u32 v11, s66, v11
s_add_u32 m0, s51, 16384
s_nop 0
buffer_load_dwordx4 v11, s[16:19], s44 offen lds
s_add_u32 m0, s51, 20480
s_nop 0
buffer_load_dwordx4 v11, s[16:19], s45 offen lds
v_add_u32 v11, s66, v11
s_add_u32 s50, s51, 131072
s_waitcnt vmcnt(14)
s_barrier
ds_read_b64_tr_b16 a[16:17], v4 offset:32768
ds_read_b64_tr_b16 a[18:19], v4 offset:33280
ds_read_b64_tr_b16 a[20:21], v5 offset:32768
ds_read_b64_tr_b16 a[22:23], v5 offset:33280
ds_read_b64_tr_b16 a[24:25], v6 offset:32768
ds_read_b64_tr_b16 a[26:27], v6 offset:33280
ds_read_b64_tr_b16 a[28:29], v7 offset:32768
ds_read_b64_tr_b16 a[30:31], v7 offset:33280
ds_read_b64_tr_b16 a[32:33], v4 offset:36864
ds_read_b64_tr_b16 a[34:35], v4 offset:37376
ds_read_b64_tr_b16 a[36:37], v5 offset:36864
ds_read_b64_tr_b16 a[38:39], v5 offset:37376
ds_read_b128 a[0:3], v2 offset:0
ds_read_b128 a[4:7], v2 offset:2048
ds_read_b128 a[8:11], v2 offset:4096
ds_read_b128 a[12:15], v2 offset:6144
s_cmp_eq_u32 s65, 0
s_cbranch_scc0 LM_xAV
LM_xAK:
s_waitcnt vmcnt(12) lgkmcnt(0)
s_barrier
v_mfma_f32_16x16x32_bf16 v[144:147], a[16:19], a[0:3], 0
v_mfma_f32_16x16x32_bf16 v[148:151], a[20:23], a[0:3], 0
ds_read_b64_tr_b16 a[88:89], v4 offset:49152
s_add_u32 m0, s51, 32768
s_nop 0
buffer_load_dwordx4 v11, s[16:19], s44 offen lds
v_mfma_f32_16x16x32_bf16 v[152:155], a[24:27], a[0:3], 0
ds_read_b64_tr_b16 a[90:91], v4 offset:49664
ds_read_b64_tr_b16 a[92:93], v5 offset:49152
s_add_u32 m0, s51, 36864
v_mfma_f32_16x16x32_bf16 v[156:159], a[28:31], a[0:3], 0
buffer_load_dwordx4 v11, s[16:19], s45 offen lds
v_mfma_f32_16x16x32_bf16 v[160:163], a[32:35], a[0:3], 0
ds_read_b64_tr_b16 a[94:95], v5 offset:49664
s_add_u32 m0, s50, 0
s_nop 0
buffer_load_dwordx4 v10, s[12:15], s32 offen lds
v_add_u32 v11, s66, v11
v_mfma_f32_16x16x32_bf16 v[164:167], a[36:39], a[0:3], 0
ds_read_b64_tr_b16 a[96:97], v6 offset:49152
v_mfma_f32_16x16x32_bf16 v[168:171], a[16:19], a[4:7], 0
ds_read_b64_tr_b16 a[98:99], v6 offset:49664
s_add_u32 m0, s50, 4096
s_nop 0
buffer_load_dwordx4 v10, s[12:15], s33 offen lds
v_mfma_f32_16x16x32_bf16 v[172:175], a[20:23], a[4:7], 0
ds_read_b64_tr_b16 a[100:101], v7 offset:49152
s_add_u32 m0, s50, 8192
v_mfma_f32_16x16x32_bf16 v[176:179], a[24:27], a[4:7], 0
buffer_load_dwordx4 v10, s[12:15], s34 offen lds
ds_read_b64_tr_b16 a[102:103], v7 offset:49664
v_mfma_f32_16x16x32_bf16 v[180:183], a[28:31], a[4:7], 0
ds_read_b64_tr_b16 a[104:105], v4 offset:53248
s_add_u32 m0, s50, 12288
v_mfma_f32_16x16x32_bf16 v[184:187], a[32:35], a[4:7], 0
buffer_load_dwordx4 v10, s[12:15], s35 offen lds
ds_read_b64_tr_b16 a[106:107], v4 offset:53760
v_mfma_f32_16x16x32_bf16 v[188:191], a[36:39], a[4:7], 0
ds_read_b64_tr_b16 a[108:109], v5 offset:53248
s_add_u32 m0, s50, 16384
v_mfma_f32_16x16x32_bf16 v[192:195], a[16:19], a[8:11], 0
buffer_load_dwordx4 v10, s[12:15], s36 offen lds
ds_read_b64_tr_b16 a[110:111], v5 offset:53760
s_add_u32 m0, s50, 20480
v_mfma_f32_16x16x32_bf16 v[196:199], a[20:23], a[8:11], 0
buffer_load_dwordx4 v10, s[12:15], s37 offen lds
v_mfma_f32_16x16x32_bf16 v[200:203], a[24:27], a[8:11], 0
ds_read_b128 a[72:75], v3 offset:0
ds_read_b128 a[76:79], v3 offset:2048
s_add_u32 m0, s50, 24576
v_mfma_f32_16x16x32_bf16 v[204:207], a[28:31], a[8:11], 0
buffer_load_dwordx4 v10, s[12:15], s38 offen lds
v_mfma_f32_16x16x32_bf16 v[208:211], a[32:35], a[8:11], 0
ds_read_b128 a[80:83], v3 offset:4096
s_add_u32 m0, s50, 28672
s_nop 0
buffer_load_dwordx4 v10, s[12:15], s39 offen lds
v_mfma_f32_16x16x32_bf16 v[212:215], a[36:39], a[8:11], 0
ds_read_b128 a[84:87], v3 offset:6144
v_add_u32 v10, 128, v10
v_mfma_f32_16x16x32_bf16 v[216:219], a[16:19], a[12:15], 0
v_mfma_f32_16x16x32_bf16 v[220:223], a[20:23], a[12:15], 0
v_mfma_f32_16x16x32_bf16 v[224:227], a[24:27], a[12:15], 0
v_mfma_f32_16x16x32_bf16 v[228:231], a[28:31], a[12:15], 0
v_mfma_f32_16x16x32_bf16 v[232:235], a[32:35], a[12:15], 0
v_mfma_f32_16x16x32_bf16 v[236:239], a[36:39], a[12:15], 0
s_waitcnt vmcnt(12) lgkmcnt(0)
s_barrier
v_mfma_f32_16x16x32_bf16 v[144:147], a[88:91], a[72:75], v[144:147]
s_add_u32 s50, s49, s51
s_add_u32 s49, s49, 32768
s_cmp_eq_u32 s49, 163840
v_mfma_f32_16x16x32_bf16 v[148:151], a[92:95], a[72:75], v[148:151]
s_cselect_b32 s49, 65536, s49
v_add_u32 v2, s49, v1
v_xor_b32 v3, 64, v2
v_mfma_f32_16x16x32_bf16 v[152:155], a[96:99], a[72:75], v[152:155]
ds_read_b64_tr_b16 a[16:17], v4 offset:0
ds_read_b64_tr_b16 a[18:19], v4 offset:512
v_mfma_f32_16x16x32_bf16 v[156:159], a[100:103], a[72:75], v[156:159]
ds_read_b64_tr_b16 a[20:21], v5 offset:0
v_mfma_f32_16x16x32_bf16 v[160:163], a[104:107], a[72:75], v[160:163]
ds_read_b64_tr_b16 a[22:23], v5 offset:512
v_mfma_f32_16x16x32_bf16 v[164:167], a[108:111], a[72:75], v[164:167]
ds_read_b64_tr_b16 a[24:25], v6 offset:0
v_mfma_f32_16x16x32_bf16 v[168:171], a[88:91], a[76:79], v[168:171]
ds_read_b64_tr_b16 a[26:27], v6 offset:512
v_mfma_f32_16x16x32_bf16 v[172:175], a[92:95], a[76:79], v[172:175]
ds_read_b64_tr_b16 a[28:29], v7 offset:0
s_add_u32 m0, s51, 49152
v_mfma_f32_16x16x32_bf16 v[176:179], a[96:99], a[76:79], v[176:179]
buffer_load_dwordx4 v11, s[16:19], s44 offen lds
v_mfma_f32_16x16x32_bf16 v[180:183], a[100:103], a[76:79], v[180:183]
ds_read_b64_tr_b16 a[30:31], v7 offset:512
v_mfma_f32_16x16x32_bf16 v[184:187], a[104:107], a[76:79], v[184:187]
ds_read_b64_tr_b16 a[32:33], v4 offset:4096
ds_read_b64_tr_b16 a[34:35], v4 offset:4608
v_mfma_f32_16x16x32_bf16 v[188:191], a[108:111], a[76:79], v[188:191]
ds_read_b64_tr_b16 a[36:37], v5 offset:4096
v_mfma_f32_16x16x32_bf16 v[192:195], a[88:91], a[80:83], v[192:195]
ds_read_b64_tr_b16 a[38:39], v5 offset:4608
v_mfma_f32_16x16x32_bf16 v[196:199], a[92:95], a[80:83], v[196:199]
ds_read_b128 a[0:3], v2 offset:0
v_mfma_f32_16x16x32_bf16 v[200:203], a[96:99], a[80:83], v[200:203]
ds_read_b128 a[4:7], v2 offset:2048
v_mfma_f32_16x16x32_bf16 v[204:207], a[100:103], a[80:83], v[204:207]
ds_read_b128 a[8:11], v2 offset:4096
s_add_u32 m0, s51, 53248
v_mfma_f32_16x16x32_bf16 v[208:211], a[104:107], a[80:83], v[208:211]
buffer_load_dwordx4 v11, s[16:19], s45 offen lds
v_mfma_f32_16x16x32_bf16 v[212:215], a[108:111], a[80:83], v[212:215]
ds_read_b128 a[12:15], v2 offset:6144
v_add_u32 v11, s66, v11
v_mfma_f32_16x16x32_bf16 v[216:219], a[88:91], a[84:87], v[216:219]
v_mfma_f32_16x16x32_bf16 v[220:223], a[92:95], a[84:87], v[220:223]
v_mfma_f32_16x16x32_bf16 v[224:227], a[96:99], a[84:87], v[224:227]
v_mfma_f32_16x16x32_bf16 v[228:231], a[100:103], a[84:87], v[228:231]
v_mfma_f32_16x16x32_bf16 v[232:235], a[104:107], a[84:87], v[232:235]
v_mfma_f32_16x16x32_bf16 v[236:239], a[108:111], a[84:87], v[236:239]
s_waitcnt vmcnt(12) lgkmcnt(0)
s_barrier
v_mfma_f32_16x16x32_bf16 v[144:147], a[16:19], a[0:3], v[144:147]
v_mfma_f32_16x16x32_bf16 v[148:151], a[20:23], a[0:3], v[148:151]
ds_read_b64_tr_b16 a[88:89], v4 offset:16384
s_add_u32 m0, s51, 0
s_nop 0
buffer_load_dwordx4 v11, s[16:19], s44 offen lds
v_mfma_f32_16x16x32_bf16 v[152:155], a[24:27], a[0:3], v[152:155]
ds_read_b64_tr_b16 a[90:91], v4 offset:16896
ds_read_b64_tr_b16 a[92:93], v5 offset:16384
s_add_u32 m0, s51, 4096
v_mfma_f32_16x16x32_bf16 v[156:159], a[28:31], a[0:3], v[156:159]
buffer_load_dwordx4 v11, s[16:19], s45 offen lds
v_mfma_f32_16x16x32_bf16 v[160:163], a[32:35], a[0:3], v[160:163]
ds_read_b64_tr_b16 a[94:95], v5 offset:16896
s_add_u32 m0, s50, 0
s_nop 0
buffer_load_dwordx4 v10, s[12:15], s32 offen lds
v_add_u32 v11, s66, v11
v_mfma_f32_16x16x32_bf16 v[164:167], a[36:39], a[0:3], v[164:167]
ds_read_b64_tr_b16 a[96:97], v6 offset:16384
v_mfma_f32_16x16x32_bf16 v[168:171], a[16:19], a[4:7], v[168:171]
ds_read_b64_tr_b16 a[98:99], v6 offset:16896
s_add_u32 m0, s50, 4096
s_nop 0
buffer_load_dwordx4 v10, s[12:15], s33 offen lds
v_mfma_f32_16x16x32_bf16 v[172:175], a[20:23], a[4:7], v[172:175]
ds_read_b64_tr_b16 a[100:101], v7 offset:16384
s_add_u32 m0, s50, 8192
v_mfma_f32_16x16x32_bf16 v[176:179], a[24:27], a[4:7], v[176:179]
buffer_load_dwordx4 v10, s[12:15], s34 offen lds
ds_read_b64_tr_b16 a[102:103], v7 offset:16896
v_mfma_f32_16x16x32_bf16 v[180:183], a[28:31], a[4:7], v[180:183]
ds_read_b64_tr_b16 a[104:105], v4 offset:20480
s_add_u32 m0, s50, 12288
v_mfma_f32_16x16x32_bf16 v[184:187], a[32:35], a[4:7], v[184:187]
buffer_load_dwordx4 v10, s[12:15], s35 offen lds
ds_read_b64_tr_b16 a[106:107], v4 offset:20992
v_mfma_f32_16x16x32_bf16 v[188:191], a[36:39], a[4:7], v[188:191]
ds_read_b64_tr_b16 a[108:109], v5 offset:20480
s_add_u32 m0, s50, 16384
v_mfma_f32_16x16x32_bf16 v[192:195], a[16:19], a[8:11], v[192:195]
buffer_load_dwordx4 v10, s[12:15], s36 offen lds
ds_read_b64_tr_b16 a[110:111], v5 offset:20992
s_add_u32 m0, s50, 20480
v_mfma_f32_16x16x32_bf16 v[196:199], a[20:23], a[8:11], v[196:199]
buffer_load_dwordx4 v10, s[12:15], s37 offen lds
v_mfma_f32_16x16x32_bf16 v[200:203], a[24:27], a[8:11], v[200:203]
ds_read_b128 a[72:75], v3 offset:0
ds_read_b128 a[76:79], v3 offset:2048
s_add_u32 m0, s50, 24576
v_mfma_f32_16x16x32_bf16 v[204:207], a[28:31], a[8:11], v[204:207]
buffer_load_dwordx4 v10, s[12:15], s38 offen lds
v_mfma_f32_16x16x32_bf16 v[208:211], a[32:35], a[8:11], v[208:211]
ds_read_b128 a[80:83], v3 offset:4096
s_add_u32 m0, s50, 28672
s_nop 0
buffer_load_dwordx4 v10, s[12:15], s39 offen lds
v_mfma_f32_16x16x32_bf16 v[212:215], a[36:39], a[8:11], v[212:215]
ds_read_b128 a[84:87], v3 offset:6144
v_add_u32 v10, 128, v10
v_mfma_f32_16x16x32_bf16 v[216:219], a[16:19], a[12:15], v[216:219]
v_mfma_f32_16x16x32_bf16 v[220:223], a[20:23], a[12:15], v[220:223]
v_mfma_f32_16x16x32_bf16 v[224:227], a[24:27], a[12:15], v[224:227]
v_mfma_f32_16x16x32_bf16 v[228:231], a[28:31], a[12:15], v[228:231]
v_mfma_f32_16x16x32_bf16 v[232:235], a[32:35], a[12:15], v[232:235]
v_mfma_f32_16x16x32_bf16 v[236:239], a[36:39], a[12:15], v[236:239]
s_waitcnt vmcnt(12) lgkmcnt(0)
s_barrier
v_mfma_f32_16x16x32_bf16 v[144:147], a[88:91], a[72:75], v[144:147]
s_add_u32 s50, s49, s51
s_add_u32 s49, s49, 32768
s_cmp_eq_u32 s49, 163840
v_mfma_f32_16x16x32_bf16 v[148:151], a[92:95], a[72:75], v[148:151]
s_cselect_b32 s49, 65536, s49
v_add_u32 v2, s49, v1
v_xor_b32 v3, 64, v2
v_mfma_f32_16x16x32_bf16 v[152:155], a[96:99], a[72:75], v[152:155]
ds_read_b64_tr_b16 a[16:17], v4 offset:32768
ds_read_b64_tr_b16 a[18:19], v4 offset:33280
v_mfma_f32_16x16x32_bf16 v[156:159], a[100:103], a[72:75], v[156:159]
ds_read_b64_tr_b16 a[20:21], v5 offset:32768
v_mfma_f32_16x16x32_bf16 v[160:163], a[104:107], a[72:75], v[160:163]
ds_read_b64_tr_b16 a[22:23], v5 offset:33280
v_mfma_f32_16x16x32_bf16 v[164:167], a[108:111], a[72:75], v[164:167]
ds_read_b64_tr_b16 a[24:25], v6 offset:32768
v_mfma_f32_16x16x32_bf16 v[168:171], a[88:91], a[76:79], v[168:171]
ds_read_b64_tr_b16 a[26:27], v6 offset:33280
v_mfma_f32_16x16x32_bf16 v[172:175], a[92:95], a[76:79], v[172:175]
ds_read_b64_tr_b16 a[28:29], v7 offset:32768
s_add_u32 m0, s51, 16384
v_mfma_f32_16x16x32_bf16 v[176:179], a[96:99], a[76:79], v[176:179]
buffer_load_dwordx4 v11, s[16:19], s44 offen lds
v_mfma_f32_16x16x32_bf16 v[180:183], a[100:103], a[76:79], v[180:183]
ds_read_b64_tr_b16 a[30:31], v7 offset:33280
v_mfma_f32_16x16x32_bf16 v[184:187], a[104:107], a[76:79], v[184:187]
ds_read_b64_tr_b16 a[32:33], v4 offset:36864
ds_read_b64_tr_b16 a[34:35], v4 offset:37376
v_mfma_f32_16x16x32_bf16 v[188:191], a[108:111], a[76:79], v[188:191]
ds_read_b64_tr_b16 a[36:37], v5 offset:36864
v_mfma_f32_16x16x32_bf16 v[192:195], a[88:91], a[80:83], v[192:195]
ds_read_b64_tr_b16 a[38:39], v5 offset:37376
v_mfma_f32_16x16x32_bf16 v[196:199], a[92:95], a[80:83], v[196:199]
ds_read_b128 a[0:3], v2 offset:0
v_mfma_f32_16x16x32_bf16 v[200:203], a[96:99], a[80:83], v[200:203]
ds_read_b128 a[4:7], v2 offset:2048
v_mfma_f32_16x16x32_bf16 v[204:207], a[100:103], a[80:83], v[204:207]
ds_read_b128 a[8:11], v2 offset:4096
s_add_u32 m0, s51, 20480
v_mfma_f32_16x16x32_bf16 v[208:211], a[104:107], a[80:83], v[208:211]
buffer_load_dwordx4 v11, s[16:19], s45 offen lds
v_mfma_f32_16x16x32_bf16 v[212:215], a[108:111], a[80:83], v[212:215]
ds_read_b128 a[12:15], v2 offset:6144
v_add_u32 v11, s66, v11
v_mfma_f32_16x16x32_bf16 v[216:219], a[88:91], a[84:87], v[216:219]
v_mfma_f32_16x16x32_bf16 v[220:223], a[92:95], a[84:87], v[220:223]
v_mfma_f32_16x16x32_bf16 v[224:227], a[96:99], a[84:87], v[224:227]
v_mfma_f32_16x16x32_bf16 v[228:231], a[100:103], a[84:87], v[228:231]
v_mfma_f32_16x16x32_bf16 v[232:235], a[104:107], a[84:87], v[232:235]
v_mfma_f32_16x16x32_bf16 v[236:239], a[108:111], a[84:87], v[236:239]
s_waitcnt vmcnt(12) lgkmcnt(0)
s_barrier
v_mfma_f32_16x16x32_bf16 v[144:147], a[16:19], a[0:3], v[144:147]
v_mfma_f32_16x16x32_bf16 v[148:151], a[20:23], a[0:3], v[148:151]
ds_read_b64_tr_b16 a[88:89], v4 offset:49152
s_add_u32 m0, s51, 32768
s_nop 0
buffer_load_dwordx4 v11, s[16:19], s44 offen lds
v_mfma_f32_16x16x32_bf16 v[152:155], a[24:27], a[0:3], v[152:155]
ds_read_b64_tr_b16 a[90:91], v4 offset:49664
ds_read_b64_tr_b16 a[92:93], v5 offset:49152
s_add_u32 m0, s51, 36864
v_mfma_f32_16x16x32_bf16 v[156:159], a[28:31], a[0:3], v[156:159]
buffer_load_dwordx4 v11, s[16:19], s45 offen lds
v_mfma_f32_16x16x32_bf16 v[160:163], a[32:35], a[0:3], v[160:163]
ds_read_b64_tr_b16 a[94:95], v5 offset:49664
s_add_u32 m0, s50, 0
s_nop 0
buffer_load_dwordx4 v10, s[12:15], s32 offen lds
v_add_u32 v11, s66, v11
v_mfma_f32_16x16x32_bf16 v[164:167], a[36:39], a[0:3], v[164:167]
ds_read_b64_tr_b16 a[96:97], v6 offset:49152
v_mfma_f32_16x16x32_bf16 v[168:171], a[16:19], a[4:7], v[168:171]
ds_read_b64_tr_b16 a[98:99], v6 offset:49664
s_add_u32 m0, s50, 4096
s_nop 0
buffer_load_dwordx4 v10, s[12:15], s33 offen lds
v_mfma_f32_16x16x32_bf16 v[172:175], a[20:23], a[4:7], v[172:175]
ds_read_b64_tr_b16 a[100:101], v7 offset:49152
s_add_u32 m0, s50, 8192
v_mfma_f32_16x16x32_bf16 v[176:179], a[24:27], a[4:7], v[176:179]
buffer_load_dwordx4 v10, s[12:15], s34 offen lds
ds_read_b64_tr_b16 a[102:103], v7 offset:49664
v_mfma_f32_16x16x32_bf16 v[180:183], a[28:31], a[4:7], v[180:183]
ds_read_b64_tr_b16 a[104:105], v4 offset:53248
s_add_u32 m0, s50, 12288
v_mfma_f32_16x16x32_bf16 v[184:187], a[32:35], a[4:7], v[184:187]
buffer_load_dwordx4 v10, s[12:15], s35 offen lds
ds_read_b64_tr_b16 a[106:107], v4 offset:53760
v_mfma_f32_16x16x32_bf16 v[188:191], a[36:39], a[4:7], v[188:191]
ds_read_b64_tr_b16 a[108:109], v5 offset:53248
s_add_u32 m0, s50, 16384
v_mfma_f32_16x16x32_bf16 v[192:195], a[16:19], a[8:11], v[192:195]
buffer_load_dwordx4 v10, s[12:15], s36 offen lds
ds_read_b64_tr_b16 a[110:111], v5 offset:53760
s_add_u32 m0, s50, 20480
v_mfma_f32_16x16x32_bf16 v[196:199], a[20:23], a[8:11], v[196:199]
buffer_load_dwordx4 v10, s[12:15], s37 offen lds
v_mfma_f32_16x16x32_bf16 v[200:203], a[24:27], a[8:11], v[200:203]
ds_read_b128 a[72:75], v3 offset:0
ds_read_b128 a[76:79], v3 offset:2048
s_add_u32 m0, s50, 24576
v_mfma_f32_16x16x32_bf16 v[204:207], a[28:31], a[8:11], v[204:207]
buffer_load_dwordx4 v10, s[12:15], s38 offen lds
v_mfma_f32_16x16x32_bf16 v[208:211], a[32:35], a[8:11], v[208:211]
ds_read_b128 a[80:83], v3 offset:4096
s_add_u32 m0, s50, 28672
s_nop 0
buffer_load_dwordx4 v10, s[12:15], s39 offen lds
v_mfma_f32_16x16x32_bf16 v[212:215], a[36:39], a[8:11], v[212:215]
ds_read_b128 a[84:87], v3 offset:6144
v_add_u32 v10, 128, v10
v_mfma_f32_16x16x32_bf16 v[216:219], a[16:19], a[12:15], v[216:219]
v_mfma_f32_16x16x32_bf16 v[220:223], a[20:23], a[12:15], v[220:223]
v_mfma_f32_16x16x32_bf16 v[224:227], a[24:27], a[12:15], v[224:227]
v_mfma_f32_16x16x32_bf16 v[228:231], a[28:31], a[12:15], v[228:231]
v_mfma_f32_16x16x32_bf16 v[232:235], a[32:35], a[12:15], v[232:235]
v_mfma_f32_16x16x32_bf16 v[236:239], a[36:39], a[12:15], v[236:239]
s_waitcnt vmcnt(12) lgkmcnt(0)
s_barrier
v_mfma_f32_16x16x32_bf16 v[144:147], a[88:91], a[72:75], v[144:147]
s_add_u32 s50, s49, s51
s_add_u32 s49, s49, 32768
s_cmp_eq_u32 s49, 163840
v_mfma_f32_16x16x32_bf16 v[148:151], a[92:95], a[72:75], v[148:151]
s_cselect_b32 s49, 65536, s49
v_add_u32 v2, s49, v1
v_xor_b32 v3, 64, v2
v_mfma_f32_16x16x32_bf16 v[152:155], a[96:99], a[72:75], v[152:155]
ds_read_b64_tr_b16 a[16:17], v4 offset:0
ds_read_b64_tr_b16 a[18:19], v4 offset:512
v_mfma_f32_16x16x32_bf16 v[156:159], a[100:103], a[72:75], v[156:159]
ds_read_b64_tr_b16 a[20:21], v5 offset:0
v_mfma_f32_16x16x32_bf16 v[160:163], a[104:107], a[72:75], v[160:163]
ds_read_b64_tr_b16 a[22:23], v5 offset:512
v_mfma_f32_16x16x32_bf16 v[164:167], a[108:111], a[72:75], v[164:167]
ds_read_b64_tr_b16 a[24:25], v6 offset:0
v_mfma_f32_16x16x32_bf16 v[168:171], a[88:91], a[76:79], v[168:171]
ds_read_b64_tr_b16 a[26:27], v6 offset:512
v_mfma_f32_16x16x32_bf16 v[172:175], a[92:95], a[76:79], v[172:175]
ds_read_b64_tr_b16 a[28:29], v7 offset:0
s_add_u32 m0, s51, 49152
v_mfma_f32_16x16x32_bf16 v[176:179], a[96:99], a[76:79], v[176:179]
buffer_load_dwordx4 v11, s[16:19], s44 offen lds
v_mfma_f32_16x16x32_bf16 v[180:183], a[100:103], a[76:79], v[180:183]
ds_read_b64_tr_b16 a[30:31], v7 offset:512
v_mfma_f32_16x16x32_bf16 v[184:187], a[104:107], a[76:79], v[184:187]
ds_read_b64_tr_b16 a[32:33], v4 offset:4096
ds_read_b64_tr_b16 a[34:35], v4 offset:4608
v_mfma_f32_16x16x32_bf16 v[188:191], a[108:111], a[76:79], v[188:191]
ds_read_b64_tr_b16 a[36:37], v5 offset:4096
v_mfma_f32_16x16x32_bf16 v[192:195], a[88:91], a[80:83], v[192:195]
ds_read_b64_tr_b16 a[38:39], v5 offset:4608
v_mfma_f32_16x16x32_bf16 v[196:199], a[92:95], a[80:83], v[196:199]
ds_read_b128 a[0:3], v2 offset:0
v_mfma_f32_16x16x32_bf16 v[200:203], a[96:99], a[80:83], v[200:203]
ds_read_b128 a[4:7], v2 offset:2048
v_mfma_f32_16x16x32_bf16 v[204:207], a[100:103], a[80:83], v[204:207]
ds_read_b128 a[8:11], v2 offset:4096
s_add_u32 m0, s51, 53248
v_mfma_f32_16x16x32_bf16 v[208:211], a[104:107], a[80:83], v[208:211]
buffer_load_dwordx4 v11, s[16:19], s45 offen lds
v_mfma_f32_16x16x32_bf16 v[212:215], a[108:111], a[80:83], v[212:215]
ds_read_b128 a[12:15], v2 offset:6144
v_add_u32 v11, s66, v11
v_mfma_f32_16x16x32_bf16 v[216:219], a[88:91], a[84:87], v[216:219]
v_mfma_f32_16x16x32_bf16 v[220:223], a[92:95], a[84:87], v[220:223]
v_mfma_f32_16x16x32_bf16 v[224:227], a[96:99], a[84:87], v[224:227]
v_mfma_f32_16x16x32_bf16 v[228:231], a[100:103], a[84:87], v[228:231]
v_mfma_f32_16x16x32_bf16 v[232:235], a[104:107], a[84:87], v[232:235]
v_mfma_f32_16x16x32_bf16 v[236:239], a[108:111], a[84:87], v[236:239]
s_waitcnt vmcnt(12) lgkmcnt(0)
s_barrier
v_mfma_f32_16x16x32_bf16 v[144:147], a[16:19], a[0:3], v[144:147]
v_mfma_f32_16x16x32_bf16 v[148:151], a[20:23], a[0:3], v[148:151]
ds_read_b64_tr_b16 a[88:89], v4 offset:16384
s_add_u32 m0, s51, 0
s_nop 0
buffer_load_dwordx4 v11, s[16:19], s44 offen lds
v_mfma_f32_16x16x32_bf16 v[152:155], a[24:27], a[0:3], v[152:155]
ds_read_b64_tr_b16 a[90:91], v4 offset:16896
ds_read_b64_tr_b16 a[92:93], v5 offset:16384
s_add_u32 m0, s51, 4096
v_mfma_f32_16x16x32_bf16 v[156:159], a[28:31], a[0:3], v[156:159]
buffer_load_dwordx4 v11, s[16:19], s45 offen lds
v_mfma_f32_16x16x32_bf16 v[160:163], a[32:35], a[0:3], v[160:163]
ds_read_b64_tr_b16 a[94:95], v5 offset:16896
s_add_u32 m0, s50, 0
s_nop 0
buffer_load_dwordx4 v10, s[12:15], s32 offen lds
v_add_u32 v11, s66, v11
v_mfma_f32_16x16x32_bf16 v[164:167], a[36:39], a[0:3], v[164:167]
ds_read_b64_tr_b16 a[96:97], v6 offset:16384
v_mfma_f32_16x16x32_bf16 v[168:171], a[16:19], a[4:7], v[168:171]
ds_read_b64_tr_b16 a[98:99], v6 offset:16896
s_add_u32 m0, s50, 4096
s_nop 0
buffer_load_dwordx4 v10, s[12:15], s33 offen lds
v_mfma_f32_16x16x32_bf16 v[172:175], a[20:23], a[4:7], v[172:175]
ds_read_b64_tr_b16 a[100:101], v7 offset:16384
s_add_u32 m0, s50, 8192
v_mfma_f32_16x16x32_bf16 v[176:179], a[24:27], a[4:7], v[176:179]
buffer_load_dwordx4 v10, s[12:15], s34 offen lds
ds_read_b64_tr_b16 a[102:103], v7 offset:16896
v_mfma_f32_16x16x32_bf16 v[180:183], a[28:31], a[4:7], v[180:183]
ds_read_b64_tr_b16 a[104:105], v4 offset:20480
s_add_u32 m0, s50, 12288
v_mfma_f32_16x16x32_bf16 v[184:187], a[32:35], a[4:7], v[184:187]
buffer_load_dwordx4 v10, s[12:15], s35 offen lds
ds_read_b64_tr_b16 a[106:107], v4 offset:20992
v_mfma_f32_16x16x32_bf16 v[188:191], a[36:39], a[4:7], v[188:191]
ds_read_b64_tr_b16 a[108:109], v5 offset:20480
s_add_u32 m0, s50, 16384
v_mfma_f32_16x16x32_bf16 v[192:195], a[16:19], a[8:11], v[192:195]
buffer_load_dwordx4 v10, s[12:15], s36 offen lds
ds_read_b64_tr_b16 a[110:111], v5 offset:20992
s_add_u32 m0, s50, 20480
v_mfma_f32_16x16x32_bf16 v[196:199], a[20:23], a[8:11], v[196:199]
buffer_load_dwordx4 v10, s[12:15], s37 offen lds
v_mfma_f32_16x16x32_bf16 v[200:203], a[24:27], a[8:11], v[200:203]
ds_read_b128 a[72:75], v3 offset:0
ds_read_b128 a[76:79], v3 offset:2048
s_add_u32 m0, s50, 24576
v_mfma_f32_16x16x32_bf16 v[204:207], a[28:31], a[8:11], v[204:207]
buffer_load_dwordx4 v10, s[12:15], s38 offen lds
v_mfma_f32_16x16x32_bf16 v[208:211], a[32:35], a[8:11], v[208:211]
ds_read_b128 a[80:83], v3 offset:4096
s_add_u32 m0, s50, 28672
s_nop 0
buffer_load_dwordx4 v10, s[12:15], s39 offen lds
v_mfma_f32_16x16x32_bf16 v[212:215], a[36:39], a[8:11], v[212:215]
ds_read_b128 a[84:87], v3 offset:6144
v_add_u32 v10, 128, v10
v_mfma_f32_16x16x32_bf16 v[216:219], a[16:19], a[12:15], v[216:219]
v_mfma_f32_16x16x32_bf16 v[220:223], a[20:23], a[12:15], v[220:223]
v_mfma_f32_16x16x32_bf16 v[224:227], a[24:27], a[12:15], v[224:227]
v_mfma_f32_16x16x32_bf16 v[228:231], a[28:31], a[12:15], v[228:231]
v_mfma_f32_16x16x32_bf16 v[232:235], a[32:35], a[12:15], v[232:235]
v_mfma_f32_16x16x32_bf16 v[236:239], a[36:39], a[12:15], v[236:239]
s_waitcnt vmcnt(12) lgkmcnt(0)
s_barrier
v_mfma_f32_16x16x32_bf16 v[144:147], a[88:91], a[72:75], v[144:147]
s_add_u32 s50, s49, s51
s_add_u32 s49, s49, 32768
s_cmp_eq_u32 s49, 163840
v_mfma_f32_16x16x32_bf16 v[148:151], a[92:95], a[72:75], v[148:151]
s_cselect_b32 s49, 65536, s49
v_add_u32 v2, s49, v1
v_xor_b32 v3, 64, v2
v_mfma_f32_16x16x32_bf16 v[152:155], a[96:99], a[72:75], v[152:155]
ds_read_b64_tr_b16 a[16:17], v4 offset:32768
ds_read_b64_tr_b16 a[18:19], v4 offset:33280
v_mfma_f32_16x16x32_bf16 v[156:159], a[100:103], a[72:75], v[156:159]
ds_read_b64_tr_b16 a[20:21], v5 offset:32768
v_mfma_f32_16x16x32_bf16 v[160:163], a[104:107], a[72:75], v[160:163]
ds_read_b64_tr_b16 a[22:23], v5 offset:33280
v_mfma_f32_16x16x32_bf16 v[164:167], a[108:111], a[72:75], v[164:167]
ds_read_b64_tr_b16 a[24:25], v6 offset:32768
v_mfma_f32_16x16x32_bf16 v[168:171], a[88:91], a[76:79], v[168:171]
ds_read_b64_tr_b16 a[26:27], v6 offset:33280
v_mfma_f32_16x16x32_bf16 v[172:175], a[92:95], a[76:79], v[172:175]
ds_read_b64_tr_b16 a[28:29], v7 offset:32768
s_add_u32 m0, s51, 16384
v_mfma_f32_16x16x32_bf16 v[176:179], a[96:99], a[76:79], v[176:179]
buffer_load_dwordx4 v11, s[16:19], s44 offen lds
v_mfma_f32_16x16x32_bf16 v[180:183], a[100:103], a[76:79], v[180:183]
ds_read_b64_tr_b16 a[30:31], v7 offset:33280
v_mfma_f32_16x16x32_bf16 v[184:187], a[104:107], a[76:79], v[184:187]
ds_read_b64_tr_b16 a[32:33], v4 offset:36864
ds_read_b64_tr_b16 a[34:35], v4 offset:37376
v_mfma_f32_16x16x32_bf16 v[188:191], a[108:111], a[76:79], v[188:191]
ds_read_b64_tr_b16 a[36:37], v5 offset:36864
v_mfma_f32_16x16x32_bf16 v[192:195], a[88:91], a[80:83], v[192:195]
ds_read_b64_tr_b16 a[38:39], v5 offset:37376
v_mfma_f32_16x16x32_bf16 v[196:199], a[92:95], a[80:83], v[196:199]
ds_read_b128 a[0:3], v2 offset:0
v_mfma_f32_16x16x32_bf16 v[200:203], a[96:99], a[80:83], v[200:203]
ds_read_b128 a[4:7], v2 offset:2048
v_mfma_f32_16x16x32_bf16 v[204:207], a[100:103], a[80:83], v[204:207]
ds_read_b128 a[8:11], v2 offset:4096
s_add_u32 m0, s51, 20480
v_mfma_f32_16x16x32_bf16 v[208:211], a[104:107], a[80:83], v[208:211]
buffer_load_dwordx4 v11, s[16:19], s45 offen lds
v_mfma_f32_16x16x32_bf16 v[212:215], a[108:111], a[80:83], v[212:215]
ds_read_b128 a[12:15], v2 offset:6144
v_add_u32 v11, s66, v11
v_mfma_f32_16x16x32_bf16 v[216:219], a[88:91], a[84:87], v[216:219]
v_mfma_f32_16x16x32_bf16 v[220:223], a[92:95], a[84:87], v[220:223]
v_mfma_f32_16x16x32_bf16 v[224:227], a[96:99], a[84:87], v[224:227]
v_mfma_f32_16x16x32_bf16 v[228:231], a[100:103], a[84:87], v[228:231]
v_mfma_f32_16x16x32_bf16 v[232:235], a[104:107], a[84:87], v[232:235]
v_mfma_f32_16x16x32_bf16 v[236:239], a[108:111], a[84:87], v[236:239]
s_waitcnt vmcnt(12) lgkmcnt(0)
s_barrier
v_mfma_f32_16x16x32_bf16 v[144:147], a[16:19], a[0:3], v[144:147]
v_mfma_f32_16x16x32_bf16 v[148:151], a[20:23], a[0:3], v[148:151]
ds_read_b64_tr_b16 a[88:89], v4 offset:49152
s_add_u32 m0, s51, 32768
s_nop 0
buffer_load_dwordx4 v11, s[16:19], s44 offen lds
v_mfma_f32_16x16x32_bf16 v[152:155], a[24:27], a[0:3], v[152:155]
ds_read_b64_tr_b16 a[90:91], v4 offset:49664
ds_read_b64_tr_b16 a[92:93], v5 offset:49152
s_add_u32 m0, s51, 36864
v_mfma_f32_16x16x32_bf16 v[156:159], a[28:31], a[0:3], v[156:159]
buffer_load_dwordx4 v11, s[16:19], s45 offen lds
v_mfma_f32_16x16x32_bf16 v[160:163], a[32:35], a[0:3], v[160:163]
ds_read_b64_tr_b16 a[94:95], v5 offset:49664
s_add_u32 m0, s50, 0
s_nop 0
buffer_load_dwordx4 v10, s[12:15], s32 offen lds
v_add_u32 v11, s66, v11
v_mfma_f32_16x16x32_bf16 v[164:167], a[36:39], a[0:3], v[164:167]
ds_read_b64_tr_b16 a[96:97], v6 offset:49152
v_mfma_f32_16x16x32_bf16 v[168:171], a[16:19], a[4:7], v[168:171]
ds_read_b64_tr_b16 a[98:99], v6 offset:49664
s_add_u32 m0, s50, 4096
s_nop 0
buffer_load_dwordx4 v10, s[12:15], s33 offen lds
v_mfma_f32_16x16x32_bf16 v[172:175], a[20:23], a[4:7], v[172:175]
ds_read_b64_tr_b16 a[100:101], v7 offset:49152
s_add_u32 m0, s50, 8192
v_mfma_f32_16x16x32_bf16 v[176:179], a[24:27], a[4:7], v[176:179]
buffer_load_dwordx4 v10, s[12:15], s34 offen lds
ds_read_b64_tr_b16 a[102:103], v7 offset:49664
v_mfma_f32_16x16x32_bf16 v[180:183], a[28:31], a[4:7], v[180:183]
ds_read_b64_tr_b16 a[104:105], v4 offset:53248
s_add_u32 m0, s50, 12288
v_mfma_f32_16x16x32_bf16 v[184:187], a[32:35], a[4:7], v[184:187]
buffer_load_dwordx4 v10, s[12:15], s35 offen lds
ds_read_b64_tr_b16 a[106:107], v4 offset:53760
v_mfma_f32_16x16x32_bf16 v[188:191], a[36:39], a[4:7], v[188:191]
ds_read_b64_tr_b16 a[108:109], v5 offset:53248
s_add_u32 m0, s50, 16384
v_mfma_f32_16x16x32_bf16 v[192:195], a[16:19], a[8:11], v[192:195]
buffer_load_dwordx4 v10, s[12:15], s36 offen lds
ds_read_b64_tr_b16 a[110:111], v5 offset:53760
s_add_u32 m0, s50, 20480
v_mfma_f32_16x16x32_bf16 v[196:199], a[20:23], a[8:11], v[196:199]
buffer_load_dwordx4 v10, s[12:15], s37 offen lds
v_mfma_f32_16x16x32_bf16 v[200:203], a[24:27], a[8:11], v[200:203]
ds_read_b128 a[72:75], v3 offset:0
ds_read_b128 a[76:79], v3 offset:2048
s_add_u32 m0, s50, 24576
v_mfma_f32_16x16x32_bf16 v[204:207], a[28:31], a[8:11], v[204:207]
buffer_load_dwordx4 v10, s[12:15], s38 offen lds
v_mfma_f32_16x16x32_bf16 v[208:211], a[32:35], a[8:11], v[208:211]
ds_read_b128 a[80:83], v3 offset:4096
s_add_u32 m0, s50, 28672
s_nop 0
buffer_load_dwordx4 v10, s[12:15], s39 offen lds
v_mfma_f32_16x16x32_bf16 v[212:215], a[36:39], a[8:11], v[212:215]
ds_read_b128 a[84:87], v3 offset:6144
v_add_u32 v10, 128, v10
v_mfma_f32_16x16x32_bf16 v[216:219], a[16:19], a[12:15], v[216:219]
v_mfma_f32_16x16x32_bf16 v[220:223], a[20:23], a[12:15], v[220:223]
v_mfma_f32_16x16x32_bf16 v[224:227], a[24:27], a[12:15], v[224:227]
v_mfma_f32_16x16x32_bf16 v[228:231], a[28:31], a[12:15], v[228:231]
v_mfma_f32_16x16x32_bf16 v[232:235], a[32:35], a[12:15], v[232:235]
v_mfma_f32_16x16x32_bf16 v[236:239], a[36:39], a[12:15], v[236:239]
s_waitcnt vmcnt(12) lgkmcnt(0)
s_barrier
v_mfma_f32_16x16x32_bf16 v[144:147], a[88:91], a[72:75], v[144:147]
s_add_u32 s50, s49, s51
s_add_u32 s49, s49, 32768
s_cmp_eq_u32 s49, 163840
v_mfma_f32_16x16x32_bf16 v[148:151], a[92:95], a[72:75], v[148:151]
s_cselect_b32 s49, 65536, s49
v_add_u32 v2, s49, v1
v_xor_b32 v3, 64, v2
v_mfma_f32_16x16x32_bf16 v[152:155], a[96:99], a[72:75], v[152:155]
ds_read_b64_tr_b16 a[16:17], v4 offset:0
ds_read_b64_tr_b16 a[18:19], v4 offset:512
v_mfma_f32_16x16x32_bf16 v[156:159], a[100:103], a[72:75], v[156:159]
ds_read_b64_tr_b16 a[20:21], v5 offset:0
v_mfma_f32_16x16x32_bf16 v[160:163], a[104:107], a[72:75], v[160:163]
ds_read_b64_tr_b16 a[22:23], v5 offset:512
v_mfma_f32_16x16x32_bf16 v[164:167], a[108:111], a[72:75], v[164:167]
ds_read_b64_tr_b16 a[24:25], v6 offset:0
v_mfma_f32_16x16x32_bf16 v[168:171], a[88:91], a[76:79], v[168:171]
ds_read_b64_tr_b16 a[26:27], v6 offset:512
v_mfma_f32_16x16x32_bf16 v[172:175], a[92:95], a[76:79], v[172:175]
ds_read_b64_tr_b16 a[28:29], v7 offset:0
s_add_u32 m0, s51, 49152
v_mfma_f32_16x16x32_bf16 v[176:179], a[96:99], a[76:79], v[176:179]
buffer_load_dwordx4 v11, s[16:19], s44 offen lds
v_mfma_f32_16x16x32_bf16 v[180:183], a[100:103], a[76:79], v[180:183]
ds_read_b64_tr_b16 a[30:31], v7 offset:512
v_mfma_f32_16x16x32_bf16 v[184:187], a[104:107], a[76:79], v[184:187]
ds_read_b64_tr_b16 a[32:33], v4 offset:4096
ds_read_b64_tr_b16 a[34:35], v4 offset:4608
v_mfma_f32_16x16x32_bf16 v[188:191], a[108:111], a[76:79], v[188:191]
ds_read_b64_tr_b16 a[36:37], v5 offset:4096
v_mfma_f32_16x16x32_bf16 v[192:195], a[88:91], a[80:83], v[192:195]
ds_read_b64_tr_b16 a[38:39], v5 offset:4608
v_mfma_f32_16x16x32_bf16 v[196:199], a[92:95], a[80:83], v[196:199]
ds_read_b128 a[0:3], v2 offset:0
v_mfma_f32_16x16x32_bf16 v[200:203], a[96:99], a[80:83], v[200:203]
ds_read_b128 a[4:7], v2 offset:2048
v_mfma_f32_16x16x32_bf16 v[204:207], a[100:103], a[80:83], v[204:207]
ds_read_b128 a[8:11], v2 offset:4096
s_add_u32 m0, s51, 53248
v_mfma_f32_16x16x32_bf16 v[208:211], a[104:107], a[80:83], v[208:211]
buffer_load_dwordx4 v11, s[16:19], s45 offen lds
v_mfma_f32_16x16x32_bf16 v[212:215], a[108:111], a[80:83], v[212:215]
ds_read_b128 a[12:15], v2 offset:6144
v_add_u32 v11, s66, v11
v_mfma_f32_16x16x32_bf16 v[216:219], a[88:91], a[84:87], v[216:219]
v_mfma_f32_16x16x32_bf16 v[220:223], a[92:95], a[84:87], v[220:223]
v_mfma_f32_16x16x32_bf16 v[224:227], a[96:99], a[84:87], v[224:227]
v_mfma_f32_16x16x32_bf16 v[228:231], a[100:103], a[84:87], v[228:231]
v_mfma_f32_16x16x32_bf16 v[232:235], a[104:107], a[84:87], v[232:235]
v_mfma_f32_16x16x32_bf16 v[236:239], a[108:111], a[84:87], v[236:239]
s_waitcnt vmcnt(12) lgkmcnt(0)
s_barrier
v_mfma_f32_16x16x32_bf16 v[144:147], a[16:19], a[0:3], v[144:147]
v_mfma_f32_16x16x32_bf16 v[148:151], a[20:23], a[0:3], v[148:151]
ds_read_b64_tr_b16 a[88:89], v4 offset:16384
s_add_u32 m0, s51, 0
s_nop 0
buffer_load_dwordx4 v9, s[8:11], s40 offen lds
v_mfma_f32_16x16x32_bf16 v[152:155], a[24:27], a[0:3], v[152:155]
ds_read_b64_tr_b16 a[90:91], v4 offset:16896
s_add_u32 m0, s51, 4096
s_nop 0
buffer_load_dwordx4 v9, s[8:11], s41 offen lds
v_mfma_f32_16x16x32_bf16 v[156:159], a[28:31], a[0:3], v[156:159]
ds_read_b64_tr_b16 a[92:93], v5 offset:16384
s_add_u32 m0, s51, 8192
v_mfma_f32_16x16x32_bf16 v[160:163], a[32:35], a[0:3], v[160:163]
buffer_load_dwordx4 v9, s[8:11], s42 offen lds
ds_read_b64_tr_b16 a[94:95], v5 offset:16896
v_mfma_f32_16x16x32_bf16 v[164:167], a[36:39], a[0:3], v[164:167]
ds_read_b64_tr_b16 a[96:97], v6 offset:16384
s_add_u32 m0, s51, 12288
s_nop 0
buffer_load_dwordx4 v9, s[8:11], s43 offen lds
v_mfma_f32_16x16x32_bf16 v[168:171], a[16:19], a[4:7], v[168:171]
ds_read_b64_tr_b16 a[98:99], v6 offset:16896
s_add_u32 m0, s50, 0
v_add_u32 v9, 262144, v9
v_mfma_f32_16x16x32_bf16 v[172:175], a[20:23], a[4:7], v[172:175]
buffer_load_dwordx4 v8, s[4:7], s24 offen lds
ds_read_b64_tr_b16 a[100:101], v7 offset:16384
s_add_u32 m0, s50, 4096
v_mfma_f32_16x16x32_bf16 v[176:179], a[24:27], a[4:7], v[176:179]
buffer_load_dwordx4 v8, s[4:7], s25 offen lds
ds_read_b64_tr_b16 a[102:103], v7 offset:16896
v_mfma_f32_16x16x32_bf16 v[180:183], a[28:31], a[4:7], v[180:183]
ds_read_b64_tr_b16 a[104:105], v4 offset:20480
s_add_u32 m0, s50, 8192
v_mfma_f32_16x16x32_bf16 v[184:187], a[32:35], a[4:7], v[184:187]
buffer_load_dwordx4 v8, s[4:7], s26 offen lds
ds_read_b64_tr_b16 a[106:107], v4 offset:20992
s_add_u32 m0, s50, 12288
v_mfma_f32_16x16x32_bf16 v[188:191], a[36:39], a[4:7], v[188:191]
buffer_load_dwordx4 v8, s[4:7], s27 offen lds
ds_read_b64_tr_b16 a[108:109], v5 offset:20480
s_add_u32 m0, s50, 16384
v_mfma_f32_16x16x32_bf16 v[192:195], a[16:19], a[8:11], v[192:195]
buffer_load_dwordx4 v8, s[4:7], s28 offen lds
v_mfma_f32_16x16x32_bf16 v[196:199], a[20:23], a[8:11], v[196:199]
ds_read_b64_tr_b16 a[110:111], v5 offset:20992
ds_read_b128 a[72:75], v3 offset:0
s_add_u32 m0, s50, 20480
v_mfma_f32_16x16x32_bf16 v[200:203], a[24:27], a[8:11], v[200:203]
buffer_load_dwordx4 v8, s[4:7], s29 offen lds
ds_read_b128 a[76:79], v3 offset:2048
s_add_u32 m0, s50, 24576
v_mfma_f32_16x16x32_bf16 v[204:207], a[28:31], a[8:11], v[204:207]
buffer_load_dwordx4 v8, s[4:7], s30 offen lds
v_mfma_f32_16x16x32_bf16 v[208:211], a[32:35], a[8:11], v[208:211]
ds_read_b128 a[80:83], v3 offset:4096
s_add_u32 m0, s50, 28672
s_nop 0
buffer_load_dwordx4 v8, s[4:7], s31 offen lds
v_mfma_f32_16x16x32_bf16 v[212:215], a[36:39], a[8:11], v[212:215]
ds_read_b128 a[84:87], v3 offset:6144
v_add_u32 v8, 128, v8
v_mfma_f32_16x16x32_bf16 v[216:219], a[16:19], a[12:15], v[216:219]
v_mfma_f32_16x16x32_bf16 v[220:223], a[20:23], a[12:15], v[220:223]
v_mfma_f32_16x16x32_bf16 v[224:227], a[24:27], a[12:15], v[224:227]
v_mfma_f32_16x16x32_bf16 v[228:231], a[28:31], a[12:15], v[228:231]
v_mfma_f32_16x16x32_bf16 v[232:235], a[32:35], a[12:15], v[232:235]
v_mfma_f32_16x16x32_bf16 v[236:239], a[36:39], a[12:15], v[236:239]
s_waitcnt vmcnt(14) lgkmcnt(0)
s_barrier
v_mfma_f32_16x16x32_bf16 v[144:147], a[88:91], a[72:75], v[144:147]
s_add_u32 s50, s49, s51
s_add_u32 s49, s49, 32768
s_cmp_eq_u32 s49, 163840
v_mfma_f32_16x16x32_bf16 v[148:151], a[92:95], a[72:75], v[148:151]
s_cselect_b32 s49, 65536, s49
v_add_u32 v2, s49, v1
v_xor_b32 v3, 64, v2
v_mfma_f32_16x16x32_bf16 v[152:155], a[96:99], a[72:75], v[152:155]
ds_read_b64_tr_b16 a[16:17], v4 offset:32768
ds_read_b64_tr_b16 a[18:19], v4 offset:33280
v_mfma_f32_16x16x32_bf16 v[156:159], a[100:103], a[72:75], v[156:159]
ds_read_b64_tr_b16 a[20:21], v5 offset:32768
s_add_u32 m0, s51, 16384
v_mfma_f32_16x16x32_bf16 v[160:163], a[104:107], a[72:75], v[160:163]
buffer_load_dwordx4 v9, s[8:11], s40 offen lds
v_mfma_f32_16x16x32_bf16 v[164:167], a[108:111], a[72:75], v[164:167]
ds_read_b64_tr_b16 a[22:23], v5 offset:33280
v_mfma_f32_16x16x32_bf16 v[168:171], a[88:91], a[76:79], v[168:171]
ds_read_b64_tr_b16 a[24:25], v6 offset:32768
ds_read_b64_tr_b16 a[26:27], v6 offset:33280
v_mfma_f32_16x16x32_bf16 v[172:175], a[92:95], a[76:79], v[172:175]
ds_read_b64_tr_b16 a[28:29], v7 offset:32768
s_add_u32 m0, s51, 20480
v_mfma_f32_16x16x32_bf16 v[176:179], a[96:99], a[76:79], v[176:179]
buffer_load_dwordx4 v9, s[8:11], s41 offen lds
v_mfma_f32_16x16x32_bf16 v[180:183], a[100:103], a[76:79], v[180:183]
ds_read_b64_tr_b16 a[30:31], v7 offset:33280
v_mfma_f32_16x16x32_bf16 v[184:187], a[104:107], a[76:79], v[184:187]
ds_read_b64_tr_b16 a[32:33], v4 offset:36864
ds_read_b64_tr_b16 a[34:35], v4 offset:37376
v_mfma_f32_16x16x32_bf16 v[188:191], a[108:111], a[76:79], v[188:191]
ds_read_b64_tr_b16 a[36:37], v5 offset:36864
s_add_u32 m0, s51, 24576
v_mfma_f32_16x16x32_bf16 v[192:195], a[88:91], a[80:83], v[192:195]
buffer_load_dwordx4 v9, s[8:11], s42 offen lds
v_mfma_f32_16x16x32_bf16 v[196:199], a[92:95], a[80:83], v[196:199]
ds_read_b64_tr_b16 a[38:39], v5 offset:37376
v_mfma_f32_16x16x32_bf16 v[200:203], a[96:99], a[80:83], v[200:203]
ds_read_b128 a[0:3], v2 offset:0
ds_read_b128 a[4:7], v2 offset:2048
v_mfma_f32_16x16x32_bf16 v[204:207], a[100:103], a[80:83], v[204:207]
ds_read_b128 a[8:11], v2 offset:4096
s_add_u32 m0, s51, 28672
v_mfma_f32_16x16x32_bf16 v[208:211], a[104:107], a[80:83], v[208:211]
buffer_load_dwordx4 v9, s[8:11], s43 offen lds
v_mfma_f32_16x16x32_bf16 v[212:215], a[108:111], a[80:83], v[212:215]
ds_read_b128 a[12:15], v2 offset:6144
v_add_u32 v9, 262144, v9
v_mfma_f32_16x16x32_bf16 v[216:219], a[88:91], a[84:87], v[216:219]
v_mfma_f32_16x16x32_bf16 v[220:223], a[92:95], a[84:87], v[220:223]
v_mfma_f32_16x16x32_bf16 v[224:227], a[96:99], a[84:87], v[224:227]
v_mfma_f32_16x16x32_bf16 v[228:231], a[100:103], a[84:87], v[228:231]
v_mfma_f32_16x16x32_bf16 v[232:235], a[104:107], a[84:87], v[232:235]
v_mfma_f32_16x16x32_bf16 v[236:239], a[108:111], a[84:87], v[236:239]
s_waitcnt vmcnt(16) lgkmcnt(0)
s_barrier
v_mfma_f32_16x16x32_bf16 v[144:147], a[16:19], a[0:3], v[144:147]
v_mfma_f32_16x16x32_bf16 v[148:151], a[20:23], a[0:3], v[148:151]
ds_read_b64_tr_b16 a[88:89], v4 offset:49152
s_add_u32 m0, s51, 32768
s_nop 0
buffer_load_dwordx4 v9, s[8:11], s40 offen lds
v_mfma_f32_16x16x32_bf16 v[152:155], a[24:27], a[0:3], v[152:155]
ds_read_b64_tr_b16 a[90:91], v4 offset:49664
s_add_u32 m0, s51, 36864
s_nop 0
buffer_load_dwordx4 v9, s[8:11], s41 offen lds
v_mfma_f32_16x16x32_bf16 v[156:159], a[28:31], a[0:3], v[156:159]
ds_read_b64_tr_b16 a[92:93], v5 offset:49152
s_add_u32 m0, s51, 40960
v_mfma_f32_16x16x32_bf16 v[160:163], a[32:35], a[0:3], v[160:163]
buffer_load_dwordx4 v9, s[8:11], s42 offen lds
ds_read_b64_tr_b16 a[94:95], v5 offset:49664
v_mfma_f32_16x16x32_bf16 v[164:167], a[36:39], a[0:3], v[164:167]
ds_read_b64_tr_b16 a[96:97], v6 offset:49152
s_add_u32 m0, s51, 45056
s_nop 0
buffer_load_dwordx4 v9, s[8:11], s43 offen lds
v_mfma_f32_16x16x32_bf16 v[168:171], a[16:19], a[4:7], v[168:171]
ds_read_b64_tr_b16 a[98:99], v6 offset:49664
s_add_u32 m0, s50, 0
v_add_u32 v9, 262144, v9
v_mfma_f32_16x16x32_bf16 v[172:175], a[20:23], a[4:7], v[172:175]
buffer_load_dwordx4 v8, s[4:7], s24 offen lds
ds_read_b64_tr_b16 a[100:101], v7 offset:49152
s_add_u32 m0, s50, 4096
v_mfma_f32_16x16x32_bf16 v[176:179], a[24:27], a[4:7], v[176:179]
buffer_load_dwordx4 v8, s[4:7], s25 offen lds
ds_read_b64_tr_b16 a[102:103], v7 offset:49664
v_mfma_f32_16x16x32_bf16 v[180:183], a[28:31], a[4:7], v[180:183]
ds_read_b64_tr_b16 a[104:105], v4 offset:53248
s_add_u32 m0, s50, 8192
v_mfma_f32_16x16x32_bf16 v[184:187], a[32:35], a[4:7], v[184:187]
buffer_load_dwordx4 v8, s[4:7], s26 offen lds
ds_read_b64_tr_b16 a[106:107], v4 offset:53760
s_add_u32 m0, s50, 12288
v_mfma_f32_16x16x32_bf16 v[188:191], a[36:39], a[4:7], v[188:191]
buffer_load_dwordx4 v8, s[4:7], s27 offen lds
ds_read_b64_tr_b16 a[108:109], v5 offset:53248
s_add_u32 m0, s50, 16384
v_mfma_f32_16x16x32_bf16 v[192:195], a[16:19], a[8:11], v[192:195]
buffer_load_dwordx4 v8, s[4:7], s28 offen lds
v_mfma_f32_16x16x32_bf16 v[196:199], a[20:23], a[8:11], v[196:199]
ds_read_b64_tr_b16 a[110:111], v5 offset:53760
ds_read_b128 a[72:75], v3 offset:0
s_add_u32 m0, s50, 20480
v_mfma_f32_16x16x32_bf16 v[200:203], a[24:27], a[8:11], v[200:203]
buffer_load_dwordx4 v8, s[4:7], s29 offen lds
ds_read_b128 a[76:79], v3 offset:2048
s_add_u32 m0, s50, 24576
v_mfma_f32_16x16x32_bf16 v[204:207], a[28:31], a[8:11], v[204:207]
buffer_load_dwordx4 v8, s[4:7], s30 offen lds
v_mfma_f32_16x16x32_bf16 v[208:211], a[32:35], a[8:11], v[208:211]
ds_read_b128 a[80:83], v3 offset:4096
s_add_u32 m0, s50, 28672
s_nop 0
buffer_load_dwordx4 v8, s[4:7], s31 offen lds
v_mfma_f32_16x16x32_bf16 v[212:215], a[36:39], a[8:11], v[212:215]
ds_read_b128 a[84:87], v3 offset:6144
v_add_u32 v8, 128, v8
v_mfma_f32_16x16x32_bf16 v[216:219], a[16:19], a[12:15], v[216:219]
v_mfma_f32_16x16x32_bf16 v[220:223], a[20:23], a[12:15], v[220:223]
v_mfma_f32_16x16x32_bf16 v[224:227], a[24:27], a[12:15], v[224:227]
v_subrev_u32 v1, s98, v1
v_mfma_f32_16x16x32_bf16 v[228:231], a[28:31], a[12:15], v[228:231]
v_add_u32 v4, s74, v4
v_add_u32 v5, s74, v5
v_mfma_f32_16x16x32_bf16 v[232:235], a[32:35], a[12:15], v[232:235]
v_add_u32 v6, s74, v6
v_add_u32 v7, s74, v7
v_mfma_f32_16x16x32_bf16 v[236:239], a[36:39], a[12:15], v[236:239]
s_waitcnt vmcnt(16) lgkmcnt(0)
s_barrier
v_mfma_f32_16x16x32_bf16 v[144:147], a[88:91], a[72:75], v[144:147]
s_add_u32 s50, s49, s51
s_add_u32 s49, s49, 32768
s_cmp_eq_u32 s49, 163840
v_mfma_f32_16x16x32_bf16 v[148:151], a[92:95], a[72:75], v[148:151]
s_cselect_b32 s49, 65536, s49
v_add_u32 v2, s49, v1
v_xor_b32 v3, 64, v2
v_mfma_f32_16x16x32_bf16 v[152:155], a[96:99], a[72:75], v[152:155]
ds_read_b64_tr_b16 a[32:33], v4 offset:0
ds_read_b64_tr_b16 a[34:35], v4 offset:512
v_mfma_f32_16x16x32_bf16 v[156:159], a[100:103], a[72:75], v[156:159]
ds_read_b64_tr_b16 a[36:37], v5 offset:0
ds_read_b64_tr_b16 a[38:39], v5 offset:512
v_mfma_f32_16x16x32_bf16 v[160:163], a[104:107], a[72:75], v[160:163]
ds_read_b64_tr_b16 a[40:41], v6 offset:0
s_add_u32 m0, s51, 49152
s_nop 0
buffer_load_dwordx4 v9, s[8:11], s40 offen lds
v_mfma_f32_16x16x32_bf16 v[164:167], a[108:111], a[72:75], v[164:167]
ds_read_b64_tr_b16 a[42:43], v6 offset:512
v_mfma_f32_16x16x32_bf16 v[168:171], a[88:91], a[76:79], v[168:171]
ds_read_b64_tr_b16 a[44:45], v7 offset:0
ds_read_b64_tr_b16 a[46:47], v7 offset:512
v_mfma_f32_16x16x32_bf16 v[172:175], a[92:95], a[76:79], v[172:175]
ds_read_b64_tr_b16 a[48:49], v4 offset:4096
ds_read_b64_tr_b16 a[50:51], v4 offset:4608
v_mfma_f32_16x16x32_bf16 v[176:179], a[96:99], a[76:79], v[176:179]
ds_read_b64_tr_b16 a[52:53], v5 offset:4096
s_add_u32 m0, s51, 53248
s_nop 0
buffer_load_dwordx4 v9, s[8:11], s41 offen lds
v_mfma_f32_16x16x32_bf16 v[180:183], a[100:103], a[76:79], v[180:183]
ds_read_b64_tr_b16 a[54:55], v5 offset:4608
v_mfma_f32_16x16x32_bf16 v[184:187], a[104:107], a[76:79], v[184:187]
ds_read_b64_tr_b16 a[56:57], v6 offset:4096
ds_read_b64_tr_b16 a[58:59], v6 offset:4608
v_mfma_f32_16x16x32_bf16 v[188:191], a[108:111], a[76:79], v[188:191]
ds_read_b64_tr_b16 a[60:61], v7 offset:4096
ds_read_b64_tr_b16 a[62:63], v7 offset:4608
v_mfma_f32_16x16x32_bf16 v[192:195], a[88:91], a[80:83], v[192:195]
ds_read_b128 a[0:3], v2 offset:0
s_add_u32 m0, s51, 57344
s_nop 0
buffer_load_dwordx4 v9, s[8:11], s42 offen lds
v_mfma_f32_16x16x32_bf16 v[196:199], a[92:95], a[80:83], v[196:199]
ds_read_b128 a[4:7], v2 offset:2048
v_mfma_f32_16x16x32_bf16 v[200:203], a[96:99], a[80:83], v[200:203]
ds_read_b128 a[8:11], v2 offset:4096
ds_read_b128 a[12:15], v2 offset:6144
v_mfma_f32_16x16x32_bf16 v[204:207], a[100:103], a[80:83], v[204:207]
ds_read_b128 a[16:19], v2 offset:8192
ds_read_b128 a[20:23], v2 offset:10240
v_mfma_f32_16x16x32_bf16 v[208:211], a[104:107], a[80:83], v[208:211]
ds_read_b128 a[24:27], v2 offset:12288
s_add_u32 m0, s51, 61440
s_nop 0
buffer_load_dwordx4 v9, s[8:11], s43 offen lds
v_mfma_f32_16x16x32_bf16 v[212:215], a[108:111], a[80:83], v[212:215]
ds_read_b128 a[28:31], v2 offset:14336
v_add_u32 v9, 262144, v9
v_mfma_f32_16x16x32_bf16 v[216:219], a[88:91], a[84:87], v[216:219]
v_mfma_f32_16x16x32_bf16 v[220:223], a[92:95], a[84:87], v[220:223]
v_mfma_f32_16x16x32_bf16 v[224:227], a[96:99], a[84:87], v[224:227]
v_mfma_f32_16x16x32_bf16 v[228:231], a[100:103], a[84:87], v[228:231]
v_mfma_f32_16x16x32_bf16 v[232:235], a[104:107], a[84:87], v[232:235]
v_mfma_f32_16x16x32_bf16 v[236:239], a[108:111], a[84:87], v[236:239]
s_nop 7
v_mov_b32 v14, 1049335798
v_cndmask_b32 v15, v14, 0, s[72:73]
s_add_u32 s68, s63, 0
v_mul_f32 v160, v14, v160
v_mul_f32 v161, v14, v161
v_mul_f32 v162, v14, v162
v_mul_f32 v163, v14, v163
v_mul_f32 v164, v15, v164
v_mul_f32 v165, v15, v165
v_mul_f32 v166, v15, v166
v_mul_f32 v167, v15, v167
v_cvt_pk_bf16_f32 v160, v160, v161
v_cvt_pk_bf16_f32 v161, v162, v163
v_cvt_pk_bf16_f32 v162, v164, v165
v_cvt_pk_bf16_f32 v163, v166, v167
buffer_store_dwordx4 v[160:163], v13, s[20:23], s68 offen offset:0 sc0 sc1
s_add_u32 s68, s63, 0
v_mul_f32 v184, v14, v184
v_mul_f32 v185, v14, v185
v_mul_f32 v186, v14, v186
v_mul_f32 v187, v14, v187
v_mul_f32 v188, v15, v188
v_mul_f32 v189, v15, v189
v_mul_f32 v190, v15, v190
v_mul_f32 v191, v15, v191
v_cvt_pk_bf16_f32 v184, v184, v185
v_cvt_pk_bf16_f32 v185, v186, v187
v_cvt_pk_bf16_f32 v186, v188, v189
v_cvt_pk_bf16_f32 v187, v190, v191
buffer_store_dwordx4 v[184:187], v13, s[20:23], s68 offen offset:256 sc0 sc1
s_add_u32 s68, s63, 2048
v_mul_f32 v208, v14, v208
v_mul_f32 v209, v14, v209
v_mul_f32 v210, v14, v210
v_mul_f32 v211, v14, v211
v_mul_f32 v212, v15, v212
v_mul_f32 v213, v15, v213
v_mul_f32 v214, v15, v214
v_mul_f32 v215, v15, v215
v_cvt_pk_bf16_f32 v208, v208, v209
v_cvt_pk_bf16_f32 v209, v210, v211
v_cvt_pk_bf16_f32 v210, v212, v213
v_cvt_pk_bf16_f32 v211, v214, v215
buffer_store_dwordx4 v[208:211], v13, s[20:23], s68 offen offset:0 sc0 sc1
s_add_u32 s68, s63, 2048
v_mul_f32 v232, v14, v232
v_mul_f32 v233, v14, v233
v_mul_f32 v234, v14, v234
v_mul_f32 v235, v14, v235
v_mul_f32 v236, v15, v236
v_mul_f32 v237, v15, v237
v_mul_f32 v238, v15, v238
v_mul_f32 v239, v15, v239
v_cvt_pk_bf16_f32 v232, v232, v233
v_cvt_pk_bf16_f32 v233, v234, v235
v_cvt_pk_bf16_f32 v234, v236, v237
v_cvt_pk_bf16_f32 v235, v238, v239
buffer_store_dwordx4 v[232:235], v13, s[20:23], s68 offen offset:256 sc0 sc1
s_add_u32 s68, s62, 0
v_cvt_pk_bf16_f32 v144, v144, v145
v_cvt_pk_bf16_f32 v145, v146, v147
v_cvt_pk_bf16_f32 v146, v148, v149
v_cvt_pk_bf16_f32 v147, v150, v151
buffer_store_dwordx4 v[144:147], v13, s[20:23], s68 offen offset:0 sc0 sc1
s_add_u32 s68, s62, 262144
v_cvt_pk_bf16_f32 v152, v152, v153
v_cvt_pk_bf16_f32 v153, v154, v155
v_cvt_pk_bf16_f32 v154, v156, v157
v_cvt_pk_bf16_f32 v155, v158, v159
buffer_store_dwordx4 v[152:155], v13, s[20:23], s68 offen offset:0 sc0 sc1
s_add_u32 s68, s62, 0
v_cvt_pk_bf16_f32 v168, v168, v169
v_cvt_pk_bf16_f32 v169, v170, v171
v_cvt_pk_bf16_f32 v170, v172, v173
v_cvt_pk_bf16_f32 v171, v174, v175
buffer_store_dwordx4 v[168:171], v13, s[20:23], s68 offen offset:256 sc0 sc1
s_add_u32 s68, s62, 262144
v_cvt_pk_bf16_f32 v176, v176, v177
v_cvt_pk_bf16_f32 v177, v178, v179
v_cvt_pk_bf16_f32 v178, v180, v181
v_cvt_pk_bf16_f32 v179, v182, v183
buffer_store_dwordx4 v[176:179], v13, s[20:23], s68 offen offset:256 sc0 sc1
s_add_u32 s68, s62, 4096
v_cvt_pk_bf16_f32 v192, v192, v193
v_cvt_pk_bf16_f32 v193, v194, v195
v_cvt_pk_bf16_f32 v194, v196, v197
v_cvt_pk_bf16_f32 v195, v198, v199
buffer_store_dwordx4 v[192:195], v13, s[20:23], s68 offen offset:0 sc0 sc1
s_add_u32 s68, s62, 266240
v_cvt_pk_bf16_f32 v200, v200, v201
v_cvt_pk_bf16_f32 v201, v202, v203
v_cvt_pk_bf16_f32 v202, v204, v205
v_cvt_pk_bf16_f32 v203, v206, v207
buffer_store_dwordx4 v[200:203], v13, s[20:23], s68 offen offset:0 sc0 sc1
s_add_u32 s68, s62, 4096
v_cvt_pk_bf16_f32 v216, v216, v217
v_cvt_pk_bf16_f32 v217, v218, v219
v_cvt_pk_bf16_f32 v218, v220, v221
v_cvt_pk_bf16_f32 v219, v222, v223
buffer_store_dwordx4 v[216:219], v13, s[20:23], s68 offen offset:256 sc0 sc1
s_add_u32 s68, s62, 266240
v_cvt_pk_bf16_f32 v224, v224, v225
v_cvt_pk_bf16_f32 v225, v226, v227
v_cvt_pk_bf16_f32 v226, v228, v229
v_cvt_pk_bf16_f32 v227, v230, v231
buffer_store_dwordx4 v[224:227], v13, s[20:23], s68 offen offset:256 sc0 sc1
s_mov_b32 s76, s92
s_mov_b32 s77, s93
s_mov_b32 s78, 256
s_mov_b32 s79, 0x20000
s_branch LM_r1
LM_xAV:
s_waitcnt vmcnt(12) lgkmcnt(0)
s_barrier
v_mfma_f32_16x16x32_bf16 v[144:147], a[0:3], a[16:19], 0
v_mfma_f32_16x16x32_bf16 v[148:151], a[0:3], a[20:23], 0
ds_read_b64_tr_b16 a[88:89], v4 offset:49152
s_add_u32 m0, s51, 32768
s_nop 0
buffer_load_dwordx4 v11, s[16:19], s44 offen lds
v_mfma_f32_16x16x32_bf16 v[152:155], a[0:3], a[24:27], 0
ds_read_b64_tr_b16 a[90:91], v4 offset:49664
ds_read_b64_tr_b16 a[92:93], v5 offset:49152
s_add_u32 m0, s51, 36864
v_mfma_f32_16x16x32_bf16 v[156:159], a[0:3], a[28:31], 0
buffer_load_dwordx4 v11, s[16:19], s45 offen lds
v_mfma_f32_16x16x32_bf16 v[160:163], a[32:35], a[0:3], 0
ds_read_b64_tr_b16 a[94:95], v5 offset:49664
s_add_u32 m0, s50, 0
s_nop 0
buffer_load_dwordx4 v10, s[12:15], s32 offen lds
v_add_u32 v11, s66, v11
v_mfma_f32_16x16x32_bf16 v[164:167], a[36:39], a[0:3], 0
ds_read_b64_tr_b16 a[96:97], v6 offset:49152
v_mfma_f32_16x16x32_bf16 v[168:171], a[4:7], a[16:19], 0
ds_read_b64_tr_b16 a[98:99], v6 offset:49664
s_add_u32 m0, s50, 4096
s_nop 0
buffer_load_dwordx4 v10, s[12:15], s33 offen lds
v_mfma_f32_16x16x32_bf16 v[172:175], a[4:7], a[20:23], 0
ds_read_b64_tr_b16 a[100:101], v7 offset:49152
s_add_u32 m0, s50, 8192
v_mfma_f32_16x16x32_bf16 v[176:179], a[4:7], a[24:27], 0
buffer_load_dwordx4 v10, s[12:15], s34 offen lds
ds_read_b64_tr_b16 a[102:103], v7 offset:49664
v_mfma_f32_16x16x32_bf16 v[180:183], a[4:7], a[28:31], 0
ds_read_b64_tr_b16 a[104:105], v4 offset:53248
s_add_u32 m0, s50, 12288
v_mfma_f32_16x16x32_bf16 v[184:187], a[32:35], a[4:7], 0
buffer_load_dwordx4 v10, s[12:15], s35 offen lds
ds_read_b64_tr_b16 a[106:107], v4 offset:53760
v_mfma_f32_16x16x32_bf16 v[188:191], a[36:39], a[4:7], 0
ds_read_b64_tr_b16 a[108:109], v5 offset:53248
s_add_u32 m0, s50, 16384
v_mfma_f32_16x16x32_bf16 v[192:195], a[8:11], a[16:19], 0
buffer_load_dwordx4 v10, s[12:15], s36 offen lds
ds_read_b64_tr_b16 a[110:111], v5 offset:53760
s_add_u32 m0, s50, 20480
v_mfma_f32_16x16x32_bf16 v[196:199], a[8:11], a[20:23], 0
buffer_load_dwordx4 v10, s[12:15], s37 offen lds
v_mfma_f32_16x16x32_bf16 v[200:203], a[8:11], a[24:27], 0
ds_read_b128 a[72:75], v3 offset:0
ds_read_b128 a[76:79], v3 offset:2048
s_add_u32 m0, s50, 24576
v_mfma_f32_16x16x32_bf16 v[204:207], a[8:11], a[28:31], 0
buffer_load_dwordx4 v10, s[12:15], s38 offen lds
v_mfma_f32_16x16x32_bf16 v[208:211], a[32:35], a[8:11], 0
ds_read_b128 a[80:83], v3 offset:4096
s_add_u32 m0, s50, 28672
s_nop 0
buffer_load_dwordx4 v10, s[12:15], s39 offen lds
v_mfma_f32_16x16x32_bf16 v[212:215], a[36:39], a[8:11], 0
ds_read_b128 a[84:87], v3 offset:6144
v_add_u32 v10, 128, v10
v_mfma_f32_16x16x32_bf16 v[216:219], a[12:15], a[16:19], 0
v_mfma_f32_16x16x32_bf16 v[220:223], a[12:15], a[20:23], 0
v_mfma_f32_16x16x32_bf16 v[224:227], a[12:15], a[24:27], 0
v_mfma_f32_16x16x32_bf16 v[228:231], a[12:15], a[28:31], 0
v_mfma_f32_16x16x32_bf16 v[232:235], a[32:35], a[12:15], 0
v_mfma_f32_16x16x32_bf16 v[236:239], a[36:39], a[12:15], 0
s_waitcnt vmcnt(12) lgkmcnt(0)
s_barrier
v_mfma_f32_16x16x32_bf16 v[144:147], a[72:75], a[88:91], v[144:147]
s_add_u32 s50, s49, s51
s_add_u32 s49, s49, 32768
s_cmp_eq_u32 s49, 163840
v_mfma_f32_16x16x32_bf16 v[148:151], a[72:75], a[92:95], v[148:151]
s_cselect_b32 s49, 65536, s49
v_add_u32 v2, s49, v1
v_xor_b32 v3, 64, v2
v_mfma_f32_16x16x32_bf16 v[152:155], a[72:75], a[96:99], v[152:155]
ds_read_b64_tr_b16 a[16:17], v4 offset:0
ds_read_b64_tr_b16 a[18:19], v4 offset:512
v_mfma_f32_16x16x32_bf16 v[156:159], a[72:75], a[100:103], v[156:159]
ds_read_b64_tr_b16 a[20:21], v5 offset:0
v_mfma_f32_16x16x32_bf16 v[160:163], a[104:107], a[72:75], v[160:163]
ds_read_b64_tr_b16 a[22:23], v5 offset:512
v_mfma_f32_16x16x32_bf16 v[164:167], a[108:111], a[72:75], v[164:167]
ds_read_b64_tr_b16 a[24:25], v6 offset:0
v_mfma_f32_16x16x32_bf16 v[168:171], a[76:79], a[88:91], v[168:171]
ds_read_b64_tr_b16 a[26:27], v6 offset:512
v_mfma_f32_16x16x32_bf16 v[172:175], a[76:79], a[92:95], v[172:175]
ds_read_b64_tr_b16 a[28:29], v7 offset:0
s_add_u32 m0, s51, 49152
v_mfma_f32_16x16x32_bf16 v[176:179], a[76:79], a[96:99], v[176:179]
buffer_load_dwordx4 v11, s[16:19], s44 offen lds
v_mfma_f32_16x16x32_bf16 v[180:183], a[76:79], a[100:103], v[180:183]
ds_read_b64_tr_b16 a[30:31], v7 offset:512
v_mfma_f32_16x16x32_bf16 v[184:187], a[104:107], a[76:79], v[184:187]
ds_read_b64_tr_b16 a[32:33], v4 offset:4096
ds_read_b64_tr_b16 a[34:35], v4 offset:4608
v_mfma_f32_16x16x32_bf16 v[188:191], a[108:111], a[76:79], v[188:191]
ds_read_b64_tr_b16 a[36:37], v5 offset:4096
v_mfma_f32_16x16x32_bf16 v[192:195], a[80:83], a[88:91], v[192:195]
ds_read_b64_tr_b16 a[38:39], v5 offset:4608
v_mfma_f32_16x16x32_bf16 v[196:199], a[80:83], a[92:95], v[196:199]
ds_read_b128 a[0:3], v2 offset:0
v_mfma_f32_16x16x32_bf16 v[200:203], a[80:83], a[96:99], v[200:203]
ds_read_b128 a[4:7], v2 offset:2048
v_mfma_f32_16x16x32_bf16 v[204:207], a[80:83], a[100:103], v[204:207]
ds_read_b128 a[8:11], v2 offset:4096
s_add_u32 m0, s51, 53248
v_mfma_f32_16x16x32_bf16 v[208:211], a[104:107], a[80:83], v[208:211]
buffer_load_dwordx4 v11, s[16:19], s45 offen lds
v_mfma_f32_16x16x32_bf16 v[212:215], a[108:111], a[80:83], v[212:215]
ds_read_b128 a[12:15], v2 offset:6144
v_add_u32 v11, s66, v11
v_mfma_f32_16x16x32_bf16 v[216:219], a[84:87], a[88:91], v[216:219]
v_mfma_f32_16x16x32_bf16 v[220:223], a[84:87], a[92:95], v[220:223]
v_mfma_f32_16x16x32_bf16 v[224:227], a[84:87], a[96:99], v[224:227]
v_mfma_f32_16x16x32_bf16 v[228:231], a[84:87], a[100:103], v[228:231]
v_mfma_f32_16x16x32_bf16 v[232:235], a[104:107], a[84:87], v[232:235]
v_mfma_f32_16x16x32_bf16 v[236:239], a[108:111], a[84:87], v[236:239]
s_waitcnt vmcnt(12) lgkmcnt(0)
s_barrier
v_mfma_f32_16x16x32_bf16 v[144:147], a[0:3], a[16:19], v[144:147]
v_mfma_f32_16x16x32_bf16 v[148:151], a[0:3], a[20:23], v[148:151]
ds_read_b64_tr_b16 a[88:89], v4 offset:16384
s_add_u32 m0, s51, 0
s_nop 0
buffer_load_dwordx4 v11, s[16:19], s44 offen lds
v_mfma_f32_16x16x32_bf16 v[152:155], a[0:3], a[24:27], v[152:155]
ds_read_b64_tr_b16 a[90:91], v4 offset:16896
ds_read_b64_tr_b16 a[92:93], v5 offset:16384
s_add_u32 m0, s51, 4096
v_mfma_f32_16x16x32_bf16 v[156:159], a[0:3], a[28:31], v[156:159]
buffer_load_dwordx4 v11, s[16:19], s45 offen lds
v_mfma_f32_16x16x32_bf16 v[160:163], a[32:35], a[0:3], v[160:163]
ds_read_b64_tr_b16 a[94:95], v5 offset:16896
s_add_u32 m0, s50, 0
s_nop 0
buffer_load_dwordx4 v10, s[12:15], s32 offen lds
v_add_u32 v11, s66, v11
v_mfma_f32_16x16x32_bf16 v[164:167], a[36:39], a[0:3], v[164:167]
ds_read_b64_tr_b16 a[96:97], v6 offset:16384
v_mfma_f32_16x16x32_bf16 v[168:171], a[4:7], a[16:19], v[168:171]
ds_read_b64_tr_b16 a[98:99], v6 offset:16896
s_add_u32 m0, s50, 4096
s_nop 0
buffer_load_dwordx4 v10, s[12:15], s33 offen lds
v_mfma_f32_16x16x32_bf16 v[172:175], a[4:7], a[20:23], v[172:175]
ds_read_b64_tr_b16 a[100:101], v7 offset:16384
s_add_u32 m0, s50, 8192
v_mfma_f32_16x16x32_bf16 v[176:179], a[4:7], a[24:27], v[176:179]
buffer_load_dwordx4 v10, s[12:15], s34 offen lds
ds_read_b64_tr_b16 a[102:103], v7 offset:16896
v_mfma_f32_16x16x32_bf16 v[180:183], a[4:7], a[28:31], v[180:183]
ds_read_b64_tr_b16 a[104:105], v4 offset:20480
s_add_u32 m0, s50, 12288
v_mfma_f32_16x16x32_bf16 v[184:187], a[32:35], a[4:7], v[184:187]
buffer_load_dwordx4 v10, s[12:15], s35 offen lds
ds_read_b64_tr_b16 a[106:107], v4 offset:20992
v_mfma_f32_16x16x32_bf16 v[188:191], a[36:39], a[4:7], v[188:191]
ds_read_b64_tr_b16 a[108:109], v5 offset:20480
s_add_u32 m0, s50, 16384
v_mfma_f32_16x16x32_bf16 v[192:195], a[8:11], a[16:19], v[192:195]
buffer_load_dwordx4 v10, s[12:15], s36 offen lds
ds_read_b64_tr_b16 a[110:111], v5 offset:20992
s_add_u32 m0, s50, 20480
v_mfma_f32_16x16x32_bf16 v[196:199], a[8:11], a[20:23], v[196:199]
buffer_load_dwordx4 v10, s[12:15], s37 offen lds
v_mfma_f32_16x16x32_bf16 v[200:203], a[8:11], a[24:27], v[200:203]
ds_read_b128 a[72:75], v3 offset:0
ds_read_b128 a[76:79], v3 offset:2048
s_add_u32 m0, s50, 24576
v_mfma_f32_16x16x32_bf16 v[204:207], a[8:11], a[28:31], v[204:207]
buffer_load_dwordx4 v10, s[12:15], s38 offen lds
v_mfma_f32_16x16x32_bf16 v[208:211], a[32:35], a[8:11], v[208:211]
ds_read_b128 a[80:83], v3 offset:4096
s_add_u32 m0, s50, 28672
s_nop 0
buffer_load_dwordx4 v10, s[12:15], s39 offen lds
v_mfma_f32_16x16x32_bf16 v[212:215], a[36:39], a[8:11], v[212:215]
ds_read_b128 a[84:87], v3 offset:6144
v_add_u32 v10, 128, v10
v_mfma_f32_16x16x32_bf16 v[216:219], a[12:15], a[16:19], v[216:219]
v_mfma_f32_16x16x32_bf16 v[220:223], a[12:15], a[20:23], v[220:223]
v_mfma_f32_16x16x32_bf16 v[224:227], a[12:15], a[24:27], v[224:227]
v_mfma_f32_16x16x32_bf16 v[228:231], a[12:15], a[28:31], v[228:231]
v_mfma_f32_16x16x32_bf16 v[232:235], a[32:35], a[12:15], v[232:235]
v_mfma_f32_16x16x32_bf16 v[236:239], a[36:39], a[12:15], v[236:239]
s_waitcnt vmcnt(12) lgkmcnt(0)
s_barrier
v_mfma_f32_16x16x32_bf16 v[144:147], a[72:75], a[88:91], v[144:147]
s_add_u32 s50, s49, s51
s_add_u32 s49, s49, 32768
s_cmp_eq_u32 s49, 163840
v_mfma_f32_16x16x32_bf16 v[148:151], a[72:75], a[92:95], v[148:151]
s_cselect_b32 s49, 65536, s49
v_add_u32 v2, s49, v1
v_xor_b32 v3, 64, v2
v_mfma_f32_16x16x32_bf16 v[152:155], a[72:75], a[96:99], v[152:155]
ds_read_b64_tr_b16 a[16:17], v4 offset:32768
ds_read_b64_tr_b16 a[18:19], v4 offset:33280
v_mfma_f32_16x16x32_bf16 v[156:159], a[72:75], a[100:103], v[156:159]
ds_read_b64_tr_b16 a[20:21], v5 offset:32768
v_mfma_f32_16x16x32_bf16 v[160:163], a[104:107], a[72:75], v[160:163]
ds_read_b64_tr_b16 a[22:23], v5 offset:33280
v_mfma_f32_16x16x32_bf16 v[164:167], a[108:111], a[72:75], v[164:167]
ds_read_b64_tr_b16 a[24:25], v6 offset:32768
v_mfma_f32_16x16x32_bf16 v[168:171], a[76:79], a[88:91], v[168:171]
ds_read_b64_tr_b16 a[26:27], v6 offset:33280
v_mfma_f32_16x16x32_bf16 v[172:175], a[76:79], a[92:95], v[172:175]
ds_read_b64_tr_b16 a[28:29], v7 offset:32768
s_add_u32 m0, s51, 16384
v_mfma_f32_16x16x32_bf16 v[176:179], a[76:79], a[96:99], v[176:179]
buffer_load_dwordx4 v11, s[16:19], s44 offen lds
v_mfma_f32_16x16x32_bf16 v[180:183], a[76:79], a[100:103], v[180:183]
ds_read_b64_tr_b16 a[30:31], v7 offset:33280
v_mfma_f32_16x16x32_bf16 v[184:187], a[104:107], a[76:79], v[184:187]
ds_read_b64_tr_b16 a[32:33], v4 offset:36864
ds_read_b64_tr_b16 a[34:35], v4 offset:37376
v_mfma_f32_16x16x32_bf16 v[188:191], a[108:111], a[76:79], v[188:191]
ds_read_b64_tr_b16 a[36:37], v5 offset:36864
v_mfma_f32_16x16x32_bf16 v[192:195], a[80:83], a[88:91], v[192:195]
ds_read_b64_tr_b16 a[38:39], v5 offset:37376
v_mfma_f32_16x16x32_bf16 v[196:199], a[80:83], a[92:95], v[196:199]
ds_read_b128 a[0:3], v2 offset:0
v_mfma_f32_16x16x32_bf16 v[200:203], a[80:83], a[96:99], v[200:203]
ds_read_b128 a[4:7], v2 offset:2048
v_mfma_f32_16x16x32_bf16 v[204:207], a[80:83], a[100:103], v[204:207]
ds_read_b128 a[8:11], v2 offset:4096
s_add_u32 m0, s51, 20480
v_mfma_f32_16x16x32_bf16 v[208:211], a[104:107], a[80:83], v[208:211]
buffer_load_dwordx4 v11, s[16:19], s45 offen lds
v_mfma_f32_16x16x32_bf16 v[212:215], a[108:111], a[80:83], v[212:215]
ds_read_b128 a[12:15], v2 offset:6144
v_add_u32 v11, s66, v11
v_mfma_f32_16x16x32_bf16 v[216:219], a[84:87], a[88:91], v[216:219]
v_mfma_f32_16x16x32_bf16 v[220:223], a[84:87], a[92:95], v[220:223]
v_mfma_f32_16x16x32_bf16 v[224:227], a[84:87], a[96:99], v[224:227]
v_mfma_f32_16x16x32_bf16 v[228:231], a[84:87], a[100:103], v[228:231]
v_mfma_f32_16x16x32_bf16 v[232:235], a[104:107], a[84:87], v[232:235]
v_mfma_f32_16x16x32_bf16 v[236:239], a[108:111], a[84:87], v[236:239]
s_waitcnt vmcnt(12) lgkmcnt(0)
s_barrier
v_mfma_f32_16x16x32_bf16 v[144:147], a[0:3], a[16:19], v[144:147]
v_mfma_f32_16x16x32_bf16 v[148:151], a[0:3], a[20:23], v[148:151]
ds_read_b64_tr_b16 a[88:89], v4 offset:49152
s_add_u32 m0, s51, 32768
s_nop 0
buffer_load_dwordx4 v11, s[16:19], s44 offen lds
v_mfma_f32_16x16x32_bf16 v[152:155], a[0:3], a[24:27], v[152:155]
ds_read_b64_tr_b16 a[90:91], v4 offset:49664
ds_read_b64_tr_b16 a[92:93], v5 offset:49152
s_add_u32 m0, s51, 36864
v_mfma_f32_16x16x32_bf16 v[156:159], a[0:3], a[28:31], v[156:159]
buffer_load_dwordx4 v11, s[16:19], s45 offen lds
v_mfma_f32_16x16x32_bf16 v[160:163], a[32:35], a[0:3], v[160:163]
ds_read_b64_tr_b16 a[94:95], v5 offset:49664
s_add_u32 m0, s50, 0
s_nop 0
buffer_load_dwordx4 v10, s[12:15], s32 offen lds
v_add_u32 v11, s66, v11
v_mfma_f32_16x16x32_bf16 v[164:167], a[36:39], a[0:3], v[164:167]
ds_read_b64_tr_b16 a[96:97], v6 offset:49152
v_mfma_f32_16x16x32_bf16 v[168:171], a[4:7], a[16:19], v[168:171]
ds_read_b64_tr_b16 a[98:99], v6 offset:49664
s_add_u32 m0, s50, 4096
s_nop 0
buffer_load_dwordx4 v10, s[12:15], s33 offen lds
v_mfma_f32_16x16x32_bf16 v[172:175], a[4:7], a[20:23], v[172:175]
ds_read_b64_tr_b16 a[100:101], v7 offset:49152
s_add_u32 m0, s50, 8192
v_mfma_f32_16x16x32_bf16 v[176:179], a[4:7], a[24:27], v[176:179]
buffer_load_dwordx4 v10, s[12:15], s34 offen lds
ds_read_b64_tr_b16 a[102:103], v7 offset:49664
v_mfma_f32_16x16x32_bf16 v[180:183], a[4:7], a[28:31], v[180:183]
ds_read_b64_tr_b16 a[104:105], v4 offset:53248
s_add_u32 m0, s50, 12288
v_mfma_f32_16x16x32_bf16 v[184:187], a[32:35], a[4:7], v[184:187]
buffer_load_dwordx4 v10, s[12:15], s35 offen lds
ds_read_b64_tr_b16 a[106:107], v4 offset:53760
v_mfma_f32_16x16x32_bf16 v[188:191], a[36:39], a[4:7], v[188:191]
ds_read_b64_tr_b16 a[108:109], v5 offset:53248
s_add_u32 m0, s50, 16384
v_mfma_f32_16x16x32_bf16 v[192:195], a[8:11], a[16:19], v[192:195]
buffer_load_dwordx4 v10, s[12:15], s36 offen lds
ds_read_b64_tr_b16 a[110:111], v5 offset:53760
s_add_u32 m0, s50, 20480
v_mfma_f32_16x16x32_bf16 v[196:199], a[8:11], a[20:23], v[196:199]
buffer_load_dwordx4 v10, s[12:15], s37 offen lds
v_mfma_f32_16x16x32_bf16 v[200:203], a[8:11], a[24:27], v[200:203]
ds_read_b128 a[72:75], v3 offset:0
ds_read_b128 a[76:79], v3 offset:2048
s_add_u32 m0, s50, 24576
v_mfma_f32_16x16x32_bf16 v[204:207], a[8:11], a[28:31], v[204:207]
buffer_load_dwordx4 v10, s[12:15], s38 offen lds
v_mfma_f32_16x16x32_bf16 v[208:211], a[32:35], a[8:11], v[208:211]
ds_read_b128 a[80:83], v3 offset:4096
s_add_u32 m0, s50, 28672
s_nop 0
buffer_load_dwordx4 v10, s[12:15], s39 offen lds
v_mfma_f32_16x16x32_bf16 v[212:215], a[36:39], a[8:11], v[212:215]
ds_read_b128 a[84:87], v3 offset:6144
v_add_u32 v10, 128, v10
v_mfma_f32_16x16x32_bf16 v[216:219], a[12:15], a[16:19], v[216:219]
v_mfma_f32_16x16x32_bf16 v[220:223], a[12:15], a[20:23], v[220:223]
v_mfma_f32_16x16x32_bf16 v[224:227], a[12:15], a[24:27], v[224:227]
v_mfma_f32_16x16x32_bf16 v[228:231], a[12:15], a[28:31], v[228:231]
v_mfma_f32_16x16x32_bf16 v[232:235], a[32:35], a[12:15], v[232:235]
v_mfma_f32_16x16x32_bf16 v[236:239], a[36:39], a[12:15], v[236:239]
s_waitcnt vmcnt(12) lgkmcnt(0)
s_barrier
v_mfma_f32_16x16x32_bf16 v[144:147], a[72:75], a[88:91], v[144:147]
s_add_u32 s50, s49, s51
s_add_u32 s49, s49, 32768
s_cmp_eq_u32 s49, 163840
v_mfma_f32_16x16x32_bf16 v[148:151], a[72:75], a[92:95], v[148:151]
s_cselect_b32 s49, 65536, s49
v_add_u32 v2, s49, v1
v_xor_b32 v3, 64, v2
v_mfma_f32_16x16x32_bf16 v[152:155], a[72:75], a[96:99], v[152:155]
ds_read_b64_tr_b16 a[16:17], v4 offset:0
ds_read_b64_tr_b16 a[18:19], v4 offset:512
v_mfma_f32_16x16x32_bf16 v[156:159], a[72:75], a[100:103], v[156:159]
ds_read_b64_tr_b16 a[20:21], v5 offset:0
v_mfma_f32_16x16x32_bf16 v[160:163], a[104:107], a[72:75], v[160:163]
ds_read_b64_tr_b16 a[22:23], v5 offset:512
v_mfma_f32_16x16x32_bf16 v[164:167], a[108:111], a[72:75], v[164:167]
ds_read_b64_tr_b16 a[24:25], v6 offset:0
v_mfma_f32_16x16x32_bf16 v[168:171], a[76:79], a[88:91], v[168:171]
ds_read_b64_tr_b16 a[26:27], v6 offset:512
v_mfma_f32_16x16x32_bf16 v[172:175], a[76:79], a[92:95], v[172:175]
ds_read_b64_tr_b16 a[28:29], v7 offset:0
s_add_u32 m0, s51, 49152
v_mfma_f32_16x16x32_bf16 v[176:179], a[76:79], a[96:99], v[176:179]
buffer_load_dwordx4 v11, s[16:19], s44 offen lds
v_mfma_f32_16x16x32_bf16 v[180:183], a[76:79], a[100:103], v[180:183]
ds_read_b64_tr_b16 a[30:31], v7 offset:512
v_mfma_f32_16x16x32_bf16 v[184:187], a[104:107], a[76:79], v[184:187]
ds_read_b64_tr_b16 a[32:33], v4 offset:4096
ds_read_b64_tr_b16 a[34:35], v4 offset:4608
v_mfma_f32_16x16x32_bf16 v[188:191], a[108:111], a[76:79], v[188:191]
ds_read_b64_tr_b16 a[36:37], v5 offset:4096
v_mfma_f32_16x16x32_bf16 v[192:195], a[80:83], a[88:91], v[192:195]
ds_read_b64_tr_b16 a[38:39], v5 offset:4608
v_mfma_f32_16x16x32_bf16 v[196:199], a[80:83], a[92:95], v[196:199]
ds_read_b128 a[0:3], v2 offset:0
v_mfma_f32_16x16x32_bf16 v[200:203], a[80:83], a[96:99], v[200:203]
ds_read_b128 a[4:7], v2 offset:2048
v_mfma_f32_16x16x32_bf16 v[204:207], a[80:83], a[100:103], v[204:207]
ds_read_b128 a[8:11], v2 offset:4096
s_add_u32 m0, s51, 53248
v_mfma_f32_16x16x32_bf16 v[208:211], a[104:107], a[80:83], v[208:211]
buffer_load_dwordx4 v11, s[16:19], s45 offen lds
v_mfma_f32_16x16x32_bf16 v[212:215], a[108:111], a[80:83], v[212:215]
ds_read_b128 a[12:15], v2 offset:6144
v_add_u32 v11, s66, v11
v_mfma_f32_16x16x32_bf16 v[216:219], a[84:87], a[88:91], v[216:219]
v_mfma_f32_16x16x32_bf16 v[220:223], a[84:87], a[92:95], v[220:223]
v_mfma_f32_16x16x32_bf16 v[224:227], a[84:87], a[96:99], v[224:227]
v_mfma_f32_16x16x32_bf16 v[228:231], a[84:87], a[100:103], v[228:231]
v_mfma_f32_16x16x32_bf16 v[232:235], a[104:107], a[84:87], v[232:235]
v_mfma_f32_16x16x32_bf16 v[236:239], a[108:111], a[84:87], v[236:239]
s_waitcnt vmcnt(12) lgkmcnt(0)
s_barrier
v_mfma_f32_16x16x32_bf16 v[144:147], a[0:3], a[16:19], v[144:147]
v_mfma_f32_16x16x32_bf16 v[148:151], a[0:3], a[20:23], v[148:151]
ds_read_b64_tr_b16 a[88:89], v4 offset:16384
s_add_u32 m0, s51, 0
s_nop 0
buffer_load_dwordx4 v11, s[16:19], s44 offen lds
v_mfma_f32_16x16x32_bf16 v[152:155], a[0:3], a[24:27], v[152:155]
ds_read_b64_tr_b16 a[90:91], v4 offset:16896
ds_read_b64_tr_b16 a[92:93], v5 offset:16384
s_add_u32 m0, s51, 4096
v_mfma_f32_16x16x32_bf16 v[156:159], a[0:3], a[28:31], v[156:159]
buffer_load_dwordx4 v11, s[16:19], s45 offen lds
v_mfma_f32_16x16x32_bf16 v[160:163], a[32:35], a[0:3], v[160:163]
ds_read_b64_tr_b16 a[94:95], v5 offset:16896
s_add_u32 m0, s50, 0
s_nop 0
buffer_load_dwordx4 v10, s[12:15], s32 offen lds
v_add_u32 v11, s66, v11
v_mfma_f32_16x16x32_bf16 v[164:167], a[36:39], a[0:3], v[164:167]
ds_read_b64_tr_b16 a[96:97], v6 offset:16384
v_mfma_f32_16x16x32_bf16 v[168:171], a[4:7], a[16:19], v[168:171]
ds_read_b64_tr_b16 a[98:99], v6 offset:16896
s_add_u32 m0, s50, 4096
s_nop 0
buffer_load_dwordx4 v10, s[12:15], s33 offen lds
v_mfma_f32_16x16x32_bf16 v[172:175], a[4:7], a[20:23], v[172:175]
ds_read_b64_tr_b16 a[100:101], v7 offset:16384
s_add_u32 m0, s50, 8192
v_mfma_f32_16x16x32_bf16 v[176:179], a[4:7], a[24:27], v[176:179]
buffer_load_dwordx4 v10, s[12:15], s34 offen lds
ds_read_b64_tr_b16 a[102:103], v7 offset:16896
v_mfma_f32_16x16x32_bf16 v[180:183], a[4:7], a[28:31], v[180:183]
ds_read_b64_tr_b16 a[104:105], v4 offset:20480
s_add_u32 m0, s50, 12288
v_mfma_f32_16x16x32_bf16 v[184:187], a[32:35], a[4:7], v[184:187]
buffer_load_dwordx4 v10, s[12:15], s35 offen lds
ds_read_b64_tr_b16 a[106:107], v4 offset:20992
v_mfma_f32_16x16x32_bf16 v[188:191], a[36:39], a[4:7], v[188:191]
ds_read_b64_tr_b16 a[108:109], v5 offset:20480
s_add_u32 m0, s50, 16384
v_mfma_f32_16x16x32_bf16 v[192:195], a[8:11], a[16:19], v[192:195]
buffer_load_dwordx4 v10, s[12:15], s36 offen lds
ds_read_b64_tr_b16 a[110:111], v5 offset:20992
s_add_u32 m0, s50, 20480
v_mfma_f32_16x16x32_bf16 v[196:199], a[8:11], a[20:23], v[196:199]
buffer_load_dwordx4 v10, s[12:15], s37 offen lds
v_mfma_f32_16x16x32_bf16 v[200:203], a[8:11], a[24:27], v[200:203]
ds_read_b128 a[72:75], v3 offset:0
ds_read_b128 a[76:79], v3 offset:2048
s_add_u32 m0, s50, 24576
v_mfma_f32_16x16x32_bf16 v[204:207], a[8:11], a[28:31], v[204:207]
buffer_load_dwordx4 v10, s[12:15], s38 offen lds
v_mfma_f32_16x16x32_bf16 v[208:211], a[32:35], a[8:11], v[208:211]
ds_read_b128 a[80:83], v3 offset:4096
s_add_u32 m0, s50, 28672
s_nop 0
buffer_load_dwordx4 v10, s[12:15], s39 offen lds
v_mfma_f32_16x16x32_bf16 v[212:215], a[36:39], a[8:11], v[212:215]
ds_read_b128 a[84:87], v3 offset:6144
v_add_u32 v10, 128, v10
v_mfma_f32_16x16x32_bf16 v[216:219], a[12:15], a[16:19], v[216:219]
v_mfma_f32_16x16x32_bf16 v[220:223], a[12:15], a[20:23], v[220:223]
v_mfma_f32_16x16x32_bf16 v[224:227], a[12:15], a[24:27], v[224:227]
v_mfma_f32_16x16x32_bf16 v[228:231], a[12:15], a[28:31], v[228:231]
v_mfma_f32_16x16x32_bf16 v[232:235], a[32:35], a[12:15], v[232:235]
v_mfma_f32_16x16x32_bf16 v[236:239], a[36:39], a[12:15], v[236:239]
s_waitcnt vmcnt(12) lgkmcnt(0)
s_barrier
v_mfma_f32_16x16x32_bf16 v[144:147], a[72:75], a[88:91], v[144:147]
s_add_u32 s50, s49, s51
s_add_u32 s49, s49, 32768
s_cmp_eq_u32 s49, 163840
v_mfma_f32_16x16x32_bf16 v[148:151], a[72:75], a[92:95], v[148:151]
s_cselect_b32 s49, 65536, s49
v_add_u32 v2, s49, v1
v_xor_b32 v3, 64, v2
v_mfma_f32_16x16x32_bf16 v[152:155], a[72:75], a[96:99], v[152:155]
ds_read_b64_tr_b16 a[16:17], v4 offset:32768
ds_read_b64_tr_b16 a[18:19], v4 offset:33280
v_mfma_f32_16x16x32_bf16 v[156:159], a[72:75], a[100:103], v[156:159]
ds_read_b64_tr_b16 a[20:21], v5 offset:32768
v_mfma_f32_16x16x32_bf16 v[160:163], a[104:107], a[72:75], v[160:163]
ds_read_b64_tr_b16 a[22:23], v5 offset:33280
v_mfma_f32_16x16x32_bf16 v[164:167], a[108:111], a[72:75], v[164:167]
ds_read_b64_tr_b16 a[24:25], v6 offset:32768
v_mfma_f32_16x16x32_bf16 v[168:171], a[76:79], a[88:91], v[168:171]
ds_read_b64_tr_b16 a[26:27], v6 offset:33280
v_mfma_f32_16x16x32_bf16 v[172:175], a[76:79], a[92:95], v[172:175]
ds_read_b64_tr_b16 a[28:29], v7 offset:32768
s_add_u32 m0, s51, 16384
v_mfma_f32_16x16x32_bf16 v[176:179], a[76:79], a[96:99], v[176:179]
buffer_load_dwordx4 v11, s[16:19], s44 offen lds
v_mfma_f32_16x16x32_bf16 v[180:183], a[76:79], a[100:103], v[180:183]
ds_read_b64_tr_b16 a[30:31], v7 offset:33280
v_mfma_f32_16x16x32_bf16 v[184:187], a[104:107], a[76:79], v[184:187]
ds_read_b64_tr_b16 a[32:33], v4 offset:36864
ds_read_b64_tr_b16 a[34:35], v4 offset:37376
v_mfma_f32_16x16x32_bf16 v[188:191], a[108:111], a[76:79], v[188:191]
ds_read_b64_tr_b16 a[36:37], v5 offset:36864
v_mfma_f32_16x16x32_bf16 v[192:195], a[80:83], a[88:91], v[192:195]
ds_read_b64_tr_b16 a[38:39], v5 offset:37376
v_mfma_f32_16x16x32_bf16 v[196:199], a[80:83], a[92:95], v[196:199]
ds_read_b128 a[0:3], v2 offset:0
v_mfma_f32_16x16x32_bf16 v[200:203], a[80:83], a[96:99], v[200:203]
ds_read_b128 a[4:7], v2 offset:2048
v_mfma_f32_16x16x32_bf16 v[204:207], a[80:83], a[100:103], v[204:207]
ds_read_b128 a[8:11], v2 offset:4096
s_add_u32 m0, s51, 20480
v_mfma_f32_16x16x32_bf16 v[208:211], a[104:107], a[80:83], v[208:211]
buffer_load_dwordx4 v11, s[16:19], s45 offen lds
v_mfma_f32_16x16x32_bf16 v[212:215], a[108:111], a[80:83], v[212:215]
ds_read_b128 a[12:15], v2 offset:6144
v_add_u32 v11, s66, v11
v_mfma_f32_16x16x32_bf16 v[216:219], a[84:87], a[88:91], v[216:219]
v_mfma_f32_16x16x32_bf16 v[220:223], a[84:87], a[92:95], v[220:223]
v_mfma_f32_16x16x32_bf16 v[224:227], a[84:87], a[96:99], v[224:227]
v_mfma_f32_16x16x32_bf16 v[228:231], a[84:87], a[100:103], v[228:231]
v_mfma_f32_16x16x32_bf16 v[232:235], a[104:107], a[84:87], v[232:235]
v_mfma_f32_16x16x32_bf16 v[236:239], a[108:111], a[84:87], v[236:239]
s_waitcnt vmcnt(12) lgkmcnt(0)
s_barrier
v_mfma_f32_16x16x32_bf16 v[144:147], a[0:3], a[16:19], v[144:147]
v_mfma_f32_16x16x32_bf16 v[148:151], a[0:3], a[20:23], v[148:151]
ds_read_b64_tr_b16 a[88:89], v4 offset:49152
s_add_u32 m0, s51, 32768
s_nop 0
buffer_load_dwordx4 v11, s[16:19], s44 offen lds
v_mfma_f32_16x16x32_bf16 v[152:155], a[0:3], a[24:27], v[152:155]
ds_read_b64_tr_b16 a[90:91], v4 offset:49664
ds_read_b64_tr_b16 a[92:93], v5 offset:49152
s_add_u32 m0, s51, 36864
v_mfma_f32_16x16x32_bf16 v[156:159], a[0:3], a[28:31], v[156:159]
buffer_load_dwordx4 v11, s[16:19], s45 offen lds
v_mfma_f32_16x16x32_bf16 v[160:163], a[32:35], a[0:3], v[160:163]
ds_read_b64_tr_b16 a[94:95], v5 offset:49664
s_add_u32 m0, s50, 0
s_nop 0
buffer_load_dwordx4 v10, s[12:15], s32 offen lds
v_add_u32 v11, s66, v11
v_mfma_f32_16x16x32_bf16 v[164:167], a[36:39], a[0:3], v[164:167]
ds_read_b64_tr_b16 a[96:97], v6 offset:49152
v_mfma_f32_16x16x32_bf16 v[168:171], a[4:7], a[16:19], v[168:171]
ds_read_b64_tr_b16 a[98:99], v6 offset:49664
s_add_u32 m0, s50, 4096
s_nop 0
buffer_load_dwordx4 v10, s[12:15], s33 offen lds
v_mfma_f32_16x16x32_bf16 v[172:175], a[4:7], a[20:23], v[172:175]
ds_read_b64_tr_b16 a[100:101], v7 offset:49152
s_add_u32 m0, s50, 8192
v_mfma_f32_16x16x32_bf16 v[176:179], a[4:7], a[24:27], v[176:179]
buffer_load_dwordx4 v10, s[12:15], s34 offen lds
ds_read_b64_tr_b16 a[102:103], v7 offset:49664
v_mfma_f32_16x16x32_bf16 v[180:183], a[4:7], a[28:31], v[180:183]
ds_read_b64_tr_b16 a[104:105], v4 offset:53248
s_add_u32 m0, s50, 12288
v_mfma_f32_16x16x32_bf16 v[184:187], a[32:35], a[4:7], v[184:187]
buffer_load_dwordx4 v10, s[12:15], s35 offen lds
ds_read_b64_tr_b16 a[106:107], v4 offset:53760
v_mfma_f32_16x16x32_bf16 v[188:191], a[36:39], a[4:7], v[188:191]
ds_read_b64_tr_b16 a[108:109], v5 offset:53248
s_add_u32 m0, s50, 16384
v_mfma_f32_16x16x32_bf16 v[192:195], a[8:11], a[16:19], v[192:195]
buffer_load_dwordx4 v10, s[12:15], s36 offen lds
ds_read_b64_tr_b16 a[110:111], v5 offset:53760
s_add_u32 m0, s50, 20480
v_mfma_f32_16x16x32_bf16 v[196:199], a[8:11], a[20:23], v[196:199]
buffer_load_dwordx4 v10, s[12:15], s37 offen lds
v_mfma_f32_16x16x32_bf16 v[200:203], a[8:11], a[24:27], v[200:203]
ds_read_b128 a[72:75], v3 offset:0
ds_read_b128 a[76:79], v3 offset:2048
s_add_u32 m0, s50, 24576
v_mfma_f32_16x16x32_bf16 v[204:207], a[8:11], a[28:31], v[204:207]
buffer_load_dwordx4 v10, s[12:15], s38 offen lds
v_mfma_f32_16x16x32_bf16 v[208:211], a[32:35], a[8:11], v[208:211]
ds_read_b128 a[80:83], v3 offset:4096
s_add_u32 m0, s50, 28672
s_nop 0
buffer_load_dwordx4 v10, s[12:15], s39 offen lds
v_mfma_f32_16x16x32_bf16 v[212:215], a[36:39], a[8:11], v[212:215]
ds_read_b128 a[84:87], v3 offset:6144
v_add_u32 v10, 128, v10
v_mfma_f32_16x16x32_bf16 v[216:219], a[12:15], a[16:19], v[216:219]
v_mfma_f32_16x16x32_bf16 v[220:223], a[12:15], a[20:23], v[220:223]
v_mfma_f32_16x16x32_bf16 v[224:227], a[12:15], a[24:27], v[224:227]
v_mfma_f32_16x16x32_bf16 v[228:231], a[12:15], a[28:31], v[228:231]
v_mfma_f32_16x16x32_bf16 v[232:235], a[32:35], a[12:15], v[232:235]
v_mfma_f32_16x16x32_bf16 v[236:239], a[36:39], a[12:15], v[236:239]
s_waitcnt vmcnt(12) lgkmcnt(0)
s_barrier
v_mfma_f32_16x16x32_bf16 v[144:147], a[72:75], a[88:91], v[144:147]
s_add_u32 s50, s49, s51
s_add_u32 s49, s49, 32768
s_cmp_eq_u32 s49, 163840
v_mfma_f32_16x16x32_bf16 v[148:151], a[72:75], a[92:95], v[148:151]
s_cselect_b32 s49, 65536, s49
v_add_u32 v2, s49, v1
v_xor_b32 v3, 64, v2
v_mfma_f32_16x16x32_bf16 v[152:155], a[72:75], a[96:99], v[152:155]
ds_read_b64_tr_b16 a[16:17], v4 offset:0
ds_read_b64_tr_b16 a[18:19], v4 offset:512
v_mfma_f32_16x16x32_bf16 v[156:159], a[72:75], a[100:103], v[156:159]
ds_read_b64_tr_b16 a[20:21], v5 offset:0
v_mfma_f32_16x16x32_bf16 v[160:163], a[104:107], a[72:75], v[160:163]
ds_read_b64_tr_b16 a[22:23], v5 offset:512
v_mfma_f32_16x16x32_bf16 v[164:167], a[108:111], a[72:75], v[164:167]
ds_read_b64_tr_b16 a[24:25], v6 offset:0
v_mfma_f32_16x16x32_bf16 v[168:171], a[76:79], a[88:91], v[168:171]
ds_read_b64_tr_b16 a[26:27], v6 offset:512
v_mfma_f32_16x16x32_bf16 v[172:175], a[76:79], a[92:95], v[172:175]
ds_read_b64_tr_b16 a[28:29], v7 offset:0
s_add_u32 m0, s51, 49152
v_mfma_f32_16x16x32_bf16 v[176:179], a[76:79], a[96:99], v[176:179]
buffer_load_dwordx4 v11, s[16:19], s44 offen lds
v_mfma_f32_16x16x32_bf16 v[180:183], a[76:79], a[100:103], v[180:183]
ds_read_b64_tr_b16 a[30:31], v7 offset:512
v_mfma_f32_16x16x32_bf16 v[184:187], a[104:107], a[76:79], v[184:187]
ds_read_b64_tr_b16 a[32:33], v4 offset:4096
ds_read_b64_tr_b16 a[34:35], v4 offset:4608
v_mfma_f32_16x16x32_bf16 v[188:191], a[108:111], a[76:79], v[188:191]
ds_read_b64_tr_b16 a[36:37], v5 offset:4096
v_mfma_f32_16x16x32_bf16 v[192:195], a[80:83], a[88:91], v[192:195]
ds_read_b64_tr_b16 a[38:39], v5 offset:4608
v_mfma_f32_16x16x32_bf16 v[196:199], a[80:83], a[92:95], v[196:199]
ds_read_b128 a[0:3], v2 offset:0
v_mfma_f32_16x16x32_bf16 v[200:203], a[80:83], a[96:99], v[200:203]
ds_read_b128 a[4:7], v2 offset:2048
v_mfma_f32_16x16x32_bf16 v[204:207], a[80:83], a[100:103], v[204:207]
ds_read_b128 a[8:11], v2 offset:4096
s_add_u32 m0, s51, 53248
v_mfma_f32_16x16x32_bf16 v[208:211], a[104:107], a[80:83], v[208:211]
buffer_load_dwordx4 v11, s[16:19], s45 offen lds
v_mfma_f32_16x16x32_bf16 v[212:215], a[108:111], a[80:83], v[212:215]
ds_read_b128 a[12:15], v2 offset:6144
v_add_u32 v11, s66, v11
v_mfma_f32_16x16x32_bf16 v[216:219], a[84:87], a[88:91], v[216:219]
v_mfma_f32_16x16x32_bf16 v[220:223], a[84:87], a[92:95], v[220:223]
v_mfma_f32_16x16x32_bf16 v[224:227], a[84:87], a[96:99], v[224:227]
v_mfma_f32_16x16x32_bf16 v[228:231], a[84:87], a[100:103], v[228:231]
v_mfma_f32_16x16x32_bf16 v[232:235], a[104:107], a[84:87], v[232:235]
v_mfma_f32_16x16x32_bf16 v[236:239], a[108:111], a[84:87], v[236:239]
s_waitcnt vmcnt(12) lgkmcnt(0)
s_barrier
v_mfma_f32_16x16x32_bf16 v[144:147], a[0:3], a[16:19], v[144:147]
v_mfma_f32_16x16x32_bf16 v[148:151], a[0:3], a[20:23], v[148:151]
ds_read_b64_tr_b16 a[88:89], v4 offset:16384
s_add_u32 m0, s51, 0
s_nop 0
buffer_load_dwordx4 v9, s[8:11], s40 offen lds
v_mfma_f32_16x16x32_bf16 v[152:155], a[0:3], a[24:27], v[152:155]
ds_read_b64_tr_b16 a[90:91], v4 offset:16896
s_add_u32 m0, s51, 4096
s_nop 0
buffer_load_dwordx4 v9, s[8:11], s41 offen lds
v_mfma_f32_16x16x32_bf16 v[156:159], a[0:3], a[28:31], v[156:159]
ds_read_b64_tr_b16 a[92:93], v5 offset:16384
s_add_u32 m0, s51, 8192
v_mfma_f32_16x16x32_bf16 v[160:163], a[32:35], a[0:3], v[160:163]
buffer_load_dwordx4 v9, s[8:11], s42 offen lds
ds_read_b64_tr_b16 a[94:95], v5 offset:16896
v_mfma_f32_16x16x32_bf16 v[164:167], a[36:39], a[0:3], v[164:167]
ds_read_b64_tr_b16 a[96:97], v6 offset:16384
s_add_u32 m0, s51, 12288
s_nop 0
buffer_load_dwordx4 v9, s[8:11], s43 offen lds
v_mfma_f32_16x16x32_bf16 v[168:171], a[4:7], a[16:19], v[168:171]
ds_read_b64_tr_b16 a[98:99], v6 offset:16896
s_add_u32 m0, s50, 0
v_add_u32 v9, 262144, v9
v_mfma_f32_16x16x32_bf16 v[172:175], a[4:7], a[20:23], v[172:175]
buffer_load_dwordx4 v8, s[4:7], s24 offen lds
ds_read_b64_tr_b16 a[100:101], v7 offset:16384
s_add_u32 m0, s50, 4096
v_mfma_f32_16x16x32_bf16 v[176:179], a[4:7], a[24:27], v[176:179]
buffer_load_dwordx4 v8, s[4:7], s25 offen lds
ds_read_b64_tr_b16 a[102:103], v7 offset:16896
v_mfma_f32_16x16x32_bf16 v[180:183], a[4:7], a[28:31], v[180:183]
ds_read_b64_tr_b16 a[104:105], v4 offset:20480
s_add_u32 m0, s50, 8192
v_mfma_f32_16x16x32_bf16 v[184:187], a[32:35], a[4:7], v[184:187]
buffer_load_dwordx4 v8, s[4:7], s26 offen lds
ds_read_b64_tr_b16 a[106:107], v4 offset:20992
s_add_u32 m0, s50, 12288
v_mfma_f32_16x16x32_bf16 v[188:191], a[36:39], a[4:7], v[188:191]
buffer_load_dwordx4 v8, s[4:7], s27 offen lds
ds_read_b64_tr_b16 a[108:109], v5 offset:20480
s_add_u32 m0, s50, 16384
v_mfma_f32_16x16x32_bf16 v[192:195], a[8:11], a[16:19], v[192:195]
buffer_load_dwordx4 v8, s[4:7], s28 offen lds
v_mfma_f32_16x16x32_bf16 v[196:199], a[8:11], a[20:23], v[196:199]
ds_read_b64_tr_b16 a[110:111], v5 offset:20992
ds_read_b128 a[72:75], v3 offset:0
s_add_u32 m0, s50, 20480
v_mfma_f32_16x16x32_bf16 v[200:203], a[8:11], a[24:27], v[200:203]
buffer_load_dwordx4 v8, s[4:7], s29 offen lds
ds_read_b128 a[76:79], v3 offset:2048
s_add_u32 m0, s50, 24576
v_mfma_f32_16x16x32_bf16 v[204:207], a[8:11], a[28:31], v[204:207]
buffer_load_dwordx4 v8, s[4:7], s30 offen lds
v_mfma_f32_16x16x32_bf16 v[208:211], a[32:35], a[8:11], v[208:211]
ds_read_b128 a[80:83], v3 offset:4096
s_add_u32 m0, s50, 28672
s_nop 0
buffer_load_dwordx4 v8, s[4:7], s31 offen lds
v_mfma_f32_16x16x32_bf16 v[212:215], a[36:39], a[8:11], v[212:215]
ds_read_b128 a[84:87], v3 offset:6144
v_add_u32 v8, 128, v8
v_mfma_f32_16x16x32_bf16 v[216:219], a[12:15], a[16:19], v[216:219]
v_mfma_f32_16x16x32_bf16 v[220:223], a[12:15], a[20:23], v[220:223]
v_mfma_f32_16x16x32_bf16 v[224:227], a[12:15], a[24:27], v[224:227]
v_mfma_f32_16x16x32_bf16 v[228:231], a[12:15], a[28:31], v[228:231]
v_mfma_f32_16x16x32_bf16 v[232:235], a[32:35], a[12:15], v[232:235]
v_mfma_f32_16x16x32_bf16 v[236:239], a[36:39], a[12:15], v[236:239]
s_waitcnt vmcnt(14) lgkmcnt(0)
s_barrier
v_mfma_f32_16x16x32_bf16 v[144:147], a[72:75], a[88:91], v[144:147]
s_add_u32 s50, s49, s51
s_add_u32 s49, s49, 32768
s_cmp_eq_u32 s49, 163840
v_mfma_f32_16x16x32_bf16 v[148:151], a[72:75], a[92:95], v[148:151]
s_cselect_b32 s49, 65536, s49
v_add_u32 v2, s49, v1
v_xor_b32 v3, 64, v2
v_mfma_f32_16x16x32_bf16 v[152:155], a[72:75], a[96:99], v[152:155]
ds_read_b64_tr_b16 a[16:17], v4 offset:32768
ds_read_b64_tr_b16 a[18:19], v4 offset:33280
v_mfma_f32_16x16x32_bf16 v[156:159], a[72:75], a[100:103], v[156:159]
ds_read_b64_tr_b16 a[20:21], v5 offset:32768
s_add_u32 m0, s51, 16384
v_mfma_f32_16x16x32_bf16 v[160:163], a[104:107], a[72:75], v[160:163]
buffer_load_dwordx4 v9, s[8:11], s40 offen lds
v_mfma_f32_16x16x32_bf16 v[164:167], a[108:111], a[72:75], v[164:167]
ds_read_b64_tr_b16 a[22:23], v5 offset:33280
v_mfma_f32_16x16x32_bf16 v[168:171], a[76:79], a[88:91], v[168:171]
ds_read_b64_tr_b16 a[24:25], v6 offset:32768
ds_read_b64_tr_b16 a[26:27], v6 offset:33280
v_mfma_f32_16x16x32_bf16 v[172:175], a[76:79], a[92:95], v[172:175]
ds_read_b64_tr_b16 a[28:29], v7 offset:32768
s_add_u32 m0, s51, 20480
v_mfma_f32_16x16x32_bf16 v[176:179], a[76:79], a[96:99], v[176:179]
buffer_load_dwordx4 v9, s[8:11], s41 offen lds
v_mfma_f32_16x16x32_bf16 v[180:183], a[76:79], a[100:103], v[180:183]
ds_read_b64_tr_b16 a[30:31], v7 offset:33280
v_mfma_f32_16x16x32_bf16 v[184:187], a[104:107], a[76:79], v[184:187]
ds_read_b64_tr_b16 a[32:33], v4 offset:36864
ds_read_b64_tr_b16 a[34:35], v4 offset:37376
v_mfma_f32_16x16x32_bf16 v[188:191], a[108:111], a[76:79], v[188:191]
ds_read_b64_tr_b16 a[36:37], v5 offset:36864
s_add_u32 m0, s51, 24576
v_mfma_f32_16x16x32_bf16 v[192:195], a[80:83], a[88:91], v[192:195]
buffer_load_dwordx4 v9, s[8:11], s42 offen lds
v_mfma_f32_16x16x32_bf16 v[196:199], a[80:83], a[92:95], v[196:199]
ds_read_b64_tr_b16 a[38:39], v5 offset:37376
v_mfma_f32_16x16x32_bf16 v[200:203], a[80:83], a[96:99], v[200:203]
ds_read_b128 a[0:3], v2 offset:0
ds_read_b128 a[4:7], v2 offset:2048
v_mfma_f32_16x16x32_bf16 v[204:207], a[80:83], a[100:103], v[204:207]
ds_read_b128 a[8:11], v2 offset:4096
s_add_u32 m0, s51, 28672
v_mfma_f32_16x16x32_bf16 v[208:211], a[104:107], a[80:83], v[208:211]
buffer_load_dwordx4 v9, s[8:11], s43 offen lds
v_mfma_f32_16x16x32_bf16 v[212:215], a[108:111], a[80:83], v[212:215]
ds_read_b128 a[12:15], v2 offset:6144
v_add_u32 v9, 262144, v9
v_mfma_f32_16x16x32_bf16 v[216:219], a[84:87], a[88:91], v[216:219]
v_mfma_f32_16x16x32_bf16 v[220:223], a[84:87], a[92:95], v[220:223]
v_mfma_f32_16x16x32_bf16 v[224:227], a[84:87], a[96:99], v[224:227]
v_mfma_f32_16x16x32_bf16 v[228:231], a[84:87], a[100:103], v[228:231]
v_mfma_f32_16x16x32_bf16 v[232:235], a[104:107], a[84:87], v[232:235]
v_mfma_f32_16x16x32_bf16 v[236:239], a[108:111], a[84:87], v[236:239]
s_waitcnt vmcnt(16) lgkmcnt(0)
s_barrier
v_mfma_f32_16x16x32_bf16 v[144:147], a[0:3], a[16:19], v[144:147]
v_mfma_f32_16x16x32_bf16 v[148:151], a[0:3], a[20:23], v[148:151]
ds_read_b64_tr_b16 a[88:89], v4 offset:49152
s_add_u32 m0, s51, 32768
s_nop 0
buffer_load_dwordx4 v9, s[8:11], s40 offen lds
v_mfma_f32_16x16x32_bf16 v[152:155], a[0:3], a[24:27], v[152:155]
ds_read_b64_tr_b16 a[90:91], v4 offset:49664
s_add_u32 m0, s51, 36864
s_nop 0
buffer_load_dwordx4 v9, s[8:11], s41 offen lds
v_mfma_f32_16x16x32_bf16 v[156:159], a[0:3], a[28:31], v[156:159]
ds_read_b64_tr_b16 a[92:93], v5 offset:49152
s_add_u32 m0, s51, 40960
v_mfma_f32_16x16x32_bf16 v[160:163], a[32:35], a[0:3], v[160:163]
buffer_load_dwordx4 v9, s[8:11], s42 offen lds
ds_read_b64_tr_b16 a[94:95], v5 offset:49664
v_mfma_f32_16x16x32_bf16 v[164:167], a[36:39], a[0:3], v[164:167]
ds_read_b64_tr_b16 a[96:97], v6 offset:49152
s_add_u32 m0, s51, 45056
s_nop 0
buffer_load_dwordx4 v9, s[8:11], s43 offen lds
v_mfma_f32_16x16x32_bf16 v[168:171], a[4:7], a[16:19], v[168:171]
ds_read_b64_tr_b16 a[98:99], v6 offset:49664
s_add_u32 m0, s50, 0
v_add_u32 v9, 262144, v9
v_mfma_f32_16x16x32_bf16 v[172:175], a[4:7], a[20:23], v[172:175]
buffer_load_dwordx4 v8, s[4:7], s24 offen lds
ds_read_b64_tr_b16 a[100:101], v7 offset:49152
s_add_u32 m0, s50, 4096
v_mfma_f32_16x16x32_bf16 v[176:179], a[4:7], a[24:27], v[176:179]
buffer_load_dwordx4 v8, s[4:7], s25 offen lds
ds_read_b64_tr_b16 a[102:103], v7 offset:49664
v_mfma_f32_16x16x32_bf16 v[180:183], a[4:7], a[28:31], v[180:183]
ds_read_b64_tr_b16 a[104:105], v4 offset:53248
s_add_u32 m0, s50, 8192
v_mfma_f32_16x16x32_bf16 v[184:187], a[32:35], a[4:7], v[184:187]
buffer_load_dwordx4 v8, s[4:7], s26 offen lds
ds_read_b64_tr_b16 a[106:107], v4 offset:53760
s_add_u32 m0, s50, 12288
v_mfma_f32_16x16x32_bf16 v[188:191], a[36:39], a[4:7], v[188:191]
buffer_load_dwordx4 v8, s[4:7], s27 offen lds
ds_read_b64_tr_b16 a[108:109], v5 offset:53248
s_add_u32 m0, s50, 16384
v_mfma_f32_16x16x32_bf16 v[192:195], a[8:11], a[16:19], v[192:195]
buffer_load_dwordx4 v8, s[4:7], s28 offen lds
v_mfma_f32_16x16x32_bf16 v[196:199], a[8:11], a[20:23], v[196:199]
ds_read_b64_tr_b16 a[110:111], v5 offset:53760
ds_read_b128 a[72:75], v3 offset:0
s_add_u32 m0, s50, 20480
v_mfma_f32_16x16x32_bf16 v[200:203], a[8:11], a[24:27], v[200:203]
buffer_load_dwordx4 v8, s[4:7], s29 offen lds
ds_read_b128 a[76:79], v3 offset:2048
s_add_u32 m0, s50, 24576
v_mfma_f32_16x16x32_bf16 v[204:207], a[8:11], a[28:31], v[204:207]
buffer_load_dwordx4 v8, s[4:7], s30 offen lds
v_mfma_f32_16x16x32_bf16 v[208:211], a[32:35], a[8:11], v[208:211]
ds_read_b128 a[80:83], v3 offset:4096
s_add_u32 m0, s50, 28672
s_nop 0
buffer_load_dwordx4 v8, s[4:7], s31 offen lds
v_mfma_f32_16x16x32_bf16 v[212:215], a[36:39], a[8:11], v[212:215]
ds_read_b128 a[84:87], v3 offset:6144
v_add_u32 v8, 128, v8
v_mfma_f32_16x16x32_bf16 v[216:219], a[12:15], a[16:19], v[216:219]
v_mfma_f32_16x16x32_bf16 v[220:223], a[12:15], a[20:23], v[220:223]
v_mfma_f32_16x16x32_bf16 v[224:227], a[12:15], a[24:27], v[224:227]
v_subrev_u32 v1, s98, v1
v_mfma_f32_16x16x32_bf16 v[228:231], a[12:15], a[28:31], v[228:231]
v_add_u32 v4, s74, v4
v_add_u32 v5, s74, v5
v_mfma_f32_16x16x32_bf16 v[232:235], a[32:35], a[12:15], v[232:235]
v_add_u32 v6, s74, v6
v_add_u32 v7, s74, v7
v_mfma_f32_16x16x32_bf16 v[236:239], a[36:39], a[12:15], v[236:239]
s_waitcnt vmcnt(16) lgkmcnt(0)
s_barrier
v_mfma_f32_16x16x32_bf16 v[144:147], a[72:75], a[88:91], v[144:147]
s_add_u32 s50, s49, s51
s_add_u32 s49, s49, 32768
s_cmp_eq_u32 s49, 163840
v_mfma_f32_16x16x32_bf16 v[148:151], a[72:75], a[92:95], v[148:151]
s_cselect_b32 s49, 65536, s49
v_add_u32 v2, s49, v1
v_xor_b32 v3, 64, v2
v_mfma_f32_16x16x32_bf16 v[152:155], a[72:75], a[96:99], v[152:155]
ds_read_b64_tr_b16 a[32:33], v4 offset:0
ds_read_b64_tr_b16 a[34:35], v4 offset:512
v_mfma_f32_16x16x32_bf16 v[156:159], a[72:75], a[100:103], v[156:159]
ds_read_b64_tr_b16 a[36:37], v5 offset:0
ds_read_b64_tr_b16 a[38:39], v5 offset:512
v_mfma_f32_16x16x32_bf16 v[160:163], a[104:107], a[72:75], v[160:163]
ds_read_b64_tr_b16 a[40:41], v6 offset:0
s_add_u32 m0, s51, 49152
s_nop 0
buffer_load_dwordx4 v9, s[8:11], s40 offen lds
v_mfma_f32_16x16x32_bf16 v[164:167], a[108:111], a[72:75], v[164:167]
ds_read_b64_tr_b16 a[42:43], v6 offset:512
v_mfma_f32_16x16x32_bf16 v[168:171], a[76:79], a[88:91], v[168:171]
ds_read_b64_tr_b16 a[44:45], v7 offset:0
ds_read_b64_tr_b16 a[46:47], v7 offset:512
v_mfma_f32_16x16x32_bf16 v[172:175], a[76:79], a[92:95], v[172:175]
ds_read_b64_tr_b16 a[48:49], v4 offset:4096
ds_read_b64_tr_b16 a[50:51], v4 offset:4608
v_mfma_f32_16x16x32_bf16 v[176:179], a[76:79], a[96:99], v[176:179]
ds_read_b64_tr_b16 a[52:53], v5 offset:4096
s_add_u32 m0, s51, 53248
s_nop 0
buffer_load_dwordx4 v9, s[8:11], s41 offen lds
v_mfma_f32_16x16x32_bf16 v[180:183], a[76:79], a[100:103], v[180:183]
ds_read_b64_tr_b16 a[54:55], v5 offset:4608
v_mfma_f32_16x16x32_bf16 v[184:187], a[104:107], a[76:79], v[184:187]
ds_read_b64_tr_b16 a[56:57], v6 offset:4096
ds_read_b64_tr_b16 a[58:59], v6 offset:4608
v_mfma_f32_16x16x32_bf16 v[188:191], a[108:111], a[76:79], v[188:191]
ds_read_b64_tr_b16 a[60:61], v7 offset:4096
ds_read_b64_tr_b16 a[62:63], v7 offset:4608
v_mfma_f32_16x16x32_bf16 v[192:195], a[80:83], a[88:91], v[192:195]
ds_read_b128 a[0:3], v2 offset:0
s_add_u32 m0, s51, 57344
s_nop 0
buffer_load_dwordx4 v9, s[8:11], s42 offen lds
v_mfma_f32_16x16x32_bf16 v[196:199], a[80:83], a[92:95], v[196:199]
ds_read_b128 a[4:7], v2 offset:2048
v_mfma_f32_16x16x32_bf16 v[200:203], a[80:83], a[96:99], v[200:203]
ds_read_b128 a[8:11], v2 offset:4096
ds_read_b128 a[12:15], v2 offset:6144
v_mfma_f32_16x16x32_bf16 v[204:207], a[80:83], a[100:103], v[204:207]
ds_read_b128 a[16:19], v2 offset:8192
ds_read_b128 a[20:23], v2 offset:10240
v_mfma_f32_16x16x32_bf16 v[208:211], a[104:107], a[80:83], v[208:211]
ds_read_b128 a[24:27], v2 offset:12288
s_add_u32 m0, s51, 61440
s_nop 0
buffer_load_dwordx4 v9, s[8:11], s43 offen lds
v_mfma_f32_16x16x32_bf16 v[212:215], a[108:111], a[80:83], v[212:215]
ds_read_b128 a[28:31], v2 offset:14336
v_add_u32 v9, 262144, v9
v_mfma_f32_16x16x32_bf16 v[216:219], a[84:87], a[88:91], v[216:219]
v_mfma_f32_16x16x32_bf16 v[220:223], a[84:87], a[92:95], v[220:223]
v_mfma_f32_16x16x32_bf16 v[224:227], a[84:87], a[96:99], v[224:227]
v_mfma_f32_16x16x32_bf16 v[228:231], a[84:87], a[100:103], v[228:231]
v_mfma_f32_16x16x32_bf16 v[232:235], a[104:107], a[84:87], v[232:235]
v_mfma_f32_16x16x32_bf16 v[236:239], a[108:111], a[84:87], v[236:239]
s_nop 7
v_mov_b32 v14, 1049335798
v_cndmask_b32 v15, v14, 0, s[72:73]
s_add_u32 s68, s63, 0
v_mul_f32 v160, v14, v160
v_mul_f32 v161, v14, v161
v_mul_f32 v162, v14, v162
v_mul_f32 v163, v14, v163
v_mul_f32 v164, v15, v164
v_mul_f32 v165, v15, v165
v_mul_f32 v166, v15, v166
v_mul_f32 v167, v15, v167
v_cvt_pk_bf16_f32 v160, v160, v161
v_cvt_pk_bf16_f32 v161, v162, v163
v_cvt_pk_bf16_f32 v162, v164, v165
v_cvt_pk_bf16_f32 v163, v166, v167
buffer_store_dwordx4 v[160:163], v13, s[20:23], s68 offen offset:0 sc0 sc1
s_add_u32 s68, s63, 0
v_mul_f32 v184, v14, v184
v_mul_f32 v185, v14, v185
v_mul_f32 v186, v14, v186
v_mul_f32 v187, v14, v187
v_mul_f32 v188, v15, v188
v_mul_f32 v189, v15, v189
v_mul_f32 v190, v15, v190
v_mul_f32 v191, v15, v191
v_cvt_pk_bf16_f32 v184, v184, v185
v_cvt_pk_bf16_f32 v185, v186, v187
v_cvt_pk_bf16_f32 v186, v188, v189
v_cvt_pk_bf16_f32 v187, v190, v191
buffer_store_dwordx4 v[184:187], v13, s[20:23], s68 offen offset:256 sc0 sc1
s_add_u32 s68, s63, 2048
v_mul_f32 v208, v14, v208
v_mul_f32 v209, v14, v209
v_mul_f32 v210, v14, v210
v_mul_f32 v211, v14, v211
v_mul_f32 v212, v15, v212
v_mul_f32 v213, v15, v213
v_mul_f32 v214, v15, v214
v_mul_f32 v215, v15, v215
v_cvt_pk_bf16_f32 v208, v208, v209
v_cvt_pk_bf16_f32 v209, v210, v211
v_cvt_pk_bf16_f32 v210, v212, v213
v_cvt_pk_bf16_f32 v211, v214, v215
buffer_store_dwordx4 v[208:211], v13, s[20:23], s68 offen offset:0 sc0 sc1
s_add_u32 s68, s63, 2048
v_mul_f32 v232, v14, v232
v_mul_f32 v233, v14, v233
v_mul_f32 v234, v14, v234
v_mul_f32 v235, v14, v235
v_mul_f32 v236, v15, v236
v_mul_f32 v237, v15, v237
v_mul_f32 v238, v15, v238
v_mul_f32 v239, v15, v239
v_cvt_pk_bf16_f32 v232, v232, v233
v_cvt_pk_bf16_f32 v233, v234, v235
v_cvt_pk_bf16_f32 v234, v236, v237
v_cvt_pk_bf16_f32 v235, v238, v239
buffer_store_dwordx4 v[232:235], v13, s[20:23], s68 offen offset:256 sc0 sc1
v_mov_b32 v14, 0x3f803f80
s_add_u32 s68, s62, 0
v_cvt_pk_bf16_f32 v144, v144, v145
v_cvt_pk_bf16_f32 v145, v146, v147
v_cvt_pk_bf16_f32 v146, v168, v169
v_cvt_pk_bf16_f32 v147, v170, v171
buffer_store_dwordx4 v[144:147], v13, s[20:23], s68 offen offset:0 sc0 sc1
s_add_u32 s68, s62, 0
v_cvt_pk_bf16_f32 v148, v148, v149
v_cvt_pk_bf16_f32 v149, v150, v151
v_cvt_pk_bf16_f32 v150, v172, v173
v_cvt_pk_bf16_f32 v151, v174, v175
v_cndmask_b32 v148, v148, v14, s[70:71]
v_cndmask_b32 v149, v149, v14, s[70:71]
v_cndmask_b32 v150, v150, v14, s[70:71]
v_cndmask_b32 v151, v151, v14, s[70:71]
buffer_store_dwordx4 v[148:151], v13, s[20:23], s68 offen offset:256 sc0 sc1
s_add_u32 s68, s62, 262144
v_cvt_pk_bf16_f32 v152, v152, v153
v_cvt_pk_bf16_f32 v153, v154, v155
v_cvt_pk_bf16_f32 v154, v176, v177
v_cvt_pk_bf16_f32 v155, v178, v179
buffer_store_dwordx4 v[152:155], v13, s[20:23], s68 offen offset:0 sc0 sc1
s_add_u32 s68, s62, 262144
v_cvt_pk_bf16_f32 v156, v156, v157
v_cvt_pk_bf16_f32 v157, v158, v159
v_cvt_pk_bf16_f32 v158, v180, v181
v_cvt_pk_bf16_f32 v159, v182, v183
v_cndmask_b32 v156, v156, v14, s[70:71]
v_cndmask_b32 v157, v157, v14, s[70:71]
v_cndmask_b32 v158, v158, v14, s[70:71]
v_cndmask_b32 v159, v159, v14, s[70:71]
buffer_store_dwordx4 v[156:159], v13, s[20:23], s68 offen offset:256 sc0 sc1
s_add_u32 s68, s62, 4096
v_cvt_pk_bf16_f32 v192, v192, v193
v_cvt_pk_bf16_f32 v193, v194, v195
v_cvt_pk_bf16_f32 v194, v216, v217
v_cvt_pk_bf16_f32 v195, v218, v219
buffer_store_dwordx4 v[192:195], v13, s[20:23], s68 offen offset:0 sc0 sc1
s_add_u32 s68, s62, 4096
v_cvt_pk_bf16_f32 v196, v196, v197
v_cvt_pk_bf16_f32 v197, v198, v199
v_cvt_pk_bf16_f32 v198, v220, v221
v_cvt_pk_bf16_f32 v199, v222, v223
v_cndmask_b32 v196, v196, v14, s[70:71]
v_cndmask_b32 v197, v197, v14, s[70:71]
v_cndmask_b32 v198, v198, v14, s[70:71]
v_cndmask_b32 v199, v199, v14, s[70:71]
buffer_store_dwordx4 v[196:199], v13, s[20:23], s68 offen offset:256 sc0 sc1
s_add_u32 s68, s62, 266240
v_cvt_pk_bf16_f32 v200, v200, v201
v_cvt_pk_bf16_f32 v201, v202, v203
v_cvt_pk_bf16_f32 v202, v224, v225
v_cvt_pk_bf16_f32 v203, v226, v227
buffer_store_dwordx4 v[200:203], v13, s[20:23], s68 offen offset:0 sc0 sc1
s_add_u32 s68, s62, 266240
v_cvt_pk_bf16_f32 v204, v204, v205
v_cvt_pk_bf16_f32 v205, v206, v207
v_cvt_pk_bf16_f32 v206, v228, v229
v_cvt_pk_bf16_f32 v207, v230, v231
v_cndmask_b32 v204, v204, v14, s[70:71]
v_cndmask_b32 v205, v205, v14, s[70:71]
v_cndmask_b32 v206, v206, v14, s[70:71]
v_cndmask_b32 v207, v207, v14, s[70:71]
buffer_store_dwordx4 v[204:207], v13, s[20:23], s68 offen offset:256 sc0 sc1
s_mov_b32 s76, s92
s_mov_b32 s77, s93
s_mov_b32 s78, 256
s_mov_b32 s79, 0x20000
s_branch LM_r1
LM_pa2:
v_add_u32 v2, s49, v1
v_xor_b32 v3, 64, v2
s_add_u32 m0, s51, 16384
s_nop 0
buffer_load_dwordx4 v9, s[8:11], s40 offen lds
s_add_u32 m0, s51, 20480
s_nop 0
buffer_load_dwordx4 v9, s[8:11], s41 offen lds
s_add_u32 m0, s51, 24576
s_nop 0
buffer_load_dwordx4 v9, s[8:11], s42 offen lds
s_add_u32 m0, s51, 28672
s_nop 0
buffer_load_dwordx4 v9, s[8:11], s43 offen lds
v_add_u32 v9, 262144, v9
s_add_u32 s50, s51, 98304
s_add_u32 m0, s50, 0
s_nop 0
buffer_load_dwordx4 v8, s[4:7], s24 offen lds
s_add_u32 m0, s50, 4096
s_nop 0
buffer_load_dwordx4 v8, s[4:7], s25 offen lds
s_add_u32 m0, s50, 8192
s_nop 0
buffer_load_dwordx4 v8, s[4:7], s26 offen lds
s_add_u32 m0, s50, 12288
s_nop 0
buffer_load_dwordx4 v8, s[4:7], s27 offen lds
s_add_u32 m0, s50, 16384
s_nop 0
buffer_load_dwordx4 v8, s[4:7], s28 offen lds
s_add_u32 m0, s50, 20480
s_nop 0
buffer_load_dwordx4 v8, s[4:7], s29 offen lds
s_add_u32 m0, s50, 24576
s_nop 0
buffer_load_dwordx4 v8, s[4:7], s30 offen lds
s_add_u32 m0, s50, 28672
s_nop 0
buffer_load_dwordx4 v8, s[4:7], s31 offen lds
v_add_u32 v8, 128, v8
s_add_u32 m0, s51, 32768
s_nop 0
buffer_load_dwordx4 v9, s[8:11], s40 offen lds
s_add_u32 m0, s51, 36864
s_nop 0
buffer_load_dwordx4 v9, s[8:11], s41 offen lds
s_add_u32 m0, s51, 40960
s_nop 0
buffer_load_dwordx4 v9, s[8:11], s42 offen lds
s_add_u32 m0, s51, 45056
s_nop 0
buffer_load_dwordx4 v9, s[8:11], s43 offen lds
v_add_u32 v9, 262144, v9
s_add_u32 m0, s51, 49152
s_nop 0
buffer_load_dwordx4 v9, s[8:11], s40 offen lds
s_add_u32 m0, s51, 53248
s_nop 0
buffer_load_dwordx4 v9, s[8:11], s41 offen lds
s_add_u32 m0, s51, 57344
s_nop 0
buffer_load_dwordx4 v9, s[8:11], s42 offen lds
s_add_u32 m0, s51, 61440
s_nop 0
buffer_load_dwordx4 v9, s[8:11], s43 offen lds
v_add_u32 v9, 262144, v9
s_add_u32 s50, s51, 131072
s_mov_b32 s76, s92
s_mov_b32 s77, s93
s_mov_b32 s78, 256
s_mov_b32 s79, 0x20000
s_waitcnt vmcnt(20)
s_barrier
ds_read_b64_tr_b16 a[32:33], v4 offset:0
ds_read_b64_tr_b16 a[34:35], v4 offset:512
ds_read_b64_tr_b16 a[36:37], v5 offset:0
ds_read_b64_tr_b16 a[38:39], v5 offset:512
ds_read_b64_tr_b16 a[40:41], v6 offset:0
ds_read_b64_tr_b16 a[42:43], v6 offset:512
ds_read_b64_tr_b16 a[44:45], v7 offset:0
ds_read_b64_tr_b16 a[46:47], v7 offset:512
ds_read_b64_tr_b16 a[48:49], v4 offset:4096
ds_read_b64_tr_b16 a[50:51], v4 offset:4608
ds_read_b64_tr_b16 a[52:53], v5 offset:4096
ds_read_b64_tr_b16 a[54:55], v5 offset:4608
ds_read_b64_tr_b16 a[56:57], v6 offset:4096
ds_read_b64_tr_b16 a[58:59], v6 offset:4608
ds_read_b64_tr_b16 a[60:61], v7 offset:4096
ds_read_b64_tr_b16 a[62:63], v7 offset:4608
ds_read_b128 a[0:3], v2 offset:0
ds_read_b128 a[4:7], v2 offset:2048
ds_read_b128 a[8:11], v2 offset:4096
ds_read_b128 a[12:15], v2 offset:6144
ds_read_b128 a[16:19], v2 offset:8192
ds_read_b128 a[20:23], v2 offset:10240
ds_read_b128 a[24:27], v2 offset:12288
ds_read_b128 a[28:31], v2 offset:14336
LM_r1:
s_mov_b32 s56, s80
s_mov_b32 s57, s81
s_mov_b32 s58, 401408
s_mov_b32 s59, 0x20000
s_lshl_b32 s96, s2, 11
s_and_b32 s97, s51, 1024
s_add_u32 s96, s96, s97
v_mov_b32 v15, 0
s_cmp_eq_u32 s64, 0
s_cbranch_scc0 LM_firstV
LM_firstK:
s_waitcnt vmcnt(16) lgkmcnt(0)
s_barrier
v_mfma_f32_16x16x32_bf16 v[16:19], a[32:35], a[0:3], 0
v_mfma_f32_16x16x32_bf16 v[20:23], a[36:39], a[0:3], 0
ds_read_b64_tr_b16 a[104:105], v4 offset:16384
s_add_u32 m0, s51, 0
v_mfma_f32_16x16x32_bf16 v[24:27], a[40:43], a[0:3], 0
buffer_load_dwordx4 v9, s[8:11], s40 offen lds
v_mfma_f32_16x16x32_bf16 v[28:31], a[44:47], a[0:3], 0
ds_read_b64_tr_b16 a[106:107], v4 offset:16896
v_mfma_f32_16x16x32_bf16 v[32:35], a[48:51], a[0:3], 0
v_mfma_f32_16x16x32_bf16 v[36:39], a[52:55], a[0:3], 0
ds_read_b64_tr_b16 a[108:109], v5 offset:16384
s_add_u32 m0, s51, 4096
v_mfma_f32_16x16x32_bf16 v[40:43], a[56:59], a[0:3], 0
buffer_load_dwordx4 v9, s[8:11], s41 offen lds
v_mfma_f32_16x16x32_bf16 v[44:47], a[60:63], a[0:3], 0
v_mfma_f32_16x16x32_bf16 v[48:51], a[32:35], a[4:7], 0
ds_read_b64_tr_b16 a[110:111], v5 offset:16896
v_mfma_f32_16x16x32_bf16 v[52:55], a[36:39], a[4:7], 0
ds_read_b64_tr_b16 a[112:113], v6 offset:16384
v_mfma_f32_16x16x32_bf16 v[56:59], a[40:43], a[4:7], 0
s_add_u32 m0, s51, 8192
v_mfma_f32_16x16x32_bf16 v[60:63], a[44:47], a[4:7], 0
buffer_load_dwordx4 v9, s[8:11], s42 offen lds
v_mfma_f32_16x16x32_bf16 v[64:67], a[48:51], a[4:7], 0
ds_read_b64_tr_b16 a[114:115], v6 offset:16896
v_mfma_f32_16x16x32_bf16 v[68:71], a[52:55], a[4:7], 0
v_mfma_f32_16x16x32_bf16 v[72:75], a[56:59], a[4:7], 0
ds_read_b64_tr_b16 a[116:117], v7 offset:16384
s_add_u32 m0, s51, 12288
v_mfma_f32_16x16x32_bf16 v[76:79], a[60:63], a[4:7], 0
buffer_load_dwordx4 v9, s[8:11], s43 offen lds
v_mfma_f32_16x16x32_bf16 v[80:83], a[32:35], a[8:11], 0
v_add_u32 v9, 262144, v9
v_mfma_f32_16x16x32_bf16 v[84:87], a[36:39], a[8:11], 0
ds_read_b64_tr_b16 a[118:119], v7 offset:16896
v_mfma_f32_16x16x32_bf16 v[88:91], a[40:43], a[8:11], 0
ds_read_b64_tr_b16 a[120:121], v4 offset:20480
v_mfma_f32_16x16x32_bf16 v[92:95], a[44:47], a[8:11], 0
s_add_u32 m0, s50, 0
v_mfma_f32_16x16x32_bf16 v[96:99], a[48:51], a[8:11], 0
buffer_load_dwordx4 v8, s[4:7], s24 offen lds
v_mfma_f32_16x16x32_bf16 v[100:103], a[52:55], a[8:11], 0
ds_read_b64_tr_b16 a[122:123], v4 offset:20992
v_mfma_f32_16x16x32_bf16 v[104:107], a[56:59], a[8:11], 0
v_mfma_f32_16x16x32_bf16 v[108:111], a[60:63], a[8:11], 0
ds_read_b64_tr_b16 a[124:125], v5 offset:20480
s_add_u32 m0, s50, 4096
v_mfma_f32_16x16x32_bf16 v[112:115], a[32:35], a[12:15], 0
buffer_load_dwordx4 v8, s[4:7], s25 offen lds
v_mfma_f32_16x16x32_bf16 v[116:119], a[36:39], a[12:15], 0
v_mfma_f32_16x16x32_bf16 v[120:123], a[40:43], a[12:15], 0
ds_read_b64_tr_b16 a[126:127], v5 offset:20992
s_add_u32 m0, s50, 8192
v_mfma_f32_16x16x32_bf16 v[124:127], a[44:47], a[12:15], 0
buffer_load_dwordx4 v8, s[4:7], s26 offen lds
v_mfma_f32_16x16x32_bf16 v[128:131], a[48:51], a[12:15], 0
v_mfma_f32_16x16x32_bf16 v[132:135], a[52:55], a[12:15], 0
ds_read_b64_tr_b16 a[128:129], v6 offset:20480
v_mfma_f32_16x16x32_bf16 v[136:139], a[56:59], a[12:15], 0
ds_read_b64_tr_b16 a[130:131], v6 offset:20992
v_mfma_f32_16x16x32_bf16 v[140:143], a[60:63], a[12:15], 0
s_add_u32 m0, s50, 12288
v_mfma_f32_16x16x32_bf16 v[144:147], a[32:35], a[16:19], 0
buffer_load_dwordx4 v8, s[4:7], s27 offen lds
v_mfma_f32_16x16x32_bf16 v[148:151], a[36:39], a[16:19], 0
ds_read_b64_tr_b16 a[132:133], v7 offset:20480
v_mfma_f32_16x16x32_bf16 v[152:155], a[40:43], a[16:19], 0
v_mfma_f32_16x16x32_bf16 v[156:159], a[44:47], a[16:19], 0
ds_read_b64_tr_b16 a[134:135], v7 offset:20992
s_add_u32 m0, s50, 16384
v_mfma_f32_16x16x32_bf16 v[160:163], a[48:51], a[16:19], 0
buffer_load_dwordx4 v8, s[4:7], s28 offen lds
v_mfma_f32_16x16x32_bf16 v[164:167], a[52:55], a[16:19], 0
v_mfma_f32_16x16x32_bf16 v[168:171], a[56:59], a[16:19], 0
ds_read_b128 a[72:75], v3 offset:0
v_mfma_f32_16x16x32_bf16 v[172:175], a[60:63], a[16:19], 0
ds_read_b128 a[76:79], v3 offset:2048
v_mfma_f32_16x16x32_bf16 v[176:179], a[32:35], a[20:23], 0
s_add_u32 m0, s50, 20480
v_mfma_f32_16x16x32_bf16 v[180:183], a[36:39], a[20:23], 0
buffer_load_dwordx4 v8, s[4:7], s29 offen lds
v_mfma_f32_16x16x32_bf16 v[184:187], a[40:43], a[20:23], 0
ds_read_b128 a[80:83], v3 offset:4096
v_mfma_f32_16x16x32_bf16 v[188:191], a[44:47], a[20:23], 0
v_mfma_f32_16x16x32_bf16 v[192:195], a[48:51], a[20:23], 0
ds_read_b128 a[84:87], v3 offset:6144
s_add_u32 m0, s50, 24576
v_mfma_f32_16x16x32_bf16 v[196:199], a[52:55], a[20:23], 0
buffer_load_dwordx4 v8, s[4:7], s30 offen lds
v_mfma_f32_16x16x32_bf16 v[200:203], a[56:59], a[20:23], 0
v_mfma_f32_16x16x32_bf16 v[204:207], a[60:63], a[20:23], 0
ds_read_b128 a[88:91], v3 offset:8192
v_mfma_f32_16x16x32_bf16 v[208:211], a[32:35], a[24:27], 0
ds_read_b128 a[92:95], v3 offset:10240
v_mfma_f32_16x16x32_bf16 v[212:215], a[36:39], a[24:27], 0
s_add_u32 m0, s50, 28672
v_mfma_f32_16x16x32_bf16 v[216:219], a[40:43], a[24:27], 0
buffer_load_dwordx4 v8, s[4:7], s31 offen lds
v_mfma_f32_16x16x32_bf16 v[220:223], a[44:47], a[24:27], 0
ds_read_b128 a[96:99], v3 offset:12288
v_add_u32 v8, 128, v8
v_mfma_f32_16x16x32_bf16 v[224:227], a[48:51], a[24:27], 0
v_mfma_f32_16x16x32_bf16 v[228:231], a[52:55], a[24:27], 0
buffer_load_dword v14, v15, s[76:79], 0 offen sc0 sc1
v_mfma_f32_16x16x32_bf16 v[232:235], a[56:59], a[24:27], 0
ds_read_b128 a[100:103], v3 offset:14336
v_mfma_f32_16x16x32_bf16 v[236:239], a[60:63], a[24:27], 0
v_mfma_f32_16x16x32_bf16 v[240:243], a[32:35], a[28:31], 0
v_mfma_f32_16x16x32_bf16 v[244:247], a[36:39], a[28:31], 0
v_mfma_f32_16x16x32_bf16 v[248:251], a[40:43], a[28:31], 0
v_mfma_f32_16x16x32_bf16 v[252:255], a[44:47], a[28:31], 0
v_mfma_f32_16x16x32_bf16 a[144:147], a[48:51], a[28:31], 0
v_mfma_f32_16x16x32_bf16 a[148:151], a[52:55], a[28:31], 0
v_mfma_f32_16x16x32_bf16 a[152:155], a[56:59], a[28:31], 0
v_mfma_f32_16x16x32_bf16 a[156:159], a[60:63], a[28:31], 0
s_waitcnt vmcnt(16) lgkmcnt(0)
s_barrier
v_mfma_f32_16x16x32_bf16 v[16:19], a[104:107], a[72:75], v[16:19]
s_add_u32 s50, s49, s51
s_add_u32 s49, s49, 32768
s_cmp_eq_u32 s49, 163840
v_mfma_f32_16x16x32_bf16 v[20:23], a[108:111], a[72:75], v[20:23]
s_cselect_b32 s49, 65536, s49
v_add_u32 v2, s49, v1
v_xor_b32 v3, 64, v2
v_mfma_f32_16x16x32_bf16 v[24:27], a[112:115], a[72:75], v[24:27]
ds_read_b64_tr_b16 a[32:33], v4 offset:32768
v_mfma_f32_16x16x32_bf16 v[28:31], a[116:119], a[72:75], v[28:31]
ds_read_b64_tr_b16 a[34:35], v4 offset:33280
v_mfma_f32_16x16x32_bf16 v[32:35], a[120:123], a[72:75], v[32:35]
ds_read_b64_tr_b16 a[36:37], v5 offset:32768
v_mfma_f32_16x16x32_bf16 v[36:39], a[124:127], a[72:75], v[36:39]
v_mfma_f32_16x16x32_bf16 v[40:43], a[128:131], a[72:75], v[40:43]
ds_read_b64_tr_b16 a[38:39], v5 offset:33280
s_add_u32 m0, s51, 16384
v_mfma_f32_16x16x32_bf16 v[44:47], a[132:135], a[72:75], v[44:47]
buffer_load_dwordx4 v9, s[8:11], s40 offen lds
v_mfma_f32_16x16x32_bf16 v[48:51], a[104:107], a[76:79], v[48:51]
v_mfma_f32_16x16x32_bf16 v[52:55], a[108:111], a[76:79], v[52:55]
ds_read_b64_tr_b16 a[40:41], v6 offset:32768
v_mfma_f32_16x16x32_bf16 v[56:59], a[112:115], a[76:79], v[56:59]
ds_read_b64_tr_b16 a[42:43], v6 offset:33280
v_mfma_f32_16x16x32_bf16 v[60:63], a[116:119], a[76:79], v[60:63]
v_mfma_f32_16x16x32_bf16 v[64:67], a[120:123], a[76:79], v[64:67]
ds_read_b64_tr_b16 a[44:45], v7 offset:32768
v_mfma_f32_16x16x32_bf16 v[68:71], a[124:127], a[76:79], v[68:71]
ds_read_b64_tr_b16 a[46:47], v7 offset:33280
v_mfma_f32_16x16x32_bf16 v[72:75], a[128:131], a[76:79], v[72:75]
v_mfma_f32_16x16x32_bf16 v[76:79], a[132:135], a[76:79], v[76:79]
ds_read_b64_tr_b16 a[48:49], v4 offset:36864
s_add_u32 m0, s51, 20480
v_mfma_f32_16x16x32_bf16 v[80:83], a[104:107], a[80:83], v[80:83]
buffer_load_dwordx4 v9, s[8:11], s41 offen lds
v_mfma_f32_16x16x32_bf16 v[84:87], a[108:111], a[80:83], v[84:87]
v_mfma_f32_16x16x32_bf16 v[88:91], a[112:115], a[80:83], v[88:91]
ds_read_b64_tr_b16 a[50:51], v4 offset:37376
v_mfma_f32_16x16x32_bf16 v[92:95], a[116:119], a[80:83], v[92:95]
ds_read_b64_tr_b16 a[52:53], v5 offset:36864
v_mfma_f32_16x16x32_bf16 v[96:99], a[120:123], a[80:83], v[96:99]
v_mfma_f32_16x16x32_bf16 v[100:103], a[124:127], a[80:83], v[100:103]
ds_read_b64_tr_b16 a[54:55], v5 offset:37376
v_mfma_f32_16x16x32_bf16 v[104:107], a[128:131], a[80:83], v[104:107]
ds_read_b64_tr_b16 a[56:57], v6 offset:36864
v_mfma_f32_16x16x32_bf16 v[108:111], a[132:135], a[80:83], v[108:111]
v_mfma_f32_16x16x32_bf16 v[112:115], a[104:107], a[84:87], v[112:115]
ds_read_b64_tr_b16 a[58:59], v6 offset:37376
s_add_u32 m0, s51, 24576
v_mfma_f32_16x16x32_bf16 v[116:119], a[108:111], a[84:87], v[116:119]
buffer_load_dwordx4 v9, s[8:11], s42 offen lds
v_mfma_f32_16x16x32_bf16 v[120:123], a[112:115], a[84:87], v[120:123]
v_mfma_f32_16x16x32_bf16 v[124:127], a[116:119], a[84:87], v[124:127]
ds_read_b64_tr_b16 a[60:61], v7 offset:36864
v_mfma_f32_16x16x32_bf16 v[128:131], a[120:123], a[84:87], v[128:131]
ds_read_b64_tr_b16 a[62:63], v7 offset:37376
v_mfma_f32_16x16x32_bf16 v[132:135], a[124:127], a[84:87], v[132:135]
v_mfma_f32_16x16x32_bf16 v[136:139], a[128:131], a[84:87], v[136:139]
ds_read_b128 a[0:3], v2 offset:0
v_mfma_f32_16x16x32_bf16 v[140:143], a[132:135], a[84:87], v[140:143]
ds_read_b128 a[4:7], v2 offset:2048
v_mfma_f32_16x16x32_bf16 v[144:147], a[104:107], a[88:91], v[144:147]
v_mfma_f32_16x16x32_bf16 v[148:151], a[108:111], a[88:91], v[148:151]
ds_read_b128 a[8:11], v2 offset:4096
s_add_u32 m0, s51, 28672
v_mfma_f32_16x16x32_bf16 v[152:155], a[112:115], a[88:91], v[152:155]
buffer_load_dwordx4 v9, s[8:11], s43 offen lds
v_mfma_f32_16x16x32_bf16 v[156:159], a[116:119], a[88:91], v[156:159]
v_add_u32 v9, 262144, v9
v_mfma_f32_16x16x32_bf16 v[160:163], a[120:123], a[88:91], v[160:163]
ds_read_b128 a[12:15], v2 offset:6144
v_mfma_f32_16x16x32_bf16 v[164:167], a[124:127], a[88:91], v[164:167]
ds_read_b128 a[16:19], v2 offset:8192
v_mfma_f32_16x16x32_bf16 v[168:171], a[128:131], a[88:91], v[168:171]
v_mfma_f32_16x16x32_bf16 v[172:175], a[132:135], a[88:91], v[172:175]
ds_read_b128 a[20:23], v2 offset:10240
v_mfma_f32_16x16x32_bf16 v[176:179], a[104:107], a[92:95], v[176:179]
ds_read_b128 a[24:27], v2 offset:12288
v_mfma_f32_16x16x32_bf16 v[180:183], a[108:111], a[92:95], v[180:183]
v_mfma_f32_16x16x32_bf16 v[184:187], a[112:115], a[92:95], v[184:187]
buffer_load_dwordx4 a[136:139], v12, s[56:59], s96 offen
v_mfma_f32_16x16x32_bf16 v[188:191], a[116:119], a[92:95], v[188:191]
ds_read_b128 a[28:31], v2 offset:14336
v_mfma_f32_16x16x32_bf16 v[192:195], a[120:123], a[92:95], v[192:195]
v_mfma_f32_16x16x32_bf16 v[196:199], a[124:127], a[92:95], v[196:199]
v_mfma_f32_16x16x32_bf16 v[200:203], a[128:131], a[92:95], v[200:203]
v_mfma_f32_16x16x32_bf16 v[204:207], a[132:135], a[92:95], v[204:207]
v_mfma_f32_16x16x32_bf16 v[208:211], a[104:107], a[96:99], v[208:211]
v_mfma_f32_16x16x32_bf16 v[212:215], a[108:111], a[96:99], v[212:215]
v_mfma_f32_16x16x32_bf16 v[216:219], a[112:115], a[96:99], v[216:219]
v_mfma_f32_16x16x32_bf16 v[220:223], a[116:119], a[96:99], v[220:223]
v_mfma_f32_16x16x32_bf16 v[224:227], a[120:123], a[96:99], v[224:227]
v_mfma_f32_16x16x32_bf16 v[228:231], a[124:127], a[96:99], v[228:231]
v_mfma_f32_16x16x32_bf16 v[232:235], a[128:131], a[96:99], v[232:235]
v_mfma_f32_16x16x32_bf16 v[236:239], a[132:135], a[96:99], v[236:239]
v_mfma_f32_16x16x32_bf16 v[240:243], a[104:107], a[100:103], v[240:243]
v_mfma_f32_16x16x32_bf16 v[244:247], a[108:111], a[100:103], v[244:247]
v_mfma_f32_16x16x32_bf16 v[248:251], a[112:115], a[100:103], v[248:251]
v_mfma_f32_16x16x32_bf16 v[252:255], a[116:119], a[100:103], v[252:255]
v_mfma_f32_16x16x32_bf16 a[144:147], a[120:123], a[100:103], a[144:147]
v_mfma_f32_16x16x32_bf16 a[148:151], a[124:127], a[100:103], a[148:151]
v_mfma_f32_16x16x32_bf16 a[152:155], a[128:131], a[100:103], a[152:155]
v_mfma_f32_16x16x32_bf16 a[156:159], a[132:135], a[100:103], a[156:159]
s_waitcnt vmcnt(16) lgkmcnt(0)
s_barrier
v_mfma_f32_16x16x32_bf16 v[16:19], a[32:35], a[0:3], v[16:19]
v_mfma_f32_16x16x32_bf16 v[20:23], a[36:39], a[0:3], v[20:23]
ds_read_b64_tr_b16 a[104:105], v4 offset:49152
s_add_u32 m0, s51, 32768
v_mfma_f32_16x16x32_bf16 v[24:27], a[40:43], a[0:3], v[24:27]
buffer_load_dwordx4 v9, s[8:11], s40 offen lds
v_mfma_f32_16x16x32_bf16 v[28:31], a[44:47], a[0:3], v[28:31]
v_mfma_f32_16x16x32_bf16 v[32:35], a[48:51], a[0:3], v[32:35]
ds_read_b64_tr_b16 a[106:107], v4 offset:49664
v_mfma_f32_16x16x32_bf16 v[36:39], a[52:55], a[0:3], v[36:39]
ds_read_b64_tr_b16 a[108:109], v5 offset:49152
v_mfma_f32_16x16x32_bf16 v[40:43], a[56:59], a[0:3], v[40:43]
s_add_u32 m0, s51, 36864
v_mfma_f32_16x16x32_bf16 v[44:47], a[60:63], a[0:3], v[44:47]
buffer_load_dwordx4 v9, s[8:11], s41 offen lds
v_mfma_f32_16x16x32_bf16 v[48:51], a[32:35], a[4:7], v[48:51]
ds_read_b64_tr_b16 a[110:111], v5 offset:49664
v_mfma_f32_16x16x32_bf16 v[52:55], a[36:39], a[4:7], v[52:55]
v_mfma_f32_16x16x32_bf16 v[56:59], a[40:43], a[4:7], v[56:59]
ds_read_b64_tr_b16 a[112:113], v6 offset:49152
s_add_u32 m0, s51, 40960
v_mfma_f32_16x16x32_bf16 v[60:63], a[44:47], a[4:7], v[60:63]
buffer_load_dwordx4 v9, s[8:11], s42 offen lds
v_mfma_f32_16x16x32_bf16 v[64:67], a[48:51], a[4:7], v[64:67]
v_mfma_f32_16x16x32_bf16 v[68:71], a[52:55], a[4:7], v[68:71]
ds_read_b64_tr_b16 a[114:115], v6 offset:49664
v_mfma_f32_16x16x32_bf16 v[72:75], a[56:59], a[4:7], v[72:75]
ds_read_b64_tr_b16 a[116:117], v7 offset:49152
v_mfma_f32_16x16x32_bf16 v[76:79], a[60:63], a[4:7], v[76:79]
s_add_u32 m0, s51, 45056
v_mfma_f32_16x16x32_bf16 v[80:83], a[32:35], a[8:11], v[80:83]
buffer_load_dwordx4 v9, s[8:11], s43 offen lds
v_mfma_f32_16x16x32_bf16 v[84:87], a[36:39], a[8:11], v[84:87]
ds_read_b64_tr_b16 a[118:119], v7 offset:49664
v_add_u32 v9, 262144, v9
v_mfma_f32_16x16x32_bf16 v[88:91], a[40:43], a[8:11], v[88:91]
v_mfma_f32_16x16x32_bf16 v[92:95], a[44:47], a[8:11], v[92:95]
ds_read_b64_tr_b16 a[120:121], v4 offset:53248
s_add_u32 m0, s50, 0
v_mfma_f32_16x16x32_bf16 v[96:99], a[48:51], a[8:11], v[96:99]
buffer_load_dwordx4 v8, s[4:7], s24 offen lds
v_mfma_f32_16x16x32_bf16 v[100:103], a[52:55], a[8:11], v[100:103]
v_mfma_f32_16x16x32_bf16 v[104:107], a[56:59], a[8:11], v[104:107]
ds_read_b64_tr_b16 a[122:123], v4 offset:53760
v_mfma_f32_16x16x32_bf16 v[108:111], a[60:63], a[8:11], v[108:111]
ds_read_b64_tr_b16 a[124:125], v5 offset:53248
v_mfma_f32_16x16x32_bf16 v[112:115], a[32:35], a[12:15], v[112:115]
s_add_u32 m0, s50, 4096
v_mfma_f32_16x16x32_bf16 v[116:119], a[36:39], a[12:15], v[116:119]
buffer_load_dwordx4 v8, s[4:7], s25 offen lds
v_mfma_f32_16x16x32_bf16 v[120:123], a[40:43], a[12:15], v[120:123]
ds_read_b64_tr_b16 a[126:127], v5 offset:53760
v_mfma_f32_16x16x32_bf16 v[124:127], a[44:47], a[12:15], v[124:127]
v_mfma_f32_16x16x32_bf16 v[128:131], a[48:51], a[12:15], v[128:131]
ds_read_b64_tr_b16 a[128:129], v6 offset:53248
s_add_u32 m0, s50, 8192
v_mfma_f32_16x16x32_bf16 v[132:135], a[52:55], a[12:15], v[132:135]
buffer_load_dwordx4 v8, s[4:7], s26 offen lds
v_mfma_f32_16x16x32_bf16 v[136:139], a[56:59], a[12:15], v[136:139]
v_mfma_f32_16x16x32_bf16 v[140:143], a[60:63], a[12:15], v[140:143]
ds_read_b64_tr_b16 a[130:131], v6 offset:53760
v_mfma_f32_16x16x32_bf16 v[144:147], a[32:35], a[16:19], v[144:147]
ds_read_b64_tr_b16 a[132:133], v7 offset:53248
v_mfma_f32_16x16x32_bf16 v[148:151], a[36:39], a[16:19], v[148:151]
s_add_u32 m0, s50, 12288
v_mfma_f32_16x16x32_bf16 v[152:155], a[40:43], a[16:19], v[152:155]
buffer_load_dwordx4 v8, s[4:7], s27 offen lds
v_mfma_f32_16x16x32_bf16 v[156:159], a[44:47], a[16:19], v[156:159]
ds_read_b64_tr_b16 a[134:135], v7 offset:53760
v_mfma_f32_16x16x32_bf16 v[160:163], a[48:51], a[16:19], v[160:163]
v_mfma_f32_16x16x32_bf16 v[164:167], a[52:55], a[16:19], v[164:167]
ds_read_b128 a[72:75], v3 offset:0
s_add_u32 m0, s50, 16384
v_mfma_f32_16x16x32_bf16 v[168:171], a[56:59], a[16:19], v[168:171]
buffer_load_dwordx4 v8, s[4:7], s28 offen lds
v_mfma_f32_16x16x32_bf16 v[172:175], a[60:63], a[16:19], v[172:175]
v_mfma_f32_16x16x32_bf16 v[176:179], a[32:35], a[20:23], v[176:179]
ds_read_b128 a[76:79], v3 offset:2048
v_mfma_f32_16x16x32_bf16 v[180:183], a[36:39], a[20:23], v[180:183]
ds_read_b128 a[80:83], v3 offset:4096
v_mfma_f32_16x16x32_bf16 v[184:187], a[40:43], a[20:23], v[184:187]
s_add_u32 m0, s50, 20480
v_mfma_f32_16x16x32_bf16 v[188:191], a[44:47], a[20:23], v[188:191]
buffer_load_dwordx4 v8, s[4:7], s29 offen lds
v_mfma_f32_16x16x32_bf16 v[192:195], a[48:51], a[20:23], v[192:195]
ds_read_b128 a[84:87], v3 offset:6144
v_mfma_f32_16x16x32_bf16 v[196:199], a[52:55], a[20:23], v[196:199]
v_mfma_f32_16x16x32_bf16 v[200:203], a[56:59], a[20:23], v[200:203]
ds_read_b128 a[88:91], v3 offset:8192
s_add_u32 m0, s50, 24576
v_mfma_f32_16x16x32_bf16 v[204:207], a[60:63], a[20:23], v[204:207]
buffer_load_dwordx4 v8, s[4:7], s30 offen lds
v_mfma_f32_16x16x32_bf16 v[208:211], a[32:35], a[24:27], v[208:211]
v_mfma_f32_16x16x32_bf16 v[212:215], a[36:39], a[24:27], v[212:215]
ds_read_b128 a[92:95], v3 offset:10240
v_mfma_f32_16x16x32_bf16 v[216:219], a[40:43], a[24:27], v[216:219]
ds_read_b128 a[96:99], v3 offset:12288
v_mfma_f32_16x16x32_bf16 v[220:223], a[44:47], a[24:27], v[220:223]
s_add_u32 m0, s50, 28672
v_mfma_f32_16x16x32_bf16 v[224:227], a[48:51], a[24:27], v[224:227]
buffer_load_dwordx4 v8, s[4:7], s31 offen lds
v_mfma_f32_16x16x32_bf16 v[228:231], a[52:55], a[24:27], v[228:231]
ds_read_b128 a[100:103], v3 offset:14336
v_add_u32 v8, 128, v8
v_mfma_f32_16x16x32_bf16 v[232:235], a[56:59], a[24:27], v[232:235]
v_mfma_f32_16x16x32_bf16 v[236:239], a[60:63], a[24:27], v[236:239]
v_mfma_f32_16x16x32_bf16 v[240:243], a[32:35], a[28:31], v[240:243]
v_mfma_f32_16x16x32_bf16 v[244:247], a[36:39], a[28:31], v[244:247]
v_mfma_f32_16x16x32_bf16 v[248:251], a[40:43], a[28:31], v[248:251]
v_mfma_f32_16x16x32_bf16 v[252:255], a[44:47], a[28:31], v[252:255]
v_mfma_f32_16x16x32_bf16 a[144:147], a[48:51], a[28:31], a[144:147]
v_mfma_f32_16x16x32_bf16 a[148:151], a[52:55], a[28:31], a[148:151]
v_mfma_f32_16x16x32_bf16 a[152:155], a[56:59], a[28:31], a[152:155]
v_mfma_f32_16x16x32_bf16 a[156:159], a[60:63], a[28:31], a[156:159]
s_waitcnt vmcnt(16) lgkmcnt(0)
s_barrier
v_mfma_f32_16x16x32_bf16 v[16:19], a[104:107], a[72:75], v[16:19]
s_add_u32 s50, s49, s51
s_add_u32 s49, s49, 32768
s_cmp_eq_u32 s49, 163840
v_mfma_f32_16x16x32_bf16 v[20:23], a[108:111], a[72:75], v[20:23]
s_cselect_b32 s49, 65536, s49
v_add_u32 v2, s49, v1
v_xor_b32 v3, 64, v2
v_mfma_f32_16x16x32_bf16 v[24:27], a[112:115], a[72:75], v[24:27]
ds_read_b64_tr_b16 a[32:33], v4 offset:0
v_mfma_f32_16x16x32_bf16 v[28:31], a[116:119], a[72:75], v[28:31]
ds_read_b64_tr_b16 a[34:35], v4 offset:512
v_mfma_f32_16x16x32_bf16 v[32:35], a[120:123], a[72:75], v[32:35]
v_mfma_f32_16x16x32_bf16 v[36:39], a[124:127], a[72:75], v[36:39]
ds_read_b64_tr_b16 a[36:37], v5 offset:0
v_mfma_f32_16x16x32_bf16 v[40:43], a[128:131], a[72:75], v[40:43]
ds_read_b64_tr_b16 a[38:39], v5 offset:512
v_mfma_f32_16x16x32_bf16 v[44:47], a[132:135], a[72:75], v[44:47]
v_mfma_f32_16x16x32_bf16 v[48:51], a[104:107], a[76:79], v[48:51]
ds_read_b64_tr_b16 a[40:41], v6 offset:0
s_add_u32 m0, s51, 49152
v_mfma_f32_16x16x32_bf16 v[52:55], a[108:111], a[76:79], v[52:55]
buffer_load_dwordx4 v9, s[8:11], s40 offen lds
v_mfma_f32_16x16x32_bf16 v[56:59], a[112:115], a[76:79], v[56:59]
v_mfma_f32_16x16x32_bf16 v[60:63], a[116:119], a[76:79], v[60:63]
ds_read_b64_tr_b16 a[42:43], v6 offset:512
v_mfma_f32_16x16x32_bf16 v[64:67], a[120:123], a[76:79], v[64:67]
ds_read_b64_tr_b16 a[44:45], v7 offset:0
v_mfma_f32_16x16x32_bf16 v[68:71], a[124:127], a[76:79], v[68:71]
v_mfma_f32_16x16x32_bf16 v[72:75], a[128:131], a[76:79], v[72:75]
ds_read_b64_tr_b16 a[46:47], v7 offset:512
v_mfma_f32_16x16x32_bf16 v[76:79], a[132:135], a[76:79], v[76:79]
ds_read_b64_tr_b16 a[48:49], v4 offset:4096
v_mfma_f32_16x16x32_bf16 v[80:83], a[104:107], a[80:83], v[80:83]
v_mfma_f32_16x16x32_bf16 v[84:87], a[108:111], a[80:83], v[84:87]
ds_read_b64_tr_b16 a[50:51], v4 offset:4608
v_mfma_f32_16x16x32_bf16 v[88:91], a[112:115], a[80:83], v[88:91]
ds_read_b64_tr_b16 a[52:53], v5 offset:4096
v_mfma_f32_16x16x32_bf16 v[92:95], a[116:119], a[80:83], v[92:95]
s_add_u32 m0, s51, 53248
v_mfma_f32_16x16x32_bf16 v[96:99], a[120:123], a[80:83], v[96:99]
buffer_load_dwordx4 v9, s[8:11], s41 offen lds
v_mfma_f32_16x16x32_bf16 v[100:103], a[124:127], a[80:83], v[100:103]
ds_read_b64_tr_b16 a[54:55], v5 offset:4608
v_mfma_f32_16x16x32_bf16 v[104:107], a[128:131], a[80:83], v[104:107]
v_mfma_f32_16x16x32_bf16 v[108:111], a[132:135], a[80:83], v[108:111]
ds_read_b64_tr_b16 a[56:57], v6 offset:4096
v_mfma_f32_16x16x32_bf16 v[112:115], a[104:107], a[84:87], v[112:115]
ds_read_b64_tr_b16 a[58:59], v6 offset:4608
v_mfma_f32_16x16x32_bf16 v[116:119], a[108:111], a[84:87], v[116:119]
v_mfma_f32_16x16x32_bf16 v[120:123], a[112:115], a[84:87], v[120:123]
ds_read_b64_tr_b16 a[60:61], v7 offset:4096
v_mfma_f32_16x16x32_bf16 v[124:127], a[116:119], a[84:87], v[124:127]
ds_read_b64_tr_b16 a[62:63], v7 offset:4608
v_mfma_f32_16x16x32_bf16 v[128:131], a[120:123], a[84:87], v[128:131]
v_mfma_f32_16x16x32_bf16 v[132:135], a[124:127], a[84:87], v[132:135]
ds_read_b128 a[0:3], v2 offset:0
s_add_u32 m0, s51, 57344
v_mfma_f32_16x16x32_bf16 v[136:139], a[128:131], a[84:87], v[136:139]
buffer_load_dwordx4 v9, s[8:11], s42 offen lds
v_mfma_f32_16x16x32_bf16 v[140:143], a[132:135], a[84:87], v[140:143]
v_mfma_f32_16x16x32_bf16 v[144:147], a[104:107], a[88:91], v[144:147]
ds_read_b128 a[4:7], v2 offset:2048
v_mfma_f32_16x16x32_bf16 v[148:151], a[108:111], a[88:91], v[148:151]
ds_read_b128 a[8:11], v2 offset:4096
v_mfma_f32_16x16x32_bf16 v[152:155], a[112:115], a[88:91], v[152:155]
v_mfma_f32_16x16x32_bf16 v[156:159], a[116:119], a[88:91], v[156:159]
ds_read_b128 a[12:15], v2 offset:6144
v_mfma_f32_16x16x32_bf16 v[160:163], a[120:123], a[88:91], v[160:163]
ds_read_b128 a[16:19], v2 offset:8192
v_mfma_f32_16x16x32_bf16 v[164:167], a[124:127], a[88:91], v[164:167]
v_mfma_f32_16x16x32_bf16 v[168:171], a[128:131], a[88:91], v[168:171]
ds_read_b128 a[20:23], v2 offset:10240
v_mfma_f32_16x16x32_bf16 v[172:175], a[132:135], a[88:91], v[172:175]
ds_read_b128 a[24:27], v2 offset:12288
v_mfma_f32_16x16x32_bf16 v[176:179], a[104:107], a[92:95], v[176:179]
s_add_u32 m0, s51, 61440
v_mfma_f32_16x16x32_bf16 v[180:183], a[108:111], a[92:95], v[180:183]
buffer_load_dwordx4 v9, s[8:11], s43 offen lds
v_mfma_f32_16x16x32_bf16 v[184:187], a[112:115], a[92:95], v[184:187]
ds_read_b128 a[28:31], v2 offset:14336
v_add_u32 v9, 262144, v9
v_mfma_f32_16x16x32_bf16 v[188:191], a[116:119], a[92:95], v[188:191]
v_mfma_f32_16x16x32_bf16 v[192:195], a[120:123], a[92:95], v[192:195]
v_mfma_f32_16x16x32_bf16 v[196:199], a[124:127], a[92:95], v[196:199]
v_mfma_f32_16x16x32_bf16 v[200:203], a[128:131], a[92:95], v[200:203]
v_mfma_f32_16x16x32_bf16 v[204:207], a[132:135], a[92:95], v[204:207]
v_mfma_f32_16x16x32_bf16 v[208:211], a[104:107], a[96:99], v[208:211]
v_mfma_f32_16x16x32_bf16 v[212:215], a[108:111], a[96:99], v[212:215]
v_mfma_f32_16x16x32_bf16 v[216:219], a[112:115], a[96:99], v[216:219]
v_mfma_f32_16x16x32_bf16 v[220:223], a[116:119], a[96:99], v[220:223]
v_mfma_f32_16x16x32_bf16 v[224:227], a[120:123], a[96:99], v[224:227]
v_mfma_f32_16x16x32_bf16 v[228:231], a[124:127], a[96:99], v[228:231]
v_mfma_f32_16x16x32_bf16 v[232:235], a[128:131], a[96:99], v[232:235]
v_mfma_f32_16x16x32_bf16 v[236:239], a[132:135], a[96:99], v[236:239]
v_mfma_f32_16x16x32_bf16 v[240:243], a[104:107], a[100:103], v[240:243]
v_mfma_f32_16x16x32_bf16 v[244:247], a[108:111], a[100:103], v[244:247]
v_mfma_f32_16x16x32_bf16 v[248:251], a[112:115], a[100:103], v[248:251]
v_mfma_f32_16x16x32_bf16 v[252:255], a[116:119], a[100:103], v[252:255]
v_mfma_f32_16x16x32_bf16 a[144:147], a[120:123], a[100:103], a[144:147]
v_mfma_f32_16x16x32_bf16 a[148:151], a[124:127], a[100:103], a[148:151]
v_mfma_f32_16x16x32_bf16 a[152:155], a[128:131], a[100:103], a[152:155]
v_mfma_f32_16x16x32_bf16 a[156:159], a[132:135], a[100:103], a[156:159]
v_readfirstlane_b32 s89, v14
s_load_dwordx2 s[96:97], s[0:1], 64
s_cmp_lg_u32 s89, 0
s_cbranch_scc0 LM_tagKwait
LM_tagKret:
s_cmp_eq_u32 s65, 2
s_cbranch_scc1 LM_nogK
s_cmp_lg_u32 s48, 0
s_cbranch_scc1 LM_noflgK
v_mov_b32 v14, s89
v_mov_b32 v15, 0
s_mov_b64 exec, 1
buffer_store_dword v14, v15, s[20:23], s3 offen sc0 sc1
s_mov_b64 exec, -1
LM_noflgK:
LM_nogK:
s_cmp_lt_u32 s48, 2
s_waitcnt lgkmcnt(0)
s_cselect_b32 s76, s86, s96
s_cselect_b32 s77, s87, s97
s_mov_b32 s78, 3670016
s_mov_b32 s56, s82
s_mov_b32 s57, s83
s_cselect_b32 s58, 1835008, 0
s_mov_b32 s59, 0x20000
s_and_b32 s53, s48, 1
s_mul_i32 s54, s53, 7168
s_mul_i32 s96, s2, 14336
s_add_u32 s96, s96, s54
s_mul_i32 s54, s53, 3584
s_mul_i32 s97, s2, 7168
s_add_u32 s97, s97, s54
s_mov_b32 s52, 6
buffer_load_dwordx4 a[136:139], v12, s[76:79], s96 offen
s_add_u32 s96, s96, 1024
.p2align 6
LM_loopK:
s_waitcnt vmcnt(16) lgkmcnt(0)
s_barrier
v_mfma_f32_16x16x32_bf16 v[16:19], a[32:35], a[0:3], v[16:19]
v_mfma_f32_16x16x32_bf16 v[20:23], a[36:39], a[0:3], v[20:23]
ds_read_b64_tr_b16 a[104:105], v4 offset:16384
s_add_u32 m0, s51, 0
v_mfma_f32_16x16x32_bf16 v[24:27], a[40:43], a[0:3], v[24:27]
buffer_load_dwordx4 v9, s[8:11], s40 offen lds
v_mfma_f32_16x16x32_bf16 v[28:31], a[44:47], a[0:3], v[28:31]
v_mfma_f32_16x16x32_bf16 v[32:35], a[48:51], a[0:3], v[32:35]
ds_read_b64_tr_b16 a[106:107], v4 offset:16896
v_mfma_f32_16x16x32_bf16 v[36:39], a[52:55], a[0:3], v[36:39]
ds_read_b64_tr_b16 a[108:109], v5 offset:16384
v_mfma_f32_16x16x32_bf16 v[40:43], a[56:59], a[0:3], v[40:43]
s_add_u32 m0, s51, 4096
v_mfma_f32_16x16x32_bf16 v[44:47], a[60:63], a[0:3], v[44:47]
buffer_load_dwordx4 v9, s[8:11], s41 offen lds
v_mfma_f32_16x16x32_bf16 v[48:51], a[32:35], a[4:7], v[48:51]
ds_read_b64_tr_b16 a[110:111], v5 offset:16896
v_mfma_f32_16x16x32_bf16 v[52:55], a[36:39], a[4:7], v[52:55]
v_mfma_f32_16x16x32_bf16 v[56:59], a[40:43], a[4:7], v[56:59]
ds_read_b64_tr_b16 a[112:113], v6 offset:16384
s_add_u32 m0, s51, 8192
v_mfma_f32_16x16x32_bf16 v[60:63], a[44:47], a[4:7], v[60:63]
buffer_load_dwordx4 v9, s[8:11], s42 offen lds
v_mfma_f32_16x16x32_bf16 v[64:67], a[48:51], a[4:7], v[64:67]
v_mfma_f32_16x16x32_bf16 v[68:71], a[52:55], a[4:7], v[68:71]
ds_read_b64_tr_b16 a[114:115], v6 offset:16896
v_mfma_f32_16x16x32_bf16 v[72:75], a[56:59], a[4:7], v[72:75]
ds_read_b64_tr_b16 a[116:117], v7 offset:16384
v_mfma_f32_16x16x32_bf16 v[76:79], a[60:63], a[4:7], v[76:79]
s_add_u32 m0, s51, 12288
v_mfma_f32_16x16x32_bf16 v[80:83], a[32:35], a[8:11], v[80:83]
buffer_load_dwordx4 v9, s[8:11], s43 offen lds
v_mfma_f32_16x16x32_bf16 v[84:87], a[36:39], a[8:11], v[84:87]
ds_read_b64_tr_b16 a[118:119], v7 offset:16896
v_add_u32 v9, 262144, v9
v_mfma_f32_16x16x32_bf16 v[88:91], a[40:43], a[8:11], v[88:91]
v_mfma_f32_16x16x32_bf16 v[92:95], a[44:47], a[8:11], v[92:95]
ds_read_b64_tr_b16 a[120:121], v4 offset:20480
s_add_u32 m0, s50, 0
v_mfma_f32_16x16x32_bf16 v[96:99], a[48:51], a[8:11], v[96:99]
buffer_load_dwordx4 v8, s[4:7], s24 offen lds
v_mfma_f32_16x16x32_bf16 v[100:103], a[52:55], a[8:11], v[100:103]
v_mfma_f32_16x16x32_bf16 v[104:107], a[56:59], a[8:11], v[104:107]
ds_read_b64_tr_b16 a[122:123], v4 offset:20992
v_mfma_f32_16x16x32_bf16 v[108:111], a[60:63], a[8:11], v[108:111]
ds_read_b64_tr_b16 a[124:125], v5 offset:20480
v_mfma_f32_16x16x32_bf16 v[112:115], a[32:35], a[12:15], v[112:115]
s_add_u32 m0, s50, 4096
v_mfma_f32_16x16x32_bf16 v[116:119], a[36:39], a[12:15], v[116:119]
buffer_load_dwordx4 v8, s[4:7], s25 offen lds
v_mfma_f32_16x16x32_bf16 v[120:123], a[40:43], a[12:15], v[120:123]
ds_read_b64_tr_b16 a[126:127], v5 offset:20992
v_mfma_f32_16x16x32_bf16 v[124:127], a[44:47], a[12:15], v[124:127]
v_mfma_f32_16x16x32_bf16 v[128:131], a[48:51], a[12:15], v[128:131]
ds_read_b64_tr_b16 a[128:129], v6 offset:20480
s_add_u32 m0, s50, 8192
v_mfma_f32_16x16x32_bf16 v[132:135], a[52:55], a[12:15], v[132:135]
buffer_load_dwordx4 v8, s[4:7], s26 offen lds
v_mfma_f32_16x16x32_bf16 v[136:139], a[56:59], a[12:15], v[136:139]
v_mfma_f32_16x16x32_bf16 v[140:143], a[60:63], a[12:15], v[140:143]
ds_read_b64_tr_b16 a[130:131], v6 offset:20992
v_mfma_f32_16x16x32_bf16 v[144:147], a[32:35], a[16:19], v[144:147]
ds_read_b64_tr_b16 a[132:133], v7 offset:20480
v_mfma_f32_16x16x32_bf16 v[148:151], a[36:39], a[16:19], v[148:151]
s_add_u32 m0, s50, 12288
v_mfma_f32_16x16x32_bf16 v[152:155], a[40:43], a[16:19], v[152:155]
buffer_load_dwordx4 v8, s[4:7], s27 offen lds
v_mfma_f32_16x16x32_bf16 v[156:159], a[44:47], a[16:19], v[156:159]
ds_read_b64_tr_b16 a[134:135], v7 offset:20992
v_mfma_f32_16x16x32_bf16 v[160:163], a[48:51], a[16:19], v[160:163]
v_mfma_f32_16x16x32_bf16 v[164:167], a[52:55], a[16:19], v[164:167]
ds_read_b128 a[72:75], v3 offset:0
s_add_u32 m0, s50, 16384
v_mfma_f32_16x16x32_bf16 v[168:171], a[56:59], a[16:19], v[168:171]
buffer_load_dwordx4 v8, s[4:7], s28 offen lds
v_mfma_f32_16x16x32_bf16 v[172:175], a[60:63], a[16:19], v[172:175]
v_mfma_f32_16x16x32_bf16 v[176:179], a[32:35], a[20:23], v[176:179]
ds_read_b128 a[76:79], v3 offset:2048
v_mfma_f32_16x16x32_bf16 v[180:183], a[36:39], a[20:23], v[180:183]
ds_read_b128 a[80:83], v3 offset:4096
v_mfma_f32_16x16x32_bf16 v[184:187], a[40:43], a[20:23], v[184:187]
s_add_u32 m0, s50, 20480
v_mfma_f32_16x16x32_bf16 v[188:191], a[44:47], a[20:23], v[188:191]
buffer_load_dwordx4 v8, s[4:7], s29 offen lds
v_mfma_f32_16x16x32_bf16 v[192:195], a[48:51], a[20:23], v[192:195]
ds_read_b128 a[84:87], v3 offset:6144
v_mfma_f32_16x16x32_bf16 v[196:199], a[52:55], a[20:23], v[196:199]
v_mfma_f32_16x16x32_bf16 v[200:203], a[56:59], a[20:23], v[200:203]
ds_read_b128 a[88:91], v3 offset:8192
s_add_u32 m0, s50, 24576
v_mfma_f32_16x16x32_bf16 v[204:207], a[60:63], a[20:23], v[204:207]
buffer_load_dwordx4 v8, s[4:7], s30 offen lds
v_mfma_f32_16x16x32_bf16 v[208:211], a[32:35], a[24:27], v[208:211]
v_mfma_f32_16x16x32_bf16 v[212:215], a[36:39], a[24:27], v[212:215]
ds_read_b128 a[92:95], v3 offset:10240
v_mfma_f32_16x16x32_bf16 v[216:219], a[40:43], a[24:27], v[216:219]
ds_read_b128 a[96:99], v3 offset:12288
v_mfma_f32_16x16x32_bf16 v[220:223], a[44:47], a[24:27], v[220:223]
s_add_u32 m0, s50, 28672
v_mfma_f32_16x16x32_bf16 v[224:227], a[48:51], a[24:27], v[224:227]
buffer_load_dwordx4 v8, s[4:7], s31 offen lds
v_mfma_f32_16x16x32_bf16 v[228:231], a[52:55], a[24:27], v[228:231]
ds_read_b128 a[100:103], v3 offset:14336
v_add_u32 v8, 128, v8
v_mfma_f32_16x16x32_bf16 v[232:235], a[56:59], a[24:27], v[232:235]
v_mfma_f32_16x16x32_bf16 v[236:239], a[60:63], a[24:27], v[236:239]
v_mfma_f32_16x16x32_bf16 v[240:243], a[32:35], a[28:31], v[240:243]
v_mfma_f32_16x16x32_bf16 v[244:247], a[36:39], a[28:31], v[244:247]
v_mfma_f32_16x16x32_bf16 v[248:251], a[40:43], a[28:31], v[248:251]
v_mfma_f32_16x16x32_bf16 v[252:255], a[44:47], a[28:31], v[252:255]
v_mfma_f32_16x16x32_bf16 a[144:147], a[48:51], a[28:31], a[144:147]
v_mfma_f32_16x16x32_bf16 a[148:151], a[52:55], a[28:31], a[148:151]
v_mfma_f32_16x16x32_bf16 a[152:155], a[56:59], a[28:31], a[152:155]
v_mfma_f32_16x16x32_bf16 a[156:159], a[60:63], a[28:31], a[156:159]
s_waitcnt vmcnt(16) lgkmcnt(0)
s_barrier
v_mfma_f32_16x16x32_bf16 v[16:19], a[104:107], a[72:75], v[16:19]
s_add_u32 s50, s49, s51
s_add_u32 s49, s49, 32768
s_cmp_eq_u32 s49, 163840
v_mfma_f32_16x16x32_bf16 v[20:23], a[108:111], a[72:75], v[20:23]
s_cselect_b32 s49, 65536, s49
v_add_u32 v2, s49, v1
v_xor_b32 v3, 64, v2
v_mfma_f32_16x16x32_bf16 v[24:27], a[112:115], a[72:75], v[24:27]
ds_read_b64_tr_b16 a[32:33], v4 offset:32768
v_mfma_f32_16x16x32_bf16 v[28:31], a[116:119], a[72:75], v[28:31]
ds_read_b64_tr_b16 a[34:35], v4 offset:33280
v_mfma_f32_16x16x32_bf16 v[32:35], a[120:123], a[72:75], v[32:35]
v_mfma_f32_16x16x32_bf16 v[36:39], a[124:127], a[72:75], v[36:39]
ds_read_b64_tr_b16 a[36:37], v5 offset:32768
s_add_u32 m0, s51, 16384
v_mfma_f32_16x16x32_bf16 v[40:43], a[128:131], a[72:75], v[40:43]
buffer_load_dwordx4 v9, s[8:11], s40 offen lds
v_mfma_f32_16x16x32_bf16 v[44:47], a[132:135], a[72:75], v[44:47]
v_mfma_f32_16x16x32_bf16 v[48:51], a[104:107], a[76:79], v[48:51]
ds_read_b64_tr_b16 a[38:39], v5 offset:33280
v_mfma_f32_16x16x32_bf16 v[52:55], a[108:111], a[76:79], v[52:55]
ds_read_b64_tr_b16 a[40:41], v6 offset:32768
v_mfma_f32_16x16x32_bf16 v[56:59], a[112:115], a[76:79], v[56:59]
v_mfma_f32_16x16x32_bf16 v[60:63], a[116:119], a[76:79], v[60:63]
ds_read_b64_tr_b16 a[42:43], v6 offset:33280
v_mfma_f32_16x16x32_bf16 v[64:67], a[120:123], a[76:79], v[64:67]
ds_read_b64_tr_b16 a[44:45], v7 offset:32768
v_mfma_f32_16x16x32_bf16 v[68:71], a[124:127], a[76:79], v[68:71]
s_add_u32 m0, s51, 20480
v_mfma_f32_16x16x32_bf16 v[72:75], a[128:131], a[76:79], v[72:75]
buffer_load_dwordx4 v9, s[8:11], s41 offen lds
v_mfma_f32_16x16x32_bf16 v[76:79], a[132:135], a[76:79], v[76:79]
ds_read_b64_tr_b16 a[46:47], v7 offset:33280
v_mfma_f32_16x16x32_bf16 v[80:83], a[104:107], a[80:83], v[80:83]
v_mfma_f32_16x16x32_bf16 v[84:87], a[108:111], a[80:83], v[84:87]
ds_read_b64_tr_b16 a[48:49], v4 offset:36864
v_mfma_f32_16x16x32_bf16 v[88:91], a[112:115], a[80:83], v[88:91]
ds_read_b64_tr_b16 a[50:51], v4 offset:37376
v_mfma_f32_16x16x32_bf16 v[92:95], a[116:119], a[80:83], v[92:95]
v_mfma_f32_16x16x32_bf16 v[96:99], a[120:123], a[80:83], v[96:99]
ds_read_b64_tr_b16 a[52:53], v5 offset:36864
s_add_u32 m0, s51, 24576
v_mfma_f32_16x16x32_bf16 v[100:103], a[124:127], a[80:83], v[100:103]
buffer_load_dwordx4 v9, s[8:11], s42 offen lds
v_mfma_f32_16x16x32_bf16 v[104:107], a[128:131], a[80:83], v[104:107]
v_mfma_f32_16x16x32_bf16 v[108:111], a[132:135], a[80:83], v[108:111]
ds_read_b64_tr_b16 a[54:55], v5 offset:37376
v_mfma_f32_16x16x32_bf16 v[112:115], a[104:107], a[84:87], v[112:115]
ds_read_b64_tr_b16 a[56:57], v6 offset:36864
v_mfma_f32_16x16x32_bf16 v[116:119], a[108:111], a[84:87], v[116:119]
v_mfma_f32_16x16x32_bf16 v[120:123], a[112:115], a[84:87], v[120:123]
ds_read_b64_tr_b16 a[58:59], v6 offset:37376
v_mfma_f32_16x16x32_bf16 v[124:127], a[116:119], a[84:87], v[124:127]
ds_read_b64_tr_b16 a[60:61], v7 offset:36864
v_mfma_f32_16x16x32_bf16 v[128:131], a[120:123], a[84:87], v[128:131]
s_add_u32 m0, s51, 28672
v_mfma_f32_16x16x32_bf16 v[132:135], a[124:127], a[84:87], v[132:135]
buffer_load_dwordx4 v9, s[8:11], s43 offen lds
v_mfma_f32_16x16x32_bf16 v[136:139], a[128:131], a[84:87], v[136:139]
ds_read_b64_tr_b16 a[62:63], v7 offset:37376
v_add_u32 v9, 262144, v9
v_mfma_f32_16x16x32_bf16 v[140:143], a[132:135], a[84:87], v[140:143]
v_mfma_f32_16x16x32_bf16 v[144:147], a[104:107], a[88:91], v[144:147]
ds_read_b128 a[0:3], v2 offset:0
v_mfma_f32_16x16x32_bf16 v[148:151], a[108:111], a[88:91], v[148:151]
ds_read_b128 a[4:7], v2 offset:2048
v_mfma_f32_16x16x32_bf16 v[152:155], a[112:115], a[88:91], v[152:155]
v_mfma_f32_16x16x32_bf16 v[156:159], a[116:119], a[88:91], v[156:159]
ds_read_b128 a[8:11], v2 offset:4096
v_mfma_f32_16x16x32_bf16 v[160:163], a[120:123], a[88:91], v[160:163]
buffer_load_dwordx4 a[136:139], v12, s[76:79], s96 offen
v_mfma_f32_16x16x32_bf16 v[164:167], a[124:127], a[88:91], v[164:167]
v_mfma_f32_16x16x32_bf16 v[168:171], a[128:131], a[88:91], v[168:171]
ds_read_b128 a[12:15], v2 offset:6144
v_mfma_f32_16x16x32_bf16 v[172:175], a[132:135], a[88:91], v[172:175]
ds_read_b128 a[16:19], v2 offset:8192
v_mfma_f32_16x16x32_bf16 v[176:179], a[104:107], a[92:95], v[176:179]
v_mfma_f32_16x16x32_bf16 v[180:183], a[108:111], a[92:95], v[180:183]
ds_read_b128 a[20:23], v2 offset:10240
v_mfma_f32_16x16x32_bf16 v[184:187], a[112:115], a[92:95], v[184:187]
ds_read_b128 a[24:27], v2 offset:12288
v_mfma_f32_16x16x32_bf16 v[188:191], a[116:119], a[92:95], v[188:191]
v_mfma_f32_16x16x32_bf16 v[192:195], a[120:123], a[92:95], v[192:195]
buffer_load_dwordx4 a[140:143], v12, s[56:59], s97 offen
v_mfma_f32_16x16x32_bf16 v[196:199], a[124:127], a[92:95], v[196:199]
ds_read_b128 a[28:31], v2 offset:14336
v_mfma_f32_16x16x32_bf16 v[200:203], a[128:131], a[92:95], v[200:203]
v_mfma_f32_16x16x32_bf16 v[204:207], a[132:135], a[92:95], v[204:207]
v_mfma_f32_16x16x32_bf16 v[208:211], a[104:107], a[96:99], v[208:211]
v_mfma_f32_16x16x32_bf16 v[212:215], a[108:111], a[96:99], v[212:215]
v_mfma_f32_16x16x32_bf16 v[216:219], a[112:115], a[96:99], v[216:219]
v_mfma_f32_16x16x32_bf16 v[220:223], a[116:119], a[96:99], v[220:223]
v_mfma_f32_16x16x32_bf16 v[224:227], a[120:123], a[96:99], v[224:227]
v_mfma_f32_16x16x32_bf16 v[228:231], a[124:127], a[96:99], v[228:231]
v_mfma_f32_16x16x32_bf16 v[232:235], a[128:131], a[96:99], v[232:235]
v_mfma_f32_16x16x32_bf16 v[236:239], a[132:135], a[96:99], v[236:239]
v_mfma_f32_16x16x32_bf16 v[240:243], a[104:107], a[100:103], v[240:243]
v_mfma_f32_16x16x32_bf16 v[244:247], a[108:111], a[100:103], v[244:247]
v_mfma_f32_16x16x32_bf16 v[248:251], a[112:115], a[100:103], v[248:251]
s_add_u32 s96, s96, 1024
s_add_u32 s97, s97, 1024
v_mfma_f32_16x16x32_bf16 v[252:255], a[116:119], a[100:103], v[252:255]
v_mfma_f32_16x16x32_bf16 a[144:147], a[120:123], a[100:103], a[144:147]
v_mfma_f32_16x16x32_bf16 a[148:151], a[124:127], a[100:103], a[148:151]
v_mfma_f32_16x16x32_bf16 a[152:155], a[128:131], a[100:103], a[152:155]
v_mfma_f32_16x16x32_bf16 a[156:159], a[132:135], a[100:103], a[156:159]
s_waitcnt vmcnt(18) lgkmcnt(0)
s_barrier
v_mfma_f32_16x16x32_bf16 v[16:19], a[32:35], a[0:3], v[16:19]
v_mfma_f32_16x16x32_bf16 v[20:23], a[36:39], a[0:3], v[20:23]
ds_read_b64_tr_b16 a[104:105], v4 offset:49152
s_add_u32 m0, s51, 32768
v_mfma_f32_16x16x32_bf16 v[24:27], a[40:43], a[0:3], v[24:27]
buffer_load_dwordx4 v9, s[8:11], s40 offen lds
v_mfma_f32_16x16x32_bf16 v[28:31], a[44:47], a[0:3], v[28:31]
v_mfma_f32_16x16x32_bf16 v[32:35], a[48:51], a[0:3], v[32:35]
ds_read_b64_tr_b16 a[106:107], v4 offset:49664
v_mfma_f32_16x16x32_bf16 v[36:39], a[52:55], a[0:3], v[36:39]
ds_read_b64_tr_b16 a[108:109], v5 offset:49152
v_mfma_f32_16x16x32_bf16 v[40:43], a[56:59], a[0:3], v[40:43]
s_add_u32 m0, s51, 36864
v_mfma_f32_16x16x32_bf16 v[44:47], a[60:63], a[0:3], v[44:47]
buffer_load_dwordx4 v9, s[8:11], s41 offen lds
v_mfma_f32_16x16x32_bf16 v[48:51], a[32:35], a[4:7], v[48:51]
ds_read_b64_tr_b16 a[110:111], v5 offset:49664
v_mfma_f32_16x16x32_bf16 v[52:55], a[36:39], a[4:7], v[52:55]
v_mfma_f32_16x16x32_bf16 v[56:59], a[40:43], a[4:7], v[56:59]
ds_read_b64_tr_b16 a[112:113], v6 offset:49152
s_add_u32 m0, s51, 40960
v_mfma_f32_16x16x32_bf16 v[60:63], a[44:47], a[4:7], v[60:63]
buffer_load_dwordx4 v9, s[8:11], s42 offen lds
v_mfma_f32_16x16x32_bf16 v[64:67], a[48:51], a[4:7], v[64:67]
v_mfma_f32_16x16x32_bf16 v[68:71], a[52:55], a[4:7], v[68:71]
ds_read_b64_tr_b16 a[114:115], v6 offset:49664
v_mfma_f32_16x16x32_bf16 v[72:75], a[56:59], a[4:7], v[72:75]
ds_read_b64_tr_b16 a[116:117], v7 offset:49152
v_mfma_f32_16x16x32_bf16 v[76:79], a[60:63], a[4:7], v[76:79]
s_add_u32 m0, s51, 45056
v_mfma_f32_16x16x32_bf16 v[80:83], a[32:35], a[8:11], v[80:83]
buffer_load_dwordx4 v9, s[8:11], s43 offen lds
v_mfma_f32_16x16x32_bf16 v[84:87], a[36:39], a[8:11], v[84:87]
ds_read_b64_tr_b16 a[118:119], v7 offset:49664
v_add_u32 v9, 262144, v9
v_mfma_f32_16x16x32_bf16 v[88:91], a[40:43], a[8:11], v[88:91]
v_mfma_f32_16x16x32_bf16 v[92:95], a[44:47], a[8:11], v[92:95]
ds_read_b64_tr_b16 a[120:121], v4 offset:53248
s_add_u32 m0, s50, 0
v_mfma_f32_16x16x32_bf16 v[96:99], a[48:51], a[8:11], v[96:99]
buffer_load_dwordx4 v8, s[4:7], s24 offen lds
v_mfma_f32_16x16x32_bf16 v[100:103], a[52:55], a[8:11], v[100:103]
v_mfma_f32_16x16x32_bf16 v[104:107], a[56:59], a[8:11], v[104:107]
ds_read_b64_tr_b16 a[122:123], v4 offset:53760
v_mfma_f32_16x16x32_bf16 v[108:111], a[60:63], a[8:11], v[108:111]
ds_read_b64_tr_b16 a[124:125], v5 offset:53248
v_mfma_f32_16x16x32_bf16 v[112:115], a[32:35], a[12:15], v[112:115]
s_add_u32 m0, s50, 4096
v_mfma_f32_16x16x32_bf16 v[116:119], a[36:39], a[12:15], v[116:119]
buffer_load_dwordx4 v8, s[4:7], s25 offen lds
v_mfma_f32_16x16x32_bf16 v[120:123], a[40:43], a[12:15], v[120:123]
ds_read_b64_tr_b16 a[126:127], v5 offset:53760
v_mfma_f32_16x16x32_bf16 v[124:127], a[44:47], a[12:15], v[124:127]
v_mfma_f32_16x16x32_bf16 v[128:131], a[48:51], a[12:15], v[128:131]
ds_read_b64_tr_b16 a[128:129], v6 offset:53248
s_add_u32 m0, s50, 8192
v_mfma_f32_16x16x32_bf16 v[132:135], a[52:55], a[12:15], v[132:135]
buffer_load_dwordx4 v8, s[4:7], s26 offen lds
v_mfma_f32_16x16x32_bf16 v[136:139], a[56:59], a[12:15], v[136:139]
v_mfma_f32_16x16x32_bf16 v[140:143], a[60:63], a[12:15], v[140:143]
ds_read_b64_tr_b16 a[130:131], v6 offset:53760
v_mfma_f32_16x16x32_bf16 v[144:147], a[32:35], a[16:19], v[144:147]
ds_read_b64_tr_b16 a[132:133], v7 offset:53248
v_mfma_f32_16x16x32_bf16 v[148:151], a[36:39], a[16:19], v[148:151]
s_add_u32 m0, s50, 12288
v_mfma_f32_16x16x32_bf16 v[152:155], a[40:43], a[16:19], v[152:155]
buffer_load_dwordx4 v8, s[4:7], s27 offen lds
v_mfma_f32_16x16x32_bf16 v[156:159], a[44:47], a[16:19], v[156:159]
ds_read_b64_tr_b16 a[134:135], v7 offset:53760
v_mfma_f32_16x16x32_bf16 v[160:163], a[48:51], a[16:19], v[160:163]
v_mfma_f32_16x16x32_bf16 v[164:167], a[52:55], a[16:19], v[164:167]
ds_read_b128 a[72:75], v3 offset:0
s_add_u32 m0, s50, 16384
v_mfma_f32_16x16x32_bf16 v[168:171], a[56:59], a[16:19], v[168:171]
buffer_load_dwordx4 v8, s[4:7], s28 offen lds
v_mfma_f32_16x16x32_bf16 v[172:175], a[60:63], a[16:19], v[172:175]
v_mfma_f32_16x16x32_bf16 v[176:179], a[32:35], a[20:23], v[176:179]
ds_read_b128 a[76:79], v3 offset:2048
v_mfma_f32_16x16x32_bf16 v[180:183], a[36:39], a[20:23], v[180:183]
ds_read_b128 a[80:83], v3 offset:4096
v_mfma_f32_16x16x32_bf16 v[184:187], a[40:43], a[20:23], v[184:187]
s_add_u32 m0, s50, 20480
v_mfma_f32_16x16x32_bf16 v[188:191], a[44:47], a[20:23], v[188:191]
buffer_load_dwordx4 v8, s[4:7], s29 offen lds
v_mfma_f32_16x16x32_bf16 v[192:195], a[48:51], a[20:23], v[192:195]
ds_read_b128 a[84:87], v3 offset:6144
v_mfma_f32_16x16x32_bf16 v[196:199], a[52:55], a[20:23], v[196:199]
v_mfma_f32_16x16x32_bf16 v[200:203], a[56:59], a[20:23], v[200:203]
ds_read_b128 a[88:91], v3 offset:8192
s_add_u32 m0, s50, 24576
v_mfma_f32_16x16x32_bf16 v[204:207], a[60:63], a[20:23], v[204:207]
buffer_load_dwordx4 v8, s[4:7], s30 offen lds
v_mfma_f32_16x16x32_bf16 v[208:211], a[32:35], a[24:27], v[208:211]
v_mfma_f32_16x16x32_bf16 v[212:215], a[36:39], a[24:27], v[212:215]
ds_read_b128 a[92:95], v3 offset:10240
v_mfma_f32_16x16x32_bf16 v[216:219], a[40:43], a[24:27], v[216:219]
ds_read_b128 a[96:99], v3 offset:12288
v_mfma_f32_16x16x32_bf16 v[220:223], a[44:47], a[24:27], v[220:223]
s_add_u32 m0, s50, 28672
v_mfma_f32_16x16x32_bf16 v[224:227], a[48:51], a[24:27], v[224:227]
buffer_load_dwordx4 v8, s[4:7], s31 offen lds
v_mfma_f32_16x16x32_bf16 v[228:231], a[52:55], a[24:27], v[228:231]
ds_read_b128 a[100:103], v3 offset:14336
v_add_u32 v8, 128, v8
v_mfma_f32_16x16x32_bf16 v[232:235], a[56:59], a[24:27], v[232:235]
v_mfma_f32_16x16x32_bf16 v[236:239], a[60:63], a[24:27], v[236:239]
v_mfma_f32_16x16x32_bf16 v[240:243], a[32:35], a[28:31], v[240:243]
v_mfma_f32_16x16x32_bf16 v[244:247], a[36:39], a[28:31], v[244:247]
v_mfma_f32_16x16x32_bf16 v[248:251], a[40:43], a[28:31], v[248:251]
v_mfma_f32_16x16x32_bf16 v[252:255], a[44:47], a[28:31], v[252:255]
v_mfma_f32_16x16x32_bf16 a[144:147], a[48:51], a[28:31], a[144:147]
v_mfma_f32_16x16x32_bf16 a[148:151], a[52:55], a[28:31], a[148:151]
v_mfma_f32_16x16x32_bf16 a[152:155], a[56:59], a[28:31], a[152:155]
v_mfma_f32_16x16x32_bf16 a[156:159], a[60:63], a[28:31], a[156:159]
s_waitcnt vmcnt(18) lgkmcnt(0)
s_barrier
v_mfma_f32_16x16x32_bf16 v[16:19], a[104:107], a[72:75], v[16:19]
s_add_u32 s50, s49, s51
s_add_u32 s49, s49, 32768
s_cmp_eq_u32 s49, 163840
v_mfma_f32_16x16x32_bf16 v[20:23], a[108:111], a[72:75], v[20:23]
s_cselect_b32 s49, 65536, s49
v_add_u32 v2, s49, v1
v_xor_b32 v3, 64, v2
v_mfma_f32_16x16x32_bf16 v[24:27], a[112:115], a[72:75], v[24:27]
ds_read_b64_tr_b16 a[32:33], v4 offset:0
v_mfma_f32_16x16x32_bf16 v[28:31], a[116:119], a[72:75], v[28:31]
ds_read_b64_tr_b16 a[34:35], v4 offset:512
v_mfma_f32_16x16x32_bf16 v[32:35], a[120:123], a[72:75], v[32:35]
v_mfma_f32_16x16x32_bf16 v[36:39], a[124:127], a[72:75], v[36:39]
ds_read_b64_tr_b16 a[36:37], v5 offset:0
v_mfma_f32_16x16x32_bf16 v[40:43], a[128:131], a[72:75], v[40:43]
ds_read_b64_tr_b16 a[38:39], v5 offset:512
v_mfma_f32_16x16x32_bf16 v[44:47], a[132:135], a[72:75], v[44:47]
v_mfma_f32_16x16x32_bf16 v[48:51], a[104:107], a[76:79], v[48:51]
ds_read_b64_tr_b16 a[40:41], v6 offset:0
s_add_u32 m0, s51, 49152
v_mfma_f32_16x16x32_bf16 v[52:55], a[108:111], a[76:79], v[52:55]
buffer_load_dwordx4 v9, s[8:11], s40 offen lds
v_mfma_f32_16x16x32_bf16 v[56:59], a[112:115], a[76:79], v[56:59]
v_mfma_f32_16x16x32_bf16 v[60:63], a[116:119], a[76:79], v[60:63]
ds_read_b64_tr_b16 a[42:43], v6 offset:512
v_mfma_f32_16x16x32_bf16 v[64:67], a[120:123], a[76:79], v[64:67]
ds_read_b64_tr_b16 a[44:45], v7 offset:0
v_mfma_f32_16x16x32_bf16 v[68:71], a[124:127], a[76:79], v[68:71]
v_mfma_f32_16x16x32_bf16 v[72:75], a[128:131], a[76:79], v[72:75]
ds_read_b64_tr_b16 a[46:47], v7 offset:512
v_mfma_f32_16x16x32_bf16 v[76:79], a[132:135], a[76:79], v[76:79]
ds_read_b64_tr_b16 a[48:49], v4 offset:4096
v_mfma_f32_16x16x32_bf16 v[80:83], a[104:107], a[80:83], v[80:83]
v_mfma_f32_16x16x32_bf16 v[84:87], a[108:111], a[80:83], v[84:87]
ds_read_b64_tr_b16 a[50:51], v4 offset:4608
v_mfma_f32_16x16x32_bf16 v[88:91], a[112:115], a[80:83], v[88:91]
ds_read_b64_tr_b16 a[52:53], v5 offset:4096
v_mfma_f32_16x16x32_bf16 v[92:95], a[116:119], a[80:83], v[92:95]
s_add_u32 m0, s51, 53248
v_mfma_f32_16x16x32_bf16 v[96:99], a[120:123], a[80:83], v[96:99]
buffer_load_dwordx4 v9, s[8:11], s41 offen lds
v_mfma_f32_16x16x32_bf16 v[100:103], a[124:127], a[80:83], v[100:103]
ds_read_b64_tr_b16 a[54:55], v5 offset:4608
v_mfma_f32_16x16x32_bf16 v[104:107], a[128:131], a[80:83], v[104:107]
v_mfma_f32_16x16x32_bf16 v[108:111], a[132:135], a[80:83], v[108:111]
ds_read_b64_tr_b16 a[56:57], v6 offset:4096
v_mfma_f32_16x16x32_bf16 v[112:115], a[104:107], a[84:87], v[112:115]
ds_read_b64_tr_b16 a[58:59], v6 offset:4608
v_mfma_f32_16x16x32_bf16 v[116:119], a[108:111], a[84:87], v[116:119]
v_mfma_f32_16x16x32_bf16 v[120:123], a[112:115], a[84:87], v[120:123]
ds_read_b64_tr_b16 a[60:61], v7 offset:4096
v_mfma_f32_16x16x32_bf16 v[124:127], a[116:119], a[84:87], v[124:127]
ds_read_b64_tr_b16 a[62:63], v7 offset:4608
v_mfma_f32_16x16x32_bf16 v[128:131], a[120:123], a[84:87], v[128:131]
v_mfma_f32_16x16x32_bf16 v[132:135], a[124:127], a[84:87], v[132:135]
ds_read_b128 a[0:3], v2 offset:0
s_add_u32 m0, s51, 57344
v_mfma_f32_16x16x32_bf16 v[136:139], a[128:131], a[84:87], v[136:139]
buffer_load_dwordx4 v9, s[8:11], s42 offen lds
v_mfma_f32_16x16x32_bf16 v[140:143], a[132:135], a[84:87], v[140:143]
v_mfma_f32_16x16x32_bf16 v[144:147], a[104:107], a[88:91], v[144:147]
ds_read_b128 a[4:7], v2 offset:2048
v_mfma_f32_16x16x32_bf16 v[148:151], a[108:111], a[88:91], v[148:151]
ds_read_b128 a[8:11], v2 offset:4096
v_mfma_f32_16x16x32_bf16 v[152:155], a[112:115], a[88:91], v[152:155]
v_mfma_f32_16x16x32_bf16 v[156:159], a[116:119], a[88:91], v[156:159]
ds_read_b128 a[12:15], v2 offset:6144
v_mfma_f32_16x16x32_bf16 v[160:163], a[120:123], a[88:91], v[160:163]
ds_read_b128 a[16:19], v2 offset:8192
v_mfma_f32_16x16x32_bf16 v[164:167], a[124:127], a[88:91], v[164:167]
v_mfma_f32_16x16x32_bf16 v[168:171], a[128:131], a[88:91], v[168:171]
ds_read_b128 a[20:23], v2 offset:10240
v_mfma_f32_16x16x32_bf16 v[172:175], a[132:135], a[88:91], v[172:175]
ds_read_b128 a[24:27], v2 offset:12288
v_mfma_f32_16x16x32_bf16 v[176:179], a[104:107], a[92:95], v[176:179]
s_add_u32 m0, s51, 61440
v_mfma_f32_16x16x32_bf16 v[180:183], a[108:111], a[92:95], v[180:183]
buffer_load_dwordx4 v9, s[8:11], s43 offen lds
v_mfma_f32_16x16x32_bf16 v[184:187], a[112:115], a[92:95], v[184:187]
ds_read_b128 a[28:31], v2 offset:14336
v_add_u32 v9, 262144, v9
v_mfma_f32_16x16x32_bf16 v[188:191], a[116:119], a[92:95], v[188:191]
v_mfma_f32_16x16x32_bf16 v[192:195], a[120:123], a[92:95], v[192:195]
v_mfma_f32_16x16x32_bf16 v[196:199], a[124:127], a[92:95], v[196:199]
v_mfma_f32_16x16x32_bf16 v[200:203], a[128:131], a[92:95], v[200:203]
v_mfma_f32_16x16x32_bf16 v[204:207], a[132:135], a[92:95], v[204:207]
v_mfma_f32_16x16x32_bf16 v[208:211], a[104:107], a[96:99], v[208:211]
v_mfma_f32_16x16x32_bf16 v[212:215], a[108:111], a[96:99], v[212:215]
v_mfma_f32_16x16x32_bf16 v[216:219], a[112:115], a[96:99], v[216:219]
v_mfma_f32_16x16x32_bf16 v[220:223], a[116:119], a[96:99], v[220:223]
v_mfma_f32_16x16x32_bf16 v[224:227], a[120:123], a[96:99], v[224:227]
v_mfma_f32_16x16x32_bf16 v[228:231], a[124:127], a[96:99], v[228:231]
v_mfma_f32_16x16x32_bf16 v[232:235], a[128:131], a[96:99], v[232:235]
v_mfma_f32_16x16x32_bf16 v[236:239], a[132:135], a[96:99], v[236:239]
v_mfma_f32_16x16x32_bf16 v[240:243], a[104:107], a[100:103], v[240:243]
v_mfma_f32_16x16x32_bf16 v[244:247], a[108:111], a[100:103], v[244:247]
v_mfma_f32_16x16x32_bf16 v[248:251], a[112:115], a[100:103], v[248:251]
v_mfma_f32_16x16x32_bf16 v[252:255], a[116:119], a[100:103], v[252:255]
v_mfma_f32_16x16x32_bf16 a[144:147], a[120:123], a[100:103], a[144:147]
s_sub_u32 s52, s52, 1
v_mfma_f32_16x16x32_bf16 a[148:151], a[124:127], a[100:103], a[148:151]
v_mfma_f32_16x16x32_bf16 a[152:155], a[128:131], a[100:103], a[152:155]
s_cmp_lg_u32 s52, 0
v_mfma_f32_16x16x32_bf16 a[156:159], a[132:135], a[100:103], a[156:159]
s_cbranch_scc1 LM_loopK
s_waitcnt vmcnt(16) lgkmcnt(0)
s_barrier
s_getpc_b64 s[76:77]
Lpw_aK:
s_add_u32 s76, s76, LM_a1-Lpw_aK
s_addc_u32 s77, s77, 0
s_mov_b32 s78, L_text_end-LM_a1
s_mov_b32 s79, 0x20000
s_lshr_b32 s96, s2, 1
s_and_b32 s96, s96, 60
s_add_u32 s96, s96, s48
s_lshl_b32 s96, s96, 10
s_and_b32 s53, s2, 7
s_lshr_b32 s54, s2, 3
s_and_b32 s55, s54, 1
s_lshl_b32 s55, s55, 3
s_add_u32 s33, s53, s55
s_lshr_b32 s34, s54, 1
s_lshl_b32 s32, s48, 13
s_lshl_b32 s16, s33, 18
s_add_u32 s16, s16, s32
s_add_u32 s16, s16, 69206016
s_mov_b32 s18, 1400897536
s_mov_b32 s19, 0
v_lshrrev_b32 v14, 4, v12
v_and_b32 v15, 8, v14
v_lshlrev_b32 v15, 3, v15
v_and_or_b32 v15, v14, 7, v15
s_lshr_b32 s53, s33, 1
s_lshl_b32 s53, s53, 3
v_add_u32 v15, s53, v15
s_lshl_b32 s53, s33, 3
s_lshr_b32 s54, s34, 1
s_add_u32 s53, s53, s54
v_cmp_gt_u32 vcc, 16, v14
v_mov_b32 v14, s53
s_mov_b32 s58, 109096960
v_cndmask_b32 v15, v14, v15, vcc
v_lshlrev_b32 v15, 2, v15
s_lshl_b32 s53, s34, 2
s_add_u32 s53, s53, s48
s_lshl_b32 s53, s53, 11
s_lshl_b32 s54, s33, 17
s_add_u32 s53, s53, s54
s_add_u32 s57, s53, 67108864
v_mfma_f32_16x16x32_bf16 v[16:19], a[32:35], a[0:3], v[16:19]
v_mfma_f32_16x16x32_bf16 v[20:23], a[36:39], a[0:3], v[20:23]
ds_read_b64_tr_b16 a[104:105], v4 offset:16384
v_mfma_f32_16x16x32_bf16 v[24:27], a[40:43], a[0:3], v[24:27]
ds_read_b64_tr_b16 a[106:107], v4 offset:16896
v_mfma_f32_16x16x32_bf16 v[28:31], a[44:47], a[0:3], v[28:31]
ds_read_b64_tr_b16 a[108:109], v5 offset:16384
v_mfma_f32_16x16x32_bf16 v[32:35], a[48:51], a[0:3], v[32:35]
v_mfma_f32_16x16x32_bf16 v[36:39], a[52:55], a[0:3], v[36:39]
ds_read_b64_tr_b16 a[110:111], v5 offset:16896
v_mfma_f32_16x16x32_bf16 v[40:43], a[56:59], a[0:3], v[40:43]
ds_read_b64_tr_b16 a[112:113], v6 offset:16384
v_mfma_f32_16x16x32_bf16 v[44:47], a[60:63], a[0:3], v[44:47]
v_mfma_f32_16x16x32_bf16 v[48:51], a[32:35], a[4:7], v[48:51]
ds_read_b64_tr_b16 a[114:115], v6 offset:16896
v_mfma_f32_16x16x32_bf16 v[52:55], a[36:39], a[4:7], v[52:55]
ds_read_b64_tr_b16 a[116:117], v7 offset:16384
v_mfma_f32_16x16x32_bf16 v[56:59], a[40:43], a[4:7], v[56:59]
v_mfma_f32_16x16x32_bf16 v[60:63], a[44:47], a[4:7], v[60:63]
ds_read_b64_tr_b16 a[118:119], v7 offset:16896
v_mfma_f32_16x16x32_bf16 v[64:67], a[48:51], a[4:7], v[64:67]
ds_read_b64_tr_b16 a[120:121], v4 offset:20480
v_mfma_f32_16x16x32_bf16 v[68:71], a[52:55], a[4:7], v[68:71]
v_mfma_f32_16x16x32_bf16 v[72:75], a[56:59], a[4:7], v[72:75]
ds_read_b64_tr_b16 a[122:123], v4 offset:20992
v_mfma_f32_16x16x32_bf16 v[76:79], a[60:63], a[4:7], v[76:79]
ds_read_b64_tr_b16 a[124:125], v5 offset:20480
v_mfma_f32_16x16x32_bf16 v[80:83], a[32:35], a[8:11], v[80:83]
v_mfma_f32_16x16x32_bf16 v[84:87], a[36:39], a[8:11], v[84:87]
ds_read_b64_tr_b16 a[126:127], v5 offset:20992
v_mfma_f32_16x16x32_bf16 v[88:91], a[40:43], a[8:11], v[88:91]
ds_read_b64_tr_b16 a[128:129], v6 offset:20480
v_mfma_f32_16x16x32_bf16 v[92:95], a[44:47], a[8:11], v[92:95]
v_mfma_f32_16x16x32_bf16 v[96:99], a[48:51], a[8:11], v[96:99]
ds_read_b64_tr_b16 a[130:131], v6 offset:20992
v_mfma_f32_16x16x32_bf16 v[100:103], a[52:55], a[8:11], v[100:103]
ds_read_b64_tr_b16 a[132:133], v7 offset:20480
v_mfma_f32_16x16x32_bf16 v[104:107], a[56:59], a[8:11], v[104:107]
v_mfma_f32_16x16x32_bf16 v[108:111], a[60:63], a[8:11], v[108:111]
ds_read_b64_tr_b16 a[134:135], v7 offset:20992
v_mfma_f32_16x16x32_bf16 v[112:115], a[32:35], a[12:15], v[112:115]
ds_read_b128 a[72:75], v3 offset:0
v_mfma_f32_16x16x32_bf16 v[116:119], a[36:39], a[12:15], v[116:119]
v_mfma_f32_16x16x32_bf16 v[120:123], a[40:43], a[12:15], v[120:123]
ds_read_b128 a[76:79], v3 offset:2048
v_mfma_f32_16x16x32_bf16 v[124:127], a[44:47], a[12:15], v[124:127]
ds_read_b128 a[80:83], v3 offset:4096
v_mfma_f32_16x16x32_bf16 v[128:131], a[48:51], a[12:15], v[128:131]
v_mfma_f32_16x16x32_bf16 v[132:135], a[52:55], a[12:15], v[132:135]
ds_read_b128 a[84:87], v3 offset:6144
v_mfma_f32_16x16x32_bf16 v[136:139], a[56:59], a[12:15], v[136:139]
ds_read_b128 a[88:91], v3 offset:8192
v_mfma_f32_16x16x32_bf16 v[140:143], a[60:63], a[12:15], v[140:143]
v_mfma_f32_16x16x32_bf16 v[144:147], a[32:35], a[16:19], v[144:147]
ds_read_b128 a[92:95], v3 offset:10240
v_mfma_f32_16x16x32_bf16 v[148:151], a[36:39], a[16:19], v[148:151]
ds_read_b128 a[96:99], v3 offset:12288
v_mfma_f32_16x16x32_bf16 v[152:155], a[40:43], a[16:19], v[152:155]
v_mfma_f32_16x16x32_bf16 v[156:159], a[44:47], a[16:19], v[156:159]
buffer_load_dwordx4 a[136:139], v12, s[76:79], s96 offen
v_mfma_f32_16x16x32_bf16 v[160:163], a[48:51], a[16:19], v[160:163]
ds_read_b128 a[100:103], v3 offset:14336
v_mfma_f32_16x16x32_bf16 v[164:167], a[52:55], a[16:19], v[164:167]
v_mfma_f32_16x16x32_bf16 v[168:171], a[56:59], a[16:19], v[168:171]
v_mfma_f32_16x16x32_bf16 v[172:175], a[60:63], a[16:19], v[172:175]
v_mfma_f32_16x16x32_bf16 v[176:179], a[32:35], a[20:23], v[176:179]
v_mfma_f32_16x16x32_bf16 v[180:183], a[36:39], a[20:23], v[180:183]
v_mfma_f32_16x16x32_bf16 v[184:187], a[40:43], a[20:23], v[184:187]
v_mfma_f32_16x16x32_bf16 v[188:191], a[44:47], a[20:23], v[188:191]
v_mfma_f32_16x16x32_bf16 v[192:195], a[48:51], a[20:23], v[192:195]
v_mfma_f32_16x16x32_bf16 v[196:199], a[52:55], a[20:23], v[196:199]
v_mfma_f32_16x16x32_bf16 v[200:203], a[56:59], a[20:23], v[200:203]
v_mfma_f32_16x16x32_bf16 v[204:207], a[60:63], a[20:23], v[204:207]
v_mfma_f32_16x16x32_bf16 v[208:211], a[32:35], a[24:27], v[208:211]
v_mfma_f32_16x16x32_bf16 v[212:215], a[36:39], a[24:27], v[212:215]
v_mfma_f32_16x16x32_bf16 v[216:219], a[40:43], a[24:27], v[216:219]
v_mfma_f32_16x16x32_bf16 v[220:223], a[44:47], a[24:27], v[220:223]
v_mfma_f32_16x16x32_bf16 v[224:227], a[48:51], a[24:27], v[224:227]
v_mfma_f32_16x16x32_bf16 v[228:231], a[52:55], a[24:27], v[228:231]
v_mfma_f32_16x16x32_bf16 v[232:235], a[56:59], a[24:27], v[232:235]
v_mfma_f32_16x16x32_bf16 v[236:239], a[60:63], a[24:27], v[236:239]
v_mfma_f32_16x16x32_bf16 v[240:243], a[32:35], a[28:31], v[240:243]
v_mfma_f32_16x16x32_bf16 v[244:247], a[36:39], a[28:31], v[244:247]
v_mfma_f32_16x16x32_bf16 v[248:251], a[40:43], a[28:31], v[248:251]
v_mfma_f32_16x16x32_bf16 v[252:255], a[44:47], a[28:31], v[252:255]
v_mfma_f32_16x16x32_bf16 a[144:147], a[48:51], a[28:31], a[144:147]
v_mfma_f32_16x16x32_bf16 a[148:151], a[52:55], a[28:31], a[148:151]
v_mfma_f32_16x16x32_bf16 a[152:155], a[56:59], a[28:31], a[152:155]
v_mfma_f32_16x16x32_bf16 a[156:159], a[60:63], a[28:31], a[156:159]
s_waitcnt vmcnt(5) lgkmcnt(0)
s_barrier
v_mfma_f32_16x16x32_bf16 v[16:19], a[104:107], a[72:75], v[16:19]
s_add_u32 s50, s49, s51
s_add_u32 s49, s49, 32768
s_cmp_eq_u32 s49, 163840
v_mfma_f32_16x16x32_bf16 v[20:23], a[108:111], a[72:75], v[20:23]
s_cselect_b32 s49, 65536, s49
v_add_u32 v2, s49, v1
v_xor_b32 v3, 64, v2
v_mfma_f32_16x16x32_bf16 v[24:27], a[112:115], a[72:75], v[24:27]
ds_read_b64_tr_b16 a[32:33], v4 offset:32768
v_mfma_f32_16x16x32_bf16 v[28:31], a[116:119], a[72:75], v[28:31]
ds_read_b64_tr_b16 a[34:35], v4 offset:33280
v_mfma_f32_16x16x32_bf16 v[32:35], a[120:123], a[72:75], v[32:35]
v_mfma_f32_16x16x32_bf16 v[36:39], a[124:127], a[72:75], v[36:39]
ds_read_b64_tr_b16 a[36:37], v5 offset:32768
v_mfma_f32_16x16x32_bf16 v[40:43], a[128:131], a[72:75], v[40:43]
ds_read_b64_tr_b16 a[38:39], v5 offset:33280
v_mfma_f32_16x16x32_bf16 v[44:47], a[132:135], a[72:75], v[44:47]
v_mfma_f32_16x16x32_bf16 v[48:51], a[104:107], a[76:79], v[48:51]
ds_read_b64_tr_b16 a[40:41], v6 offset:32768
v_mfma_f32_16x16x32_bf16 v[52:55], a[108:111], a[76:79], v[52:55]
ds_read_b64_tr_b16 a[42:43], v6 offset:33280
v_mfma_f32_16x16x32_bf16 v[56:59], a[112:115], a[76:79], v[56:59]
v_mfma_f32_16x16x32_bf16 v[60:63], a[116:119], a[76:79], v[60:63]
ds_read_b64_tr_b16 a[44:45], v7 offset:32768
v_mfma_f32_16x16x32_bf16 v[64:67], a[120:123], a[76:79], v[64:67]
ds_read_b64_tr_b16 a[46:47], v7 offset:33280
v_mfma_f32_16x16x32_bf16 v[68:71], a[124:127], a[76:79], v[68:71]
v_mfma_f32_16x16x32_bf16 v[72:75], a[128:131], a[76:79], v[72:75]
ds_read_b64_tr_b16 a[48:49], v4 offset:36864
v_mfma_f32_16x16x32_bf16 v[76:79], a[132:135], a[76:79], v[76:79]
ds_read_b64_tr_b16 a[50:51], v4 offset:37376
v_mfma_f32_16x16x32_bf16 v[80:83], a[104:107], a[80:83], v[80:83]
v_mfma_f32_16x16x32_bf16 v[84:87], a[108:111], a[80:83], v[84:87]
ds_read_b64_tr_b16 a[52:53], v5 offset:36864
v_mfma_f32_16x16x32_bf16 v[88:91], a[112:115], a[80:83], v[88:91]
ds_read_b64_tr_b16 a[54:55], v5 offset:37376
v_mfma_f32_16x16x32_bf16 v[92:95], a[116:119], a[80:83], v[92:95]
v_mfma_f32_16x16x32_bf16 v[96:99], a[120:123], a[80:83], v[96:99]
ds_read_b64_tr_b16 a[56:57], v6 offset:36864
v_mfma_f32_16x16x32_bf16 v[100:103], a[124:127], a[80:83], v[100:103]
ds_read_b64_tr_b16 a[58:59], v6 offset:37376
v_mfma_f32_16x16x32_bf16 v[104:107], a[128:131], a[80:83], v[104:107]
v_mfma_f32_16x16x32_bf16 v[108:111], a[132:135], a[80:83], v[108:111]
ds_read_b64_tr_b16 a[60:61], v7 offset:36864
v_mfma_f32_16x16x32_bf16 v[112:115], a[104:107], a[84:87], v[112:115]
ds_read_b64_tr_b16 a[62:63], v7 offset:37376
v_mfma_f32_16x16x32_bf16 v[116:119], a[108:111], a[84:87], v[116:119]
v_mfma_f32_16x16x32_bf16 v[120:123], a[112:115], a[84:87], v[120:123]
ds_read_b128 a[0:3], v2 offset:0
v_mfma_f32_16x16x32_bf16 v[124:127], a[116:119], a[84:87], v[124:127]
ds_read_b128 a[4:7], v2 offset:2048
v_mfma_f32_16x16x32_bf16 v[128:131], a[120:123], a[84:87], v[128:131]
v_mfma_f32_16x16x32_bf16 v[132:135], a[124:127], a[84:87], v[132:135]
ds_read_b128 a[8:11], v2 offset:4096
v_mfma_f32_16x16x32_bf16 v[136:139], a[128:131], a[84:87], v[136:139]
ds_read_b128 a[12:15], v2 offset:6144
v_mfma_f32_16x16x32_bf16 v[140:143], a[132:135], a[84:87], v[140:143]
v_mfma_f32_16x16x32_bf16 v[144:147], a[104:107], a[88:91], v[144:147]
ds_read_b128 a[16:19], v2 offset:8192
v_mfma_f32_16x16x32_bf16 v[148:151], a[108:111], a[88:91], v[148:151]
ds_read_b128 a[20:23], v2 offset:10240
v_mfma_f32_16x16x32_bf16 v[152:155], a[112:115], a[88:91], v[152:155]
v_mfma_f32_16x16x32_bf16 v[156:159], a[116:119], a[88:91], v[156:159]
ds_read_b128 a[24:27], v2 offset:12288
v_mfma_f32_16x16x32_bf16 v[160:163], a[120:123], a[88:91], v[160:163]
ds_read_b128 a[28:31], v2 offset:14336
v_mfma_f32_16x16x32_bf16 v[164:167], a[124:127], a[88:91], v[164:167]
v_mfma_f32_16x16x32_bf16 v[168:171], a[128:131], a[88:91], v[168:171]
v_mfma_f32_16x16x32_bf16 v[172:175], a[132:135], a[88:91], v[172:175]
v_mfma_f32_16x16x32_bf16 v[176:179], a[104:107], a[92:95], v[176:179]
v_mfma_f32_16x16x32_bf16 v[180:183], a[108:111], a[92:95], v[180:183]
v_mfma_f32_16x16x32_bf16 v[184:187], a[112:115], a[92:95], v[184:187]
v_mfma_f32_16x16x32_bf16 v[188:191], a[116:119], a[92:95], v[188:191]
v_mfma_f32_16x16x32_bf16 v[192:195], a[120:123], a[92:95], v[192:195]
v_mfma_f32_16x16x32_bf16 v[196:199], a[124:127], a[92:95], v[196:199]
v_mfma_f32_16x16x32_bf16 v[200:203], a[128:131], a[92:95], v[200:203]
v_mfma_f32_16x16x32_bf16 v[204:207], a[132:135], a[92:95], v[204:207]
v_mfma_f32_16x16x32_bf16 v[208:211], a[104:107], a[96:99], v[208:211]
v_mfma_f32_16x16x32_bf16 v[212:215], a[108:111], a[96:99], v[212:215]
v_mfma_f32_16x16x32_bf16 v[216:219], a[112:115], a[96:99], v[216:219]
v_mfma_f32_16x16x32_bf16 v[220:223], a[116:119], a[96:99], v[220:223]
v_mfma_f32_16x16x32_bf16 v[224:227], a[120:123], a[96:99], v[224:227]
v_mfma_f32_16x16x32_bf16 v[228:231], a[124:127], a[96:99], v[228:231]
v_mfma_f32_16x16x32_bf16 v[232:235], a[128:131], a[96:99], v[232:235]
v_mfma_f32_16x16x32_bf16 v[236:239], a[132:135], a[96:99], v[236:239]
v_mfma_f32_16x16x32_bf16 v[240:243], a[104:107], a[100:103], v[240:243]
v_mfma_f32_16x16x32_bf16 v[244:247], a[108:111], a[100:103], v[244:247]
v_mfma_f32_16x16x32_bf16 v[248:251], a[112:115], a[100:103], v[248:251]
v_mfma_f32_16x16x32_bf16 v[252:255], a[116:119], a[100:103], v[252:255]
v_mfma_f32_16x16x32_bf16 a[144:147], a[120:123], a[100:103], a[144:147]
v_mfma_f32_16x16x32_bf16 a[148:151], a[124:127], a[100:103], a[148:151]
v_mfma_f32_16x16x32_bf16 a[152:155], a[128:131], a[100:103], a[152:155]
v_mfma_f32_16x16x32_bf16 a[156:159], a[132:135], a[100:103], a[156:159]
s_waitcnt vmcnt(0) lgkmcnt(0)
s_barrier
v_mfma_f32_16x16x32_bf16 v[16:19], a[32:35], a[0:3], v[16:19]
v_mfma_f32_16x16x32_bf16 v[20:23], a[36:39], a[0:3], v[20:23]
ds_read_b64_tr_b16 a[104:105], v4 offset:49152
v_mfma_f32_16x16x32_bf16 v[24:27], a[40:43], a[0:3], v[24:27]
ds_read_b64_tr_b16 a[106:107], v4 offset:49664
v_mfma_f32_16x16x32_bf16 v[28:31], a[44:47], a[0:3], v[28:31]
ds_read_b64_tr_b16 a[108:109], v5 offset:49152
v_mfma_f32_16x16x32_bf16 v[32:35], a[48:51], a[0:3], v[32:35]
v_mfma_f32_16x16x32_bf16 v[36:39], a[52:55], a[0:3], v[36:39]
ds_read_b64_tr_b16 a[110:111], v5 offset:49664
v_mfma_f32_16x16x32_bf16 v[40:43], a[56:59], a[0:3], v[40:43]
ds_read_b64_tr_b16 a[112:113], v6 offset:49152
v_mfma_f32_16x16x32_bf16 v[44:47], a[60:63], a[0:3], v[44:47]
v_mfma_f32_16x16x32_bf16 v[48:51], a[32:35], a[4:7], v[48:51]
ds_read_b64_tr_b16 a[114:115], v6 offset:49664
v_mfma_f32_16x16x32_bf16 v[52:55], a[36:39], a[4:7], v[52:55]
ds_read_b64_tr_b16 a[116:117], v7 offset:49152
v_mfma_f32_16x16x32_bf16 v[56:59], a[40:43], a[4:7], v[56:59]
v_mfma_f32_16x16x32_bf16 v[60:63], a[44:47], a[4:7], v[60:63]
ds_read_b64_tr_b16 a[118:119], v7 offset:49664
v_mfma_f32_16x16x32_bf16 v[64:67], a[48:51], a[4:7], v[64:67]
ds_read_b64_tr_b16 a[120:121], v4 offset:53248
v_mfma_f32_16x16x32_bf16 v[68:71], a[52:55], a[4:7], v[68:71]
v_mfma_f32_16x16x32_bf16 v[72:75], a[56:59], a[4:7], v[72:75]
ds_read_b64_tr_b16 a[122:123], v4 offset:53760
v_mfma_f32_16x16x32_bf16 v[76:79], a[60:63], a[4:7], v[76:79]
ds_read_b64_tr_b16 a[124:125], v5 offset:53248
v_mfma_f32_16x16x32_bf16 v[80:83], a[32:35], a[8:11], v[80:83]
v_mfma_f32_16x16x32_bf16 v[84:87], a[36:39], a[8:11], v[84:87]
ds_read_b64_tr_b16 a[126:127], v5 offset:53760
v_mfma_f32_16x16x32_bf16 v[88:91], a[40:43], a[8:11], v[88:91]
ds_read_b64_tr_b16 a[128:129], v6 offset:53248
v_mfma_f32_16x16x32_bf16 v[92:95], a[44:47], a[8:11], v[92:95]
v_mfma_f32_16x16x32_bf16 v[96:99], a[48:51], a[8:11], v[96:99]
ds_read_b64_tr_b16 a[130:131], v6 offset:53760
v_mfma_f32_16x16x32_bf16 v[100:103], a[52:55], a[8:11], v[100:103]
ds_read_b64_tr_b16 a[132:133], v7 offset:53248
v_mfma_f32_16x16x32_bf16 v[104:107], a[56:59], a[8:11], v[104:107]
v_mfma_f32_16x16x32_bf16 v[108:111], a[60:63], a[8:11], v[108:111]
ds_read_b64_tr_b16 a[134:135], v7 offset:53760
v_mfma_f32_16x16x32_bf16 v[112:115], a[32:35], a[12:15], v[112:115]
ds_read_b128 a[72:75], v3 offset:0
v_mfma_f32_16x16x32_bf16 v[116:119], a[36:39], a[12:15], v[116:119]
v_mfma_f32_16x16x32_bf16 v[120:123], a[40:43], a[12:15], v[120:123]
ds_read_b128 a[76:79], v3 offset:2048
v_mfma_f32_16x16x32_bf16 v[124:127], a[44:47], a[12:15], v[124:127]
ds_read_b128 a[80:83], v3 offset:4096
v_mfma_f32_16x16x32_bf16 v[128:131], a[48:51], a[12:15], v[128:131]
v_mfma_f32_16x16x32_bf16 v[132:135], a[52:55], a[12:15], v[132:135]
ds_read_b128 a[84:87], v3 offset:6144
v_mfma_f32_16x16x32_bf16 v[136:139], a[56:59], a[12:15], v[136:139]
ds_read_b128 a[88:91], v3 offset:8192
v_mfma_f32_16x16x32_bf16 v[140:143], a[60:63], a[12:15], v[140:143]
v_mfma_f32_16x16x32_bf16 v[144:147], a[32:35], a[16:19], v[144:147]
ds_read_b128 a[92:95], v3 offset:10240
v_mfma_f32_16x16x32_bf16 v[148:151], a[36:39], a[16:19], v[148:151]
ds_read_b128 a[96:99], v3 offset:12288
v_mfma_f32_16x16x32_bf16 v[152:155], a[40:43], a[16:19], v[152:155]
v_mfma_f32_16x16x32_bf16 v[156:159], a[44:47], a[16:19], v[156:159]
buffer_load_dword v14, v15, s[20:23], s58 offen sc0 sc1
v_mfma_f32_16x16x32_bf16 v[160:163], a[48:51], a[16:19], v[160:163]
ds_read_b128 a[100:103], v3 offset:14336
v_mfma_f32_16x16x32_bf16 v[164:167], a[52:55], a[16:19], v[164:167]
v_mfma_f32_16x16x32_bf16 v[168:171], a[56:59], a[16:19], v[168:171]
v_mfma_f32_16x16x32_bf16 v[172:175], a[60:63], a[16:19], v[172:175]
v_mfma_f32_16x16x32_bf16 v[176:179], a[32:35], a[20:23], v[176:179]
v_mfma_f32_16x16x32_bf16 v[180:183], a[36:39], a[20:23], v[180:183]
v_mfma_f32_16x16x32_bf16 v[184:187], a[40:43], a[20:23], v[184:187]
v_mfma_f32_16x16x32_bf16 v[188:191], a[44:47], a[20:23], v[188:191]
v_mfma_f32_16x16x32_bf16 v[192:195], a[48:51], a[20:23], v[192:195]
v_mfma_f32_16x16x32_bf16 v[196:199], a[52:55], a[20:23], v[196:199]
v_mfma_f32_16x16x32_bf16 v[200:203], a[56:59], a[20:23], v[200:203]
v_mfma_f32_16x16x32_bf16 v[204:207], a[60:63], a[20:23], v[204:207]
v_mfma_f32_16x16x32_bf16 v[208:211], a[32:35], a[24:27], v[208:211]
v_mfma_f32_16x16x32_bf16 v[212:215], a[36:39], a[24:27], v[212:215]
v_mfma_f32_16x16x32_bf16 v[216:219], a[40:43], a[24:27], v[216:219]
v_mfma_f32_16x16x32_bf16 v[220:223], a[44:47], a[24:27], v[220:223]
v_mfma_f32_16x16x32_bf16 v[224:227], a[48:51], a[24:27], v[224:227]
v_mfma_f32_16x16x32_bf16 v[228:231], a[52:55], a[24:27], v[228:231]
v_mfma_f32_16x16x32_bf16 v[232:235], a[56:59], a[24:27], v[232:235]
v_mfma_f32_16x16x32_bf16 v[236:239], a[60:63], a[24:27], v[236:239]
v_mfma_f32_16x16x32_bf16 v[240:243], a[32:35], a[28:31], v[240:243]
v_mfma_f32_16x16x32_bf16 v[244:247], a[36:39], a[28:31], v[244:247]
v_mfma_f32_16x16x32_bf16 v[248:251], a[40:43], a[28:31], v[248:251]
v_mfma_f32_16x16x32_bf16 v[252:255], a[44:47], a[28:31], v[252:255]
v_mfma_f32_16x16x32_bf16 a[144:147], a[48:51], a[28:31], a[144:147]
v_mfma_f32_16x16x32_bf16 a[148:151], a[52:55], a[28:31], a[148:151]
v_mfma_f32_16x16x32_bf16 a[152:155], a[56:59], a[28:31], a[152:155]
v_mfma_f32_16x16x32_bf16 a[156:159], a[60:63], a[28:31], a[156:159]
s_waitcnt vmcnt(0) lgkmcnt(0)
v_cmp_ne_u32 vcc, s89, v14
s_cbranch_vccnz LM_gKwait
LM_gKret:
s_barrier
v_mfma_f32_16x16x32_bf16 v[16:19], a[104:107], a[72:75], v[16:19]
s_add_u32 s50, s49, s51
s_add_u32 s49, s49, 32768
s_cmp_eq_u32 s49, 163840
v_mfma_f32_16x16x32_bf16 v[20:23], a[108:111], a[72:75], v[20:23]
s_cselect_b32 s49, 65536, s49
v_add_u32 v2, s49, v1
v_xor_b32 v3, 64, v2
v_mfma_f32_16x16x32_bf16 v[24:27], a[112:115], a[72:75], v[24:27]
buffer_load_dwordx4 a[48:51], v12, s[20:23], s57 offen offset:0 sc1
v_mfma_f32_16x16x32_bf16 v[28:31], a[116:119], a[72:75], v[28:31]
buffer_load_dwordx4 a[52:55], v12, s[20:23], s57 offen offset:1024 sc1
v_mfma_f32_16x16x32_bf16 v[32:35], a[120:123], a[72:75], v[32:35]
s_add_u32 m0, s32, 0
v_mfma_f32_16x16x32_bf16 v[36:39], a[124:127], a[72:75], v[36:39]
buffer_load_dwordx4 v12, s[20:23], s16 offen offset:0 sc1 lds
v_mfma_f32_16x16x32_bf16 v[40:43], a[128:131], a[72:75], v[40:43]
buffer_load_dwordx4 v12, s[20:23], s16 offen offset:1024 sc1 lds
v_mfma_f32_16x16x32_bf16 v[44:47], a[132:135], a[72:75], v[44:47]
v_mfma_f32_16x16x32_bf16 v[48:51], a[104:107], a[76:79], v[48:51]
buffer_load_dwordx4 v12, s[20:23], s16 offen offset:2048 sc1 lds
v_mfma_f32_16x16x32_bf16 v[52:55], a[108:111], a[76:79], v[52:55]
buffer_load_dwordx4 v12, s[20:23], s16 offen offset:3072 sc1 lds
v_mfma_f32_16x16x32_bf16 v[56:59], a[112:115], a[76:79], v[56:59]
s_add_u32 s16, s16, 4096
s_add_u32 m0, s32, 4096
v_mfma_f32_16x16x32_bf16 v[60:63], a[116:119], a[76:79], v[60:63]
buffer_load_dwordx4 v12, s[20:23], s16 offen offset:0 sc1 lds
v_mfma_f32_16x16x32_bf16 v[64:67], a[120:123], a[76:79], v[64:67]
buffer_load_dwordx4 v12, s[20:23], s16 offen offset:1024 sc1 lds
v_mfma_f32_16x16x32_bf16 v[68:71], a[124:127], a[76:79], v[68:71]
v_mfma_f32_16x16x32_bf16 v[72:75], a[128:131], a[76:79], v[72:75]
buffer_load_dwordx4 v12, s[20:23], s16 offen offset:2048 sc1 lds
v_mfma_f32_16x16x32_bf16 v[76:79], a[132:135], a[76:79], v[76:79]
buffer_load_dwordx4 v12, s[20:23], s16 offen offset:3072 sc1 lds
v_mfma_f32_16x16x32_bf16 v[80:83], a[104:107], a[80:83], v[80:83]
s_add_u32 s16, s16, 28672
s_add_u32 m0, s32, 32768
v_mfma_f32_16x16x32_bf16 v[84:87], a[108:111], a[80:83], v[84:87]
buffer_load_dwordx4 v12, s[20:23], s16 offen offset:0 sc1 lds
v_mfma_f32_16x16x32_bf16 v[88:91], a[112:115], a[80:83], v[88:91]
buffer_load_dwordx4 v12, s[20:23], s16 offen offset:1024 sc1 lds
v_mfma_f32_16x16x32_bf16 v[92:95], a[116:119], a[80:83], v[92:95]
v_mfma_f32_16x16x32_bf16 v[96:99], a[120:123], a[80:83], v[96:99]
buffer_load_dwordx4 v12, s[20:23], s16 offen offset:2048 sc1 lds
v_mfma_f32_16x16x32_bf16 v[100:103], a[124:127], a[80:83], v[100:103]
buffer_load_dwordx4 v12, s[20:23], s16 offen offset:3072 sc1 lds
v_mfma_f32_16x16x32_bf16 v[104:107], a[128:131], a[80:83], v[104:107]
s_add_u32 s16, s16, 4096
s_add_u32 m0, s32, 36864
v_mfma_f32_16x16x32_bf16 v[108:111], a[132:135], a[80:83], v[108:111]
buffer_load_dwordx4 v12, s[20:23], s16 offen offset:0 sc1 lds
v_mfma_f32_16x16x32_bf16 v[112:115], a[104:107], a[84:87], v[112:115]
buffer_load_dwordx4 v12, s[20:23], s16 offen offset:1024 sc1 lds
v_mfma_f32_16x16x32_bf16 v[116:119], a[108:111], a[84:87], v[116:119]
v_mfma_f32_16x16x32_bf16 v[120:123], a[112:115], a[84:87], v[120:123]
buffer_load_dwordx4 v12, s[20:23], s16 offen offset:2048 sc1 lds
v_mfma_f32_16x16x32_bf16 v[124:127], a[116:119], a[84:87], v[124:127]
buffer_load_dwordx4 v12, s[20:23], s16 offen offset:3072 sc1 lds
v_mfma_f32_16x16x32_bf16 v[128:131], a[120:123], a[84:87], v[128:131]
s_add_u32 s16, s16, 28672
s_add_u32 m0, s32, 65536
v_mfma_f32_16x16x32_bf16 v[132:135], a[124:127], a[84:87], v[132:135]
buffer_load_dwordx4 v12, s[20:23], s16 offen offset:0 sc1 lds
v_mfma_f32_16x16x32_bf16 v[136:139], a[128:131], a[84:87], v[136:139]
buffer_load_dwordx4 v12, s[20:23], s16 offen offset:1024 sc1 lds
v_mfma_f32_16x16x32_bf16 v[140:143], a[132:135], a[84:87], v[140:143]
v_mfma_f32_16x16x32_bf16 v[144:147], a[104:107], a[88:91], v[144:147]
buffer_load_dwordx4 v12, s[20:23], s16 offen offset:2048 sc1 lds
v_mfma_f32_16x16x32_bf16 v[148:151], a[108:111], a[88:91], v[148:151]
buffer_load_dwordx4 v12, s[20:23], s16 offen offset:3072 sc1 lds
v_mfma_f32_16x16x32_bf16 v[152:155], a[112:115], a[88:91], v[152:155]
s_add_u32 s16, s16, 4096
s_add_u32 m0, s32, 69632
v_mfma_f32_16x16x32_bf16 v[156:159], a[116:119], a[88:91], v[156:159]
buffer_load_dwordx4 v12, s[20:23], s16 offen offset:0 sc1 lds
v_mfma_f32_16x16x32_bf16 v[160:163], a[120:123], a[88:91], v[160:163]
buffer_load_dwordx4 v12, s[20:23], s16 offen offset:1024 sc1 lds
v_mfma_f32_16x16x32_bf16 v[164:167], a[124:127], a[88:91], v[164:167]
v_mfma_f32_16x16x32_bf16 v[168:171], a[128:131], a[88:91], v[168:171]
buffer_load_dwordx4 v12, s[20:23], s16 offen offset:2048 sc1 lds
v_mfma_f32_16x16x32_bf16 v[172:175], a[132:135], a[88:91], v[172:175]
buffer_load_dwordx4 v12, s[20:23], s16 offen offset:3072 sc1 lds
v_mfma_f32_16x16x32_bf16 v[176:179], a[104:107], a[92:95], v[176:179]
s_add_u32 s16, s16, 28672
s_add_u32 m0, s32, 98304
v_mfma_f32_16x16x32_bf16 v[180:183], a[108:111], a[92:95], v[180:183]
buffer_load_dwordx4 v12, s[20:23], s16 offen offset:0 sc1 lds
v_mfma_f32_16x16x32_bf16 v[184:187], a[112:115], a[92:95], v[184:187]
buffer_load_dwordx4 v12, s[20:23], s16 offen offset:1024 sc1 lds
v_mfma_f32_16x16x32_bf16 v[188:191], a[116:119], a[92:95], v[188:191]
v_mfma_f32_16x16x32_bf16 v[192:195], a[120:123], a[92:95], v[192:195]
buffer_load_dwordx4 v12, s[20:23], s16 offen offset:2048 sc1 lds
v_mfma_f32_16x16x32_bf16 v[196:199], a[124:127], a[92:95], v[196:199]
buffer_load_dwordx4 v12, s[20:23], s16 offen offset:3072 sc1 lds
v_mfma_f32_16x16x32_bf16 v[200:203], a[128:131], a[92:95], v[200:203]
s_add_u32 s16, s16, 4096
s_add_u32 m0, s32, 102400
v_mfma_f32_16x16x32_bf16 v[204:207], a[132:135], a[92:95], v[204:207]
buffer_load_dwordx4 v12, s[20:23], s16 offen offset:0 sc1 lds
v_mfma_f32_16x16x32_bf16 v[208:211], a[104:107], a[96:99], v[208:211]
buffer_load_dwordx4 v12, s[20:23], s16 offen offset:1024 sc1 lds
v_mfma_f32_16x16x32_bf16 v[212:215], a[108:111], a[96:99], v[212:215]
v_mfma_f32_16x16x32_bf16 v[216:219], a[112:115], a[96:99], v[216:219]
buffer_load_dwordx4 v12, s[20:23], s16 offen offset:2048 sc1 lds
v_mfma_f32_16x16x32_bf16 v[220:223], a[116:119], a[96:99], v[220:223]
buffer_load_dwordx4 v12, s[20:23], s16 offen offset:3072 sc1 lds
v_mfma_f32_16x16x32_bf16 v[224:227], a[120:123], a[96:99], v[224:227]
v_mfma_f32_16x16x32_bf16 v[228:231], a[124:127], a[96:99], v[228:231]
v_mfma_f32_16x16x32_bf16 v[232:235], a[128:131], a[96:99], v[232:235]
v_mfma_f32_16x16x32_bf16 v[236:239], a[132:135], a[96:99], v[236:239]
v_mfma_f32_16x16x32_bf16 v[240:243], a[104:107], a[100:103], v[240:243]
v_mfma_f32_16x16x32_bf16 v[244:247], a[108:111], a[100:103], v[244:247]
v_mfma_f32_16x16x32_bf16 v[248:251], a[112:115], a[100:103], v[248:251]
v_mfma_f32_16x16x32_bf16 v[252:255], a[116:119], a[100:103], v[252:255]
v_mfma_f32_16x16x32_bf16 a[144:147], a[120:123], a[100:103], a[144:147]
v_mfma_f32_16x16x32_bf16 a[148:151], a[124:127], a[100:103], a[148:151]
v_mfma_f32_16x16x32_bf16 a[152:155], a[128:131], a[100:103], a[152:155]
v_mfma_f32_16x16x32_bf16 a[156:159], a[132:135], a[100:103], a[156:159]
s_nop 7
v_cvt_pk_bf16_f32 v16, v16, v17
v_cvt_pk_bf16_f32 v17, v18, v19
v_cvt_pk_bf16_f32 v18, v20, v21
v_cvt_pk_bf16_f32 v19, v22, v23
v_cvt_pk_bf16_f32 v20, v24, v25
v_cvt_pk_bf16_f32 v21, v26, v27
v_cvt_pk_bf16_f32 v22, v28, v29
v_cvt_pk_bf16_f32 v23, v30, v31
v_cvt_pk_bf16_f32 v24, v32, v33
v_cvt_pk_bf16_f32 v25, v34, v35
v_cvt_pk_bf16_f32 v26, v36, v37
v_cvt_pk_bf16_f32 v27, v38, v39
v_cvt_pk_bf16_f32 v28, v40, v41
v_cvt_pk_bf16_f32 v29, v42, v43
v_cvt_pk_bf16_f32 v30, v44, v45
v_cvt_pk_bf16_f32 v31, v46, v47
v_cvt_pk_bf16_f32 v32, v48, v49
v_cvt_pk_bf16_f32 v33, v50, v51
v_cvt_pk_bf16_f32 v34, v52, v53
v_cvt_pk_bf16_f32 v35, v54, v55
v_cvt_pk_bf16_f32 v36, v56, v57
v_cvt_pk_bf16_f32 v37, v58, v59
v_cvt_pk_bf16_f32 v38, v60, v61
v_cvt_pk_bf16_f32 v39, v62, v63
v_cvt_pk_bf16_f32 v40, v64, v65
v_cvt_pk_bf16_f32 v41, v66, v67
v_cvt_pk_bf16_f32 v42, v68, v69
v_cvt_pk_bf16_f32 v43, v70, v71
v_cvt_pk_bf16_f32 v44, v72, v73
v_cvt_pk_bf16_f32 v45, v74, v75
v_cvt_pk_bf16_f32 v46, v76, v77
v_cvt_pk_bf16_f32 v47, v78, v79
v_cvt_pk_bf16_f32 v48, v80, v81
v_cvt_pk_bf16_f32 v49, v82, v83
v_cvt_pk_bf16_f32 v50, v84, v85
v_cvt_pk_bf16_f32 v51, v86, v87
v_cvt_pk_bf16_f32 v52, v88, v89
v_cvt_pk_bf16_f32 v53, v90, v91
v_cvt_pk_bf16_f32 v54, v92, v93
v_cvt_pk_bf16_f32 v55, v94, v95
v_cvt_pk_bf16_f32 v56, v96, v97
v_cvt_pk_bf16_f32 v57, v98, v99
v_cvt_pk_bf16_f32 v58, v100, v101
v_cvt_pk_bf16_f32 v59, v102, v103
v_cvt_pk_bf16_f32 v60, v104, v105
v_cvt_pk_bf16_f32 v61, v106, v107
v_cvt_pk_bf16_f32 v62, v108, v109
v_cvt_pk_bf16_f32 v63, v110, v111
v_cvt_pk_bf16_f32 v64, v112, v113
v_cvt_pk_bf16_f32 v65, v114, v115
v_cvt_pk_bf16_f32 v66, v116, v117
v_cvt_pk_bf16_f32 v67, v118, v119
v_cvt_pk_bf16_f32 v68, v120, v121
v_cvt_pk_bf16_f32 v69, v122, v123
v_cvt_pk_bf16_f32 v70, v124, v125
v_cvt_pk_bf16_f32 v71, v126, v127
v_cvt_pk_bf16_f32 v72, v128, v129
v_cvt_pk_bf16_f32 v73, v130, v131
v_cvt_pk_bf16_f32 v74, v132, v133
v_cvt_pk_bf16_f32 v75, v134, v135
v_cvt_pk_bf16_f32 v76, v136, v137
v_cvt_pk_bf16_f32 v77, v138, v139
v_cvt_pk_bf16_f32 v78, v140, v141
v_cvt_pk_bf16_f32 v79, v142, v143
v_cvt_pk_bf16_f32 v80, v144, v145
v_cvt_pk_bf16_f32 v81, v146, v147
v_cvt_pk_bf16_f32 v82, v148, v149
v_cvt_pk_bf16_f32 v83, v150, v151
v_cvt_pk_bf16_f32 v84, v152, v153
v_cvt_pk_bf16_f32 v85, v154, v155
v_cvt_pk_bf16_f32 v86, v156, v157
v_cvt_pk_bf16_f32 v87, v158, v159
v_cvt_pk_bf16_f32 v88, v160, v161
v_cvt_pk_bf16_f32 v89, v162, v163
v_cvt_pk_bf16_f32 v90, v164, v165
v_cvt_pk_bf16_f32 v91, v166, v167
v_cvt_pk_bf16_f32 v92, v168, v169
v_cvt_pk_bf16_f32 v93, v170, v171
v_cvt_pk_bf16_f32 v94, v172, v173
v_cvt_pk_bf16_f32 v95, v174, v175
v_cvt_pk_bf16_f32 v96, v176, v177
v_cvt_pk_bf16_f32 v97, v178, v179
v_cvt_pk_bf16_f32 v98, v180, v181
v_cvt_pk_bf16_f32 v99, v182, v183
v_cvt_pk_bf16_f32 v100, v184, v185
v_cvt_pk_bf16_f32 v101, v186, v187
v_cvt_pk_bf16_f32 v102, v188, v189
v_cvt_pk_bf16_f32 v103, v190, v191
v_cvt_pk_bf16_f32 v104, v192, v193
v_cvt_pk_bf16_f32 v105, v194, v195
v_cvt_pk_bf16_f32 v106, v196, v197
v_cvt_pk_bf16_f32 v107, v198, v199
v_cvt_pk_bf16_f32 v108, v200, v201
v_cvt_pk_bf16_f32 v109, v202, v203
v_cvt_pk_bf16_f32 v110, v204, v205
v_cvt_pk_bf16_f32 v111, v206, v207
v_cvt_pk_bf16_f32 v112, v208, v209
v_cvt_pk_bf16_f32 v113, v210, v211
v_cvt_pk_bf16_f32 v114, v212, v213
v_cvt_pk_bf16_f32 v115, v214, v215
v_cvt_pk_bf16_f32 v116, v216, v217
v_cvt_pk_bf16_f32 v117, v218, v219
v_cvt_pk_bf16_f32 v118, v220, v221
v_cvt_pk_bf16_f32 v119, v222, v223
v_cvt_pk_bf16_f32 v120, v224, v225
v_cvt_pk_bf16_f32 v121, v226, v227
v_cvt_pk_bf16_f32 v122, v228, v229
v_cvt_pk_bf16_f32 v123, v230, v231
v_cvt_pk_bf16_f32 v124, v232, v233
v_cvt_pk_bf16_f32 v125, v234, v235
v_cvt_pk_bf16_f32 v126, v236, v237
v_cvt_pk_bf16_f32 v127, v238, v239
v_cvt_pk_bf16_f32 v128, v240, v241
v_cvt_pk_bf16_f32 v129, v242, v243
v_cvt_pk_bf16_f32 v130, v244, v245
v_cvt_pk_bf16_f32 v131, v246, v247
v_cvt_pk_bf16_f32 v132, v248, v249
v_cvt_pk_bf16_f32 v133, v250, v251
v_cvt_pk_bf16_f32 v134, v252, v253
v_cvt_pk_bf16_f32 v135, v254, v255
v_accvgpr_read_b32 v144, a144
v_accvgpr_read_b32 v145, a145
v_accvgpr_read_b32 v146, a146
v_accvgpr_read_b32 v147, a147
v_accvgpr_read_b32 v148, a148
v_accvgpr_read_b32 v149, a149
v_accvgpr_read_b32 v150, a150
v_accvgpr_read_b32 v151, a151
v_cvt_pk_bf16_f32 v136, v144, v145
v_cvt_pk_bf16_f32 v137, v146, v147
v_cvt_pk_bf16_f32 v138, v148, v149
v_cvt_pk_bf16_f32 v139, v150, v151
v_accvgpr_read_b32 v152, a152
v_accvgpr_read_b32 v153, a153
v_accvgpr_read_b32 v154, a154
v_accvgpr_read_b32 v155, a155
v_accvgpr_read_b32 v156, a156
v_accvgpr_read_b32 v157, a157
v_accvgpr_read_b32 v158, a158
v_accvgpr_read_b32 v159, a159
v_cvt_pk_bf16_f32 v140, v152, v153
v_cvt_pk_bf16_f32 v141, v154, v155
v_cvt_pk_bf16_f32 v142, v156, v157
v_cvt_pk_bf16_f32 v143, v158, v159
s_branch LM_a1
LM_firstV:
s_waitcnt vmcnt(16) lgkmcnt(0)
s_barrier
v_mfma_f32_16x16x32_bf16 v[16:19], a[0:3], a[32:35], 0
v_mfma_f32_16x16x32_bf16 v[20:23], a[0:3], a[36:39], 0
ds_read_b64_tr_b16 a[104:105], v4 offset:16384
s_add_u32 m0, s51, 0
v_mfma_f32_16x16x32_bf16 v[24:27], a[0:3], a[40:43], 0
buffer_load_dwordx4 v9, s[8:11], s40 offen lds
v_mfma_f32_16x16x32_bf16 v[28:31], a[0:3], a[44:47], 0
ds_read_b64_tr_b16 a[106:107], v4 offset:16896
v_mfma_f32_16x16x32_bf16 v[32:35], a[0:3], a[48:51], 0
v_mfma_f32_16x16x32_bf16 v[36:39], a[0:3], a[52:55], 0
ds_read_b64_tr_b16 a[108:109], v5 offset:16384
s_add_u32 m0, s51, 4096
v_mfma_f32_16x16x32_bf16 v[40:43], a[0:3], a[56:59], 0
buffer_load_dwordx4 v9, s[8:11], s41 offen lds
v_mfma_f32_16x16x32_bf16 v[44:47], a[0:3], a[60:63], 0
v_mfma_f32_16x16x32_bf16 v[48:51], a[4:7], a[32:35], 0
ds_read_b64_tr_b16 a[110:111], v5 offset:16896
v_mfma_f32_16x16x32_bf16 v[52:55], a[4:7], a[36:39], 0
ds_read_b64_tr_b16 a[112:113], v6 offset:16384
v_mfma_f32_16x16x32_bf16 v[56:59], a[4:7], a[40:43], 0
s_add_u32 m0, s51, 8192
v_mfma_f32_16x16x32_bf16 v[60:63], a[4:7], a[44:47], 0
buffer_load_dwordx4 v9, s[8:11], s42 offen lds
v_mfma_f32_16x16x32_bf16 v[64:67], a[4:7], a[48:51], 0
ds_read_b64_tr_b16 a[114:115], v6 offset:16896
v_mfma_f32_16x16x32_bf16 v[68:71], a[4:7], a[52:55], 0
v_mfma_f32_16x16x32_bf16 v[72:75], a[4:7], a[56:59], 0
ds_read_b64_tr_b16 a[116:117], v7 offset:16384
s_add_u32 m0, s51, 12288
v_mfma_f32_16x16x32_bf16 v[76:79], a[4:7], a[60:63], 0
buffer_load_dwordx4 v9, s[8:11], s43 offen lds
v_mfma_f32_16x16x32_bf16 v[80:83], a[8:11], a[32:35], 0
v_add_u32 v9, 262144, v9
v_mfma_f32_16x16x32_bf16 v[84:87], a[8:11], a[36:39], 0
ds_read_b64_tr_b16 a[118:119], v7 offset:16896
v_mfma_f32_16x16x32_bf16 v[88:91], a[8:11], a[40:43], 0
ds_read_b64_tr_b16 a[120:121], v4 offset:20480
v_mfma_f32_16x16x32_bf16 v[92:95], a[8:11], a[44:47], 0
s_add_u32 m0, s50, 0
v_mfma_f32_16x16x32_bf16 v[96:99], a[8:11], a[48:51], 0
buffer_load_dwordx4 v8, s[4:7], s24 offen lds
v_mfma_f32_16x16x32_bf16 v[100:103], a[8:11], a[52:55], 0
ds_read_b64_tr_b16 a[122:123], v4 offset:20992
v_mfma_f32_16x16x32_bf16 v[104:107], a[8:11], a[56:59], 0
v_mfma_f32_16x16x32_bf16 v[108:111], a[8:11], a[60:63], 0
ds_read_b64_tr_b16 a[124:125], v5 offset:20480
s_add_u32 m0, s50, 4096
v_mfma_f32_16x16x32_bf16 v[112:115], a[12:15], a[32:35], 0
buffer_load_dwordx4 v8, s[4:7], s25 offen lds
v_mfma_f32_16x16x32_bf16 v[116:119], a[12:15], a[36:39], 0
v_mfma_f32_16x16x32_bf16 v[120:123], a[12:15], a[40:43], 0
ds_read_b64_tr_b16 a[126:127], v5 offset:20992
s_add_u32 m0, s50, 8192
v_mfma_f32_16x16x32_bf16 v[124:127], a[12:15], a[44:47], 0
buffer_load_dwordx4 v8, s[4:7], s26 offen lds
v_mfma_f32_16x16x32_bf16 v[128:131], a[12:15], a[48:51], 0
v_mfma_f32_16x16x32_bf16 v[132:135], a[12:15], a[52:55], 0
ds_read_b64_tr_b16 a[128:129], v6 offset:20480
v_mfma_f32_16x16x32_bf16 v[136:139], a[12:15], a[56:59], 0
ds_read_b64_tr_b16 a[130:131], v6 offset:20992
v_mfma_f32_16x16x32_bf16 v[140:143], a[12:15], a[60:63], 0
s_add_u32 m0, s50, 12288
v_mfma_f32_16x16x32_bf16 v[144:147], a[16:19], a[32:35], 0
buffer_load_dwordx4 v8, s[4:7], s27 offen lds
v_mfma_f32_16x16x32_bf16 v[148:151], a[16:19], a[36:39], 0
ds_read_b64_tr_b16 a[132:133], v7 offset:20480
v_mfma_f32_16x16x32_bf16 v[152:155], a[16:19], a[40:43], 0
v_mfma_f32_16x16x32_bf16 v[156:159], a[16:19], a[44:47], 0
ds_read_b64_tr_b16 a[134:135], v7 offset:20992
s_add_u32 m0, s50, 16384
v_mfma_f32_16x16x32_bf16 v[160:163], a[16:19], a[48:51], 0
buffer_load_dwordx4 v8, s[4:7], s28 offen lds
v_mfma_f32_16x16x32_bf16 v[164:167], a[16:19], a[52:55], 0
v_mfma_f32_16x16x32_bf16 v[168:171], a[16:19], a[56:59], 0
ds_read_b128 a[72:75], v3 offset:0
v_mfma_f32_16x16x32_bf16 v[172:175], a[16:19], a[60:63], 0
ds_read_b128 a[76:79], v3 offset:2048
v_mfma_f32_16x16x32_bf16 v[176:179], a[20:23], a[32:35], 0
s_add_u32 m0, s50, 20480
v_mfma_f32_16x16x32_bf16 v[180:183], a[20:23], a[36:39], 0
buffer_load_dwordx4 v8, s[4:7], s29 offen lds
v_mfma_f32_16x16x32_bf16 v[184:187], a[20:23], a[40:43], 0
ds_read_b128 a[80:83], v3 offset:4096
v_mfma_f32_16x16x32_bf16 v[188:191], a[20:23], a[44:47], 0
v_mfma_f32_16x16x32_bf16 v[192:195], a[20:23], a[48:51], 0
ds_read_b128 a[84:87], v3 offset:6144
s_add_u32 m0, s50, 24576
v_mfma_f32_16x16x32_bf16 v[196:199], a[20:23], a[52:55], 0
buffer_load_dwordx4 v8, s[4:7], s30 offen lds
v_mfma_f32_16x16x32_bf16 v[200:203], a[20:23], a[56:59], 0
v_mfma_f32_16x16x32_bf16 v[204:207], a[20:23], a[60:63], 0
ds_read_b128 a[88:91], v3 offset:8192
v_mfma_f32_16x16x32_bf16 v[208:211], a[24:27], a[32:35], 0
ds_read_b128 a[92:95], v3 offset:10240
v_mfma_f32_16x16x32_bf16 v[212:215], a[24:27], a[36:39], 0
s_add_u32 m0, s50, 28672
v_mfma_f32_16x16x32_bf16 v[216:219], a[24:27], a[40:43], 0
buffer_load_dwordx4 v8, s[4:7], s31 offen lds
v_mfma_f32_16x16x32_bf16 v[220:223], a[24:27], a[44:47], 0
ds_read_b128 a[96:99], v3 offset:12288
v_add_u32 v8, 128, v8
v_mfma_f32_16x16x32_bf16 v[224:227], a[24:27], a[48:51], 0
v_mfma_f32_16x16x32_bf16 v[228:231], a[24:27], a[52:55], 0
buffer_load_dword v14, v15, s[76:79], 0 offen sc0 sc1
v_mfma_f32_16x16x32_bf16 v[232:235], a[24:27], a[56:59], 0
ds_read_b128 a[100:103], v3 offset:14336
v_mfma_f32_16x16x32_bf16 v[236:239], a[24:27], a[60:63], 0
v_mfma_f32_16x16x32_bf16 v[240:243], a[28:31], a[32:35], 0
v_mfma_f32_16x16x32_bf16 v[244:247], a[28:31], a[36:39], 0
v_mfma_f32_16x16x32_bf16 v[248:251], a[28:31], a[40:43], 0
v_mfma_f32_16x16x32_bf16 v[252:255], a[28:31], a[44:47], 0
v_mfma_f32_16x16x32_bf16 a[144:147], a[28:31], a[48:51], 0
v_mfma_f32_16x16x32_bf16 a[148:151], a[28:31], a[52:55], 0
v_mfma_f32_16x16x32_bf16 a[152:155], a[28:31], a[56:59], 0
v_mfma_f32_16x16x32_bf16 a[156:159], a[28:31], a[60:63], 0
s_waitcnt vmcnt(16) lgkmcnt(0)
s_barrier
v_mfma_f32_16x16x32_bf16 v[16:19], a[72:75], a[104:107], v[16:19]
s_add_u32 s50, s49, s51
s_add_u32 s49, s49, 32768
s_cmp_eq_u32 s49, 163840
v_mfma_f32_16x16x32_bf16 v[20:23], a[72:75], a[108:111], v[20:23]
s_cselect_b32 s49, 65536, s49
v_add_u32 v2, s49, v1
v_xor_b32 v3, 64, v2
v_mfma_f32_16x16x32_bf16 v[24:27], a[72:75], a[112:115], v[24:27]
ds_read_b64_tr_b16 a[32:33], v4 offset:32768
v_mfma_f32_16x16x32_bf16 v[28:31], a[72:75], a[116:119], v[28:31]
ds_read_b64_tr_b16 a[34:35], v4 offset:33280
v_mfma_f32_16x16x32_bf16 v[32:35], a[72:75], a[120:123], v[32:35]
ds_read_b64_tr_b16 a[36:37], v5 offset:32768
v_mfma_f32_16x16x32_bf16 v[36:39], a[72:75], a[124:127], v[36:39]
v_mfma_f32_16x16x32_bf16 v[40:43], a[72:75], a[128:131], v[40:43]
ds_read_b64_tr_b16 a[38:39], v5 offset:33280
s_add_u32 m0, s51, 16384
v_mfma_f32_16x16x32_bf16 v[44:47], a[72:75], a[132:135], v[44:47]
buffer_load_dwordx4 v9, s[8:11], s40 offen lds
v_mfma_f32_16x16x32_bf16 v[48:51], a[76:79], a[104:107], v[48:51]
v_mfma_f32_16x16x32_bf16 v[52:55], a[76:79], a[108:111], v[52:55]
ds_read_b64_tr_b16 a[40:41], v6 offset:32768
v_mfma_f32_16x16x32_bf16 v[56:59], a[76:79], a[112:115], v[56:59]
ds_read_b64_tr_b16 a[42:43], v6 offset:33280
v_mfma_f32_16x16x32_bf16 v[60:63], a[76:79], a[116:119], v[60:63]
v_mfma_f32_16x16x32_bf16 v[64:67], a[76:79], a[120:123], v[64:67]
ds_read_b64_tr_b16 a[44:45], v7 offset:32768
v_mfma_f32_16x16x32_bf16 v[68:71], a[76:79], a[124:127], v[68:71]
ds_read_b64_tr_b16 a[46:47], v7 offset:33280
v_mfma_f32_16x16x32_bf16 v[72:75], a[76:79], a[128:131], v[72:75]
v_mfma_f32_16x16x32_bf16 v[76:79], a[76:79], a[132:135], v[76:79]
ds_read_b64_tr_b16 a[48:49], v4 offset:36864
s_add_u32 m0, s51, 20480
v_mfma_f32_16x16x32_bf16 v[80:83], a[80:83], a[104:107], v[80:83]
buffer_load_dwordx4 v9, s[8:11], s41 offen lds
v_mfma_f32_16x16x32_bf16 v[84:87], a[80:83], a[108:111], v[84:87]
v_mfma_f32_16x16x32_bf16 v[88:91], a[80:83], a[112:115], v[88:91]
ds_read_b64_tr_b16 a[50:51], v4 offset:37376
v_mfma_f32_16x16x32_bf16 v[92:95], a[80:83], a[116:119], v[92:95]
ds_read_b64_tr_b16 a[52:53], v5 offset:36864
v_mfma_f32_16x16x32_bf16 v[96:99], a[80:83], a[120:123], v[96:99]
v_mfma_f32_16x16x32_bf16 v[100:103], a[80:83], a[124:127], v[100:103]
ds_read_b64_tr_b16 a[54:55], v5 offset:37376
v_mfma_f32_16x16x32_bf16 v[104:107], a[80:83], a[128:131], v[104:107]
ds_read_b64_tr_b16 a[56:57], v6 offset:36864
v_mfma_f32_16x16x32_bf16 v[108:111], a[80:83], a[132:135], v[108:111]
v_mfma_f32_16x16x32_bf16 v[112:115], a[84:87], a[104:107], v[112:115]
ds_read_b64_tr_b16 a[58:59], v6 offset:37376
s_add_u32 m0, s51, 24576
v_mfma_f32_16x16x32_bf16 v[116:119], a[84:87], a[108:111], v[116:119]
buffer_load_dwordx4 v9, s[8:11], s42 offen lds
v_mfma_f32_16x16x32_bf16 v[120:123], a[84:87], a[112:115], v[120:123]
v_mfma_f32_16x16x32_bf16 v[124:127], a[84:87], a[116:119], v[124:127]
ds_read_b64_tr_b16 a[60:61], v7 offset:36864
v_mfma_f32_16x16x32_bf16 v[128:131], a[84:87], a[120:123], v[128:131]
ds_read_b64_tr_b16 a[62:63], v7 offset:37376
v_mfma_f32_16x16x32_bf16 v[132:135], a[84:87], a[124:127], v[132:135]
v_mfma_f32_16x16x32_bf16 v[136:139], a[84:87], a[128:131], v[136:139]
ds_read_b128 a[0:3], v2 offset:0
v_mfma_f32_16x16x32_bf16 v[140:143], a[84:87], a[132:135], v[140:143]
ds_read_b128 a[4:7], v2 offset:2048
v_mfma_f32_16x16x32_bf16 v[144:147], a[88:91], a[104:107], v[144:147]
v_mfma_f32_16x16x32_bf16 v[148:151], a[88:91], a[108:111], v[148:151]
ds_read_b128 a[8:11], v2 offset:4096
s_add_u32 m0, s51, 28672
v_mfma_f32_16x16x32_bf16 v[152:155], a[88:91], a[112:115], v[152:155]
buffer_load_dwordx4 v9, s[8:11], s43 offen lds
v_mfma_f32_16x16x32_bf16 v[156:159], a[88:91], a[116:119], v[156:159]
v_add_u32 v9, 262144, v9
v_mfma_f32_16x16x32_bf16 v[160:163], a[88:91], a[120:123], v[160:163]
ds_read_b128 a[12:15], v2 offset:6144
v_mfma_f32_16x16x32_bf16 v[164:167], a[88:91], a[124:127], v[164:167]
ds_read_b128 a[16:19], v2 offset:8192
v_mfma_f32_16x16x32_bf16 v[168:171], a[88:91], a[128:131], v[168:171]
v_mfma_f32_16x16x32_bf16 v[172:175], a[88:91], a[132:135], v[172:175]
ds_read_b128 a[20:23], v2 offset:10240
v_mfma_f32_16x16x32_bf16 v[176:179], a[92:95], a[104:107], v[176:179]
ds_read_b128 a[24:27], v2 offset:12288
v_mfma_f32_16x16x32_bf16 v[180:183], a[92:95], a[108:111], v[180:183]
v_mfma_f32_16x16x32_bf16 v[184:187], a[92:95], a[112:115], v[184:187]
buffer_load_dwordx4 a[136:139], v12, s[56:59], s96 offen
v_mfma_f32_16x16x32_bf16 v[188:191], a[92:95], a[116:119], v[188:191]
ds_read_b128 a[28:31], v2 offset:14336
v_mfma_f32_16x16x32_bf16 v[192:195], a[92:95], a[120:123], v[192:195]
v_mfma_f32_16x16x32_bf16 v[196:199], a[92:95], a[124:127], v[196:199]
v_mfma_f32_16x16x32_bf16 v[200:203], a[92:95], a[128:131], v[200:203]
v_mfma_f32_16x16x32_bf16 v[204:207], a[92:95], a[132:135], v[204:207]
v_mfma_f32_16x16x32_bf16 v[208:211], a[96:99], a[104:107], v[208:211]
v_mfma_f32_16x16x32_bf16 v[212:215], a[96:99], a[108:111], v[212:215]
v_mfma_f32_16x16x32_bf16 v[216:219], a[96:99], a[112:115], v[216:219]
v_mfma_f32_16x16x32_bf16 v[220:223], a[96:99], a[116:119], v[220:223]
v_mfma_f32_16x16x32_bf16 v[224:227], a[96:99], a[120:123], v[224:227]
v_mfma_f32_16x16x32_bf16 v[228:231], a[96:99], a[124:127], v[228:231]
v_mfma_f32_16x16x32_bf16 v[232:235], a[96:99], a[128:131], v[232:235]
v_mfma_f32_16x16x32_bf16 v[236:239], a[96:99], a[132:135], v[236:239]
v_mfma_f32_16x16x32_bf16 v[240:243], a[100:103], a[104:107], v[240:243]
v_mfma_f32_16x16x32_bf16 v[244:247], a[100:103], a[108:111], v[244:247]
v_mfma_f32_16x16x32_bf16 v[248:251], a[100:103], a[112:115], v[248:251]
v_mfma_f32_16x16x32_bf16 v[252:255], a[100:103], a[116:119], v[252:255]
v_mfma_f32_16x16x32_bf16 a[144:147], a[100:103], a[120:123], a[144:147]
v_mfma_f32_16x16x32_bf16 a[148:151], a[100:103], a[124:127], a[148:151]
v_mfma_f32_16x16x32_bf16 a[152:155], a[100:103], a[128:131], a[152:155]
v_mfma_f32_16x16x32_bf16 a[156:159], a[100:103], a[132:135], a[156:159]
s_waitcnt vmcnt(16) lgkmcnt(0)
s_barrier
v_mfma_f32_16x16x32_bf16 v[16:19], a[0:3], a[32:35], v[16:19]
v_mfma_f32_16x16x32_bf16 v[20:23], a[0:3], a[36:39], v[20:23]
ds_read_b64_tr_b16 a[104:105], v4 offset:49152
s_add_u32 m0, s51, 32768
v_mfma_f32_16x16x32_bf16 v[24:27], a[0:3], a[40:43], v[24:27]
buffer_load_dwordx4 v9, s[8:11], s40 offen lds
v_mfma_f32_16x16x32_bf16 v[28:31], a[0:3], a[44:47], v[28:31]
v_mfma_f32_16x16x32_bf16 v[32:35], a[0:3], a[48:51], v[32:35]
ds_read_b64_tr_b16 a[106:107], v4 offset:49664
v_mfma_f32_16x16x32_bf16 v[36:39], a[0:3], a[52:55], v[36:39]
ds_read_b64_tr_b16 a[108:109], v5 offset:49152
v_mfma_f32_16x16x32_bf16 v[40:43], a[0:3], a[56:59], v[40:43]
s_add_u32 m0, s51, 36864
v_mfma_f32_16x16x32_bf16 v[44:47], a[0:3], a[60:63], v[44:47]
buffer_load_dwordx4 v9, s[8:11], s41 offen lds
v_mfma_f32_16x16x32_bf16 v[48:51], a[4:7], a[32:35], v[48:51]
ds_read_b64_tr_b16 a[110:111], v5 offset:49664
v_mfma_f32_16x16x32_bf16 v[52:55], a[4:7], a[36:39], v[52:55]
v_mfma_f32_16x16x32_bf16 v[56:59], a[4:7], a[40:43], v[56:59]
ds_read_b64_tr_b16 a[112:113], v6 offset:49152
s_add_u32 m0, s51, 40960
v_mfma_f32_16x16x32_bf16 v[60:63], a[4:7], a[44:47], v[60:63]
buffer_load_dwordx4 v9, s[8:11], s42 offen lds
v_mfma_f32_16x16x32_bf16 v[64:67], a[4:7], a[48:51], v[64:67]
v_mfma_f32_16x16x32_bf16 v[68:71], a[4:7], a[52:55], v[68:71]
ds_read_b64_tr_b16 a[114:115], v6 offset:49664
v_mfma_f32_16x16x32_bf16 v[72:75], a[4:7], a[56:59], v[72:75]
ds_read_b64_tr_b16 a[116:117], v7 offset:49152
v_mfma_f32_16x16x32_bf16 v[76:79], a[4:7], a[60:63], v[76:79]
s_add_u32 m0, s51, 45056
v_mfma_f32_16x16x32_bf16 v[80:83], a[8:11], a[32:35], v[80:83]
buffer_load_dwordx4 v9, s[8:11], s43 offen lds
v_mfma_f32_16x16x32_bf16 v[84:87], a[8:11], a[36:39], v[84:87]
ds_read_b64_tr_b16 a[118:119], v7 offset:49664
v_add_u32 v9, 262144, v9
v_mfma_f32_16x16x32_bf16 v[88:91], a[8:11], a[40:43], v[88:91]
v_mfma_f32_16x16x32_bf16 v[92:95], a[8:11], a[44:47], v[92:95]
ds_read_b64_tr_b16 a[120:121], v4 offset:53248
s_add_u32 m0, s50, 0
v_mfma_f32_16x16x32_bf16 v[96:99], a[8:11], a[48:51], v[96:99]
buffer_load_dwordx4 v8, s[4:7], s24 offen lds
v_mfma_f32_16x16x32_bf16 v[100:103], a[8:11], a[52:55], v[100:103]
v_mfma_f32_16x16x32_bf16 v[104:107], a[8:11], a[56:59], v[104:107]
ds_read_b64_tr_b16 a[122:123], v4 offset:53760
v_mfma_f32_16x16x32_bf16 v[108:111], a[8:11], a[60:63], v[108:111]
ds_read_b64_tr_b16 a[124:125], v5 offset:53248
v_mfma_f32_16x16x32_bf16 v[112:115], a[12:15], a[32:35], v[112:115]
s_add_u32 m0, s50, 4096
v_mfma_f32_16x16x32_bf16 v[116:119], a[12:15], a[36:39], v[116:119]
buffer_load_dwordx4 v8, s[4:7], s25 offen lds
v_mfma_f32_16x16x32_bf16 v[120:123], a[12:15], a[40:43], v[120:123]
ds_read_b64_tr_b16 a[126:127], v5 offset:53760
v_mfma_f32_16x16x32_bf16 v[124:127], a[12:15], a[44:47], v[124:127]
v_mfma_f32_16x16x32_bf16 v[128:131], a[12:15], a[48:51], v[128:131]
ds_read_b64_tr_b16 a[128:129], v6 offset:53248
s_add_u32 m0, s50, 8192
v_mfma_f32_16x16x32_bf16 v[132:135], a[12:15], a[52:55], v[132:135]
buffer_load_dwordx4 v8, s[4:7], s26 offen lds
v_mfma_f32_16x16x32_bf16 v[136:139], a[12:15], a[56:59], v[136:139]
v_mfma_f32_16x16x32_bf16 v[140:143], a[12:15], a[60:63], v[140:143]
ds_read_b64_tr_b16 a[130:131], v6 offset:53760
v_mfma_f32_16x16x32_bf16 v[144:147], a[16:19], a[32:35], v[144:147]
ds_read_b64_tr_b16 a[132:133], v7 offset:53248
v_mfma_f32_16x16x32_bf16 v[148:151], a[16:19], a[36:39], v[148:151]
s_add_u32 m0, s50, 12288
v_mfma_f32_16x16x32_bf16 v[152:155], a[16:19], a[40:43], v[152:155]
buffer_load_dwordx4 v8, s[4:7], s27 offen lds
v_mfma_f32_16x16x32_bf16 v[156:159], a[16:19], a[44:47], v[156:159]
ds_read_b64_tr_b16 a[134:135], v7 offset:53760
v_mfma_f32_16x16x32_bf16 v[160:163], a[16:19], a[48:51], v[160:163]
v_mfma_f32_16x16x32_bf16 v[164:167], a[16:19], a[52:55], v[164:167]
ds_read_b128 a[72:75], v3 offset:0
s_add_u32 m0, s50, 16384
v_mfma_f32_16x16x32_bf16 v[168:171], a[16:19], a[56:59], v[168:171]
buffer_load_dwordx4 v8, s[4:7], s28 offen lds
v_mfma_f32_16x16x32_bf16 v[172:175], a[16:19], a[60:63], v[172:175]
v_mfma_f32_16x16x32_bf16 v[176:179], a[20:23], a[32:35], v[176:179]
ds_read_b128 a[76:79], v3 offset:2048
v_mfma_f32_16x16x32_bf16 v[180:183], a[20:23], a[36:39], v[180:183]
ds_read_b128 a[80:83], v3 offset:4096
v_mfma_f32_16x16x32_bf16 v[184:187], a[20:23], a[40:43], v[184:187]
s_add_u32 m0, s50, 20480
v_mfma_f32_16x16x32_bf16 v[188:191], a[20:23], a[44:47], v[188:191]
buffer_load_dwordx4 v8, s[4:7], s29 offen lds
v_mfma_f32_16x16x32_bf16 v[192:195], a[20:23], a[48:51], v[192:195]
ds_read_b128 a[84:87], v3 offset:6144
v_mfma_f32_16x16x32_bf16 v[196:199], a[20:23], a[52:55], v[196:199]
v_mfma_f32_16x16x32_bf16 v[200:203], a[20:23], a[56:59], v[200:203]
ds_read_b128 a[88:91], v3 offset:8192
s_add_u32 m0, s50, 24576
v_mfma_f32_16x16x32_bf16 v[204:207], a[20:23], a[60:63], v[204:207]
buffer_load_dwordx4 v8, s[4:7], s30 offen lds
v_mfma_f32_16x16x32_bf16 v[208:211], a[24:27], a[32:35], v[208:211]
v_mfma_f32_16x16x32_bf16 v[212:215], a[24:27], a[36:39], v[212:215]
ds_read_b128 a[92:95], v3 offset:10240
v_mfma_f32_16x16x32_bf16 v[216:219], a[24:27], a[40:43], v[216:219]
ds_read_b128 a[96:99], v3 offset:12288
v_mfma_f32_16x16x32_bf16 v[220:223], a[24:27], a[44:47], v[220:223]
s_add_u32 m0, s50, 28672
v_mfma_f32_16x16x32_bf16 v[224:227], a[24:27], a[48:51], v[224:227]
buffer_load_dwordx4 v8, s[4:7], s31 offen lds
v_mfma_f32_16x16x32_bf16 v[228:231], a[24:27], a[52:55], v[228:231]
ds_read_b128 a[100:103], v3 offset:14336
v_add_u32 v8, 128, v8
v_mfma_f32_16x16x32_bf16 v[232:235], a[24:27], a[56:59], v[232:235]
v_mfma_f32_16x16x32_bf16 v[236:239], a[24:27], a[60:63], v[236:239]
v_mfma_f32_16x16x32_bf16 v[240:243], a[28:31], a[32:35], v[240:243]
v_mfma_f32_16x16x32_bf16 v[244:247], a[28:31], a[36:39], v[244:247]
v_mfma_f32_16x16x32_bf16 v[248:251], a[28:31], a[40:43], v[248:251]
v_mfma_f32_16x16x32_bf16 v[252:255], a[28:31], a[44:47], v[252:255]
v_mfma_f32_16x16x32_bf16 a[144:147], a[28:31], a[48:51], a[144:147]
v_mfma_f32_16x16x32_bf16 a[148:151], a[28:31], a[52:55], a[148:151]
v_mfma_f32_16x16x32_bf16 a[152:155], a[28:31], a[56:59], a[152:155]
v_mfma_f32_16x16x32_bf16 a[156:159], a[28:31], a[60:63], a[156:159]
s_waitcnt vmcnt(16) lgkmcnt(0)
s_barrier
v_mfma_f32_16x16x32_bf16 v[16:19], a[72:75], a[104:107], v[16:19]
s_add_u32 s50, s49, s51
s_add_u32 s49, s49, 32768
s_cmp_eq_u32 s49, 163840
v_mfma_f32_16x16x32_bf16 v[20:23], a[72:75], a[108:111], v[20:23]
s_cselect_b32 s49, 65536, s49
v_add_u32 v2, s49, v1
v_xor_b32 v3, 64, v2
v_mfma_f32_16x16x32_bf16 v[24:27], a[72:75], a[112:115], v[24:27]
ds_read_b64_tr_b16 a[32:33], v4 offset:0
v_mfma_f32_16x16x32_bf16 v[28:31], a[72:75], a[116:119], v[28:31]
ds_read_b64_tr_b16 a[34:35], v4 offset:512
v_mfma_f32_16x16x32_bf16 v[32:35], a[72:75], a[120:123], v[32:35]
v_mfma_f32_16x16x32_bf16 v[36:39], a[72:75], a[124:127], v[36:39]
ds_read_b64_tr_b16 a[36:37], v5 offset:0
v_mfma_f32_16x16x32_bf16 v[40:43], a[72:75], a[128:131], v[40:43]
ds_read_b64_tr_b16 a[38:39], v5 offset:512
v_mfma_f32_16x16x32_bf16 v[44:47], a[72:75], a[132:135], v[44:47]
v_mfma_f32_16x16x32_bf16 v[48:51], a[76:79], a[104:107], v[48:51]
ds_read_b64_tr_b16 a[40:41], v6 offset:0
s_add_u32 m0, s51, 49152
v_mfma_f32_16x16x32_bf16 v[52:55], a[76:79], a[108:111], v[52:55]
buffer_load_dwordx4 v9, s[8:11], s40 offen lds
v_mfma_f32_16x16x32_bf16 v[56:59], a[76:79], a[112:115], v[56:59]
v_mfma_f32_16x16x32_bf16 v[60:63], a[76:79], a[116:119], v[60:63]
ds_read_b64_tr_b16 a[42:43], v6 offset:512
v_mfma_f32_16x16x32_bf16 v[64:67], a[76:79], a[120:123], v[64:67]
ds_read_b64_tr_b16 a[44:45], v7 offset:0
v_mfma_f32_16x16x32_bf16 v[68:71], a[76:79], a[124:127], v[68:71]
v_mfma_f32_16x16x32_bf16 v[72:75], a[76:79], a[128:131], v[72:75]
ds_read_b64_tr_b16 a[46:47], v7 offset:512
v_mfma_f32_16x16x32_bf16 v[76:79], a[76:79], a[132:135], v[76:79]
ds_read_b64_tr_b16 a[48:49], v4 offset:4096
v_mfma_f32_16x16x32_bf16 v[80:83], a[80:83], a[104:107], v[80:83]
v_mfma_f32_16x16x32_bf16 v[84:87], a[80:83], a[108:111], v[84:87]
ds_read_b64_tr_b16 a[50:51], v4 offset:4608
v_mfma_f32_16x16x32_bf16 v[88:91], a[80:83], a[112:115], v[88:91]
ds_read_b64_tr_b16 a[52:53], v5 offset:4096
v_mfma_f32_16x16x32_bf16 v[92:95], a[80:83], a[116:119], v[92:95]
s_add_u32 m0, s51, 53248
v_mfma_f32_16x16x32_bf16 v[96:99], a[80:83], a[120:123], v[96:99]
buffer_load_dwordx4 v9, s[8:11], s41 offen lds
v_mfma_f32_16x16x32_bf16 v[100:103], a[80:83], a[124:127], v[100:103]
ds_read_b64_tr_b16 a[54:55], v5 offset:4608
v_mfma_f32_16x16x32_bf16 v[104:107], a[80:83], a[128:131], v[104:107]
v_mfma_f32_16x16x32_bf16 v[108:111], a[80:83], a[132:135], v[108:111]
ds_read_b64_tr_b16 a[56:57], v6 offset:4096
v_mfma_f32_16x16x32_bf16 v[112:115], a[84:87], a[104:107], v[112:115]
ds_read_b64_tr_b16 a[58:59], v6 offset:4608
v_mfma_f32_16x16x32_bf16 v[116:119], a[84:87], a[108:111], v[116:119]
v_mfma_f32_16x16x32_bf16 v[120:123], a[84:87], a[112:115], v[120:123]
ds_read_b64_tr_b16 a[60:61], v7 offset:4096
v_mfma_f32_16x16x32_bf16 v[124:127], a[84:87], a[116:119], v[124:127]
ds_read_b64_tr_b16 a[62:63], v7 offset:4608
v_mfma_f32_16x16x32_bf16 v[128:131], a[84:87], a[120:123], v[128:131]
v_mfma_f32_16x16x32_bf16 v[132:135], a[84:87], a[124:127], v[132:135]
ds_read_b128 a[0:3], v2 offset:0
s_add_u32 m0, s51, 57344
v_mfma_f32_16x16x32_bf16 v[136:139], a[84:87], a[128:131], v[136:139]
buffer_load_dwordx4 v9, s[8:11], s42 offen lds
v_mfma_f32_16x16x32_bf16 v[140:143], a[84:87], a[132:135], v[140:143]
v_mfma_f32_16x16x32_bf16 v[144:147], a[88:91], a[104:107], v[144:147]
ds_read_b128 a[4:7], v2 offset:2048
v_mfma_f32_16x16x32_bf16 v[148:151], a[88:91], a[108:111], v[148:151]
ds_read_b128 a[8:11], v2 offset:4096
v_mfma_f32_16x16x32_bf16 v[152:155], a[88:91], a[112:115], v[152:155]
v_mfma_f32_16x16x32_bf16 v[156:159], a[88:91], a[116:119], v[156:159]
ds_read_b128 a[12:15], v2 offset:6144
v_mfma_f32_16x16x32_bf16 v[160:163], a[88:91], a[120:123], v[160:163]
ds_read_b128 a[16:19], v2 offset:8192
v_mfma_f32_16x16x32_bf16 v[164:167], a[88:91], a[124:127], v[164:167]
v_mfma_f32_16x16x32_bf16 v[168:171], a[88:91], a[128:131], v[168:171]
ds_read_b128 a[20:23], v2 offset:10240
v_mfma_f32_16x16x32_bf16 v[172:175], a[88:91], a[132:135], v[172:175]
ds_read_b128 a[24:27], v2 offset:12288
v_mfma_f32_16x16x32_bf16 v[176:179], a[92:95], a[104:107], v[176:179]
s_add_u32 m0, s51, 61440
v_mfma_f32_16x16x32_bf16 v[180:183], a[92:95], a[108:111], v[180:183]
buffer_load_dwordx4 v9, s[8:11], s43 offen lds
v_mfma_f32_16x16x32_bf16 v[184:187], a[92:95], a[112:115], v[184:187]
ds_read_b128 a[28:31], v2 offset:14336
v_add_u32 v9, 262144, v9
v_mfma_f32_16x16x32_bf16 v[188:191], a[92:95], a[116:119], v[188:191]
v_mfma_f32_16x16x32_bf16 v[192:195], a[92:95], a[120:123], v[192:195]
v_mfma_f32_16x16x32_bf16 v[196:199], a[92:95], a[124:127], v[196:199]
v_mfma_f32_16x16x32_bf16 v[200:203], a[92:95], a[128:131], v[200:203]
v_mfma_f32_16x16x32_bf16 v[204:207], a[92:95], a[132:135], v[204:207]
v_mfma_f32_16x16x32_bf16 v[208:211], a[96:99], a[104:107], v[208:211]
v_mfma_f32_16x16x32_bf16 v[212:215], a[96:99], a[108:111], v[212:215]
v_mfma_f32_16x16x32_bf16 v[216:219], a[96:99], a[112:115], v[216:219]
v_mfma_f32_16x16x32_bf16 v[220:223], a[96:99], a[116:119], v[220:223]
v_mfma_f32_16x16x32_bf16 v[224:227], a[96:99], a[120:123], v[224:227]
v_mfma_f32_16x16x32_bf16 v[228:231], a[96:99], a[124:127], v[228:231]
v_mfma_f32_16x16x32_bf16 v[232:235], a[96:99], a[128:131], v[232:235]
v_mfma_f32_16x16x32_bf16 v[236:239], a[96:99], a[132:135], v[236:239]
v_mfma_f32_16x16x32_bf16 v[240:243], a[100:103], a[104:107], v[240:243]
v_mfma_f32_16x16x32_bf16 v[244:247], a[100:103], a[108:111], v[244:247]
v_mfma_f32_16x16x32_bf16 v[248:251], a[100:103], a[112:115], v[248:251]
v_mfma_f32_16x16x32_bf16 v[252:255], a[100:103], a[116:119], v[252:255]
v_mfma_f32_16x16x32_bf16 a[144:147], a[100:103], a[120:123], a[144:147]
v_mfma_f32_16x16x32_bf16 a[148:151], a[100:103], a[124:127], a[148:151]
v_mfma_f32_16x16x32_bf16 a[152:155], a[100:103], a[128:131], a[152:155]
v_mfma_f32_16x16x32_bf16 a[156:159], a[100:103], a[132:135], a[156:159]
v_readfirstlane_b32 s89, v14
s_load_dwordx2 s[96:97], s[0:1], 64
s_cmp_lg_u32 s89, 0
s_cbranch_scc0 LM_tagVwait
LM_tagVret:
s_cmp_eq_u32 s65, 2
s_cbranch_scc1 LM_nogV
s_cmp_lg_u32 s48, 0
s_cbranch_scc1 LM_noflgV
v_mov_b32 v14, s89
v_mov_b32 v15, 0
s_mov_b64 exec, 1
buffer_store_dword v14, v15, s[20:23], s3 offen sc0 sc1
s_mov_b64 exec, -1
LM_noflgV:
LM_nogV:
s_cmp_lt_u32 s48, 2
s_waitcnt lgkmcnt(0)
s_cselect_b32 s76, s86, s96
s_cselect_b32 s77, s87, s97
s_mov_b32 s78, 3670016
s_mov_b32 s56, s82
s_mov_b32 s57, s83
s_cselect_b32 s58, 1835008, 0
s_mov_b32 s59, 0x20000
s_and_b32 s53, s48, 1
s_mul_i32 s54, s53, 7168
s_mul_i32 s96, s2, 14336
s_add_u32 s96, s96, s54
s_mul_i32 s54, s53, 3584
s_mul_i32 s97, s2, 7168
s_add_u32 s97, s97, s54
s_mov_b32 s52, 6
buffer_load_dwordx4 a[136:139], v12, s[76:79], s96 offen
s_add_u32 s96, s96, 1024
.p2align 6
LM_loopV:
s_waitcnt vmcnt(16) lgkmcnt(0)
s_barrier
v_mfma_f32_16x16x32_bf16 v[16:19], a[0:3], a[32:35], v[16:19]
v_mfma_f32_16x16x32_bf16 v[20:23], a[0:3], a[36:39], v[20:23]
ds_read_b64_tr_b16 a[104:105], v4 offset:16384
s_add_u32 m0, s51, 0
v_mfma_f32_16x16x32_bf16 v[24:27], a[0:3], a[40:43], v[24:27]
buffer_load_dwordx4 v9, s[8:11], s40 offen lds
v_mfma_f32_16x16x32_bf16 v[28:31], a[0:3], a[44:47], v[28:31]
v_mfma_f32_16x16x32_bf16 v[32:35], a[0:3], a[48:51], v[32:35]
ds_read_b64_tr_b16 a[106:107], v4 offset:16896
v_mfma_f32_16x16x32_bf16 v[36:39], a[0:3], a[52:55], v[36:39]
ds_read_b64_tr_b16 a[108:109], v5 offset:16384
v_mfma_f32_16x16x32_bf16 v[40:43], a[0:3], a[56:59], v[40:43]
s_add_u32 m0, s51, 4096
v_mfma_f32_16x16x32_bf16 v[44:47], a[0:3], a[60:63], v[44:47]
buffer_load_dwordx4 v9, s[8:11], s41 offen lds
v_mfma_f32_16x16x32_bf16 v[48:51], a[4:7], a[32:35], v[48:51]
ds_read_b64_tr_b16 a[110:111], v5 offset:16896
v_mfma_f32_16x16x32_bf16 v[52:55], a[4:7], a[36:39], v[52:55]
v_mfma_f32_16x16x32_bf16 v[56:59], a[4:7], a[40:43], v[56:59]
ds_read_b64_tr_b16 a[112:113], v6 offset:16384
s_add_u32 m0, s51, 8192
v_mfma_f32_16x16x32_bf16 v[60:63], a[4:7], a[44:47], v[60:63]
buffer_load_dwordx4 v9, s[8:11], s42 offen lds
v_mfma_f32_16x16x32_bf16 v[64:67], a[4:7], a[48:51], v[64:67]
v_mfma_f32_16x16x32_bf16 v[68:71], a[4:7], a[52:55], v[68:71]
ds_read_b64_tr_b16 a[114:115], v6 offset:16896
v_mfma_f32_16x16x32_bf16 v[72:75], a[4:7], a[56:59], v[72:75]
ds_read_b64_tr_b16 a[116:117], v7 offset:16384
v_mfma_f32_16x16x32_bf16 v[76:79], a[4:7], a[60:63], v[76:79]
s_add_u32 m0, s51, 12288
v_mfma_f32_16x16x32_bf16 v[80:83], a[8:11], a[32:35], v[80:83]
buffer_load_dwordx4 v9, s[8:11], s43 offen lds
v_mfma_f32_16x16x32_bf16 v[84:87], a[8:11], a[36:39], v[84:87]
ds_read_b64_tr_b16 a[118:119], v7 offset:16896
v_add_u32 v9, 262144, v9
v_mfma_f32_16x16x32_bf16 v[88:91], a[8:11], a[40:43], v[88:91]
v_mfma_f32_16x16x32_bf16 v[92:95], a[8:11], a[44:47], v[92:95]
ds_read_b64_tr_b16 a[120:121], v4 offset:20480
s_add_u32 m0, s50, 0
v_mfma_f32_16x16x32_bf16 v[96:99], a[8:11], a[48:51], v[96:99]
buffer_load_dwordx4 v8, s[4:7], s24 offen lds
v_mfma_f32_16x16x32_bf16 v[100:103], a[8:11], a[52:55], v[100:103]
v_mfma_f32_16x16x32_bf16 v[104:107], a[8:11], a[56:59], v[104:107]
ds_read_b64_tr_b16 a[122:123], v4 offset:20992
v_mfma_f32_16x16x32_bf16 v[108:111], a[8:11], a[60:63], v[108:111]
ds_read_b64_tr_b16 a[124:125], v5 offset:20480
v_mfma_f32_16x16x32_bf16 v[112:115], a[12:15], a[32:35], v[112:115]
s_add_u32 m0, s50, 4096
v_mfma_f32_16x16x32_bf16 v[116:119], a[12:15], a[36:39], v[116:119]
buffer_load_dwordx4 v8, s[4:7], s25 offen lds
v_mfma_f32_16x16x32_bf16 v[120:123], a[12:15], a[40:43], v[120:123]
ds_read_b64_tr_b16 a[126:127], v5 offset:20992
v_mfma_f32_16x16x32_bf16 v[124:127], a[12:15], a[44:47], v[124:127]
v_mfma_f32_16x16x32_bf16 v[128:131], a[12:15], a[48:51], v[128:131]
ds_read_b64_tr_b16 a[128:129], v6 offset:20480
s_add_u32 m0, s50, 8192
v_mfma_f32_16x16x32_bf16 v[132:135], a[12:15], a[52:55], v[132:135]
buffer_load_dwordx4 v8, s[4:7], s26 offen lds
v_mfma_f32_16x16x32_bf16 v[136:139], a[12:15], a[56:59], v[136:139]
v_mfma_f32_16x16x32_bf16 v[140:143], a[12:15], a[60:63], v[140:143]
ds_read_b64_tr_b16 a[130:131], v6 offset:20992
v_mfma_f32_16x16x32_bf16 v[144:147], a[16:19], a[32:35], v[144:147]
ds_read_b64_tr_b16 a[132:133], v7 offset:20480
v_mfma_f32_16x16x32_bf16 v[148:151], a[16:19], a[36:39], v[148:151]
s_add_u32 m0, s50, 12288
v_mfma_f32_16x16x32_bf16 v[152:155], a[16:19], a[40:43], v[152:155]
buffer_load_dwordx4 v8, s[4:7], s27 offen lds
v_mfma_f32_16x16x32_bf16 v[156:159], a[16:19], a[44:47], v[156:159]
ds_read_b64_tr_b16 a[134:135], v7 offset:20992
v_mfma_f32_16x16x32_bf16 v[160:163], a[16:19], a[48:51], v[160:163]
v_mfma_f32_16x16x32_bf16 v[164:167], a[16:19], a[52:55], v[164:167]
ds_read_b128 a[72:75], v3 offset:0
s_add_u32 m0, s50, 16384
v_mfma_f32_16x16x32_bf16 v[168:171], a[16:19], a[56:59], v[168:171]
buffer_load_dwordx4 v8, s[4:7], s28 offen lds
v_mfma_f32_16x16x32_bf16 v[172:175], a[16:19], a[60:63], v[172:175]
v_mfma_f32_16x16x32_bf16 v[176:179], a[20:23], a[32:35], v[176:179]
ds_read_b128 a[76:79], v3 offset:2048
v_mfma_f32_16x16x32_bf16 v[180:183], a[20:23], a[36:39], v[180:183]
ds_read_b128 a[80:83], v3 offset:4096
v_mfma_f32_16x16x32_bf16 v[184:187], a[20:23], a[40:43], v[184:187]
s_add_u32 m0, s50, 20480
v_mfma_f32_16x16x32_bf16 v[188:191], a[20:23], a[44:47], v[188:191]
buffer_load_dwordx4 v8, s[4:7], s29 offen lds
v_mfma_f32_16x16x32_bf16 v[192:195], a[20:23], a[48:51], v[192:195]
ds_read_b128 a[84:87], v3 offset:6144
v_mfma_f32_16x16x32_bf16 v[196:199], a[20:23], a[52:55], v[196:199]
v_mfma_f32_16x16x32_bf16 v[200:203], a[20:23], a[56:59], v[200:203]
ds_read_b128 a[88:91], v3 offset:8192
s_add_u32 m0, s50, 24576
v_mfma_f32_16x16x32_bf16 v[204:207], a[20:23], a[60:63], v[204:207]
buffer_load_dwordx4 v8, s[4:7], s30 offen lds
v_mfma_f32_16x16x32_bf16 v[208:211], a[24:27], a[32:35], v[208:211]
v_mfma_f32_16x16x32_bf16 v[212:215], a[24:27], a[36:39], v[212:215]
ds_read_b128 a[92:95], v3 offset:10240
v_mfma_f32_16x16x32_bf16 v[216:219], a[24:27], a[40:43], v[216:219]
ds_read_b128 a[96:99], v3 offset:12288
v_mfma_f32_16x16x32_bf16 v[220:223], a[24:27], a[44:47], v[220:223]
s_add_u32 m0, s50, 28672
v_mfma_f32_16x16x32_bf16 v[224:227], a[24:27], a[48:51], v[224:227]
buffer_load_dwordx4 v8, s[4:7], s31 offen lds
v_mfma_f32_16x16x32_bf16 v[228:231], a[24:27], a[52:55], v[228:231]
ds_read_b128 a[100:103], v3 offset:14336
v_add_u32 v8, 128, v8
v_mfma_f32_16x16x32_bf16 v[232:235], a[24:27], a[56:59], v[232:235]
v_mfma_f32_16x16x32_bf16 v[236:239], a[24:27], a[60:63], v[236:239]
v_mfma_f32_16x16x32_bf16 v[240:243], a[28:31], a[32:35], v[240:243]
v_mfma_f32_16x16x32_bf16 v[244:247], a[28:31], a[36:39], v[244:247]
v_mfma_f32_16x16x32_bf16 v[248:251], a[28:31], a[40:43], v[248:251]
v_mfma_f32_16x16x32_bf16 v[252:255], a[28:31], a[44:47], v[252:255]
v_mfma_f32_16x16x32_bf16 a[144:147], a[28:31], a[48:51], a[144:147]
v_mfma_f32_16x16x32_bf16 a[148:151], a[28:31], a[52:55], a[148:151]
v_mfma_f32_16x16x32_bf16 a[152:155], a[28:31], a[56:59], a[152:155]
v_mfma_f32_16x16x32_bf16 a[156:159], a[28:31], a[60:63], a[156:159]
s_waitcnt vmcnt(16) lgkmcnt(0)
s_barrier
v_mfma_f32_16x16x32_bf16 v[16:19], a[72:75], a[104:107], v[16:19]
s_add_u32 s50, s49, s51
s_add_u32 s49, s49, 32768
s_cmp_eq_u32 s49, 163840
v_mfma_f32_16x16x32_bf16 v[20:23], a[72:75], a[108:111], v[20:23]
s_cselect_b32 s49, 65536, s49
v_add_u32 v2, s49, v1
v_xor_b32 v3, 64, v2
v_mfma_f32_16x16x32_bf16 v[24:27], a[72:75], a[112:115], v[24:27]
ds_read_b64_tr_b16 a[32:33], v4 offset:32768
v_mfma_f32_16x16x32_bf16 v[28:31], a[72:75], a[116:119], v[28:31]
ds_read_b64_tr_b16 a[34:35], v4 offset:33280
v_mfma_f32_16x16x32_bf16 v[32:35], a[72:75], a[120:123], v[32:35]
v_mfma_f32_16x16x32_bf16 v[36:39], a[72:75], a[124:127], v[36:39]
ds_read_b64_tr_b16 a[36:37], v5 offset:32768
s_add_u32 m0, s51, 16384
v_mfma_f32_16x16x32_bf16 v[40:43], a[72:75], a[128:131], v[40:43]
buffer_load_dwordx4 v9, s[8:11], s40 offen lds
v_mfma_f32_16x16x32_bf16 v[44:47], a[72:75], a[132:135], v[44:47]
v_mfma_f32_16x16x32_bf16 v[48:51], a[76:79], a[104:107], v[48:51]
ds_read_b64_tr_b16 a[38:39], v5 offset:33280
v_mfma_f32_16x16x32_bf16 v[52:55], a[76:79], a[108:111], v[52:55]
ds_read_b64_tr_b16 a[40:41], v6 offset:32768
v_mfma_f32_16x16x32_bf16 v[56:59], a[76:79], a[112:115], v[56:59]
v_mfma_f32_16x16x32_bf16 v[60:63], a[76:79], a[116:119], v[60:63]
ds_read_b64_tr_b16 a[42:43], v6 offset:33280
v_mfma_f32_16x16x32_bf16 v[64:67], a[76:79], a[120:123], v[64:67]
ds_read_b64_tr_b16 a[44:45], v7 offset:32768
v_mfma_f32_16x16x32_bf16 v[68:71], a[76:79], a[124:127], v[68:71]
s_add_u32 m0, s51, 20480
v_mfma_f32_16x16x32_bf16 v[72:75], a[76:79], a[128:131], v[72:75]
buffer_load_dwordx4 v9, s[8:11], s41 offen lds
v_mfma_f32_16x16x32_bf16 v[76:79], a[76:79], a[132:135], v[76:79]
ds_read_b64_tr_b16 a[46:47], v7 offset:33280
v_mfma_f32_16x16x32_bf16 v[80:83], a[80:83], a[104:107], v[80:83]
v_mfma_f32_16x16x32_bf16 v[84:87], a[80:83], a[108:111], v[84:87]
ds_read_b64_tr_b16 a[48:49], v4 offset:36864
v_mfma_f32_16x16x32_bf16 v[88:91], a[80:83], a[112:115], v[88:91]
ds_read_b64_tr_b16 a[50:51], v4 offset:37376
v_mfma_f32_16x16x32_bf16 v[92:95], a[80:83], a[116:119], v[92:95]
v_mfma_f32_16x16x32_bf16 v[96:99], a[80:83], a[120:123], v[96:99]
ds_read_b64_tr_b16 a[52:53], v5 offset:36864
s_add_u32 m0, s51, 24576
v_mfma_f32_16x16x32_bf16 v[100:103], a[80:83], a[124:127], v[100:103]
buffer_load_dwordx4 v9, s[8:11], s42 offen lds
v_mfma_f32_16x16x32_bf16 v[104:107], a[80:83], a[128:131], v[104:107]
v_mfma_f32_16x16x32_bf16 v[108:111], a[80:83], a[132:135], v[108:111]
ds_read_b64_tr_b16 a[54:55], v5 offset:37376
v_mfma_f32_16x16x32_bf16 v[112:115], a[84:87], a[104:107], v[112:115]
ds_read_b64_tr_b16 a[56:57], v6 offset:36864
v_mfma_f32_16x16x32_bf16 v[116:119], a[84:87], a[108:111], v[116:119]
v_mfma_f32_16x16x32_bf16 v[120:123], a[84:87], a[112:115], v[120:123]
ds_read_b64_tr_b16 a[58:59], v6 offset:37376
v_mfma_f32_16x16x32_bf16 v[124:127], a[84:87], a[116:119], v[124:127]
ds_read_b64_tr_b16 a[60:61], v7 offset:36864
v_mfma_f32_16x16x32_bf16 v[128:131], a[84:87], a[120:123], v[128:131]
s_add_u32 m0, s51, 28672
v_mfma_f32_16x16x32_bf16 v[132:135], a[84:87], a[124:127], v[132:135]
buffer_load_dwordx4 v9, s[8:11], s43 offen lds
v_mfma_f32_16x16x32_bf16 v[136:139], a[84:87], a[128:131], v[136:139]
ds_read_b64_tr_b16 a[62:63], v7 offset:37376
v_add_u32 v9, 262144, v9
v_mfma_f32_16x16x32_bf16 v[140:143], a[84:87], a[132:135], v[140:143]
v_mfma_f32_16x16x32_bf16 v[144:147], a[88:91], a[104:107], v[144:147]
ds_read_b128 a[0:3], v2 offset:0
v_mfma_f32_16x16x32_bf16 v[148:151], a[88:91], a[108:111], v[148:151]
ds_read_b128 a[4:7], v2 offset:2048
v_mfma_f32_16x16x32_bf16 v[152:155], a[88:91], a[112:115], v[152:155]
v_mfma_f32_16x16x32_bf16 v[156:159], a[88:91], a[116:119], v[156:159]
ds_read_b128 a[8:11], v2 offset:4096
v_mfma_f32_16x16x32_bf16 v[160:163], a[88:91], a[120:123], v[160:163]
buffer_load_dwordx4 a[136:139], v12, s[76:79], s96 offen
v_mfma_f32_16x16x32_bf16 v[164:167], a[88:91], a[124:127], v[164:167]
v_mfma_f32_16x16x32_bf16 v[168:171], a[88:91], a[128:131], v[168:171]
ds_read_b128 a[12:15], v2 offset:6144
v_mfma_f32_16x16x32_bf16 v[172:175], a[88:91], a[132:135], v[172:175]
ds_read_b128 a[16:19], v2 offset:8192
v_mfma_f32_16x16x32_bf16 v[176:179], a[92:95], a[104:107], v[176:179]
v_mfma_f32_16x16x32_bf16 v[180:183], a[92:95], a[108:111], v[180:183]
ds_read_b128 a[20:23], v2 offset:10240
v_mfma_f32_16x16x32_bf16 v[184:187], a[92:95], a[112:115], v[184:187]
ds_read_b128 a[24:27], v2 offset:12288
v_mfma_f32_16x16x32_bf16 v[188:191], a[92:95], a[116:119], v[188:191]
v_mfma_f32_16x16x32_bf16 v[192:195], a[92:95], a[120:123], v[192:195]
buffer_load_dwordx4 a[140:143], v12, s[56:59], s97 offen
v_mfma_f32_16x16x32_bf16 v[196:199], a[92:95], a[124:127], v[196:199]
ds_read_b128 a[28:31], v2 offset:14336
v_mfma_f32_16x16x32_bf16 v[200:203], a[92:95], a[128:131], v[200:203]
v_mfma_f32_16x16x32_bf16 v[204:207], a[92:95], a[132:135], v[204:207]
v_mfma_f32_16x16x32_bf16 v[208:211], a[96:99], a[104:107], v[208:211]
v_mfma_f32_16x16x32_bf16 v[212:215], a[96:99], a[108:111], v[212:215]
v_mfma_f32_16x16x32_bf16 v[216:219], a[96:99], a[112:115], v[216:219]
v_mfma_f32_16x16x32_bf16 v[220:223], a[96:99], a[116:119], v[220:223]
v_mfma_f32_16x16x32_bf16 v[224:227], a[96:99], a[120:123], v[224:227]
v_mfma_f32_16x16x32_bf16 v[228:231], a[96:99], a[124:127], v[228:231]
v_mfma_f32_16x16x32_bf16 v[232:235], a[96:99], a[128:131], v[232:235]
v_mfma_f32_16x16x32_bf16 v[236:239], a[96:99], a[132:135], v[236:239]
v_mfma_f32_16x16x32_bf16 v[240:243], a[100:103], a[104:107], v[240:243]
v_mfma_f32_16x16x32_bf16 v[244:247], a[100:103], a[108:111], v[244:247]
v_mfma_f32_16x16x32_bf16 v[248:251], a[100:103], a[112:115], v[248:251]
s_add_u32 s96, s96, 1024
s_add_u32 s97, s97, 1024
v_mfma_f32_16x16x32_bf16 v[252:255], a[100:103], a[116:119], v[252:255]
v_mfma_f32_16x16x32_bf16 a[144:147], a[100:103], a[120:123], a[144:147]
v_mfma_f32_16x16x32_bf16 a[148:151], a[100:103], a[124:127], a[148:151]
v_mfma_f32_16x16x32_bf16 a[152:155], a[100:103], a[128:131], a[152:155]
v_mfma_f32_16x16x32_bf16 a[156:159], a[100:103], a[132:135], a[156:159]
s_waitcnt vmcnt(18) lgkmcnt(0)
s_barrier
v_mfma_f32_16x16x32_bf16 v[16:19], a[0:3], a[32:35], v[16:19]
v_mfma_f32_16x16x32_bf16 v[20:23], a[0:3], a[36:39], v[20:23]
ds_read_b64_tr_b16 a[104:105], v4 offset:49152
s_add_u32 m0, s51, 32768
v_mfma_f32_16x16x32_bf16 v[24:27], a[0:3], a[40:43], v[24:27]
buffer_load_dwordx4 v9, s[8:11], s40 offen lds
v_mfma_f32_16x16x32_bf16 v[28:31], a[0:3], a[44:47], v[28:31]
v_mfma_f32_16x16x32_bf16 v[32:35], a[0:3], a[48:51], v[32:35]
ds_read_b64_tr_b16 a[106:107], v4 offset:49664
v_mfma_f32_16x16x32_bf16 v[36:39], a[0:3], a[52:55], v[36:39]
ds_read_b64_tr_b16 a[108:109], v5 offset:49152
v_mfma_f32_16x16x32_bf16 v[40:43], a[0:3], a[56:59], v[40:43]
s_add_u32 m0, s51, 36864
v_mfma_f32_16x16x32_bf16 v[44:47], a[0:3], a[60:63], v[44:47]
buffer_load_dwordx4 v9, s[8:11], s41 offen lds
v_mfma_f32_16x16x32_bf16 v[48:51], a[4:7], a[32:35], v[48:51]
ds_read_b64_tr_b16 a[110:111], v5 offset:49664
v_mfma_f32_16x16x32_bf16 v[52:55], a[4:7], a[36:39], v[52:55]
v_mfma_f32_16x16x32_bf16 v[56:59], a[4:7], a[40:43], v[56:59]
ds_read_b64_tr_b16 a[112:113], v6 offset:49152
s_add_u32 m0, s51, 40960
v_mfma_f32_16x16x32_bf16 v[60:63], a[4:7], a[44:47], v[60:63]
buffer_load_dwordx4 v9, s[8:11], s42 offen lds
v_mfma_f32_16x16x32_bf16 v[64:67], a[4:7], a[48:51], v[64:67]
v_mfma_f32_16x16x32_bf16 v[68:71], a[4:7], a[52:55], v[68:71]
ds_read_b64_tr_b16 a[114:115], v6 offset:49664
v_mfma_f32_16x16x32_bf16 v[72:75], a[4:7], a[56:59], v[72:75]
ds_read_b64_tr_b16 a[116:117], v7 offset:49152
v_mfma_f32_16x16x32_bf16 v[76:79], a[4:7], a[60:63], v[76:79]
s_add_u32 m0, s51, 45056
v_mfma_f32_16x16x32_bf16 v[80:83], a[8:11], a[32:35], v[80:83]
buffer_load_dwordx4 v9, s[8:11], s43 offen lds
v_mfma_f32_16x16x32_bf16 v[84:87], a[8:11], a[36:39], v[84:87]
ds_read_b64_tr_b16 a[118:119], v7 offset:49664
v_add_u32 v9, 262144, v9
v_mfma_f32_16x16x32_bf16 v[88:91], a[8:11], a[40:43], v[88:91]
v_mfma_f32_16x16x32_bf16 v[92:95], a[8:11], a[44:47], v[92:95]
ds_read_b64_tr_b16 a[120:121], v4 offset:53248
s_add_u32 m0, s50, 0
v_mfma_f32_16x16x32_bf16 v[96:99], a[8:11], a[48:51], v[96:99]
buffer_load_dwordx4 v8, s[4:7], s24 offen lds
v_mfma_f32_16x16x32_bf16 v[100:103], a[8:11], a[52:55], v[100:103]
v_mfma_f32_16x16x32_bf16 v[104:107], a[8:11], a[56:59], v[104:107]
ds_read_b64_tr_b16 a[122:123], v4 offset:53760
v_mfma_f32_16x16x32_bf16 v[108:111], a[8:11], a[60:63], v[108:111]
ds_read_b64_tr_b16 a[124:125], v5 offset:53248
v_mfma_f32_16x16x32_bf16 v[112:115], a[12:15], a[32:35], v[112:115]
s_add_u32 m0, s50, 4096
v_mfma_f32_16x16x32_bf16 v[116:119], a[12:15], a[36:39], v[116:119]
buffer_load_dwordx4 v8, s[4:7], s25 offen lds
v_mfma_f32_16x16x32_bf16 v[120:123], a[12:15], a[40:43], v[120:123]
ds_read_b64_tr_b16 a[126:127], v5 offset:53760
v_mfma_f32_16x16x32_bf16 v[124:127], a[12:15], a[44:47], v[124:127]
v_mfma_f32_16x16x32_bf16 v[128:131], a[12:15], a[48:51], v[128:131]
ds_read_b64_tr_b16 a[128:129], v6 offset:53248
s_add_u32 m0, s50, 8192
v_mfma_f32_16x16x32_bf16 v[132:135], a[12:15], a[52:55], v[132:135]
buffer_load_dwordx4 v8, s[4:7], s26 offen lds
v_mfma_f32_16x16x32_bf16 v[136:139], a[12:15], a[56:59], v[136:139]
v_mfma_f32_16x16x32_bf16 v[140:143], a[12:15], a[60:63], v[140:143]
ds_read_b64_tr_b16 a[130:131], v6 offset:53760
v_mfma_f32_16x16x32_bf16 v[144:147], a[16:19], a[32:35], v[144:147]
ds_read_b64_tr_b16 a[132:133], v7 offset:53248
v_mfma_f32_16x16x32_bf16 v[148:151], a[16:19], a[36:39], v[148:151]
s_add_u32 m0, s50, 12288
v_mfma_f32_16x16x32_bf16 v[152:155], a[16:19], a[40:43], v[152:155]
buffer_load_dwordx4 v8, s[4:7], s27 offen lds
v_mfma_f32_16x16x32_bf16 v[156:159], a[16:19], a[44:47], v[156:159]
ds_read_b64_tr_b16 a[134:135], v7 offset:53760
v_mfma_f32_16x16x32_bf16 v[160:163], a[16:19], a[48:51], v[160:163]
v_mfma_f32_16x16x32_bf16 v[164:167], a[16:19], a[52:55], v[164:167]
ds_read_b128 a[72:75], v3 offset:0
s_add_u32 m0, s50, 16384
v_mfma_f32_16x16x32_bf16 v[168:171], a[16:19], a[56:59], v[168:171]
buffer_load_dwordx4 v8, s[4:7], s28 offen lds
v_mfma_f32_16x16x32_bf16 v[172:175], a[16:19], a[60:63], v[172:175]
v_mfma_f32_16x16x32_bf16 v[176:179], a[20:23], a[32:35], v[176:179]
ds_read_b128 a[76:79], v3 offset:2048
v_mfma_f32_16x16x32_bf16 v[180:183], a[20:23], a[36:39], v[180:183]
ds_read_b128 a[80:83], v3 offset:4096
v_mfma_f32_16x16x32_bf16 v[184:187], a[20:23], a[40:43], v[184:187]
s_add_u32 m0, s50, 20480
v_mfma_f32_16x16x32_bf16 v[188:191], a[20:23], a[44:47], v[188:191]
buffer_load_dwordx4 v8, s[4:7], s29 offen lds
v_mfma_f32_16x16x32_bf16 v[192:195], a[20:23], a[48:51], v[192:195]
ds_read_b128 a[84:87], v3 offset:6144
v_mfma_f32_16x16x32_bf16 v[196:199], a[20:23], a[52:55], v[196:199]
v_mfma_f32_16x16x32_bf16 v[200:203], a[20:23], a[56:59], v[200:203]
ds_read_b128 a[88:91], v3 offset:8192
s_add_u32 m0, s50, 24576
v_mfma_f32_16x16x32_bf16 v[204:207], a[20:23], a[60:63], v[204:207]
buffer_load_dwordx4 v8, s[4:7], s30 offen lds
v_mfma_f32_16x16x32_bf16 v[208:211], a[24:27], a[32:35], v[208:211]
v_mfma_f32_16x16x32_bf16 v[212:215], a[24:27], a[36:39], v[212:215]
ds_read_b128 a[92:95], v3 offset:10240
v_mfma_f32_16x16x32_bf16 v[216:219], a[24:27], a[40:43], v[216:219]
ds_read_b128 a[96:99], v3 offset:12288
v_mfma_f32_16x16x32_bf16 v[220:223], a[24:27], a[44:47], v[220:223]
s_add_u32 m0, s50, 28672
v_mfma_f32_16x16x32_bf16 v[224:227], a[24:27], a[48:51], v[224:227]
buffer_load_dwordx4 v8, s[4:7], s31 offen lds
v_mfma_f32_16x16x32_bf16 v[228:231], a[24:27], a[52:55], v[228:231]
ds_read_b128 a[100:103], v3 offset:14336
v_add_u32 v8, 128, v8
v_mfma_f32_16x16x32_bf16 v[232:235], a[24:27], a[56:59], v[232:235]
v_mfma_f32_16x16x32_bf16 v[236:239], a[24:27], a[60:63], v[236:239]
v_mfma_f32_16x16x32_bf16 v[240:243], a[28:31], a[32:35], v[240:243]
v_mfma_f32_16x16x32_bf16 v[244:247], a[28:31], a[36:39], v[244:247]
v_mfma_f32_16x16x32_bf16 v[248:251], a[28:31], a[40:43], v[248:251]
v_mfma_f32_16x16x32_bf16 v[252:255], a[28:31], a[44:47], v[252:255]
v_mfma_f32_16x16x32_bf16 a[144:147], a[28:31], a[48:51], a[144:147]
v_mfma_f32_16x16x32_bf16 a[148:151], a[28:31], a[52:55], a[148:151]
v_mfma_f32_16x16x32_bf16 a[152:155], a[28:31], a[56:59], a[152:155]
v_mfma_f32_16x16x32_bf16 a[156:159], a[28:31], a[60:63], a[156:159]
s_waitcnt vmcnt(18) lgkmcnt(0)
s_barrier
v_mfma_f32_16x16x32_bf16 v[16:19], a[72:75], a[104:107], v[16:19]
s_add_u32 s50, s49, s51
s_add_u32 s49, s49, 32768
s_cmp_eq_u32 s49, 163840
v_mfma_f32_16x16x32_bf16 v[20:23], a[72:75], a[108:111], v[20:23]
s_cselect_b32 s49, 65536, s49
v_add_u32 v2, s49, v1
v_xor_b32 v3, 64, v2
v_mfma_f32_16x16x32_bf16 v[24:27], a[72:75], a[112:115], v[24:27]
ds_read_b64_tr_b16 a[32:33], v4 offset:0
v_mfma_f32_16x16x32_bf16 v[28:31], a[72:75], a[116:119], v[28:31]
ds_read_b64_tr_b16 a[34:35], v4 offset:512
v_mfma_f32_16x16x32_bf16 v[32:35], a[72:75], a[120:123], v[32:35]
v_mfma_f32_16x16x32_bf16 v[36:39], a[72:75], a[124:127], v[36:39]
ds_read_b64_tr_b16 a[36:37], v5 offset:0
v_mfma_f32_16x16x32_bf16 v[40:43], a[72:75], a[128:131], v[40:43]
ds_read_b64_tr_b16 a[38:39], v5 offset:512
v_mfma_f32_16x16x32_bf16 v[44:47], a[72:75], a[132:135], v[44:47]
v_mfma_f32_16x16x32_bf16 v[48:51], a[76:79], a[104:107], v[48:51]
ds_read_b64_tr_b16 a[40:41], v6 offset:0
s_add_u32 m0, s51, 49152
v_mfma_f32_16x16x32_bf16 v[52:55], a[76:79], a[108:111], v[52:55]
buffer_load_dwordx4 v9, s[8:11], s40 offen lds
v_mfma_f32_16x16x32_bf16 v[56:59], a[76:79], a[112:115], v[56:59]
v_mfma_f32_16x16x32_bf16 v[60:63], a[76:79], a[116:119], v[60:63]
ds_read_b64_tr_b16 a[42:43], v6 offset:512
v_mfma_f32_16x16x32_bf16 v[64:67], a[76:79], a[120:123], v[64:67]
ds_read_b64_tr_b16 a[44:45], v7 offset:0
v_mfma_f32_16x16x32_bf16 v[68:71], a[76:79], a[124:127], v[68:71]
v_mfma_f32_16x16x32_bf16 v[72:75], a[76:79], a[128:131], v[72:75]
ds_read_b64_tr_b16 a[46:47], v7 offset:512
v_mfma_f32_16x16x32_bf16 v[76:79], a[76:79], a[132:135], v[76:79]
ds_read_b64_tr_b16 a[48:49], v4 offset:4096
v_mfma_f32_16x16x32_bf16 v[80:83], a[80:83], a[104:107], v[80:83]
v_mfma_f32_16x16x32_bf16 v[84:87], a[80:83], a[108:111], v[84:87]
ds_read_b64_tr_b16 a[50:51], v4 offset:4608
v_mfma_f32_16x16x32_bf16 v[88:91], a[80:83], a[112:115], v[88:91]
ds_read_b64_tr_b16 a[52:53], v5 offset:4096
v_mfma_f32_16x16x32_bf16 v[92:95], a[80:83], a[116:119], v[92:95]
s_add_u32 m0, s51, 53248
v_mfma_f32_16x16x32_bf16 v[96:99], a[80:83], a[120:123], v[96:99]
buffer_load_dwordx4 v9, s[8:11], s41 offen lds
v_mfma_f32_16x16x32_bf16 v[100:103], a[80:83], a[124:127], v[100:103]
ds_read_b64_tr_b16 a[54:55], v5 offset:4608
v_mfma_f32_16x16x32_bf16 v[104:107], a[80:83], a[128:131], v[104:107]
v_mfma_f32_16x16x32_bf16 v[108:111], a[80:83], a[132:135], v[108:111]
ds_read_b64_tr_b16 a[56:57], v6 offset:4096
v_mfma_f32_16x16x32_bf16 v[112:115], a[84:87], a[104:107], v[112:115]
ds_read_b64_tr_b16 a[58:59], v6 offset:4608
v_mfma_f32_16x16x32_bf16 v[116:119], a[84:87], a[108:111], v[116:119]
v_mfma_f32_16x16x32_bf16 v[120:123], a[84:87], a[112:115], v[120:123]
ds_read_b64_tr_b16 a[60:61], v7 offset:4096
v_mfma_f32_16x16x32_bf16 v[124:127], a[84:87], a[116:119], v[124:127]
ds_read_b64_tr_b16 a[62:63], v7 offset:4608
v_mfma_f32_16x16x32_bf16 v[128:131], a[84:87], a[120:123], v[128:131]
v_mfma_f32_16x16x32_bf16 v[132:135], a[84:87], a[124:127], v[132:135]
ds_read_b128 a[0:3], v2 offset:0
s_add_u32 m0, s51, 57344
v_mfma_f32_16x16x32_bf16 v[136:139], a[84:87], a[128:131], v[136:139]
buffer_load_dwordx4 v9, s[8:11], s42 offen lds
v_mfma_f32_16x16x32_bf16 v[140:143], a[84:87], a[132:135], v[140:143]
v_mfma_f32_16x16x32_bf16 v[144:147], a[88:91], a[104:107], v[144:147]
ds_read_b128 a[4:7], v2 offset:2048
v_mfma_f32_16x16x32_bf16 v[148:151], a[88:91], a[108:111], v[148:151]
ds_read_b128 a[8:11], v2 offset:4096
v_mfma_f32_16x16x32_bf16 v[152:155], a[88:91], a[112:115], v[152:155]
v_mfma_f32_16x16x32_bf16 v[156:159], a[88:91], a[116:119], v[156:159]
ds_read_b128 a[12:15], v2 offset:6144
v_mfma_f32_16x16x32_bf16 v[160:163], a[88:91], a[120:123], v[160:163]
ds_read_b128 a[16:19], v2 offset:8192
v_mfma_f32_16x16x32_bf16 v[164:167], a[88:91], a[124:127], v[164:167]
v_mfma_f32_16x16x32_bf16 v[168:171], a[88:91], a[128:131], v[168:171]
ds_read_b128 a[20:23], v2 offset:10240
v_mfma_f32_16x16x32_bf16 v[172:175], a[88:91], a[132:135], v[172:175]
ds_read_b128 a[24:27], v2 offset:12288
v_mfma_f32_16x16x32_bf16 v[176:179], a[92:95], a[104:107], v[176:179]
s_add_u32 m0, s51, 61440
v_mfma_f32_16x16x32_bf16 v[180:183], a[92:95], a[108:111], v[180:183]
buffer_load_dwordx4 v9, s[8:11], s43 offen lds
v_mfma_f32_16x16x32_bf16 v[184:187], a[92:95], a[112:115], v[184:187]
ds_read_b128 a[28:31], v2 offset:14336
v_add_u32 v9, 262144, v9
v_mfma_f32_16x16x32_bf16 v[188:191], a[92:95], a[116:119], v[188:191]
v_mfma_f32_16x16x32_bf16 v[192:195], a[92:95], a[120:123], v[192:195]
v_mfma_f32_16x16x32_bf16 v[196:199], a[92:95], a[124:127], v[196:199]
v_mfma_f32_16x16x32_bf16 v[200:203], a[92:95], a[128:131], v[200:203]
v_mfma_f32_16x16x32_bf16 v[204:207], a[92:95], a[132:135], v[204:207]
v_mfma_f32_16x16x32_bf16 v[208:211], a[96:99], a[104:107], v[208:211]
v_mfma_f32_16x16x32_bf16 v[212:215], a[96:99], a[108:111], v[212:215]
v_mfma_f32_16x16x32_bf16 v[216:219], a[96:99], a[112:115], v[216:219]
v_mfma_f32_16x16x32_bf16 v[220:223], a[96:99], a[116:119], v[220:223]
v_mfma_f32_16x16x32_bf16 v[224:227], a[96:99], a[120:123], v[224:227]
v_mfma_f32_16x16x32_bf16 v[228:231], a[96:99], a[124:127], v[228:231]
v_mfma_f32_16x16x32_bf16 v[232:235], a[96:99], a[128:131], v[232:235]
v_mfma_f32_16x16x32_bf16 v[236:239], a[96:99], a[132:135], v[236:239]
v_mfma_f32_16x16x32_bf16 v[240:243], a[100:103], a[104:107], v[240:243]
v_mfma_f32_16x16x32_bf16 v[244:247], a[100:103], a[108:111], v[244:247]
v_mfma_f32_16x16x32_bf16 v[248:251], a[100:103], a[112:115], v[248:251]
v_mfma_f32_16x16x32_bf16 v[252:255], a[100:103], a[116:119], v[252:255]
v_mfma_f32_16x16x32_bf16 a[144:147], a[100:103], a[120:123], a[144:147]
s_sub_u32 s52, s52, 1
v_mfma_f32_16x16x32_bf16 a[148:151], a[100:103], a[124:127], a[148:151]
v_mfma_f32_16x16x32_bf16 a[152:155], a[100:103], a[128:131], a[152:155]
s_cmp_lg_u32 s52, 0
v_mfma_f32_16x16x32_bf16 a[156:159], a[100:103], a[132:135], a[156:159]
s_cbranch_scc1 LM_loopV
s_waitcnt vmcnt(16) lgkmcnt(0)
s_barrier
s_getpc_b64 s[76:77]
Lpw_aV:
s_add_u32 s76, s76, LM_a1-Lpw_aV
s_addc_u32 s77, s77, 0
s_mov_b32 s78, L_text_end-LM_a1
s_mov_b32 s79, 0x20000
s_lshr_b32 s96, s2, 1
s_and_b32 s96, s96, 60
s_add_u32 s96, s96, s48
s_lshl_b32 s96, s96, 10
s_and_b32 s53, s2, 7
s_lshr_b32 s54, s2, 3
s_and_b32 s55, s54, 1
s_lshl_b32 s55, s55, 3
s_add_u32 s33, s53, s55
s_lshr_b32 s34, s54, 1
s_lshl_b32 s32, s48, 13
s_lshl_b32 s16, s33, 18
s_add_u32 s16, s16, s32
s_add_u32 s16, s16, 69206016
s_mov_b32 s18, 1400897536
s_mov_b32 s19, 0
v_lshrrev_b32 v14, 4, v12
v_and_b32 v15, 8, v14
v_lshlrev_b32 v15, 3, v15
v_and_or_b32 v15, v14, 7, v15
s_lshr_b32 s53, s33, 1
s_lshl_b32 s53, s53, 3
v_add_u32 v15, s53, v15
s_lshl_b32 s53, s33, 3
s_lshr_b32 s54, s34, 1
s_add_u32 s53, s53, s54
v_cmp_gt_u32 vcc, 16, v14
v_mov_b32 v14, s53
s_mov_b32 s58, 109096960
v_cndmask_b32 v15, v14, v15, vcc
v_lshlrev_b32 v15, 2, v15
s_lshl_b32 s53, s34, 2
s_add_u32 s53, s53, s48
s_lshl_b32 s53, s53, 11
s_lshl_b32 s54, s33, 17
s_add_u32 s53, s53, s54
s_add_u32 s57, s53, 67108864
v_mfma_f32_16x16x32_bf16 v[16:19], a[0:3], a[32:35], v[16:19]
v_mfma_f32_16x16x32_bf16 v[20:23], a[0:3], a[36:39], v[20:23]
ds_read_b64_tr_b16 a[104:105], v4 offset:16384
v_mfma_f32_16x16x32_bf16 v[24:27], a[0:3], a[40:43], v[24:27]
ds_read_b64_tr_b16 a[106:107], v4 offset:16896
v_mfma_f32_16x16x32_bf16 v[28:31], a[0:3], a[44:47], v[28:31]
ds_read_b64_tr_b16 a[108:109], v5 offset:16384
v_mfma_f32_16x16x32_bf16 v[32:35], a[0:3], a[48:51], v[32:35]
v_mfma_f32_16x16x32_bf16 v[36:39], a[0:3], a[52:55], v[36:39]
ds_read_b64_tr_b16 a[110:111], v5 offset:16896
v_mfma_f32_16x16x32_bf16 v[40:43], a[0:3], a[56:59], v[40:43]
ds_read_b64_tr_b16 a[112:113], v6 offset:16384
v_mfma_f32_16x16x32_bf16 v[44:47], a[0:3], a[60:63], v[44:47]
v_mfma_f32_16x16x32_bf16 v[48:51], a[4:7], a[32:35], v[48:51]
ds_read_b64_tr_b16 a[114:115], v6 offset:16896
v_mfma_f32_16x16x32_bf16 v[52:55], a[4:7], a[36:39], v[52:55]
ds_read_b64_tr_b16 a[116:117], v7 offset:16384
v_mfma_f32_16x16x32_bf16 v[56:59], a[4:7], a[40:43], v[56:59]
v_mfma_f32_16x16x32_bf16 v[60:63], a[4:7], a[44:47], v[60:63]
ds_read_b64_tr_b16 a[118:119], v7 offset:16896
v_mfma_f32_16x16x32_bf16 v[64:67], a[4:7], a[48:51], v[64:67]
ds_read_b64_tr_b16 a[120:121], v4 offset:20480
v_mfma_f32_16x16x32_bf16 v[68:71], a[4:7], a[52:55], v[68:71]
v_mfma_f32_16x16x32_bf16 v[72:75], a[4:7], a[56:59], v[72:75]
ds_read_b64_tr_b16 a[122:123], v4 offset:20992
v_mfma_f32_16x16x32_bf16 v[76:79], a[4:7], a[60:63], v[76:79]
ds_read_b64_tr_b16 a[124:125], v5 offset:20480
v_mfma_f32_16x16x32_bf16 v[80:83], a[8:11], a[32:35], v[80:83]
v_mfma_f32_16x16x32_bf16 v[84:87], a[8:11], a[36:39], v[84:87]
ds_read_b64_tr_b16 a[126:127], v5 offset:20992
v_mfma_f32_16x16x32_bf16 v[88:91], a[8:11], a[40:43], v[88:91]
ds_read_b64_tr_b16 a[128:129], v6 offset:20480
v_mfma_f32_16x16x32_bf16 v[92:95], a[8:11], a[44:47], v[92:95]
v_mfma_f32_16x16x32_bf16 v[96:99], a[8:11], a[48:51], v[96:99]
ds_read_b64_tr_b16 a[130:131], v6 offset:20992
v_mfma_f32_16x16x32_bf16 v[100:103], a[8:11], a[52:55], v[100:103]
ds_read_b64_tr_b16 a[132:133], v7 offset:20480
v_mfma_f32_16x16x32_bf16 v[104:107], a[8:11], a[56:59], v[104:107]
v_mfma_f32_16x16x32_bf16 v[108:111], a[8:11], a[60:63], v[108:111]
ds_read_b64_tr_b16 a[134:135], v7 offset:20992
v_mfma_f32_16x16x32_bf16 v[112:115], a[12:15], a[32:35], v[112:115]
ds_read_b128 a[72:75], v3 offset:0
v_mfma_f32_16x16x32_bf16 v[116:119], a[12:15], a[36:39], v[116:119]
v_mfma_f32_16x16x32_bf16 v[120:123], a[12:15], a[40:43], v[120:123]
ds_read_b128 a[76:79], v3 offset:2048
v_mfma_f32_16x16x32_bf16 v[124:127], a[12:15], a[44:47], v[124:127]
ds_read_b128 a[80:83], v3 offset:4096
v_mfma_f32_16x16x32_bf16 v[128:131], a[12:15], a[48:51], v[128:131]
v_mfma_f32_16x16x32_bf16 v[132:135], a[12:15], a[52:55], v[132:135]
ds_read_b128 a[84:87], v3 offset:6144
v_mfma_f32_16x16x32_bf16 v[136:139], a[12:15], a[56:59], v[136:139]
ds_read_b128 a[88:91], v3 offset:8192
v_mfma_f32_16x16x32_bf16 v[140:143], a[12:15], a[60:63], v[140:143]
v_mfma_f32_16x16x32_bf16 v[144:147], a[16:19], a[32:35], v[144:147]
ds_read_b128 a[92:95], v3 offset:10240
v_mfma_f32_16x16x32_bf16 v[148:151], a[16:19], a[36:39], v[148:151]
ds_read_b128 a[96:99], v3 offset:12288
v_mfma_f32_16x16x32_bf16 v[152:155], a[16:19], a[40:43], v[152:155]
v_mfma_f32_16x16x32_bf16 v[156:159], a[16:19], a[44:47], v[156:159]
buffer_load_dwordx4 a[136:139], v12, s[76:79], s96 offen
v_mfma_f32_16x16x32_bf16 v[160:163], a[16:19], a[48:51], v[160:163]
ds_read_b128 a[100:103], v3 offset:14336
v_mfma_f32_16x16x32_bf16 v[164:167], a[16:19], a[52:55], v[164:167]
v_mfma_f32_16x16x32_bf16 v[168:171], a[16:19], a[56:59], v[168:171]
v_mfma_f32_16x16x32_bf16 v[172:175], a[16:19], a[60:63], v[172:175]
v_mfma_f32_16x16x32_bf16 v[176:179], a[20:23], a[32:35], v[176:179]
v_mfma_f32_16x16x32_bf16 v[180:183], a[20:23], a[36:39], v[180:183]
v_mfma_f32_16x16x32_bf16 v[184:187], a[20:23], a[40:43], v[184:187]
v_mfma_f32_16x16x32_bf16 v[188:191], a[20:23], a[44:47], v[188:191]
v_mfma_f32_16x16x32_bf16 v[192:195], a[20:23], a[48:51], v[192:195]
v_mfma_f32_16x16x32_bf16 v[196:199], a[20:23], a[52:55], v[196:199]
v_mfma_f32_16x16x32_bf16 v[200:203], a[20:23], a[56:59], v[200:203]
v_mfma_f32_16x16x32_bf16 v[204:207], a[20:23], a[60:63], v[204:207]
v_mfma_f32_16x16x32_bf16 v[208:211], a[24:27], a[32:35], v[208:211]
v_mfma_f32_16x16x32_bf16 v[212:215], a[24:27], a[36:39], v[212:215]
v_mfma_f32_16x16x32_bf16 v[216:219], a[24:27], a[40:43], v[216:219]
v_mfma_f32_16x16x32_bf16 v[220:223], a[24:27], a[44:47], v[220:223]
v_mfma_f32_16x16x32_bf16 v[224:227], a[24:27], a[48:51], v[224:227]
v_mfma_f32_16x16x32_bf16 v[228:231], a[24:27], a[52:55], v[228:231]
v_mfma_f32_16x16x32_bf16 v[232:235], a[24:27], a[56:59], v[232:235]
v_mfma_f32_16x16x32_bf16 v[236:239], a[24:27], a[60:63], v[236:239]
v_mfma_f32_16x16x32_bf16 v[240:243], a[28:31], a[32:35], v[240:243]
v_mfma_f32_16x16x32_bf16 v[244:247], a[28:31], a[36:39], v[244:247]
v_mfma_f32_16x16x32_bf16 v[248:251], a[28:31], a[40:43], v[248:251]
v_mfma_f32_16x16x32_bf16 v[252:255], a[28:31], a[44:47], v[252:255]
v_mfma_f32_16x16x32_bf16 a[144:147], a[28:31], a[48:51], a[144:147]
v_mfma_f32_16x16x32_bf16 a[148:151], a[28:31], a[52:55], a[148:151]
v_mfma_f32_16x16x32_bf16 a[152:155], a[28:31], a[56:59], a[152:155]
v_mfma_f32_16x16x32_bf16 a[156:159], a[28:31], a[60:63], a[156:159]
s_waitcnt vmcnt(5) lgkmcnt(0)
s_barrier
v_mfma_f32_16x16x32_bf16 v[16:19], a[72:75], a[104:107], v[16:19]
s_add_u32 s50, s49, s51
s_add_u32 s49, s49, 32768
s_cmp_eq_u32 s49, 163840
v_mfma_f32_16x16x32_bf16 v[20:23], a[72:75], a[108:111], v[20:23]
s_cselect_b32 s49, 65536, s49
v_add_u32 v2, s49, v1
v_xor_b32 v3, 64, v2
v_mfma_f32_16x16x32_bf16 v[24:27], a[72:75], a[112:115], v[24:27]
ds_read_b64_tr_b16 a[32:33], v4 offset:32768
v_mfma_f32_16x16x32_bf16 v[28:31], a[72:75], a[116:119], v[28:31]
ds_read_b64_tr_b16 a[34:35], v4 offset:33280
v_mfma_f32_16x16x32_bf16 v[32:35], a[72:75], a[120:123], v[32:35]
v_mfma_f32_16x16x32_bf16 v[36:39], a[72:75], a[124:127], v[36:39]
ds_read_b64_tr_b16 a[36:37], v5 offset:32768
v_mfma_f32_16x16x32_bf16 v[40:43], a[72:75], a[128:131], v[40:43]
ds_read_b64_tr_b16 a[38:39], v5 offset:33280
v_mfma_f32_16x16x32_bf16 v[44:47], a[72:75], a[132:135], v[44:47]
v_mfma_f32_16x16x32_bf16 v[48:51], a[76:79], a[104:107], v[48:51]
ds_read_b64_tr_b16 a[40:41], v6 offset:32768
v_mfma_f32_16x16x32_bf16 v[52:55], a[76:79], a[108:111], v[52:55]
ds_read_b64_tr_b16 a[42:43], v6 offset:33280
v_mfma_f32_16x16x32_bf16 v[56:59], a[76:79], a[112:115], v[56:59]
v_mfma_f32_16x16x32_bf16 v[60:63], a[76:79], a[116:119], v[60:63]
ds_read_b64_tr_b16 a[44:45], v7 offset:32768
v_mfma_f32_16x16x32_bf16 v[64:67], a[76:79], a[120:123], v[64:67]
ds_read_b64_tr_b16 a[46:47], v7 offset:33280
v_mfma_f32_16x16x32_bf16 v[68:71], a[76:79], a[124:127], v[68:71]
v_mfma_f32_16x16x32_bf16 v[72:75], a[76:79], a[128:131], v[72:75]
ds_read_b64_tr_b16 a[48:49], v4 offset:36864
v_mfma_f32_16x16x32_bf16 v[76:79], a[76:79], a[132:135], v[76:79]
ds_read_b64_tr_b16 a[50:51], v4 offset:37376
v_mfma_f32_16x16x32_bf16 v[80:83], a[80:83], a[104:107], v[80:83]
v_mfma_f32_16x16x32_bf16 v[84:87], a[80:83], a[108:111], v[84:87]
ds_read_b64_tr_b16 a[52:53], v5 offset:36864
v_mfma_f32_16x16x32_bf16 v[88:91], a[80:83], a[112:115], v[88:91]
ds_read_b64_tr_b16 a[54:55], v5 offset:37376
v_mfma_f32_16x16x32_bf16 v[92:95], a[80:83], a[116:119], v[92:95]
v_mfma_f32_16x16x32_bf16 v[96:99], a[80:83], a[120:123], v[96:99]
ds_read_b64_tr_b16 a[56:57], v6 offset:36864
v_mfma_f32_16x16x32_bf16 v[100:103], a[80:83], a[124:127], v[100:103]
ds_read_b64_tr_b16 a[58:59], v6 offset:37376
v_mfma_f32_16x16x32_bf16 v[104:107], a[80:83], a[128:131], v[104:107]
v_mfma_f32_16x16x32_bf16 v[108:111], a[80:83], a[132:135], v[108:111]
ds_read_b64_tr_b16 a[60:61], v7 offset:36864
v_mfma_f32_16x16x32_bf16 v[112:115], a[84:87], a[104:107], v[112:115]
ds_read_b64_tr_b16 a[62:63], v7 offset:37376
v_mfma_f32_16x16x32_bf16 v[116:119], a[84:87], a[108:111], v[116:119]
v_mfma_f32_16x16x32_bf16 v[120:123], a[84:87], a[112:115], v[120:123]
ds_read_b128 a[0:3], v2 offset:0
v_mfma_f32_16x16x32_bf16 v[124:127], a[84:87], a[116:119], v[124:127]
ds_read_b128 a[4:7], v2 offset:2048
v_mfma_f32_16x16x32_bf16 v[128:131], a[84:87], a[120:123], v[128:131]
v_mfma_f32_16x16x32_bf16 v[132:135], a[84:87], a[124:127], v[132:135]
ds_read_b128 a[8:11], v2 offset:4096
v_mfma_f32_16x16x32_bf16 v[136:139], a[84:87], a[128:131], v[136:139]
ds_read_b128 a[12:15], v2 offset:6144
v_mfma_f32_16x16x32_bf16 v[140:143], a[84:87], a[132:135], v[140:143]
v_mfma_f32_16x16x32_bf16 v[144:147], a[88:91], a[104:107], v[144:147]
ds_read_b128 a[16:19], v2 offset:8192
v_mfma_f32_16x16x32_bf16 v[148:151], a[88:91], a[108:111], v[148:151]
ds_read_b128 a[20:23], v2 offset:10240
v_mfma_f32_16x16x32_bf16 v[152:155], a[88:91], a[112:115], v[152:155]
v_mfma_f32_16x16x32_bf16 v[156:159], a[88:91], a[116:119], v[156:159]
ds_read_b128 a[24:27], v2 offset:12288
v_mfma_f32_16x16x32_bf16 v[160:163], a[88:91], a[120:123], v[160:163]
ds_read_b128 a[28:31], v2 offset:14336
v_mfma_f32_16x16x32_bf16 v[164:167], a[88:91], a[124:127], v[164:167]
v_mfma_f32_16x16x32_bf16 v[168:171], a[88:91], a[128:131], v[168:171]
v_mfma_f32_16x16x32_bf16 v[172:175], a[88:91], a[132:135], v[172:175]
v_mfma_f32_16x16x32_bf16 v[176:179], a[92:95], a[104:107], v[176:179]
v_mfma_f32_16x16x32_bf16 v[180:183], a[92:95], a[108:111], v[180:183]
v_mfma_f32_16x16x32_bf16 v[184:187], a[92:95], a[112:115], v[184:187]
v_mfma_f32_16x16x32_bf16 v[188:191], a[92:95], a[116:119], v[188:191]
v_mfma_f32_16x16x32_bf16 v[192:195], a[92:95], a[120:123], v[192:195]
v_mfma_f32_16x16x32_bf16 v[196:199], a[92:95], a[124:127], v[196:199]
v_mfma_f32_16x16x32_bf16 v[200:203], a[92:95], a[128:131], v[200:203]
v_mfma_f32_16x16x32_bf16 v[204:207], a[92:95], a[132:135], v[204:207]
v_mfma_f32_16x16x32_bf16 v[208:211], a[96:99], a[104:107], v[208:211]
v_mfma_f32_16x16x32_bf16 v[212:215], a[96:99], a[108:111], v[212:215]
v_mfma_f32_16x16x32_bf16 v[216:219], a[96:99], a[112:115], v[216:219]
v_mfma_f32_16x16x32_bf16 v[220:223], a[96:99], a[116:119], v[220:223]
v_mfma_f32_16x16x32_bf16 v[224:227], a[96:99], a[120:123], v[224:227]
v_mfma_f32_16x16x32_bf16 v[228:231], a[96:99], a[124:127], v[228:231]
v_mfma_f32_16x16x32_bf16 v[232:235], a[96:99], a[128:131], v[232:235]
v_mfma_f32_16x16x32_bf16 v[236:239], a[96:99], a[132:135], v[236:239]
v_mfma_f32_16x16x32_bf16 v[240:243], a[100:103], a[104:107], v[240:243]
v_mfma_f32_16x16x32_bf16 v[244:247], a[100:103], a[108:111], v[244:247]
v_mfma_f32_16x16x32_bf16 v[248:251], a[100:103], a[112:115], v[248:251]
v_mfma_f32_16x16x32_bf16 v[252:255], a[100:103], a[116:119], v[252:255]
v_mfma_f32_16x16x32_bf16 a[144:147], a[100:103], a[120:123], a[144:147]
v_mfma_f32_16x16x32_bf16 a[148:151], a[100:103], a[124:127], a[148:151]
v_mfma_f32_16x16x32_bf16 a[152:155], a[100:103], a[128:131], a[152:155]
v_mfma_f32_16x16x32_bf16 a[156:159], a[100:103], a[132:135], a[156:159]
s_waitcnt vmcnt(0) lgkmcnt(0)
s_barrier
v_mfma_f32_16x16x32_bf16 v[16:19], a[0:3], a[32:35], v[16:19]
v_mfma_f32_16x16x32_bf16 v[20:23], a[0:3], a[36:39], v[20:23]
ds_read_b64_tr_b16 a[104:105], v4 offset:49152
v_mfma_f32_16x16x32_bf16 v[24:27], a[0:3], a[40:43], v[24:27]
ds_read_b64_tr_b16 a[106:107], v4 offset:49664
v_mfma_f32_16x16x32_bf16 v[28:31], a[0:3], a[44:47], v[28:31]
ds_read_b64_tr_b16 a[108:109], v5 offset:49152
v_mfma_f32_16x16x32_bf16 v[32:35], a[0:3], a[48:51], v[32:35]
v_mfma_f32_16x16x32_bf16 v[36:39], a[0:3], a[52:55], v[36:39]
ds_read_b64_tr_b16 a[110:111], v5 offset:49664
v_mfma_f32_16x16x32_bf16 v[40:43], a[0:3], a[56:59], v[40:43]
ds_read_b64_tr_b16 a[112:113], v6 offset:49152
v_mfma_f32_16x16x32_bf16 v[44:47], a[0:3], a[60:63], v[44:47]
v_mfma_f32_16x16x32_bf16 v[48:51], a[4:7], a[32:35], v[48:51]
ds_read_b64_tr_b16 a[114:115], v6 offset:49664
v_mfma_f32_16x16x32_bf16 v[52:55], a[4:7], a[36:39], v[52:55]
ds_read_b64_tr_b16 a[116:117], v7 offset:49152
v_mfma_f32_16x16x32_bf16 v[56:59], a[4:7], a[40:43], v[56:59]
v_mfma_f32_16x16x32_bf16 v[60:63], a[4:7], a[44:47], v[60:63]
ds_read_b64_tr_b16 a[118:119], v7 offset:49664
v_mfma_f32_16x16x32_bf16 v[64:67], a[4:7], a[48:51], v[64:67]
ds_read_b64_tr_b16 a[120:121], v4 offset:53248
v_mfma_f32_16x16x32_bf16 v[68:71], a[4:7], a[52:55], v[68:71]
v_mfma_f32_16x16x32_bf16 v[72:75], a[4:7], a[56:59], v[72:75]
ds_read_b64_tr_b16 a[122:123], v4 offset:53760
v_mfma_f32_16x16x32_bf16 v[76:79], a[4:7], a[60:63], v[76:79]
ds_read_b64_tr_b16 a[124:125], v5 offset:53248
v_mfma_f32_16x16x32_bf16 v[80:83], a[8:11], a[32:35], v[80:83]
v_mfma_f32_16x16x32_bf16 v[84:87], a[8:11], a[36:39], v[84:87]
ds_read_b64_tr_b16 a[126:127], v5 offset:53760
v_mfma_f32_16x16x32_bf16 v[88:91], a[8:11], a[40:43], v[88:91]
ds_read_b64_tr_b16 a[128:129], v6 offset:53248
v_mfma_f32_16x16x32_bf16 v[92:95], a[8:11], a[44:47], v[92:95]
v_mfma_f32_16x16x32_bf16 v[96:99], a[8:11], a[48:51], v[96:99]
ds_read_b64_tr_b16 a[130:131], v6 offset:53760
v_mfma_f32_16x16x32_bf16 v[100:103], a[8:11], a[52:55], v[100:103]
ds_read_b64_tr_b16 a[132:133], v7 offset:53248
v_mfma_f32_16x16x32_bf16 v[104:107], a[8:11], a[56:59], v[104:107]
v_mfma_f32_16x16x32_bf16 v[108:111], a[8:11], a[60:63], v[108:111]
ds_read_b64_tr_b16 a[134:135], v7 offset:53760
v_mfma_f32_16x16x32_bf16 v[112:115], a[12:15], a[32:35], v[112:115]
ds_read_b128 a[72:75], v3 offset:0
v_mfma_f32_16x16x32_bf16 v[116:119], a[12:15], a[36:39], v[116:119]
v_mfma_f32_16x16x32_bf16 v[120:123], a[12:15], a[40:43], v[120:123]
ds_read_b128 a[76:79], v3 offset:2048
v_mfma_f32_16x16x32_bf16 v[124:127], a[12:15], a[44:47], v[124:127]
ds_read_b128 a[80:83], v3 offset:4096
v_mfma_f32_16x16x32_bf16 v[128:131], a[12:15], a[48:51], v[128:131]
v_mfma_f32_16x16x32_bf16 v[132:135], a[12:15], a[52:55], v[132:135]
ds_read_b128 a[84:87], v3 offset:6144
v_mfma_f32_16x16x32_bf16 v[136:139], a[12:15], a[56:59], v[136:139]
ds_read_b128 a[88:91], v3 offset:8192
v_mfma_f32_16x16x32_bf16 v[140:143], a[12:15], a[60:63], v[140:143]
v_mfma_f32_16x16x32_bf16 v[144:147], a[16:19], a[32:35], v[144:147]
ds_read_b128 a[92:95], v3 offset:10240
v_mfma_f32_16x16x32_bf16 v[148:151], a[16:19], a[36:39], v[148:151]
ds_read_b128 a[96:99], v3 offset:12288
v_mfma_f32_16x16x32_bf16 v[152:155], a[16:19], a[40:43], v[152:155]
v_mfma_f32_16x16x32_bf16 v[156:159], a[16:19], a[44:47], v[156:159]
buffer_load_dword v14, v15, s[20:23], s58 offen sc0 sc1
v_mfma_f32_16x16x32_bf16 v[160:163], a[16:19], a[48:51], v[160:163]
ds_read_b128 a[100:103], v3 offset:14336
v_mfma_f32_16x16x32_bf16 v[164:167], a[16:19], a[52:55], v[164:167]
v_mfma_f32_16x16x32_bf16 v[168:171], a[16:19], a[56:59], v[168:171]
v_mfma_f32_16x16x32_bf16 v[172:175], a[16:19], a[60:63], v[172:175]
v_mfma_f32_16x16x32_bf16 v[176:179], a[20:23], a[32:35], v[176:179]
v_mfma_f32_16x16x32_bf16 v[180:183], a[20:23], a[36:39], v[180:183]
v_mfma_f32_16x16x32_bf16 v[184:187], a[20:23], a[40:43], v[184:187]
v_mfma_f32_16x16x32_bf16 v[188:191], a[20:23], a[44:47], v[188:191]
v_mfma_f32_16x16x32_bf16 v[192:195], a[20:23], a[48:51], v[192:195]
v_mfma_f32_16x16x32_bf16 v[196:199], a[20:23], a[52:55], v[196:199]
v_mfma_f32_16x16x32_bf16 v[200:203], a[20:23], a[56:59], v[200:203]
v_mfma_f32_16x16x32_bf16 v[204:207], a[20:23], a[60:63], v[204:207]
v_mfma_f32_16x16x32_bf16 v[208:211], a[24:27], a[32:35], v[208:211]
v_mfma_f32_16x16x32_bf16 v[212:215], a[24:27], a[36:39], v[212:215]
v_mfma_f32_16x16x32_bf16 v[216:219], a[24:27], a[40:43], v[216:219]
v_mfma_f32_16x16x32_bf16 v[220:223], a[24:27], a[44:47], v[220:223]
v_mfma_f32_16x16x32_bf16 v[224:227], a[24:27], a[48:51], v[224:227]
v_mfma_f32_16x16x32_bf16 v[228:231], a[24:27], a[52:55], v[228:231]
v_mfma_f32_16x16x32_bf16 v[232:235], a[24:27], a[56:59], v[232:235]
v_mfma_f32_16x16x32_bf16 v[236:239], a[24:27], a[60:63], v[236:239]
v_mfma_f32_16x16x32_bf16 v[240:243], a[28:31], a[32:35], v[240:243]
v_mfma_f32_16x16x32_bf16 v[244:247], a[28:31], a[36:39], v[244:247]
v_mfma_f32_16x16x32_bf16 v[248:251], a[28:31], a[40:43], v[248:251]
v_mfma_f32_16x16x32_bf16 v[252:255], a[28:31], a[44:47], v[252:255]
v_mfma_f32_16x16x32_bf16 a[144:147], a[28:31], a[48:51], a[144:147]
v_mfma_f32_16x16x32_bf16 a[148:151], a[28:31], a[52:55], a[148:151]
v_mfma_f32_16x16x32_bf16 a[152:155], a[28:31], a[56:59], a[152:155]
v_mfma_f32_16x16x32_bf16 a[156:159], a[28:31], a[60:63], a[156:159]
s_waitcnt vmcnt(0) lgkmcnt(0)
v_cmp_ne_u32 vcc, s89, v14
s_cbranch_vccnz LM_gVwait
LM_gVret:
s_barrier
v_mfma_f32_16x16x32_bf16 v[16:19], a[72:75], a[104:107], v[16:19]
s_add_u32 s50, s49, s51
s_add_u32 s49, s49, 32768
s_cmp_eq_u32 s49, 163840
v_mfma_f32_16x16x32_bf16 v[20:23], a[72:75], a[108:111], v[20:23]
s_cselect_b32 s49, 65536, s49
v_add_u32 v2, s49, v1
v_xor_b32 v3, 64, v2
v_mfma_f32_16x16x32_bf16 v[24:27], a[72:75], a[112:115], v[24:27]
buffer_load_dwordx4 a[48:51], v12, s[20:23], s57 offen offset:0 sc1
v_mfma_f32_16x16x32_bf16 v[28:31], a[72:75], a[116:119], v[28:31]
buffer_load_dwordx4 a[52:55], v12, s[20:23], s57 offen offset:1024 sc1
v_mfma_f32_16x16x32_bf16 v[32:35], a[72:75], a[120:123], v[32:35]
s_add_u32 m0, s32, 0
v_mfma_f32_16x16x32_bf16 v[36:39], a[72:75], a[124:127], v[36:39]
buffer_load_dwordx4 v12, s[20:23], s16 offen offset:0 sc1 lds
v_mfma_f32_16x16x32_bf16 v[40:43], a[72:75], a[128:131], v[40:43]
buffer_load_dwordx4 v12, s[20:23], s16 offen offset:1024 sc1 lds
v_mfma_f32_16x16x32_bf16 v[44:47], a[72:75], a[132:135], v[44:47]
v_mfma_f32_16x16x32_bf16 v[48:51], a[76:79], a[104:107], v[48:51]
buffer_load_dwordx4 v12, s[20:23], s16 offen offset:2048 sc1 lds
v_mfma_f32_16x16x32_bf16 v[52:55], a[76:79], a[108:111], v[52:55]
buffer_load_dwordx4 v12, s[20:23], s16 offen offset:3072 sc1 lds
v_mfma_f32_16x16x32_bf16 v[56:59], a[76:79], a[112:115], v[56:59]
s_add_u32 s16, s16, 4096
s_add_u32 m0, s32, 4096
v_mfma_f32_16x16x32_bf16 v[60:63], a[76:79], a[116:119], v[60:63]
buffer_load_dwordx4 v12, s[20:23], s16 offen offset:0 sc1 lds
v_mfma_f32_16x16x32_bf16 v[64:67], a[76:79], a[120:123], v[64:67]
buffer_load_dwordx4 v12, s[20:23], s16 offen offset:1024 sc1 lds
v_mfma_f32_16x16x32_bf16 v[68:71], a[76:79], a[124:127], v[68:71]
v_mfma_f32_16x16x32_bf16 v[72:75], a[76:79], a[128:131], v[72:75]
buffer_load_dwordx4 v12, s[20:23], s16 offen offset:2048 sc1 lds
v_mfma_f32_16x16x32_bf16 v[76:79], a[76:79], a[132:135], v[76:79]
buffer_load_dwordx4 v12, s[20:23], s16 offen offset:3072 sc1 lds
v_mfma_f32_16x16x32_bf16 v[80:83], a[80:83], a[104:107], v[80:83]
s_add_u32 s16, s16, 28672
s_add_u32 m0, s32, 32768
v_mfma_f32_16x16x32_bf16 v[84:87], a[80:83], a[108:111], v[84:87]
buffer_load_dwordx4 v12, s[20:23], s16 offen offset:0 sc1 lds
v_mfma_f32_16x16x32_bf16 v[88:91], a[80:83], a[112:115], v[88:91]
buffer_load_dwordx4 v12, s[20:23], s16 offen offset:1024 sc1 lds
v_mfma_f32_16x16x32_bf16 v[92:95], a[80:83], a[116:119], v[92:95]
v_mfma_f32_16x16x32_bf16 v[96:99], a[80:83], a[120:123], v[96:99]
buffer_load_dwordx4 v12, s[20:23], s16 offen offset:2048 sc1 lds
v_mfma_f32_16x16x32_bf16 v[100:103], a[80:83], a[124:127], v[100:103]
buffer_load_dwordx4 v12, s[20:23], s16 offen offset:3072 sc1 lds
v_mfma_f32_16x16x32_bf16 v[104:107], a[80:83], a[128:131], v[104:107]
s_add_u32 s16, s16, 4096
s_add_u32 m0, s32, 36864
v_mfma_f32_16x16x32_bf16 v[108:111], a[80:83], a[132:135], v[108:111]
buffer_load_dwordx4 v12, s[20:23], s16 offen offset:0 sc1 lds
v_mfma_f32_16x16x32_bf16 v[112:115], a[84:87], a[104:107], v[112:115]
buffer_load_dwordx4 v12, s[20:23], s16 offen offset:1024 sc1 lds
v_mfma_f32_16x16x32_bf16 v[116:119], a[84:87], a[108:111], v[116:119]
v_mfma_f32_16x16x32_bf16 v[120:123], a[84:87], a[112:115], v[120:123]
buffer_load_dwordx4 v12, s[20:23], s16 offen offset:2048 sc1 lds
v_mfma_f32_16x16x32_bf16 v[124:127], a[84:87], a[116:119], v[124:127]
buffer_load_dwordx4 v12, s[20:23], s16 offen offset:3072 sc1 lds
v_mfma_f32_16x16x32_bf16 v[128:131], a[84:87], a[120:123], v[128:131]
s_add_u32 s16, s16, 28672
s_add_u32 m0, s32, 65536
v_mfma_f32_16x16x32_bf16 v[132:135], a[84:87], a[124:127], v[132:135]
buffer_load_dwordx4 v12, s[20:23], s16 offen offset:0 sc1 lds
v_mfma_f32_16x16x32_bf16 v[136:139], a[84:87], a[128:131], v[136:139]
buffer_load_dwordx4 v12, s[20:23], s16 offen offset:1024 sc1 lds
v_mfma_f32_16x16x32_bf16 v[140:143], a[84:87], a[132:135], v[140:143]
v_mfma_f32_16x16x32_bf16 v[144:147], a[88:91], a[104:107], v[144:147]
buffer_load_dwordx4 v12, s[20:23], s16 offen offset:2048 sc1 lds
v_mfma_f32_16x16x32_bf16 v[148:151], a[88:91], a[108:111], v[148:151]
buffer_load_dwordx4 v12, s[20:23], s16 offen offset:3072 sc1 lds
v_mfma_f32_16x16x32_bf16 v[152:155], a[88:91], a[112:115], v[152:155]
s_add_u32 s16, s16, 4096
s_add_u32 m0, s32, 69632
v_mfma_f32_16x16x32_bf16 v[156:159], a[88:91], a[116:119], v[156:159]
buffer_load_dwordx4 v12, s[20:23], s16 offen offset:0 sc1 lds
v_mfma_f32_16x16x32_bf16 v[160:163], a[88:91], a[120:123], v[160:163]
buffer_load_dwordx4 v12, s[20:23], s16 offen offset:1024 sc1 lds
v_mfma_f32_16x16x32_bf16 v[164:167], a[88:91], a[124:127], v[164:167]
v_mfma_f32_16x16x32_bf16 v[168:171], a[88:91], a[128:131], v[168:171]
buffer_load_dwordx4 v12, s[20:23], s16 offen offset:2048 sc1 lds
v_mfma_f32_16x16x32_bf16 v[172:175], a[88:91], a[132:135], v[172:175]
buffer_load_dwordx4 v12, s[20:23], s16 offen offset:3072 sc1 lds
v_mfma_f32_16x16x32_bf16 v[176:179], a[92:95], a[104:107], v[176:179]
s_add_u32 s16, s16, 28672
s_add_u32 m0, s32, 98304
v_mfma_f32_16x16x32_bf16 v[180:183], a[92:95], a[108:111], v[180:183]
buffer_load_dwordx4 v12, s[20:23], s16 offen offset:0 sc1 lds
v_mfma_f32_16x16x32_bf16 v[184:187], a[92:95], a[112:115], v[184:187]
buffer_load_dwordx4 v12, s[20:23], s16 offen offset:1024 sc1 lds
v_mfma_f32_16x16x32_bf16 v[188:191], a[92:95], a[116:119], v[188:191]
v_mfma_f32_16x16x32_bf16 v[192:195], a[92:95], a[120:123], v[192:195]
buffer_load_dwordx4 v12, s[20:23], s16 offen offset:2048 sc1 lds
v_mfma_f32_16x16x32_bf16 v[196:199], a[92:95], a[124:127], v[196:199]
buffer_load_dwordx4 v12, s[20:23], s16 offen offset:3072 sc1 lds
v_mfma_f32_16x16x32_bf16 v[200:203], a[92:95], a[128:131], v[200:203]
s_add_u32 s16, s16, 4096
s_add_u32 m0, s32, 102400
v_mfma_f32_16x16x32_bf16 v[204:207], a[92:95], a[132:135], v[204:207]
buffer_load_dwordx4 v12, s[20:23], s16 offen offset:0 sc1 lds
v_mfma_f32_16x16x32_bf16 v[208:211], a[96:99], a[104:107], v[208:211]
buffer_load_dwordx4 v12, s[20:23], s16 offen offset:1024 sc1 lds
v_mfma_f32_16x16x32_bf16 v[212:215], a[96:99], a[108:111], v[212:215]
v_mfma_f32_16x16x32_bf16 v[216:219], a[96:99], a[112:115], v[216:219]
buffer_load_dwordx4 v12, s[20:23], s16 offen offset:2048 sc1 lds
v_mfma_f32_16x16x32_bf16 v[220:223], a[96:99], a[116:119], v[220:223]
buffer_load_dwordx4 v12, s[20:23], s16 offen offset:3072 sc1 lds
v_mfma_f32_16x16x32_bf16 v[224:227], a[96:99], a[120:123], v[224:227]
v_mfma_f32_16x16x32_bf16 v[228:231], a[96:99], a[124:127], v[228:231]
v_mfma_f32_16x16x32_bf16 v[232:235], a[96:99], a[128:131], v[232:235]
v_mfma_f32_16x16x32_bf16 v[236:239], a[96:99], a[132:135], v[236:239]
v_mfma_f32_16x16x32_bf16 v[240:243], a[100:103], a[104:107], v[240:243]
v_mfma_f32_16x16x32_bf16 v[244:247], a[100:103], a[108:111], v[244:247]
v_mfma_f32_16x16x32_bf16 v[248:251], a[100:103], a[112:115], v[248:251]
v_mfma_f32_16x16x32_bf16 v[252:255], a[100:103], a[116:119], v[252:255]
v_mfma_f32_16x16x32_bf16 a[144:147], a[100:103], a[120:123], a[144:147]
v_mfma_f32_16x16x32_bf16 a[148:151], a[100:103], a[124:127], a[148:151]
v_mfma_f32_16x16x32_bf16 a[152:155], a[100:103], a[128:131], a[152:155]
v_mfma_f32_16x16x32_bf16 a[156:159], a[100:103], a[132:135], a[156:159]
s_nop 7
v_cvt_pk_bf16_f32 v16, v16, v17
v_cvt_pk_bf16_f32 v17, v18, v19
v_cvt_pk_bf16_f32 v18, v48, v49
v_cvt_pk_bf16_f32 v19, v50, v51
v_cvt_pk_bf16_f32 v20, v20, v21
v_cvt_pk_bf16_f32 v21, v22, v23
v_cvt_pk_bf16_f32 v22, v52, v53
v_cvt_pk_bf16_f32 v23, v54, v55
v_cvt_pk_bf16_f32 v24, v24, v25
v_cvt_pk_bf16_f32 v25, v26, v27
v_cvt_pk_bf16_f32 v26, v56, v57
v_cvt_pk_bf16_f32 v27, v58, v59
v_cvt_pk_bf16_f32 v28, v28, v29
v_cvt_pk_bf16_f32 v29, v30, v31
v_cvt_pk_bf16_f32 v30, v60, v61
v_cvt_pk_bf16_f32 v31, v62, v63
v_cvt_pk_bf16_f32 v32, v32, v33
v_cvt_pk_bf16_f32 v33, v34, v35
v_cvt_pk_bf16_f32 v34, v64, v65
v_cvt_pk_bf16_f32 v35, v66, v67
v_cvt_pk_bf16_f32 v36, v36, v37
v_cvt_pk_bf16_f32 v37, v38, v39
v_cvt_pk_bf16_f32 v38, v68, v69
v_cvt_pk_bf16_f32 v39, v70, v71
v_cvt_pk_bf16_f32 v40, v40, v41
v_cvt_pk_bf16_f32 v41, v42, v43
v_cvt_pk_bf16_f32 v42, v72, v73
v_cvt_pk_bf16_f32 v43, v74, v75
v_cvt_pk_bf16_f32 v44, v44, v45
v_cvt_pk_bf16_f32 v45, v46, v47
v_cvt_pk_bf16_f32 v46, v76, v77
v_cvt_pk_bf16_f32 v47, v78, v79
v_cvt_pk_bf16_f32 v48, v80, v81
v_cvt_pk_bf16_f32 v49, v82, v83
v_cvt_pk_bf16_f32 v50, v112, v113
v_cvt_pk_bf16_f32 v51, v114, v115
v_cvt_pk_bf16_f32 v52, v84, v85
v_cvt_pk_bf16_f32 v53, v86, v87
v_cvt_pk_bf16_f32 v54, v116, v117
v_cvt_pk_bf16_f32 v55, v118, v119
v_cvt_pk_bf16_f32 v56, v88, v89
v_cvt_pk_bf16_f32 v57, v90, v91
v_cvt_pk_bf16_f32 v58, v120, v121
v_cvt_pk_bf16_f32 v59, v122, v123
v_cvt_pk_bf16_f32 v60, v92, v93
v_cvt_pk_bf16_f32 v61, v94, v95
v_cvt_pk_bf16_f32 v62, v124, v125
v_cvt_pk_bf16_f32 v63, v126, v127
v_cvt_pk_bf16_f32 v64, v96, v97
v_cvt_pk_bf16_f32 v65, v98, v99
v_cvt_pk_bf16_f32 v66, v128, v129
v_cvt_pk_bf16_f32 v67, v130, v131
v_cvt_pk_bf16_f32 v68, v100, v101
v_cvt_pk_bf16_f32 v69, v102, v103
v_cvt_pk_bf16_f32 v70, v132, v133
v_cvt_pk_bf16_f32 v71, v134, v135
v_cvt_pk_bf16_f32 v72, v104, v105
v_cvt_pk_bf16_f32 v73, v106, v107
v_cvt_pk_bf16_f32 v74, v136, v137
v_cvt_pk_bf16_f32 v75, v138, v139
v_cvt_pk_bf16_f32 v76, v108, v109
v_cvt_pk_bf16_f32 v77, v110, v111
v_cvt_pk_bf16_f32 v78, v140, v141
v_cvt_pk_bf16_f32 v79, v142, v143
v_cvt_pk_bf16_f32 v80, v144, v145
v_cvt_pk_bf16_f32 v81, v146, v147
v_cvt_pk_bf16_f32 v82, v176, v177
v_cvt_pk_bf16_f32 v83, v178, v179
v_cvt_pk_bf16_f32 v84, v148, v149
v_cvt_pk_bf16_f32 v85, v150, v151
v_cvt_pk_bf16_f32 v86, v180, v181
v_cvt_pk_bf16_f32 v87, v182, v183
v_cvt_pk_bf16_f32 v88, v152, v153
v_cvt_pk_bf16_f32 v89, v154, v155
v_cvt_pk_bf16_f32 v90, v184, v185
v_cvt_pk_bf16_f32 v91, v186, v187
v_cvt_pk_bf16_f32 v92, v156, v157
v_cvt_pk_bf16_f32 v93, v158, v159
v_cvt_pk_bf16_f32 v94, v188, v189
v_cvt_pk_bf16_f32 v95, v190, v191
v_cvt_pk_bf16_f32 v96, v160, v161
v_cvt_pk_bf16_f32 v97, v162, v163
v_cvt_pk_bf16_f32 v98, v192, v193
v_cvt_pk_bf16_f32 v99, v194, v195
v_cvt_pk_bf16_f32 v100, v164, v165
v_cvt_pk_bf16_f32 v101, v166, v167
v_cvt_pk_bf16_f32 v102, v196, v197
v_cvt_pk_bf16_f32 v103, v198, v199
v_cvt_pk_bf16_f32 v104, v168, v169
v_cvt_pk_bf16_f32 v105, v170, v171
v_cvt_pk_bf16_f32 v106, v200, v201
v_cvt_pk_bf16_f32 v107, v202, v203
v_cvt_pk_bf16_f32 v108, v172, v173
v_cvt_pk_bf16_f32 v109, v174, v175
v_cvt_pk_bf16_f32 v110, v204, v205
v_cvt_pk_bf16_f32 v111, v206, v207
v_cvt_pk_bf16_f32 v112, v208, v209
v_cvt_pk_bf16_f32 v113, v210, v211
v_cvt_pk_bf16_f32 v114, v240, v241
v_cvt_pk_bf16_f32 v115, v242, v243
v_cvt_pk_bf16_f32 v116, v212, v213
v_cvt_pk_bf16_f32 v117, v214, v215
v_cvt_pk_bf16_f32 v118, v244, v245
v_cvt_pk_bf16_f32 v119, v246, v247
v_cvt_pk_bf16_f32 v120, v216, v217
v_cvt_pk_bf16_f32 v121, v218, v219
v_cvt_pk_bf16_f32 v122, v248, v249
v_cvt_pk_bf16_f32 v123, v250, v251
v_cvt_pk_bf16_f32 v124, v220, v221
v_cvt_pk_bf16_f32 v125, v222, v223
v_cvt_pk_bf16_f32 v126, v252, v253
v_cvt_pk_bf16_f32 v127, v254, v255
v_accvgpr_read_b32 v144, a144
v_accvgpr_read_b32 v145, a145
v_accvgpr_read_b32 v146, a146
v_accvgpr_read_b32 v147, a147
v_cvt_pk_bf16_f32 v128, v224, v225
v_cvt_pk_bf16_f32 v129, v226, v227
v_cvt_pk_bf16_f32 v130, v144, v145
v_cvt_pk_bf16_f32 v131, v146, v147
v_accvgpr_read_b32 v148, a148
v_accvgpr_read_b32 v149, a149
v_accvgpr_read_b32 v150, a150
v_accvgpr_read_b32 v151, a151
v_cvt_pk_bf16_f32 v132, v228, v229
v_cvt_pk_bf16_f32 v133, v230, v231
v_cvt_pk_bf16_f32 v134, v148, v149
v_cvt_pk_bf16_f32 v135, v150, v151
v_accvgpr_read_b32 v152, a152
v_accvgpr_read_b32 v153, a153
v_accvgpr_read_b32 v154, a154
v_accvgpr_read_b32 v155, a155
v_cvt_pk_bf16_f32 v136, v232, v233
v_cvt_pk_bf16_f32 v137, v234, v235
v_cvt_pk_bf16_f32 v138, v152, v153
v_cvt_pk_bf16_f32 v139, v154, v155
v_accvgpr_read_b32 v156, a156
v_accvgpr_read_b32 v157, a157
v_accvgpr_read_b32 v158, a158
v_accvgpr_read_b32 v159, a159
v_cvt_pk_bf16_f32 v140, v236, v237
v_cvt_pk_bf16_f32 v141, v238, v239
v_cvt_pk_bf16_f32 v142, v156, v157
v_cvt_pk_bf16_f32 v143, v158, v159
LM_a1:
s_sub_u32 s59, 15, s101
s_cmp_eq_u32 s65, 2
s_cselect_b32 s59, s101, s59
s_cselect_b32 s58, 0, 896
s_mov_b32 s4, s82
s_mov_b32 s5, s83
s_mov_b32 s6, 1835008
s_mov_b32 s7, 0x20000
s_mov_b32 s8, s86
s_mov_b32 s9, s87
s_mov_b32 s10, 3670016
s_mov_b32 s11, 0x20000
s_mul_i32 s24, s59, 114688
s_add_u32 s24, s24, 0
s_mul_i32 s25, s59, 114688
s_add_u32 s25, s25, 28672
s_mul_i32 s26, s59, 114688
s_add_u32 s26, s26, 57344
s_mul_i32 s27, s59, 114688
s_add_u32 s27, s27, 86016
s_lshl_b32 s40, s100, 9
s_add_u32 s40, s40, 0
s_lshl_b32 s41, s100, 9
s_add_u32 s41, s41, 128
s_lshl_b32 s42, s100, 9
s_add_u32 s42, s42, 256
s_lshl_b32 s43, s100, 9
s_add_u32 s43, s43, 384
v_subrev_u32 v8, s58, v10
v_subrev_u32 v9, 8388608, v9
v_subrev_u32 v1, s75, v1
s_mov_b32 s49, 131072
v_add_u32 v2, s49, v1
v_xor_b32 v3, 64, v2
s_load_dwordx2 s[36:37], s[0:1], 64
s_load_dwordx2 s[44:45], s[0:1], 16
s_sub_u32 s53, s67, 109084672
s_lshr_b32 s54, s53, 7
s_and_b32 s53, s53, 127
s_add_u32 s53, s53, s48
s_min_u32 s53, s53, 62
s_mul_i32 s55, s53, 37
s_lshr_b32 s55, s55, 8
s_mul_i32 s56, s55, 7
s_sub_u32 s56, s53, s56
s_lshl_b32 s35, s54, 3
s_add_u32 s35, s35, s55
s_mul_i32 s17, s35, 28672
s_mul_i32 s35, s35, 28672
s_lshl_b32 s38, s56, 12
s_add_u32 s17, s17, s38
s_add_u32 s17, s17, 112197632
s_mov_b32 s38, 3670016
s_mov_b32 s39, 0x20000
s_mul_i32 s57, s54, 25088
s_lshl_b32 s58, s56, 4
s_add_u32 s58, s58, s54
s_lshl_b32 s58, s58, 12
s_add_u32 s58, s58, 115867648
v_lshrrev_b32 v233, 4, v12
v_lshrrev_b32 v236, 3, v233
v_bfe_u32 v237, v233, 1, 2
v_lshrrev_b32 v238, 4, v233
v_xor_b32 v237, v237, v238
v_and_b32 v238, 1, v233
v_mul_u32_u24 v234, 896, v236
v_lshl_add_u32 v234, v237, 5, v234
v_lshl_add_u32 v234, v238, 4, v234
v_bfe_u32 v236, v233, 2, 3
v_lshrrev_b32 v237, 5, v233
v_lshlrev_b32 v237, 10, v237
v_lshl_add_u32 v237, v236, 7, v237
v_and_b32 v238, 3, v233
v_lshl_add_u32 v237, v238, 3, v237
s_lshl_b32 s46, s48, 12
s_add_u32 s46, s46, 131072
v_add_u32 v237, s46, v237
v_lshrrev_b32 v236, 1, v236
v_xor_b32 v252, 0, v236
v_lshl_add_u32 v252, v252, 5, v237
v_xor_b32 v253, 1, v236
v_lshl_add_u32 v253, v253, 5, v237
v_xor_b32 v254, 2, v236
v_lshl_add_u32 v254, v254, 5, v237
v_xor_b32 v255, 3, v236
v_lshl_add_u32 v255, v255, 5, v237
s_cmp_eq_u32 s55, 8
s_waitcnt lgkmcnt(0)
s_cmov_b32 s36, s44
s_cmov_b32 s37, s45
s_cmov_b32 s38, 401408
s_cmov_b32 s35, s57
s_cmov_b32 s17, s58
s_lshl_b32 s56, s56, 7
s_add_u32 s35, s35, s56
v_mov_b64 v[160:161], 0
v_mov_b64 v[162:163], 0
v_mov_b64 v[164:165], 0
v_mov_b64 v[166:167], 0
v_mov_b64 v[168:169], 0
v_mov_b64 v[170:171], 0
v_mov_b64 v[172:173], 0
v_mov_b64 v[174:175], 0
v_mov_b64 v[152:153], 0
v_mov_b64 v[154:155], 0
v_mov_b64 v[156:157], 0
v_mov_b64 v[158:159], 0
v_accvgpr_write_b32 a40, 0
v_accvgpr_write_b32 a41, 0
v_accvgpr_write_b32 a42, 0
v_accvgpr_write_b32 a43, 0
v_accvgpr_write_b32 a44, 0
v_accvgpr_write_b32 a45, 0
v_accvgpr_write_b32 a46, 0
v_accvgpr_write_b32 a47, 0
v_add_u32 v224, 0, v12
v_add_u32 v225, 32768, v12
s_waitcnt vmcnt(24)
s_barrier
ds_read_b128 a[0:3], v224 offset:0
ds_read_b128 a[4:7], v224 offset:1024
ds_read_b128 a[16:19], v224 offset:2048
ds_read_b128 a[20:23], v224 offset:3072
ds_read_b128 a[8:11], v224 offset:4096
ds_read_b128 a[12:15], v224 offset:5120
v_accvgpr_read_b32 v144, a48
v_accvgpr_read_b32 v145, a49
v_accvgpr_read_b32 v146, a50
v_accvgpr_read_b32 v147, a51
v_accvgpr_read_b32 v148, a52
v_accvgpr_read_b32 v149, a53
v_accvgpr_read_b32 v150, a54
v_accvgpr_read_b32 v151, a55
s_waitcnt lgkmcnt(4)
v_mfma_f32_32x32x16_bf16 v[192:207], a[0:3], v[144:147], 0
v_mfma_f32_32x32x16_bf16 v[192:207], a[4:7], v[148:151], v[192:207]
s_nop 11
v_max3_f32 v228, v192, v193, v194
v_max3_f32 v228, v228, v195, v196
v_max3_f32 v228, v228, v197, v198
v_max3_f32 v228, v228, v199, v200
v_max3_f32 v228, v228, v201, v202
v_max3_f32 v228, v228, v203, v204
v_max3_f32 v228, v228, v205, v206
v_max_f32 v228, v228, v207
v_mov_b32 v229, v228
s_nop 1
v_permlane32_swap_b32 v228, v229
v_max_f32 v228, v228, v229
v_sub_f32 v228, 0, v228
v_mov_b32 v176, v228
v_mov_b32 v177, v228
v_mov_b32 v178, v228
v_mov_b32 v179, v228
v_mov_b32 v180, v228
v_mov_b32 v181, v228
v_mov_b32 v182, v228
v_mov_b32 v183, v228
v_mov_b32 v184, v228
v_mov_b32 v185, v228
v_mov_b32 v186, v228
v_mov_b32 v187, v228
v_mov_b32 v188, v228
v_mov_b32 v189, v228
v_mov_b32 v190, v228
v_mov_b32 v191, v228
v_add_f32 v192, v192, v228
v_add_f32 v193, v193, v228
v_add_f32 v194, v194, v228
v_add_f32 v195, v195, v228
v_add_f32 v196, v196, v228
v_add_f32 v197, v197, v228
v_add_f32 v198, v198, v228
v_add_f32 v199, v199, v228
v_add_f32 v200, v200, v228
v_add_f32 v201, v201, v228
v_add_f32 v202, v202, v228
v_add_f32 v203, v203, v228
v_add_f32 v204, v204, v228
v_add_f32 v205, v205, v228
v_add_f32 v206, v206, v228
v_add_f32 v207, v207, v228
s_waitcnt lgkmcnt(0)
s_waitcnt lgkmcnt(2)
v_mfma_f32_32x32x16_bf16 v[208:223], a[8:11], v[144:147], v[176:191]
ds_read_b128 a[0:3], v224 offset:8192
s_add_u32 m0, s46, 0
s_nop 0
buffer_load_dwordx4 v234, s[36:39], s35 offen lds
s_add_u32 s35, s35, 7168
s_add_u32 m0, s46, 1024
s_nop 0
buffer_load_dwordx4 v234, s[36:39], s35 offen lds
s_add_u32 s35, s35, 7168
v_exp_f32 v192, v192
v_exp_f32 v193, v193
v_exp_f32 v194, v194
v_exp_f32 v195, v195
v_mfma_f32_32x32x16_bf16 v[208:223], a[12:15], v[148:151], v[208:223]
ds_read_b128 a[4:7], v224 offset:9216
s_add_u32 m0, s46, 2048
s_nop 0
buffer_load_dwordx4 v234, s[36:39], s35 offen lds
s_add_u32 s35, s35, 7168
s_add_u32 m0, s46, 3072
s_nop 0
buffer_load_dwordx4 v234, s[36:39], s35 offen lds
s_add_u32 s35, s35, 7168
v_exp_f32 v200, v200
v_exp_f32 v201, v201
v_exp_f32 v202, v202
v_exp_f32 v203, v203
v_mfma_f32_32x32x16_bf16 v[160:175], a[40:43], v[152:155], v[160:175]
ds_read_b128 a[24:27], v224 offset:6144
s_add_u32 s68, s60, 0
buffer_store_dwordx4 v[16:19], v12, s[20:23], s68 offen offset:0 sc0 sc1
v_cvt_pk_bf16_f32 v152, v192, v193
v_cvt_pk_bf16_f32 v153, v194, v195
v_cvt_pk_bf16_f32 v154, v200, v201
v_cvt_pk_bf16_f32 v155, v202, v203
v_exp_f32 v196, v196
v_exp_f32 v197, v197
v_exp_f32 v198, v198
v_exp_f32 v199, v199
v_mfma_f32_32x32x16_bf16 v[160:175], a[44:47], v[156:159], v[160:175]
ds_read_b128 a[28:31], v224 offset:7168
v_exp_f32 v204, v204
v_exp_f32 v205, v205
v_exp_f32 v206, v206
v_exp_f32 v207, v207
v_cvt_pk_bf16_f32 v156, v196, v197
v_cvt_pk_bf16_f32 v157, v198, v199
v_cvt_pk_bf16_f32 v158, v204, v205
v_cvt_pk_bf16_f32 v159, v206, v207
s_waitcnt lgkmcnt(2)
v_mfma_f32_32x32x16_bf16 v[192:207], a[0:3], v[144:147], v[176:191]
ds_read_b128 a[8:11], v224 offset:12288
buffer_store_dwordx4 v[20:23], v12, s[20:23], s68 offen offset:1024 sc0 sc1
v_exp_f32 v208, v208
v_exp_f32 v209, v209
v_exp_f32 v210, v210
v_exp_f32 v211, v211
v_mfma_f32_32x32x16_bf16 v[192:207], a[4:7], v[148:151], v[192:207]
ds_read_b128 a[12:15], v224 offset:13312
v_exp_f32 v216, v216
v_exp_f32 v217, v217
v_exp_f32 v218, v218
v_exp_f32 v219, v219
v_mfma_f32_32x32x16_bf16 v[160:175], a[16:19], v[152:155], v[160:175]
ds_read_b128 a[32:35], v224 offset:10240
v_cvt_pk_bf16_f32 v152, v208, v209
v_cvt_pk_bf16_f32 v153, v210, v211
v_cvt_pk_bf16_f32 v154, v216, v217
v_cvt_pk_bf16_f32 v155, v218, v219
v_exp_f32 v212, v212
v_exp_f32 v213, v213
v_exp_f32 v214, v214
v_exp_f32 v215, v215
v_mfma_f32_32x32x16_bf16 v[160:175], a[20:23], v[156:159], v[160:175]
ds_read_b128 a[36:39], v224 offset:11264
v_exp_f32 v220, v220
v_exp_f32 v221, v221
v_exp_f32 v222, v222
v_exp_f32 v223, v223
v_cvt_pk_bf16_f32 v156, v212, v213
v_cvt_pk_bf16_f32 v157, v214, v215
v_cvt_pk_bf16_f32 v158, v220, v221
v_cvt_pk_bf16_f32 v159, v222, v223
s_waitcnt lgkmcnt(2)
v_mfma_f32_32x32x16_bf16 v[208:223], a[8:11], v[144:147], v[176:191]
ds_read_b128 a[0:3], v224 offset:16384
buffer_store_dwordx4 v[24:27], v12, s[20:23], s68 offen offset:2048 sc0 sc1
v_exp_f32 v192, v192
v_exp_f32 v193, v193
v_exp_f32 v194, v194
v_exp_f32 v195, v195
v_mfma_f32_32x32x16_bf16 v[208:223], a[12:15], v[148:151], v[208:223]
ds_read_b128 a[4:7], v224 offset:17408
buffer_store_dwordx4 v[28:31], v12, s[20:23], s68 offen offset:3072 sc0 sc1
v_exp_f32 v200, v200
v_exp_f32 v201, v201
v_exp_f32 v202, v202
v_exp_f32 v203, v203
v_cmp_lt_f32 vcc, s18, v172
s_cmp_lg_u32 vcc_hi, 0
s_cbranch_scc1 LA_ren1A0
LA_ren1retA0:
v_mfma_f32_32x32x16_bf16 v[160:175], a[24:27], v[152:155], v[160:175]
ds_read_b128 a[40:43], v224 offset:14336
v_cvt_pk_bf16_f32 v152, v192, v193
v_cvt_pk_bf16_f32 v153, v194, v195
v_cvt_pk_bf16_f32 v154, v200, v201
v_cvt_pk_bf16_f32 v155, v202, v203
v_exp_f32 v196, v196
v_exp_f32 v197, v197
v_exp_f32 v198, v198
v_exp_f32 v199, v199
v_mfma_f32_32x32x16_bf16 v[160:175], a[28:31], v[156:159], v[160:175]
ds_read_b128 a[44:47], v224 offset:15360
v_exp_f32 v204, v204
v_exp_f32 v205, v205
v_exp_f32 v206, v206
v_exp_f32 v207, v207
v_cvt_pk_bf16_f32 v156, v196, v197
v_cvt_pk_bf16_f32 v157, v198, v199
v_cvt_pk_bf16_f32 v158, v204, v205
v_cvt_pk_bf16_f32 v159, v206, v207
s_waitcnt lgkmcnt(2)
v_mfma_f32_32x32x16_bf16 v[192:207], a[0:3], v[144:147], v[176:191]
ds_read_b128 a[8:11], v224 offset:20480
s_add_u32 s69, s61, 0
buffer_store_dwordx4 v[32:35], v12, s[20:23], s69 offen offset:0 sc0 sc1
v_exp_f32 v208, v208
v_exp_f32 v209, v209
v_exp_f32 v210, v210
v_exp_f32 v211, v211
v_mfma_f32_32x32x16_bf16 v[192:207], a[4:7], v[148:151], v[192:207]
ds_read_b128 a[12:15], v224 offset:21504
v_exp_f32 v216, v216
v_exp_f32 v217, v217
v_exp_f32 v218, v218
v_exp_f32 v219, v219
v_mfma_f32_32x32x16_bf16 v[160:175], a[32:35], v[152:155], v[160:175]
ds_read_b128 a[16:19], v224 offset:18432
v_cvt_pk_bf16_f32 v152, v208, v209
v_cvt_pk_bf16_f32 v153, v210, v211
v_cvt_pk_bf16_f32 v154, v216, v217
v_cvt_pk_bf16_f32 v155, v218, v219
v_exp_f32 v212, v212
v_exp_f32 v213, v213
v_exp_f32 v214, v214
v_exp_f32 v215, v215
v_mfma_f32_32x32x16_bf16 v[160:175], a[36:39], v[156:159], v[160:175]
ds_read_b128 a[20:23], v224 offset:19456
v_exp_f32 v220, v220
v_exp_f32 v221, v221
v_exp_f32 v222, v222
v_exp_f32 v223, v223
v_cvt_pk_bf16_f32 v156, v212, v213
v_cvt_pk_bf16_f32 v157, v214, v215
v_cvt_pk_bf16_f32 v158, v220, v221
v_cvt_pk_bf16_f32 v159, v222, v223
s_waitcnt lgkmcnt(2)
v_mfma_f32_32x32x16_bf16 v[208:223], a[8:11], v[144:147], v[176:191]
ds_read_b128 a[0:3], v224 offset:24576
buffer_store_dwordx4 v[36:39], v12, s[20:23], s69 offen offset:1024 sc0 sc1
v_exp_f32 v192, v192
v_exp_f32 v193, v193
v_exp_f32 v194, v194
v_exp_f32 v195, v195
v_mfma_f32_32x32x16_bf16 v[208:223], a[12:15], v[148:151], v[208:223]
ds_read_b128 a[4:7], v224 offset:25600
buffer_store_dwordx4 v[40:43], v12, s[20:23], s69 offen offset:2048 sc0 sc1
v_exp_f32 v200, v200
v_exp_f32 v201, v201
v_exp_f32 v202, v202
v_exp_f32 v203, v203
v_mfma_f32_32x32x16_bf16 v[160:175], a[40:43], v[152:155], v[160:175]
ds_read_b128 a[24:27], v224 offset:22528
v_cvt_pk_bf16_f32 v152, v192, v193
v_cvt_pk_bf16_f32 v153, v194, v195
v_cvt_pk_bf16_f32 v154, v200, v201
v_cvt_pk_bf16_f32 v155, v202, v203
v_exp_f32 v196, v196
v_exp_f32 v197, v197
v_exp_f32 v198, v198
v_exp_f32 v199, v199
v_mfma_f32_32x32x16_bf16 v[160:175], a[44:47], v[156:159], v[160:175]
ds_read_b128 a[28:31], v224 offset:23552
v_exp_f32 v204, v204
v_exp_f32 v205, v205
v_exp_f32 v206, v206
v_exp_f32 v207, v207
v_cvt_pk_bf16_f32 v156, v196, v197
v_cvt_pk_bf16_f32 v157, v198, v199
v_cvt_pk_bf16_f32 v158, v204, v205
v_cvt_pk_bf16_f32 v159, v206, v207
s_waitcnt lgkmcnt(2)
v_mfma_f32_32x32x16_bf16 v[192:207], a[0:3], v[144:147], v[176:191]
ds_read_b128 a[8:11], v224 offset:28672
buffer_store_dwordx4 v[44:47], v12, s[20:23], s69 offen offset:3072 sc0 sc1
v_exp_f32 v208, v208
v_exp_f32 v209, v209
v_exp_f32 v210, v210
v_exp_f32 v211, v211
v_mfma_f32_32x32x16_bf16 v[192:207], a[4:7], v[148:151], v[192:207]
ds_read_b128 a[12:15], v224 offset:29696
v_exp_f32 v216, v216
v_exp_f32 v217, v217
v_exp_f32 v218, v218
v_exp_f32 v219, v219
s_cmp_lg_u32 s19, 0
s_cbranch_scc1 LA_ren2A0
LA_ren2retA0:
v_mfma_f32_32x32x16_bf16 v[160:175], a[16:19], v[152:155], v[160:175]
ds_read_b128 a[32:35], v224 offset:26624
v_cvt_pk_bf16_f32 v152, v208, v209
v_cvt_pk_bf16_f32 v153, v210, v211
v_cvt_pk_bf16_f32 v154, v216, v217
v_cvt_pk_bf16_f32 v155, v218, v219
v_exp_f32 v212, v212
v_exp_f32 v213, v213
v_exp_f32 v214, v214
v_exp_f32 v215, v215
v_mfma_f32_32x32x16_bf16 v[160:175], a[20:23], v[156:159], v[160:175]
ds_read_b128 a[36:39], v224 offset:27648
v_exp_f32 v220, v220
v_exp_f32 v221, v221
v_exp_f32 v222, v222
v_exp_f32 v223, v223
v_cvt_pk_bf16_f32 v156, v212, v213
v_cvt_pk_bf16_f32 v157, v214, v215
v_cvt_pk_bf16_f32 v158, v220, v221
v_cvt_pk_bf16_f32 v159, v222, v223
s_waitcnt vmcnt(8) lgkmcnt(2)
s_barrier
v_mfma_f32_32x32x16_bf16 v[208:223], a[8:11], v[144:147], v[176:191]
ds_read_b128 a[0:3], v225 offset:0
s_add_u32 s68, s60, 32768
buffer_store_dwordx4 v[48:51], v12, s[20:23], s68 offen offset:0 sc0 sc1
v_exp_f32 v192, v192
v_exp_f32 v193, v193
v_exp_f32 v194, v194
v_exp_f32 v195, v195
v_mfma_f32_32x32x16_bf16 v[208:223], a[12:15], v[148:151], v[208:223]
ds_read_b128 a[4:7], v225 offset:1024
buffer_store_dwordx4 v[52:55], v12, s[20:23], s68 offen offset:1024 sc0 sc1
v_exp_f32 v200, v200
v_exp_f32 v201, v201
v_exp_f32 v202, v202
v_exp_f32 v203, v203
v_mfma_f32_32x32x16_bf16 v[160:175], a[24:27], v[152:155], v[160:175]
ds_read_b128 a[40:43], v224 offset:30720
v_cvt_pk_bf16_f32 v152, v192, v193
v_cvt_pk_bf16_f32 v153, v194, v195
v_cvt_pk_bf16_f32 v154, v200, v201
v_cvt_pk_bf16_f32 v155, v202, v203
v_exp_f32 v196, v196
v_exp_f32 v197, v197
v_exp_f32 v198, v198
v_exp_f32 v199, v199
v_mfma_f32_32x32x16_bf16 v[160:175], a[28:31], v[156:159], v[160:175]
ds_read_b128 a[44:47], v224 offset:31744
v_exp_f32 v204, v204
v_exp_f32 v205, v205
v_exp_f32 v206, v206
v_exp_f32 v207, v207
v_cvt_pk_bf16_f32 v156, v196, v197
v_cvt_pk_bf16_f32 v157, v198, v199
v_cvt_pk_bf16_f32 v158, v204, v205
v_cvt_pk_bf16_f32 v159, v206, v207
ds_read_b64_tr_b16 v[236:237], v252 offset:0
ds_read_b64_tr_b16 v[238:239], v252 offset:2048
ds_read_b64_tr_b16 v[240:241], v253 offset:0
ds_read_b64_tr_b16 v[242:243], v253 offset:2048
ds_read_b64_tr_b16 v[244:245], v254 offset:0
ds_read_b64_tr_b16 v[246:247], v254 offset:2048
ds_read_b64_tr_b16 v[248:249], v255 offset:0
ds_read_b64_tr_b16 v[250:251], v255 offset:2048
s_waitcnt lgkmcnt(0)
s_waitcnt lgkmcnt(2)
v_mfma_f32_32x32x16_bf16 v[192:207], a[0:3], v[144:147], v[176:191]
ds_read_b128 a[8:11], v225 offset:4096
buffer_store_dwordx4 v[56:59], v12, s[20:23], s68 offen offset:2048 sc0 sc1
v_exp_f32 v208, v208
v_exp_f32 v209, v209
v_exp_f32 v210, v210
v_exp_f32 v211, v211
v_mfma_f32_32x32x16_bf16 v[192:207], a[4:7], v[148:151], v[192:207]
ds_read_b128 a[12:15], v225 offset:5120
v_exp_f32 v216, v216
v_exp_f32 v217, v217
v_exp_f32 v218, v218
v_exp_f32 v219, v219
v_mfma_f32_32x32x16_bf16 v[160:175], a[32:35], v[152:155], v[160:175]
ds_read_b128 a[16:19], v225 offset:2048
v_cvt_pk_bf16_f32 v152, v208, v209
v_cvt_pk_bf16_f32 v153, v210, v211
v_cvt_pk_bf16_f32 v154, v216, v217
v_cvt_pk_bf16_f32 v155, v218, v219
v_exp_f32 v212, v212
v_exp_f32 v213, v213
v_exp_f32 v214, v214
v_exp_f32 v215, v215
v_mfma_f32_32x32x16_bf16 v[160:175], a[36:39], v[156:159], v[160:175]
ds_read_b128 a[20:23], v225 offset:3072
v_exp_f32 v220, v220
v_exp_f32 v221, v221
v_exp_f32 v222, v222
v_exp_f32 v223, v223
v_cvt_pk_bf16_f32 v156, v212, v213
v_cvt_pk_bf16_f32 v157, v214, v215
v_cvt_pk_bf16_f32 v158, v220, v221
v_cvt_pk_bf16_f32 v159, v222, v223
v_add_u32 v224, 32768, v12
v_add_u32 v225, 65536, v12
s_waitcnt lgkmcnt(2)
v_mfma_f32_32x32x16_bf16 v[208:223], a[8:11], v[144:147], v[176:191]
ds_read_b128 a[0:3], v224 offset:8192
buffer_store_dwordx4 v[236:239], v12, s[20:23], s17 offen offset:0 sc0 sc1
buffer_store_dwordx4 v[240:243], v12, s[20:23], s17 offen offset:1024 sc0 sc1
v_exp_f32 v192, v192
v_exp_f32 v193, v193
v_exp_f32 v194, v194
v_exp_f32 v195, v195
v_mfma_f32_32x32x16_bf16 v[208:223], a[12:15], v[148:151], v[208:223]
ds_read_b128 a[4:7], v224 offset:9216
buffer_store_dwordx4 v[244:247], v12, s[20:23], s17 offen offset:2048 sc0 sc1
buffer_store_dwordx4 v[248:251], v12, s[20:23], s17 offen offset:3072 sc0 sc1
v_exp_f32 v200, v200
v_exp_f32 v201, v201
v_exp_f32 v202, v202
v_exp_f32 v203, v203
v_mfma_f32_32x32x16_bf16 v[160:175], a[40:43], v[152:155], v[160:175]
ds_read_b128 a[24:27], v224 offset:6144
buffer_store_dwordx4 v[60:63], v12, s[20:23], s68 offen offset:3072 sc0 sc1
s_add_u32 s69, s61, 32768
buffer_store_dwordx4 v[64:67], v12, s[20:23], s69 offen offset:0 sc0 sc1
v_cvt_pk_bf16_f32 v152, v192, v193
v_cvt_pk_bf16_f32 v153, v194, v195
v_cvt_pk_bf16_f32 v154, v200, v201
v_cvt_pk_bf16_f32 v155, v202, v203
v_exp_f32 v196, v196
v_exp_f32 v197, v197
v_exp_f32 v198, v198
v_exp_f32 v199, v199
v_mfma_f32_32x32x16_bf16 v[160:175], a[44:47], v[156:159], v[160:175]
ds_read_b128 a[28:31], v224 offset:7168
v_exp_f32 v204, v204
v_exp_f32 v205, v205
v_exp_f32 v206, v206
v_exp_f32 v207, v207
v_cvt_pk_bf16_f32 v156, v196, v197
v_cvt_pk_bf16_f32 v157, v198, v199
v_cvt_pk_bf16_f32 v158, v204, v205
v_cvt_pk_bf16_f32 v159, v206, v207
s_waitcnt lgkmcnt(2)
v_mfma_f32_32x32x16_bf16 v[192:207], a[0:3], v[144:147], v[176:191]
ds_read_b128 a[8:11], v224 offset:12288
buffer_store_dwordx4 v[68:71], v12, s[20:23], s69 offen offset:1024 sc0 sc1
v_exp_f32 v208, v208
v_exp_f32 v209, v209
v_exp_f32 v210, v210
v_exp_f32 v211, v211
v_mfma_f32_32x32x16_bf16 v[192:207], a[4:7], v[148:151], v[192:207]
ds_read_b128 a[12:15], v224 offset:13312
v_exp_f32 v216, v216
v_exp_f32 v217, v217
v_exp_f32 v218, v218
v_exp_f32 v219, v219
v_mfma_f32_32x32x16_bf16 v[160:175], a[16:19], v[152:155], v[160:175]
ds_read_b128 a[32:35], v224 offset:10240
v_cvt_pk_bf16_f32 v152, v208, v209
v_cvt_pk_bf16_f32 v153, v210, v211
v_cvt_pk_bf16_f32 v154, v216, v217
v_cvt_pk_bf16_f32 v155, v218, v219
v_exp_f32 v212, v212
v_exp_f32 v213, v213
v_exp_f32 v214, v214
v_exp_f32 v215, v215
v_mfma_f32_32x32x16_bf16 v[160:175], a[20:23], v[156:159], v[160:175]
ds_read_b128 a[36:39], v224 offset:11264
v_exp_f32 v220, v220
v_exp_f32 v221, v221
v_exp_f32 v222, v222
v_exp_f32 v223, v223
v_cvt_pk_bf16_f32 v156, v212, v213
v_cvt_pk_bf16_f32 v157, v214, v215
v_cvt_pk_bf16_f32 v158, v220, v221
v_cvt_pk_bf16_f32 v159, v222, v223
s_waitcnt lgkmcnt(2)
v_mfma_f32_32x32x16_bf16 v[208:223], a[8:11], v[144:147], v[176:191]
ds_read_b128 a[0:3], v224 offset:16384
buffer_store_dwordx4 v[72:75], v12, s[20:23], s69 offen offset:2048 sc0 sc1
v_exp_f32 v192, v192
v_exp_f32 v193, v193
v_exp_f32 v194, v194
v_exp_f32 v195, v195
v_mfma_f32_32x32x16_bf16 v[208:223], a[12:15], v[148:151], v[208:223]
ds_read_b128 a[4:7], v224 offset:17408
buffer_store_dwordx4 v[76:79], v12, s[20:23], s69 offen offset:3072 sc0 sc1
v_exp_f32 v200, v200
v_exp_f32 v201, v201
v_exp_f32 v202, v202
v_exp_f32 v203, v203
v_cmp_lt_f32 vcc, s18, v172
s_cmp_lg_u32 vcc_hi, 0
s_cbranch_scc1 LA_ren1A1
LA_ren1retA1:
v_mfma_f32_32x32x16_bf16 v[160:175], a[24:27], v[152:155], v[160:175]
ds_read_b128 a[40:43], v224 offset:14336
v_cvt_pk_bf16_f32 v152, v192, v193
v_cvt_pk_bf16_f32 v153, v194, v195
v_cvt_pk_bf16_f32 v154, v200, v201
v_cvt_pk_bf16_f32 v155, v202, v203
v_exp_f32 v196, v196
v_exp_f32 v197, v197
v_exp_f32 v198, v198
v_exp_f32 v199, v199
v_mfma_f32_32x32x16_bf16 v[160:175], a[28:31], v[156:159], v[160:175]
ds_read_b128 a[44:47], v224 offset:15360
v_exp_f32 v204, v204
v_exp_f32 v205, v205
v_exp_f32 v206, v206
v_exp_f32 v207, v207
v_cvt_pk_bf16_f32 v156, v196, v197
v_cvt_pk_bf16_f32 v157, v198, v199
v_cvt_pk_bf16_f32 v158, v204, v205
v_cvt_pk_bf16_f32 v159, v206, v207
s_waitcnt lgkmcnt(2)
v_mfma_f32_32x32x16_bf16 v[192:207], a[0:3], v[144:147], v[176:191]
ds_read_b128 a[8:11], v224 offset:20480
s_add_u32 s68, s60, 65536
buffer_store_dwordx4 v[80:83], v12, s[20:23], s68 offen offset:0 sc0 sc1
v_exp_f32 v208, v208
v_exp_f32 v209, v209
v_exp_f32 v210, v210
v_exp_f32 v211, v211
v_mfma_f32_32x32x16_bf16 v[192:207], a[4:7], v[148:151], v[192:207]
ds_read_b128 a[12:15], v224 offset:21504
v_exp_f32 v216, v216
v_exp_f32 v217, v217
v_exp_f32 v218, v218
v_exp_f32 v219, v219
v_mfma_f32_32x32x16_bf16 v[160:175], a[32:35], v[152:155], v[160:175]
ds_read_b128 a[16:19], v224 offset:18432
v_cvt_pk_bf16_f32 v152, v208, v209
v_cvt_pk_bf16_f32 v153, v210, v211
v_cvt_pk_bf16_f32 v154, v216, v217
v_cvt_pk_bf16_f32 v155, v218, v219
v_exp_f32 v212, v212
v_exp_f32 v213, v213
v_exp_f32 v214, v214
v_exp_f32 v215, v215
v_mfma_f32_32x32x16_bf16 v[160:175], a[36:39], v[156:159], v[160:175]
ds_read_b128 a[20:23], v224 offset:19456
v_exp_f32 v220, v220
v_exp_f32 v221, v221
v_exp_f32 v222, v222
v_exp_f32 v223, v223
v_cvt_pk_bf16_f32 v156, v212, v213
v_cvt_pk_bf16_f32 v157, v214, v215
v_cvt_pk_bf16_f32 v158, v220, v221
v_cvt_pk_bf16_f32 v159, v222, v223
s_waitcnt lgkmcnt(2)
v_mfma_f32_32x32x16_bf16 v[208:223], a[8:11], v[144:147], v[176:191]
ds_read_b128 a[0:3], v224 offset:24576
buffer_store_dwordx4 v[84:87], v12, s[20:23], s68 offen offset:1024 sc0 sc1
v_exp_f32 v192, v192
v_exp_f32 v193, v193
v_exp_f32 v194, v194
v_exp_f32 v195, v195
v_mfma_f32_32x32x16_bf16 v[208:223], a[12:15], v[148:151], v[208:223]
ds_read_b128 a[4:7], v224 offset:25600
v_exp_f32 v200, v200
v_exp_f32 v201, v201
v_exp_f32 v202, v202
v_exp_f32 v203, v203
v_mfma_f32_32x32x16_bf16 v[160:175], a[40:43], v[152:155], v[160:175]
ds_read_b128 a[24:27], v224 offset:22528
v_cvt_pk_bf16_f32 v152, v192, v193
v_cvt_pk_bf16_f32 v153, v194, v195
v_cvt_pk_bf16_f32 v154, v200, v201
v_cvt_pk_bf16_f32 v155, v202, v203
v_exp_f32 v196, v196
v_exp_f32 v197, v197
v_exp_f32 v198, v198
v_exp_f32 v199, v199
v_mfma_f32_32x32x16_bf16 v[160:175], a[44:47], v[156:159], v[160:175]
ds_read_b128 a[28:31], v224 offset:23552
v_exp_f32 v204, v204
v_exp_f32 v205, v205
v_exp_f32 v206, v206
v_exp_f32 v207, v207
v_cvt_pk_bf16_f32 v156, v196, v197
v_cvt_pk_bf16_f32 v157, v198, v199
v_cvt_pk_bf16_f32 v158, v204, v205
v_cvt_pk_bf16_f32 v159, v206, v207
s_waitcnt lgkmcnt(2)
v_mfma_f32_32x32x16_bf16 v[192:207], a[0:3], v[144:147], v[176:191]
ds_read_b128 a[8:11], v224 offset:28672
buffer_store_dwordx4 v[88:91], v12, s[20:23], s68 offen offset:2048 sc0 sc1
v_exp_f32 v208, v208
v_exp_f32 v209, v209
v_exp_f32 v210, v210
v_exp_f32 v211, v211
v_mfma_f32_32x32x16_bf16 v[192:207], a[4:7], v[148:151], v[192:207]
ds_read_b128 a[12:15], v224 offset:29696
buffer_store_dwordx4 v[92:95], v12, s[20:23], s68 offen offset:3072 sc0 sc1
v_exp_f32 v216, v216
v_exp_f32 v217, v217
v_exp_f32 v218, v218
v_exp_f32 v219, v219
s_cmp_lg_u32 s19, 0
s_cbranch_scc1 LA_ren2A1
LA_ren2retA1:
v_mfma_f32_32x32x16_bf16 v[160:175], a[16:19], v[152:155], v[160:175]
ds_read_b128 a[32:35], v224 offset:26624
v_cvt_pk_bf16_f32 v152, v208, v209
v_cvt_pk_bf16_f32 v153, v210, v211
v_cvt_pk_bf16_f32 v154, v216, v217
v_cvt_pk_bf16_f32 v155, v218, v219
v_exp_f32 v212, v212
v_exp_f32 v213, v213
v_exp_f32 v214, v214
v_exp_f32 v215, v215
v_mfma_f32_32x32x16_bf16 v[160:175], a[20:23], v[156:159], v[160:175]
ds_read_b128 a[36:39], v224 offset:27648
v_exp_f32 v220, v220
v_exp_f32 v221, v221
v_exp_f32 v222, v222
v_exp_f32 v223, v223
v_cvt_pk_bf16_f32 v156, v212, v213
v_cvt_pk_bf16_f32 v157, v214, v215
v_cvt_pk_bf16_f32 v158, v220, v221
v_cvt_pk_bf16_f32 v159, v222, v223
s_waitcnt lgkmcnt(2)
v_mfma_f32_32x32x16_bf16 v[208:223], a[8:11], v[144:147], v[176:191]
ds_read_b128 a[0:3], v225 offset:0
s_add_u32 s69, s61, 65536
buffer_store_dwordx4 v[96:99], v12, s[20:23], s69 offen offset:0 sc0 sc1
v_exp_f32 v192, v192
v_exp_f32 v193, v193
v_exp_f32 v194, v194
v_exp_f32 v195, v195
v_mfma_f32_32x32x16_bf16 v[208:223], a[12:15], v[148:151], v[208:223]
ds_read_b128 a[4:7], v225 offset:1024
v_exp_f32 v200, v200
v_exp_f32 v201, v201
v_exp_f32 v202, v202
v_exp_f32 v203, v203
v_mfma_f32_32x32x16_bf16 v[160:175], a[24:27], v[152:155], v[160:175]
ds_read_b128 a[40:43], v224 offset:30720
v_cvt_pk_bf16_f32 v152, v192, v193
v_cvt_pk_bf16_f32 v153, v194, v195
v_cvt_pk_bf16_f32 v154, v200, v201
v_cvt_pk_bf16_f32 v155, v202, v203
v_exp_f32 v196, v196
v_exp_f32 v197, v197
v_exp_f32 v198, v198
v_exp_f32 v199, v199
v_mfma_f32_32x32x16_bf16 v[160:175], a[28:31], v[156:159], v[160:175]
ds_read_b128 a[44:47], v224 offset:31744
v_exp_f32 v204, v204
v_exp_f32 v205, v205
v_exp_f32 v206, v206
v_exp_f32 v207, v207
v_cvt_pk_bf16_f32 v156, v196, v197
v_cvt_pk_bf16_f32 v157, v198, v199
v_cvt_pk_bf16_f32 v158, v204, v205
v_cvt_pk_bf16_f32 v159, v206, v207
s_waitcnt lgkmcnt(2)
v_mfma_f32_32x32x16_bf16 v[192:207], a[0:3], v[144:147], v[176:191]
ds_read_b128 a[8:11], v225 offset:4096
buffer_store_dwordx4 v[100:103], v12, s[20:23], s69 offen offset:1024 sc0 sc1
v_exp_f32 v208, v208
v_exp_f32 v209, v209
v_exp_f32 v210, v210
v_exp_f32 v211, v211
v_mfma_f32_32x32x16_bf16 v[192:207], a[4:7], v[148:151], v[192:207]
ds_read_b128 a[12:15], v225 offset:5120
buffer_store_dwordx4 v[104:107], v12, s[20:23], s69 offen offset:2048 sc0 sc1
v_exp_f32 v216, v216
v_exp_f32 v217, v217
v_exp_f32 v218, v218
v_exp_f32 v219, v219
v_mfma_f32_32x32x16_bf16 v[160:175], a[32:35], v[152:155], v[160:175]
ds_read_b128 a[16:19], v225 offset:2048
v_cvt_pk_bf16_f32 v152, v208, v209
v_cvt_pk_bf16_f32 v153, v210, v211
v_cvt_pk_bf16_f32 v154, v216, v217
v_cvt_pk_bf16_f32 v155, v218, v219
v_exp_f32 v212, v212
v_exp_f32 v213, v213
v_exp_f32 v214, v214
v_exp_f32 v215, v215
v_mfma_f32_32x32x16_bf16 v[160:175], a[36:39], v[156:159], v[160:175]
ds_read_b128 a[20:23], v225 offset:3072
v_exp_f32 v220, v220
v_exp_f32 v221, v221
v_exp_f32 v222, v222
v_exp_f32 v223, v223
v_cvt_pk_bf16_f32 v156, v212, v213
v_cvt_pk_bf16_f32 v157, v214, v215
v_cvt_pk_bf16_f32 v158, v220, v221
v_cvt_pk_bf16_f32 v159, v222, v223
v_add_u32 v224, 65536, v12
v_add_u32 v225, 98304, v12
s_waitcnt lgkmcnt(2)
v_mfma_f32_32x32x16_bf16 v[208:223], a[8:11], v[144:147], v[176:191]
ds_read_b128 a[0:3], v224 offset:8192
buffer_store_dwordx4 v[108:111], v12, s[20:23], s69 offen offset:3072 sc0 sc1
v_exp_f32 v192, v192
v_exp_f32 v193, v193
v_exp_f32 v194, v194
v_exp_f32 v195, v195
v_mfma_f32_32x32x16_bf16 v[208:223], a[12:15], v[148:151], v[208:223]
ds_read_b128 a[4:7], v224 offset:9216
v_exp_f32 v200, v200
v_exp_f32 v201, v201
v_exp_f32 v202, v202
v_exp_f32 v203, v203
v_mfma_f32_32x32x16_bf16 v[160:175], a[40:43], v[152:155], v[160:175]
ds_read_b128 a[24:27], v224 offset:6144
v_cvt_pk_bf16_f32 v152, v192, v193
v_cvt_pk_bf16_f32 v153, v194, v195
v_cvt_pk_bf16_f32 v154, v200, v201
v_cvt_pk_bf16_f32 v155, v202, v203
v_exp_f32 v196, v196
v_exp_f32 v197, v197
v_exp_f32 v198, v198
v_exp_f32 v199, v199
v_mfma_f32_32x32x16_bf16 v[160:175], a[44:47], v[156:159], v[160:175]
ds_read_b128 a[28:31], v224 offset:7168
v_exp_f32 v204, v204
v_exp_f32 v205, v205
v_exp_f32 v206, v206
v_exp_f32 v207, v207
v_cvt_pk_bf16_f32 v156, v196, v197
v_cvt_pk_bf16_f32 v157, v198, v199
v_cvt_pk_bf16_f32 v158, v204, v205
v_cvt_pk_bf16_f32 v159, v206, v207
s_waitcnt lgkmcnt(2)
v_mfma_f32_32x32x16_bf16 v[192:207], a[0:3], v[144:147], v[176:191]
ds_read_b128 a[8:11], v224 offset:12288
s_add_u32 s68, s60, 98304
buffer_store_dwordx4 v[112:115], v12, s[20:23], s68 offen offset:0 sc0 sc1
v_exp_f32 v208, v208
v_exp_f32 v209, v209
v_exp_f32 v210, v210
v_exp_f32 v211, v211
v_mfma_f32_32x32x16_bf16 v[192:207], a[4:7], v[148:151], v[192:207]
ds_read_b128 a[12:15], v224 offset:13312
buffer_store_dwordx4 v[116:119], v12, s[20:23], s68 offen offset:1024 sc0 sc1
v_exp_f32 v216, v216
v_exp_f32 v217, v217
v_exp_f32 v218, v218
v_exp_f32 v219, v219
v_mfma_f32_32x32x16_bf16 v[160:175], a[16:19], v[152:155], v[160:175]
ds_read_b128 a[32:35], v224 offset:10240
v_cvt_pk_bf16_f32 v152, v208, v209
v_cvt_pk_bf16_f32 v153, v210, v211
v_cvt_pk_bf16_f32 v154, v216, v217
v_cvt_pk_bf16_f32 v155, v218, v219
v_exp_f32 v212, v212
v_exp_f32 v213, v213
v_exp_f32 v214, v214
v_exp_f32 v215, v215
v_mfma_f32_32x32x16_bf16 v[160:175], a[20:23], v[156:159], v[160:175]
ds_read_b128 a[36:39], v224 offset:11264
v_exp_f32 v220, v220
v_exp_f32 v221, v221
v_exp_f32 v222, v222
v_exp_f32 v223, v223
v_cvt_pk_bf16_f32 v156, v212, v213
v_cvt_pk_bf16_f32 v157, v214, v215
v_cvt_pk_bf16_f32 v158, v220, v221
v_cvt_pk_bf16_f32 v159, v222, v223
s_waitcnt lgkmcnt(2)
v_mfma_f32_32x32x16_bf16 v[208:223], a[8:11], v[144:147], v[176:191]
ds_read_b128 a[0:3], v224 offset:16384
buffer_store_dwordx4 v[120:123], v12, s[20:23], s68 offen offset:2048 sc0 sc1
v_exp_f32 v192, v192
v_exp_f32 v193, v193
v_exp_f32 v194, v194
v_exp_f32 v195, v195
v_mfma_f32_32x32x16_bf16 v[208:223], a[12:15], v[148:151], v[208:223]
ds_read_b128 a[4:7], v224 offset:17408
v_exp_f32 v200, v200
v_exp_f32 v201, v201
v_exp_f32 v202, v202
v_exp_f32 v203, v203
v_cmp_lt_f32 vcc, s18, v172
s_cmp_lg_u32 vcc_hi, 0
s_cbranch_scc1 LA_ren1A2
LA_ren1retA2:
v_mfma_f32_32x32x16_bf16 v[160:175], a[24:27], v[152:155], v[160:175]
ds_read_b128 a[40:43], v224 offset:14336
v_cvt_pk_bf16_f32 v152, v192, v193
v_cvt_pk_bf16_f32 v153, v194, v195
v_cvt_pk_bf16_f32 v154, v200, v201
v_cvt_pk_bf16_f32 v155, v202, v203
v_exp_f32 v196, v196
v_exp_f32 v197, v197
v_exp_f32 v198, v198
v_exp_f32 v199, v199
v_mfma_f32_32x32x16_bf16 v[160:175], a[28:31], v[156:159], v[160:175]
ds_read_b128 a[44:47], v224 offset:15360
v_exp_f32 v204, v204
v_exp_f32 v205, v205
v_exp_f32 v206, v206
v_exp_f32 v207, v207
v_cvt_pk_bf16_f32 v156, v196, v197
v_cvt_pk_bf16_f32 v157, v198, v199
v_cvt_pk_bf16_f32 v158, v204, v205
v_cvt_pk_bf16_f32 v159, v206, v207
s_waitcnt lgkmcnt(2)
v_mfma_f32_32x32x16_bf16 v[192:207], a[0:3], v[144:147], v[176:191]
ds_read_b128 a[8:11], v224 offset:20480
buffer_store_dwordx4 v[124:127], v12, s[20:23], s68 offen offset:3072 sc0 sc1
v_exp_f32 v208, v208
v_exp_f32 v209, v209
v_exp_f32 v210, v210
v_exp_f32 v211, v211
v_mfma_f32_32x32x16_bf16 v[192:207], a[4:7], v[148:151], v[192:207]
ds_read_b128 a[12:15], v224 offset:21504
s_add_u32 s69, s61, 98304
buffer_store_dwordx4 v[128:131], v12, s[20:23], s69 offen offset:0 sc0 sc1
v_exp_f32 v216, v216
v_exp_f32 v217, v217
v_exp_f32 v218, v218
v_exp_f32 v219, v219
v_mfma_f32_32x32x16_bf16 v[160:175], a[32:35], v[152:155], v[160:175]
ds_read_b128 a[16:19], v224 offset:18432
v_cvt_pk_bf16_f32 v152, v208, v209
v_cvt_pk_bf16_f32 v153, v210, v211
v_cvt_pk_bf16_f32 v154, v216, v217
v_cvt_pk_bf16_f32 v155, v218, v219
v_exp_f32 v212, v212
v_exp_f32 v213, v213
v_exp_f32 v214, v214
v_exp_f32 v215, v215
v_mfma_f32_32x32x16_bf16 v[160:175], a[36:39], v[156:159], v[160:175]
ds_read_b128 a[20:23], v224 offset:19456
v_exp_f32 v220, v220
v_exp_f32 v221, v221
v_exp_f32 v222, v222
v_exp_f32 v223, v223
v_cvt_pk_bf16_f32 v156, v212, v213
v_cvt_pk_bf16_f32 v157, v214, v215
v_cvt_pk_bf16_f32 v158, v220, v221
v_cvt_pk_bf16_f32 v159, v222, v223
s_waitcnt lgkmcnt(2)
v_mfma_f32_32x32x16_bf16 v[208:223], a[8:11], v[144:147], v[176:191]
ds_read_b128 a[0:3], v224 offset:24576
buffer_store_dwordx4 v[132:135], v12, s[20:23], s69 offen offset:1024 sc0 sc1
v_exp_f32 v192, v192
v_exp_f32 v193, v193
v_exp_f32 v194, v194
v_exp_f32 v195, v195
v_mfma_f32_32x32x16_bf16 v[208:223], a[12:15], v[148:151], v[208:223]
ds_read_b128 a[4:7], v224 offset:25600
v_exp_f32 v200, v200
v_exp_f32 v201, v201
v_exp_f32 v202, v202
v_exp_f32 v203, v203
v_mfma_f32_32x32x16_bf16 v[160:175], a[40:43], v[152:155], v[160:175]
ds_read_b128 a[24:27], v224 offset:22528
v_cvt_pk_bf16_f32 v152, v192, v193
v_cvt_pk_bf16_f32 v153, v194, v195
v_cvt_pk_bf16_f32 v154, v200, v201
v_cvt_pk_bf16_f32 v155, v202, v203
v_exp_f32 v196, v196
v_exp_f32 v197, v197
v_exp_f32 v198, v198
v_exp_f32 v199, v199
v_mfma_f32_32x32x16_bf16 v[160:175], a[44:47], v[156:159], v[160:175]
ds_read_b128 a[28:31], v224 offset:23552
v_exp_f32 v204, v204
v_exp_f32 v205, v205
v_exp_f32 v206, v206
v_exp_f32 v207, v207
v_cvt_pk_bf16_f32 v156, v196, v197
v_cvt_pk_bf16_f32 v157, v198, v199
v_cvt_pk_bf16_f32 v158, v204, v205
v_cvt_pk_bf16_f32 v159, v206, v207
s_waitcnt lgkmcnt(2)
v_mfma_f32_32x32x16_bf16 v[192:207], a[0:3], v[144:147], v[176:191]
ds_read_b128 a[8:11], v224 offset:28672
buffer_store_dwordx4 v[136:139], v12, s[20:23], s69 offen offset:2048 sc0 sc1
v_exp_f32 v208, v208
v_exp_f32 v209, v209
v_exp_f32 v210, v210
v_exp_f32 v211, v211
v_mfma_f32_32x32x16_bf16 v[192:207], a[4:7], v[148:151], v[192:207]
ds_read_b128 a[12:15], v224 offset:29696
buffer_store_dwordx4 v[140:143], v12, s[20:23], s69 offen offset:3072 sc0 sc1
v_exp_f32 v216, v216
v_exp_f32 v217, v217
v_exp_f32 v218, v218
v_exp_f32 v219, v219
s_cmp_lg_u32 s19, 0
s_cbranch_scc1 LA_ren2A2
LA_ren2retA2:
v_mfma_f32_32x32x16_bf16 v[160:175], a[16:19], v[152:155], v[160:175]
ds_read_b128 a[32:35], v224 offset:26624
v_cvt_pk_bf16_f32 v152, v208, v209
v_cvt_pk_bf16_f32 v153, v210, v211
v_cvt_pk_bf16_f32 v154, v216, v217
v_cvt_pk_bf16_f32 v155, v218, v219
v_exp_f32 v212, v212
v_exp_f32 v213, v213
v_exp_f32 v214, v214
v_exp_f32 v215, v215
v_mfma_f32_32x32x16_bf16 v[160:175], a[20:23], v[156:159], v[160:175]
ds_read_b128 a[36:39], v224 offset:27648
v_exp_f32 v220, v220
v_exp_f32 v221, v221
v_exp_f32 v222, v222
v_exp_f32 v223, v223
v_cvt_pk_bf16_f32 v156, v212, v213
v_cvt_pk_bf16_f32 v157, v214, v215
v_cvt_pk_bf16_f32 v158, v220, v221
v_cvt_pk_bf16_f32 v159, v222, v223
s_waitcnt lgkmcnt(2)
v_mfma_f32_32x32x16_bf16 v[208:223], a[8:11], v[144:147], v[176:191]
ds_read_b128 a[0:3], v225 offset:0
v_exp_f32 v192, v192
v_exp_f32 v193, v193
v_exp_f32 v194, v194
v_exp_f32 v195, v195
v_mfma_f32_32x32x16_bf16 v[208:223], a[12:15], v[148:151], v[208:223]
ds_read_b128 a[4:7], v225 offset:1024
v_exp_f32 v200, v200
v_exp_f32 v201, v201
v_exp_f32 v202, v202
v_exp_f32 v203, v203
v_mfma_f32_32x32x16_bf16 v[160:175], a[24:27], v[152:155], v[160:175]
ds_read_b128 a[40:43], v224 offset:30720
v_cvt_pk_bf16_f32 v152, v192, v193
v_cvt_pk_bf16_f32 v153, v194, v195
v_cvt_pk_bf16_f32 v154, v200, v201
v_cvt_pk_bf16_f32 v155, v202, v203
v_exp_f32 v196, v196
v_exp_f32 v197, v197
v_exp_f32 v198, v198
v_exp_f32 v199, v199
v_mfma_f32_32x32x16_bf16 v[160:175], a[28:31], v[156:159], v[160:175]
ds_read_b128 a[44:47], v224 offset:31744
v_exp_f32 v204, v204
v_exp_f32 v205, v205
v_exp_f32 v206, v206
v_exp_f32 v207, v207
v_cvt_pk_bf16_f32 v156, v196, v197
v_cvt_pk_bf16_f32 v157, v198, v199
v_cvt_pk_bf16_f32 v158, v204, v205
v_cvt_pk_bf16_f32 v159, v206, v207
s_waitcnt lgkmcnt(2)
v_mfma_f32_32x32x16_bf16 v[192:207], a[0:3], v[144:147], v[176:191]
ds_read_b128 a[8:11], v225 offset:4096
v_exp_f32 v208, v208
v_exp_f32 v209, v209
v_exp_f32 v210, v210
v_exp_f32 v211, v211
v_mfma_f32_32x32x16_bf16 v[192:207], a[4:7], v[148:151], v[192:207]
ds_read_b128 a[12:15], v225 offset:5120
v_exp_f32 v216, v216
v_exp_f32 v217, v217
v_exp_f32 v218, v218
v_exp_f32 v219, v219
v_mfma_f32_32x32x16_bf16 v[160:175], a[32:35], v[152:155], v[160:175]
ds_read_b128 a[16:19], v225 offset:2048
v_cvt_pk_bf16_f32 v152, v208, v209
v_cvt_pk_bf16_f32 v153, v210, v211
v_cvt_pk_bf16_f32 v154, v216, v217
v_cvt_pk_bf16_f32 v155, v218, v219
v_exp_f32 v212, v212
v_exp_f32 v213, v213
v_exp_f32 v214, v214
v_exp_f32 v215, v215
v_mfma_f32_32x32x16_bf16 v[160:175], a[36:39], v[156:159], v[160:175]
ds_read_b128 a[20:23], v225 offset:3072
v_exp_f32 v220, v220
v_exp_f32 v221, v221
v_exp_f32 v222, v222
v_exp_f32 v223, v223
v_cvt_pk_bf16_f32 v156, v212, v213
v_cvt_pk_bf16_f32 v157, v214, v215
v_cvt_pk_bf16_f32 v158, v220, v221
v_cvt_pk_bf16_f32 v159, v222, v223
v_add_u32 v224, 98304, v12
v_add_u32 v225, 0, v12
s_waitcnt lgkmcnt(2)
v_mfma_f32_32x32x16_bf16 v[208:223], a[8:11], v[144:147], v[176:191]
ds_read_b128 a[0:3], v224 offset:8192
v_exp_f32 v192, v192
v_exp_f32 v193, v193
v_exp_f32 v194, v194
v_exp_f32 v195, v195
v_mfma_f32_32x32x16_bf16 v[208:223], a[12:15], v[148:151], v[208:223]
ds_read_b128 a[4:7], v224 offset:9216
v_exp_f32 v200, v200
v_exp_f32 v201, v201
v_exp_f32 v202, v202
v_exp_f32 v203, v203
v_mfma_f32_32x32x16_bf16 v[160:175], a[40:43], v[152:155], v[160:175]
ds_read_b128 a[24:27], v224 offset:6144
v_cvt_pk_bf16_f32 v152, v192, v193
v_cvt_pk_bf16_f32 v153, v194, v195
v_cvt_pk_bf16_f32 v154, v200, v201
v_cvt_pk_bf16_f32 v155, v202, v203
v_exp_f32 v196, v196
v_exp_f32 v197, v197
v_exp_f32 v198, v198
v_exp_f32 v199, v199
v_mfma_f32_32x32x16_bf16 v[160:175], a[44:47], v[156:159], v[160:175]
ds_read_b128 a[28:31], v224 offset:7168
v_exp_f32 v204, v204
v_exp_f32 v205, v205
v_exp_f32 v206, v206
v_exp_f32 v207, v207
v_cvt_pk_bf16_f32 v156, v196, v197
v_cvt_pk_bf16_f32 v157, v198, v199
v_cvt_pk_bf16_f32 v158, v204, v205
v_cvt_pk_bf16_f32 v159, v206, v207
s_waitcnt lgkmcnt(2)
v_mfma_f32_32x32x16_bf16 v[192:207], a[0:3], v[144:147], v[176:191]
ds_read_b128 a[8:11], v224 offset:12288
v_exp_f32 v208, v208
v_exp_f32 v209, v209
v_exp_f32 v210, v210
v_exp_f32 v211, v211
v_mfma_f32_32x32x16_bf16 v[192:207], a[4:7], v[148:151], v[192:207]
ds_read_b128 a[12:15], v224 offset:13312
v_exp_f32 v216, v216
v_exp_f32 v217, v217
v_exp_f32 v218, v218
v_exp_f32 v219, v219
v_mfma_f32_32x32x16_bf16 v[160:175], a[16:19], v[152:155], v[160:175]
ds_read_b128 a[32:35], v224 offset:10240
v_cvt_pk_bf16_f32 v152, v208, v209
v_cvt_pk_bf16_f32 v153, v210, v211
v_cvt_pk_bf16_f32 v154, v216, v217
v_cvt_pk_bf16_f32 v155, v218, v219
v_exp_f32 v212, v212
v_exp_f32 v213, v213
v_exp_f32 v214, v214
v_exp_f32 v215, v215
v_mfma_f32_32x32x16_bf16 v[160:175], a[20:23], v[156:159], v[160:175]
ds_read_b128 a[36:39], v224 offset:11264
v_exp_f32 v220, v220
v_exp_f32 v221, v221
v_exp_f32 v222, v222
v_exp_f32 v223, v223
v_cvt_pk_bf16_f32 v156, v212, v213
v_cvt_pk_bf16_f32 v157, v214, v215
v_cvt_pk_bf16_f32 v158, v220, v221
v_cvt_pk_bf16_f32 v159, v222, v223
s_waitcnt vmcnt(0) lgkmcnt(2)
s_barrier
s_cmp_lg_u32 s48, 0
s_cbranch_scc1 LM_noflkv
v_mov_b32 v14, s89
v_mov_b32 v15, 0
s_mov_b64 exec, 1
buffer_store_dword v14, v15, s[20:23], s67 offen sc0 sc1
s_mov_b64 exec, -1
LM_noflkv:
v_mfma_f32_32x32x16_bf16 v[208:223], a[8:11], v[144:147], v[176:191]
ds_read_b128 a[0:3], v224 offset:16384
s_add_u32 m0, s51, 0
s_nop 0
buffer_load_dwordx4 v9, s[8:11], s40 offen lds
v_exp_f32 v192, v192
v_exp_f32 v193, v193
v_exp_f32 v194, v194
v_exp_f32 v195, v195
v_mfma_f32_32x32x16_bf16 v[208:223], a[12:15], v[148:151], v[208:223]
ds_read_b128 a[4:7], v224 offset:17408
s_add_u32 m0, s51, 4096
s_nop 0
buffer_load_dwordx4 v9, s[8:11], s41 offen lds
v_exp_f32 v200, v200
v_exp_f32 v201, v201
v_exp_f32 v202, v202
v_exp_f32 v203, v203
v_cmp_lt_f32 vcc, s18, v172
s_cmp_lg_u32 vcc_hi, 0
s_cbranch_scc1 LA_ren1A3
LA_ren1retA3:
v_mfma_f32_32x32x16_bf16 v[160:175], a[24:27], v[152:155], v[160:175]
ds_read_b128 a[40:43], v224 offset:14336
s_add_u32 m0, s51, 8192
s_nop 0
buffer_load_dwordx4 v9, s[8:11], s42 offen lds
v_cvt_pk_bf16_f32 v152, v192, v193
v_cvt_pk_bf16_f32 v153, v194, v195
v_cvt_pk_bf16_f32 v154, v200, v201
v_cvt_pk_bf16_f32 v155, v202, v203
v_exp_f32 v196, v196
v_exp_f32 v197, v197
v_exp_f32 v198, v198
v_exp_f32 v199, v199
v_mfma_f32_32x32x16_bf16 v[160:175], a[28:31], v[156:159], v[160:175]
ds_read_b128 a[44:47], v224 offset:15360
s_add_u32 m0, s51, 12288
s_nop 0
buffer_load_dwordx4 v9, s[8:11], s43 offen lds
v_add_u32 v9, 262144, v9
v_exp_f32 v204, v204
v_exp_f32 v205, v205
v_exp_f32 v206, v206
v_exp_f32 v207, v207
v_cvt_pk_bf16_f32 v156, v196, v197
v_cvt_pk_bf16_f32 v157, v198, v199
v_cvt_pk_bf16_f32 v158, v204, v205
v_cvt_pk_bf16_f32 v159, v206, v207
s_waitcnt lgkmcnt(2)
v_mfma_f32_32x32x16_bf16 v[192:207], a[0:3], v[144:147], v[176:191]
ds_read_b128 a[8:11], v224 offset:20480
s_add_u32 m0, s51, 131072
s_nop 0
buffer_load_dwordx4 v8, s[4:7], s24 offen lds
v_exp_f32 v208, v208
v_exp_f32 v209, v209
v_exp_f32 v210, v210
v_exp_f32 v211, v211
v_mfma_f32_32x32x16_bf16 v[192:207], a[4:7], v[148:151], v[192:207]
ds_read_b128 a[12:15], v224 offset:21504
s_add_u32 m0, s51, 135168
s_nop 0
buffer_load_dwordx4 v8, s[4:7], s25 offen lds
v_exp_f32 v216, v216
v_exp_f32 v217, v217
v_exp_f32 v218, v218
v_exp_f32 v219, v219
v_mfma_f32_32x32x16_bf16 v[160:175], a[32:35], v[152:155], v[160:175]
ds_read_b128 a[16:19], v224 offset:18432
s_add_u32 m0, s51, 139264
s_nop 0
buffer_load_dwordx4 v8, s[4:7], s26 offen lds
v_cvt_pk_bf16_f32 v152, v208, v209
v_cvt_pk_bf16_f32 v153, v210, v211
v_cvt_pk_bf16_f32 v154, v216, v217
v_cvt_pk_bf16_f32 v155, v218, v219
v_exp_f32 v212, v212
v_exp_f32 v213, v213
v_exp_f32 v214, v214
v_exp_f32 v215, v215
v_mfma_f32_32x32x16_bf16 v[160:175], a[36:39], v[156:159], v[160:175]
ds_read_b128 a[20:23], v224 offset:19456
s_add_u32 m0, s51, 143360
s_nop 0
buffer_load_dwordx4 v8, s[4:7], s27 offen lds
v_add_u32 v8, 128, v8
v_exp_f32 v220, v220
v_exp_f32 v221, v221
v_exp_f32 v222, v222
v_exp_f32 v223, v223
v_cvt_pk_bf16_f32 v156, v212, v213
v_cvt_pk_bf16_f32 v157, v214, v215
v_cvt_pk_bf16_f32 v158, v220, v221
v_cvt_pk_bf16_f32 v159, v222, v223
s_waitcnt lgkmcnt(2)
v_mfma_f32_32x32x16_bf16 v[208:223], a[8:11], v[144:147], v[176:191]
ds_read_b128 a[0:3], v224 offset:24576
s_add_u32 m0, s51, 16384
s_nop 0
buffer_load_dwordx4 v9, s[8:11], s40 offen lds
v_exp_f32 v192, v192
v_exp_f32 v193, v193
v_exp_f32 v194, v194
v_exp_f32 v195, v195
v_mfma_f32_32x32x16_bf16 v[208:223], a[12:15], v[148:151], v[208:223]
ds_read_b128 a[4:7], v224 offset:25600
s_add_u32 m0, s51, 20480
s_nop 0
buffer_load_dwordx4 v9, s[8:11], s41 offen lds
v_exp_f32 v200, v200
v_exp_f32 v201, v201
v_exp_f32 v202, v202
v_exp_f32 v203, v203
v_mfma_f32_32x32x16_bf16 v[160:175], a[40:43], v[152:155], v[160:175]
ds_read_b128 a[24:27], v224 offset:22528
s_add_u32 m0, s51, 24576
s_nop 0
buffer_load_dwordx4 v9, s[8:11], s42 offen lds
v_cvt_pk_bf16_f32 v152, v192, v193
v_cvt_pk_bf16_f32 v153, v194, v195
v_cvt_pk_bf16_f32 v154, v200, v201
v_cvt_pk_bf16_f32 v155, v202, v203
v_exp_f32 v196, v196
v_exp_f32 v197, v197
v_exp_f32 v198, v198
v_exp_f32 v199, v199
v_mfma_f32_32x32x16_bf16 v[160:175], a[44:47], v[156:159], v[160:175]
ds_read_b128 a[28:31], v224 offset:23552
s_add_u32 m0, s51, 28672
s_nop 0
buffer_load_dwordx4 v9, s[8:11], s43 offen lds
v_add_u32 v9, 262144, v9
v_exp_f32 v204, v204
v_exp_f32 v205, v205
v_exp_f32 v206, v206
v_exp_f32 v207, v207
v_cvt_pk_bf16_f32 v156, v196, v197
v_cvt_pk_bf16_f32 v157, v198, v199
v_cvt_pk_bf16_f32 v158, v204, v205
v_cvt_pk_bf16_f32 v159, v206, v207
s_waitcnt lgkmcnt(2)
v_mfma_f32_32x32x16_bf16 v[192:207], a[0:3], v[144:147], v[176:191]
ds_read_b128 a[8:11], v224 offset:28672
s_add_u32 m0, s51, 65536
s_nop 0
buffer_load_dwordx4 v8, s[4:7], s24 offen lds
v_exp_f32 v208, v208
v_exp_f32 v209, v209
v_exp_f32 v210, v210
v_exp_f32 v211, v211
v_mfma_f32_32x32x16_bf16 v[192:207], a[4:7], v[148:151], v[192:207]
ds_read_b128 a[12:15], v224 offset:29696
s_add_u32 m0, s51, 69632
s_nop 0
buffer_load_dwordx4 v8, s[4:7], s25 offen lds
v_exp_f32 v216, v216
v_exp_f32 v217, v217
v_exp_f32 v218, v218
v_exp_f32 v219, v219
s_cmp_lg_u32 s19, 0
s_cbranch_scc1 LA_ren2A3
LA_ren2retA3:
v_mfma_f32_32x32x16_bf16 v[160:175], a[16:19], v[152:155], v[160:175]
ds_read_b128 a[32:35], v224 offset:26624
s_add_u32 m0, s51, 73728
s_nop 0
buffer_load_dwordx4 v8, s[4:7], s26 offen lds
v_cvt_pk_bf16_f32 v152, v208, v209
v_cvt_pk_bf16_f32 v153, v210, v211
v_cvt_pk_bf16_f32 v154, v216, v217
v_cvt_pk_bf16_f32 v155, v218, v219
v_exp_f32 v212, v212
v_exp_f32 v213, v213
v_exp_f32 v214, v214
v_exp_f32 v215, v215
v_mfma_f32_32x32x16_bf16 v[160:175], a[20:23], v[156:159], v[160:175]
ds_read_b128 a[36:39], v224 offset:27648
s_add_u32 m0, s51, 77824
s_nop 0
buffer_load_dwordx4 v8, s[4:7], s27 offen lds
v_add_u32 v8, 128, v8
v_exp_f32 v220, v220
v_exp_f32 v221, v221
v_exp_f32 v222, v222
v_exp_f32 v223, v223
v_cvt_pk_bf16_f32 v156, v212, v213
v_cvt_pk_bf16_f32 v157, v214, v215
v_cvt_pk_bf16_f32 v158, v220, v221
v_cvt_pk_bf16_f32 v159, v222, v223
s_waitcnt lgkmcnt(2)
v_mfma_f32_32x32x16_bf16 v[208:223], a[8:11], v[144:147], v[176:191]
s_add_u32 m0, s51, 32768
s_nop 0
buffer_load_dwordx4 v9, s[8:11], s40 offen lds
v_exp_f32 v192, v192
v_exp_f32 v193, v193
v_exp_f32 v194, v194
v_exp_f32 v195, v195
v_mfma_f32_32x32x16_bf16 v[208:223], a[12:15], v[148:151], v[208:223]
s_add_u32 m0, s51, 36864
s_nop 0
buffer_load_dwordx4 v9, s[8:11], s41 offen lds
v_exp_f32 v200, v200
v_exp_f32 v201, v201
v_exp_f32 v202, v202
v_exp_f32 v203, v203
v_mfma_f32_32x32x16_bf16 v[160:175], a[24:27], v[152:155], v[160:175]
ds_read_b128 a[40:43], v224 offset:30720
s_add_u32 m0, s51, 40960
s_nop 0
buffer_load_dwordx4 v9, s[8:11], s42 offen lds
v_cvt_pk_bf16_f32 v152, v192, v193
v_cvt_pk_bf16_f32 v153, v194, v195
v_cvt_pk_bf16_f32 v154, v200, v201
v_cvt_pk_bf16_f32 v155, v202, v203
v_exp_f32 v196, v196
v_exp_f32 v197, v197
v_exp_f32 v198, v198
v_exp_f32 v199, v199
v_mfma_f32_32x32x16_bf16 v[160:175], a[28:31], v[156:159], v[160:175]
ds_read_b128 a[44:47], v224 offset:31744
s_add_u32 m0, s51, 45056
s_nop 0
buffer_load_dwordx4 v9, s[8:11], s43 offen lds
v_add_u32 v9, 262144, v9
v_exp_f32 v204, v204
v_exp_f32 v205, v205
v_exp_f32 v206, v206
v_exp_f32 v207, v207
v_cvt_pk_bf16_f32 v156, v196, v197
v_cvt_pk_bf16_f32 v157, v198, v199
v_cvt_pk_bf16_f32 v158, v204, v205
v_cvt_pk_bf16_f32 v159, v206, v207
s_waitcnt lgkmcnt(0)
s_add_u32 m0, s51, 49152
s_nop 0
buffer_load_dwordx4 v9, s[8:11], s40 offen lds
v_exp_f32 v208, v208
v_exp_f32 v209, v209
v_exp_f32 v210, v210
v_exp_f32 v211, v211
s_add_u32 m0, s51, 53248
s_nop 0
buffer_load_dwordx4 v9, s[8:11], s41 offen lds
v_exp_f32 v216, v216
v_exp_f32 v217, v217
v_exp_f32 v218, v218
v_exp_f32 v219, v219
v_mfma_f32_32x32x16_bf16 v[160:175], a[32:35], v[152:155], v[160:175]
s_add_u32 m0, s51, 57344
s_nop 0
buffer_load_dwordx4 v9, s[8:11], s42 offen lds
v_cvt_pk_bf16_f32 v152, v208, v209
v_cvt_pk_bf16_f32 v153, v210, v211
v_cvt_pk_bf16_f32 v154, v216, v217
v_cvt_pk_bf16_f32 v155, v218, v219
v_exp_f32 v212, v212
v_exp_f32 v213, v213
v_exp_f32 v214, v214
v_exp_f32 v215, v215
v_mfma_f32_32x32x16_bf16 v[160:175], a[36:39], v[156:159], v[160:175]
s_add_u32 m0, s51, 61440
s_nop 0
buffer_load_dwordx4 v9, s[8:11], s43 offen lds
v_add_u32 v9, 262144, v9
v_exp_f32 v220, v220
v_exp_f32 v221, v221
v_exp_f32 v222, v222
v_exp_f32 v223, v223
v_cvt_pk_bf16_f32 v156, v212, v213
v_cvt_pk_bf16_f32 v157, v214, v215
v_cvt_pk_bf16_f32 v158, v220, v221
v_cvt_pk_bf16_f32 v159, v222, v223
s_nop 1
v_mfma_f32_32x32x16_bf16 v[160:175], a[40:43], v[152:155], v[160:175]
v_mfma_f32_32x32x16_bf16 v[160:175], a[44:47], v[156:159], v[160:175]
v_accvgpr_write_b32 a80, v176
v_accvgpr_write_b32 a81, v144
v_accvgpr_write_b32 a82, v145
v_accvgpr_write_b32 a83, v146
v_accvgpr_write_b32 a84, v147
v_accvgpr_write_b32 a85, v148
v_accvgpr_write_b32 a86, v149
v_accvgpr_write_b32 a87, v150
v_accvgpr_write_b32 a88, v151
s_nop 2
v_accvgpr_write_b32 a64, v160
v_accvgpr_write_b32 a65, v161
v_accvgpr_write_b32 a66, v162
v_accvgpr_write_b32 a67, v163
v_accvgpr_write_b32 a68, v164
v_accvgpr_write_b32 a69, v165
v_accvgpr_write_b32 a70, v166
v_accvgpr_write_b32 a71, v167
v_accvgpr_write_b32 a72, v168
v_accvgpr_write_b32 a73, v169
v_accvgpr_write_b32 a74, v170
v_accvgpr_write_b32 a75, v171
v_accvgpr_write_b32 a76, v172
v_accvgpr_write_b32 a77, v173
v_accvgpr_write_b32 a78, v174
v_accvgpr_write_b32 a79, v175
s_add_u32 s50, s51, 98304
s_waitcnt vmcnt(16)
s_barrier
ds_read_b64_tr_b16 a[224:225], v4 offset:0
ds_read_b64_tr_b16 a[226:227], v4 offset:512
ds_read_b64_tr_b16 a[228:229], v5 offset:0
ds_read_b64_tr_b16 a[230:231], v5 offset:512
ds_read_b64_tr_b16 a[232:233], v6 offset:0
ds_read_b64_tr_b16 a[234:235], v6 offset:512
ds_read_b64_tr_b16 a[236:237], v7 offset:0
ds_read_b64_tr_b16 a[238:239], v7 offset:512
ds_read_b64_tr_b16 a[240:241], v4 offset:4096
ds_read_b64_tr_b16 a[242:243], v4 offset:4608
ds_read_b64_tr_b16 a[244:245], v5 offset:4096
ds_read_b64_tr_b16 a[246:247], v5 offset:4608
ds_read_b64_tr_b16 a[248:249], v6 offset:4096
ds_read_b64_tr_b16 a[250:251], v6 offset:4608
ds_read_b64_tr_b16 a[252:253], v7 offset:4096
ds_read_b64_tr_b16 a[254:255], v7 offset:4608
ds_read_b128 a[208:211], v2 offset:0
ds_read_b128 a[212:215], v2 offset:2048
ds_read_b128 a[216:219], v2 offset:4096
ds_read_b128 a[220:223], v2 offset:6144
s_and_b32 s90, s2, 7
s_lshr_b32 s91, s2, 3
s_and_b32 s92, s91, 1
s_lshl_b32 s92, s92, 3
s_add_u32 s60, s90, s92
s_lshr_b32 s91, s91, 1
s_lshr_b32 s80, s91, 3
s_and_b32 s91, s91, 7
s_add_u32 s61, s91, 8
s_sub_u32 s85, 15, s61
s_lshl_b32 s92, s60, 3
s_add_u32 s92, s92, s91
s_lshl_b32 s84, s92, 7
s_add_u32 s84, s84, 109051904
s_lshl_b32 s83, s92, 2
s_add_u32 s83, s83, s48
s_lshl_b32 s83, s83, 15
s_add_u32 s83, s83, 75497472
s_lshl_b32 s74, s48, 12
s_lshl_b32 s75, s60, 21
s_add_u32 s75, s75, s74
s_add_u32 s93, s61, 1
s_lshl_b32 s93, s93, 2
s_min_u32 s94, s93, 39
s_sub_u32 s95, 68, s94
s_cmp_eq_u32 s80, 0
s_cselect_b32 s62, 0, s94
s_cselect_b32 s63, s94, s93
s_cselect_b32 s87, s94, s95
s_mov_b32 s88, 0
s_sub_u32 s72, s63, s62
s_add_u32 s18, s72, 3
s_add_u32 s19, s84, 16384
s_cmp_eq_u32 s80, 0
s_cselect_b32 s18, 2, s18
s_cselect_b32 s19, s19, s84
s_cselect_b32 s45, 11, 5
s_cmp_lg_u32 s94, s93
s_cbranch_scc1 L2_split
s_cmp_eq_u32 s80, 0
s_cselect_b32 s61, s61, s85
s_mov_b32 s80, 4
s_mov_b32 s62, 0
s_mov_b32 s63, s87
s_mov_b32 s72, s87
L2_split:
s_lshl_b32 s66, s62, 15
s_add_u32 s66, s66, s75
s_mov_b32 s71, 0
s_mov_b32 s81, 1233125376
s_add_u32 s86, s74, 163840
s_mov_b32 s12, s20
s_mov_b32 s13, s21
s_mov_b32 s14, 33554432
s_mov_b32 s15, 0x20000
s_mov_b32 s98, s19
v_add_u32 v13, 16384, v12
s_add_u32 s97, s84, 16384
v_mov_b32 v17, 0
s_lshl_b32 s96, s100, 20
s_lshl_b32 s53, s101, 16
s_add_u32 s96, s96, s53
s_lshl_b32 s53, s48, 14
s_add_u32 s96, s96, s53
s_add_u32 s96, s96, 33554432
v_mbcnt_lo_u32_b32 v15, -1, 0
v_and_b32 v14, 6, v15
v_and_b32 v15, 1, v15
v_lshl_add_u32 v15, v14, 1, v15
v_lshlrev_b32 v15, 2, v15
s_cmp_ge_u32 s2, 128
s_cbranch_scc1 LM_qb
LM_qa:
s_waitcnt vmcnt(12) lgkmcnt(0)
s_barrier
v_mfma_f32_16x16x32_bf16 v[128:131], a[224:227], a[208:211], 0
v_mfma_f32_16x16x32_bf16 v[132:135], a[228:231], a[208:211], 0
ds_read_b64_tr_b16 a[176:177], v4 offset:16384
ds_read_b64_tr_b16 a[178:179], v4 offset:16896
s_add_u32 m0, s51, 0
v_mfma_f32_16x16x32_bf16 v[136:139], a[232:235], a[208:211], 0
buffer_load_dwordx4 v9, s[8:11], s40 offen lds
v_mfma_f32_16x16x32_bf16 v[140:143], a[236:239], a[208:211], 0
ds_read_b64_tr_b16 a[180:181], v5 offset:16384
v_mfma_f32_16x16x32_bf16 v[144:147], a[240:243], a[208:211], 0
ds_read_b64_tr_b16 a[182:183], v5 offset:16896
s_add_u32 m0, s51, 4096
v_mfma_f32_16x16x32_bf16 v[148:151], a[244:247], a[208:211], 0
buffer_load_dwordx4 v9, s[8:11], s41 offen lds
v_mfma_f32_16x16x32_bf16 v[152:155], a[248:251], a[208:211], 0
ds_read_b64_tr_b16 a[184:185], v6 offset:16384
v_mfma_f32_16x16x32_bf16 v[156:159], a[252:255], a[208:211], 0
ds_read_b64_tr_b16 a[186:187], v6 offset:16896
v_mfma_f32_16x16x32_bf16 v[160:163], a[224:227], a[212:215], 0
ds_read_b64_tr_b16 a[188:189], v7 offset:16384
s_add_u32 m0, s51, 8192
v_mfma_f32_16x16x32_bf16 v[164:167], a[228:231], a[212:215], 0
buffer_load_dwordx4 v9, s[8:11], s42 offen lds
ds_read_b64_tr_b16 a[190:191], v7 offset:16896
v_mfma_f32_16x16x32_bf16 v[168:171], a[232:235], a[212:215], 0
ds_read_b64_tr_b16 a[192:193], v4 offset:20480
s_add_u32 m0, s51, 12288
v_mfma_f32_16x16x32_bf16 v[172:175], a[236:239], a[212:215], 0
buffer_load_dwordx4 v9, s[8:11], s43 offen lds
v_mfma_f32_16x16x32_bf16 v[176:179], a[240:243], a[212:215], 0
ds_read_b64_tr_b16 a[194:195], v4 offset:20992
v_add_u32 v9, 262144, v9
v_mfma_f32_16x16x32_bf16 v[180:183], a[244:247], a[212:215], 0
ds_read_b64_tr_b16 a[196:197], v5 offset:20480
v_mfma_f32_16x16x32_bf16 v[184:187], a[248:251], a[212:215], 0
ds_read_b64_tr_b16 a[198:199], v5 offset:20992
s_add_u32 m0, s50, 0
v_mfma_f32_16x16x32_bf16 v[188:191], a[252:255], a[212:215], 0
buffer_load_dwordx4 v8, s[4:7], s24 offen lds
v_mfma_f32_16x16x32_bf16 v[192:195], a[224:227], a[216:219], 0
ds_read_b64_tr_b16 a[200:201], v6 offset:20480
v_mfma_f32_16x16x32_bf16 v[196:199], a[228:231], a[216:219], 0
ds_read_b64_tr_b16 a[202:203], v6 offset:20992
s_add_u32 m0, s50, 4096
s_nop 0
buffer_load_dwordx4 v8, s[4:7], s25 offen lds
v_mfma_f32_16x16x32_bf16 v[200:203], a[232:235], a[216:219], 0
ds_read_b64_tr_b16 a[204:205], v7 offset:20480
v_mfma_f32_16x16x32_bf16 v[204:207], a[236:239], a[216:219], 0
ds_read_b64_tr_b16 a[206:207], v7 offset:20992
v_mfma_f32_16x16x32_bf16 v[208:211], a[240:243], a[216:219], 0
ds_read_b128 a[160:163], v3 offset:0
s_add_u32 m0, s50, 8192
v_mfma_f32_16x16x32_bf16 v[212:215], a[244:247], a[216:219], 0
buffer_load_dwordx4 v8, s[4:7], s26 offen lds
v_mfma_f32_16x16x32_bf16 v[216:219], a[248:251], a[216:219], 0
ds_read_b128 a[164:167], v3 offset:2048
v_mfma_f32_16x16x32_bf16 v[220:223], a[252:255], a[216:219], 0
ds_read_b128 a[168:171], v3 offset:4096
s_add_u32 m0, s50, 12288
v_mfma_f32_16x16x32_bf16 v[224:227], a[224:227], a[220:223], 0
buffer_load_dwordx4 v8, s[4:7], s27 offen lds
v_mfma_f32_16x16x32_bf16 v[228:231], a[228:231], a[220:223], 0
ds_read_b128 a[172:175], v3 offset:6144
v_add_u32 v8, 128, v8
v_mfma_f32_16x16x32_bf16 v[232:235], a[232:235], a[220:223], 0
v_mfma_f32_16x16x32_bf16 v[236:239], a[236:239], a[220:223], 0
v_mfma_f32_16x16x32_bf16 v[240:243], a[240:243], a[220:223], 0
v_mfma_f32_16x16x32_bf16 v[244:247], a[244:247], a[220:223], 0
v_mfma_f32_16x16x32_bf16 v[248:251], a[248:251], a[220:223], 0
v_mfma_f32_16x16x32_bf16 v[252:255], a[252:255], a[220:223], 0
s_waitcnt vmcnt(12) lgkmcnt(0)
s_barrier
v_mfma_f32_16x16x32_bf16 v[128:131], a[176:179], a[160:163], v[128:131]
s_add_u32 s50, s49, s51
s_add_u32 s49, s49, 32768
s_cmp_eq_u32 s49, 163840
v_mfma_f32_16x16x32_bf16 v[132:135], a[180:183], a[160:163], v[132:135]
s_cselect_b32 s49, 65536, s49
v_add_u32 v2, s49, v1
v_xor_b32 v3, 64, v2
v_mfma_f32_16x16x32_bf16 v[136:139], a[184:187], a[160:163], v[136:139]
ds_read_b64_tr_b16 a[224:225], v4 offset:32768
v_mfma_f32_16x16x32_bf16 v[140:143], a[188:191], a[160:163], v[140:143]
ds_read_b64_tr_b16 a[226:227], v4 offset:33280
v_mfma_f32_16x16x32_bf16 v[144:147], a[192:195], a[160:163], v[144:147]
ds_read_b64_tr_b16 a[228:229], v5 offset:32768
v_mfma_f32_16x16x32_bf16 v[148:151], a[196:199], a[160:163], v[148:151]
ds_read_b64_tr_b16 a[230:231], v5 offset:33280
s_add_u32 m0, s51, 16384
v_mfma_f32_16x16x32_bf16 v[152:155], a[200:203], a[160:163], v[152:155]
buffer_load_dwordx4 v9, s[8:11], s40 offen lds
v_mfma_f32_16x16x32_bf16 v[156:159], a[204:207], a[160:163], v[156:159]
ds_read_b64_tr_b16 a[232:233], v6 offset:32768
v_mfma_f32_16x16x32_bf16 v[160:163], a[176:179], a[164:167], v[160:163]
ds_read_b64_tr_b16 a[234:235], v6 offset:33280
v_mfma_f32_16x16x32_bf16 v[164:167], a[180:183], a[164:167], v[164:167]
ds_read_b64_tr_b16 a[236:237], v7 offset:32768
v_mfma_f32_16x16x32_bf16 v[168:171], a[184:187], a[164:167], v[168:171]
ds_read_b64_tr_b16 a[238:239], v7 offset:33280
v_mfma_f32_16x16x32_bf16 v[172:175], a[188:191], a[164:167], v[172:175]
ds_read_b64_tr_b16 a[240:241], v4 offset:36864
s_add_u32 m0, s51, 20480
v_mfma_f32_16x16x32_bf16 v[176:179], a[192:195], a[164:167], v[176:179]
buffer_load_dwordx4 v9, s[8:11], s41 offen lds
v_mfma_f32_16x16x32_bf16 v[180:183], a[196:199], a[164:167], v[180:183]
ds_read_b64_tr_b16 a[242:243], v4 offset:37376
v_mfma_f32_16x16x32_bf16 v[184:187], a[200:203], a[164:167], v[184:187]
ds_read_b64_tr_b16 a[244:245], v5 offset:36864
v_mfma_f32_16x16x32_bf16 v[188:191], a[204:207], a[164:167], v[188:191]
ds_read_b64_tr_b16 a[246:247], v5 offset:37376
v_mfma_f32_16x16x32_bf16 v[192:195], a[176:179], a[168:171], v[192:195]
ds_read_b64_tr_b16 a[248:249], v6 offset:36864
v_mfma_f32_16x16x32_bf16 v[196:199], a[180:183], a[168:171], v[196:199]
ds_read_b64_tr_b16 a[250:251], v6 offset:37376
s_add_u32 m0, s51, 24576
v_mfma_f32_16x16x32_bf16 v[200:203], a[184:187], a[168:171], v[200:203]
buffer_load_dwordx4 v9, s[8:11], s42 offen lds
v_mfma_f32_16x16x32_bf16 v[204:207], a[188:191], a[168:171], v[204:207]
ds_read_b64_tr_b16 a[252:253], v7 offset:36864
v_mfma_f32_16x16x32_bf16 v[208:211], a[192:195], a[168:171], v[208:211]
ds_read_b64_tr_b16 a[254:255], v7 offset:37376
v_mfma_f32_16x16x32_bf16 v[212:215], a[196:199], a[168:171], v[212:215]
ds_read_b128 a[208:211], v2 offset:0
v_mfma_f32_16x16x32_bf16 v[216:219], a[200:203], a[168:171], v[216:219]
ds_read_b128 a[212:215], v2 offset:2048
v_mfma_f32_16x16x32_bf16 v[220:223], a[204:207], a[168:171], v[220:223]
ds_read_b128 a[216:219], v2 offset:4096
s_add_u32 m0, s51, 28672
v_mfma_f32_16x16x32_bf16 v[224:227], a[176:179], a[172:175], v[224:227]
buffer_load_dwordx4 v9, s[8:11], s43 offen lds
v_mfma_f32_16x16x32_bf16 v[228:231], a[180:183], a[172:175], v[228:231]
ds_read_b128 a[220:223], v2 offset:6144
v_add_u32 v9, 262144, v9
v_mfma_f32_16x16x32_bf16 v[232:235], a[184:187], a[172:175], v[232:235]
v_mfma_f32_16x16x32_bf16 v[236:239], a[188:191], a[172:175], v[236:239]
v_mfma_f32_16x16x32_bf16 v[240:243], a[192:195], a[172:175], v[240:243]
v_mfma_f32_16x16x32_bf16 v[244:247], a[196:199], a[172:175], v[244:247]
v_mfma_f32_16x16x32_bf16 v[248:251], a[200:203], a[172:175], v[248:251]
v_mfma_f32_16x16x32_bf16 v[252:255], a[204:207], a[172:175], v[252:255]
s_waitcnt vmcnt(12) lgkmcnt(0)
s_barrier
v_mfma_f32_16x16x32_bf16 v[128:131], a[224:227], a[208:211], v[128:131]
v_mfma_f32_16x16x32_bf16 v[132:135], a[228:231], a[208:211], v[132:135]
ds_read_b64_tr_b16 a[176:177], v4 offset:49152
ds_read_b64_tr_b16 a[178:179], v4 offset:49664
s_add_u32 m0, s51, 32768
v_mfma_f32_16x16x32_bf16 v[136:139], a[232:235], a[208:211], v[136:139]
buffer_load_dwordx4 v9, s[8:11], s40 offen lds
v_mfma_f32_16x16x32_bf16 v[140:143], a[236:239], a[208:211], v[140:143]
ds_read_b64_tr_b16 a[180:181], v5 offset:49152
v_mfma_f32_16x16x32_bf16 v[144:147], a[240:243], a[208:211], v[144:147]
ds_read_b64_tr_b16 a[182:183], v5 offset:49664
s_add_u32 m0, s51, 36864
v_mfma_f32_16x16x32_bf16 v[148:151], a[244:247], a[208:211], v[148:151]
buffer_load_dwordx4 v9, s[8:11], s41 offen lds
v_mfma_f32_16x16x32_bf16 v[152:155], a[248:251], a[208:211], v[152:155]
ds_read_b64_tr_b16 a[184:185], v6 offset:49152
v_mfma_f32_16x16x32_bf16 v[156:159], a[252:255], a[208:211], v[156:159]
ds_read_b64_tr_b16 a[186:187], v6 offset:49664
v_mfma_f32_16x16x32_bf16 v[160:163], a[224:227], a[212:215], v[160:163]
ds_read_b64_tr_b16 a[188:189], v7 offset:49152
s_add_u32 m0, s51, 40960
v_mfma_f32_16x16x32_bf16 v[164:167], a[228:231], a[212:215], v[164:167]
buffer_load_dwordx4 v9, s[8:11], s42 offen lds
ds_read_b64_tr_b16 a[190:191], v7 offset:49664
v_mfma_f32_16x16x32_bf16 v[168:171], a[232:235], a[212:215], v[168:171]
ds_read_b64_tr_b16 a[192:193], v4 offset:53248
s_add_u32 m0, s51, 45056
v_mfma_f32_16x16x32_bf16 v[172:175], a[236:239], a[212:215], v[172:175]
buffer_load_dwordx4 v9, s[8:11], s43 offen lds
v_mfma_f32_16x16x32_bf16 v[176:179], a[240:243], a[212:215], v[176:179]
ds_read_b64_tr_b16 a[194:195], v4 offset:53760
v_add_u32 v9, 262144, v9
v_mfma_f32_16x16x32_bf16 v[180:183], a[244:247], a[212:215], v[180:183]
ds_read_b64_tr_b16 a[196:197], v5 offset:53248
v_mfma_f32_16x16x32_bf16 v[184:187], a[248:251], a[212:215], v[184:187]
ds_read_b64_tr_b16 a[198:199], v5 offset:53760
s_add_u32 m0, s50, 0
v_mfma_f32_16x16x32_bf16 v[188:191], a[252:255], a[212:215], v[188:191]
buffer_load_dwordx4 v8, s[4:7], s24 offen lds
v_mfma_f32_16x16x32_bf16 v[192:195], a[224:227], a[216:219], v[192:195]
ds_read_b64_tr_b16 a[200:201], v6 offset:53248
v_mfma_f32_16x16x32_bf16 v[196:199], a[228:231], a[216:219], v[196:199]
ds_read_b64_tr_b16 a[202:203], v6 offset:53760
s_add_u32 m0, s50, 4096
s_nop 0
buffer_load_dwordx4 v8, s[4:7], s25 offen lds
v_mfma_f32_16x16x32_bf16 v[200:203], a[232:235], a[216:219], v[200:203]
ds_read_b64_tr_b16 a[204:205], v7 offset:53248
v_mfma_f32_16x16x32_bf16 v[204:207], a[236:239], a[216:219], v[204:207]
ds_read_b64_tr_b16 a[206:207], v7 offset:53760
v_mfma_f32_16x16x32_bf16 v[208:211], a[240:243], a[216:219], v[208:211]
ds_read_b128 a[160:163], v3 offset:0
s_add_u32 m0, s50, 8192
v_mfma_f32_16x16x32_bf16 v[212:215], a[244:247], a[216:219], v[212:215]
buffer_load_dwordx4 v8, s[4:7], s26 offen lds
v_mfma_f32_16x16x32_bf16 v[216:219], a[248:251], a[216:219], v[216:219]
ds_read_b128 a[164:167], v3 offset:2048
v_mfma_f32_16x16x32_bf16 v[220:223], a[252:255], a[216:219], v[220:223]
ds_read_b128 a[168:171], v3 offset:4096
s_add_u32 m0, s50, 12288
v_mfma_f32_16x16x32_bf16 v[224:227], a[224:227], a[220:223], v[224:227]
buffer_load_dwordx4 v8, s[4:7], s27 offen lds
v_mfma_f32_16x16x32_bf16 v[228:231], a[228:231], a[220:223], v[228:231]
ds_read_b128 a[172:175], v3 offset:6144
v_add_u32 v8, 128, v8
v_mfma_f32_16x16x32_bf16 v[232:235], a[232:235], a[220:223], v[232:235]
v_mfma_f32_16x16x32_bf16 v[236:239], a[236:239], a[220:223], v[236:239]
v_mfma_f32_16x16x32_bf16 v[240:243], a[240:243], a[220:223], v[240:243]
v_mfma_f32_16x16x32_bf16 v[244:247], a[244:247], a[220:223], v[244:247]
v_mfma_f32_16x16x32_bf16 v[248:251], a[248:251], a[220:223], v[248:251]
v_mfma_f32_16x16x32_bf16 v[252:255], a[252:255], a[220:223], v[252:255]
s_waitcnt vmcnt(12) lgkmcnt(0)
s_barrier
v_mfma_f32_16x16x32_bf16 v[128:131], a[176:179], a[160:163], v[128:131]
s_add_u32 s50, s49, s51
s_add_u32 s49, s49, 32768
s_cmp_eq_u32 s49, 163840
v_mfma_f32_16x16x32_bf16 v[132:135], a[180:183], a[160:163], v[132:135]
s_cselect_b32 s49, 65536, s49
v_add_u32 v2, s49, v1
v_xor_b32 v3, 64, v2
v_mfma_f32_16x16x32_bf16 v[136:139], a[184:187], a[160:163], v[136:139]
ds_read_b64_tr_b16 a[224:225], v4 offset:0
v_mfma_f32_16x16x32_bf16 v[140:143], a[188:191], a[160:163], v[140:143]
ds_read_b64_tr_b16 a[226:227], v4 offset:512
v_mfma_f32_16x16x32_bf16 v[144:147], a[192:195], a[160:163], v[144:147]
ds_read_b64_tr_b16 a[228:229], v5 offset:0
v_mfma_f32_16x16x32_bf16 v[148:151], a[196:199], a[160:163], v[148:151]
ds_read_b64_tr_b16 a[230:231], v5 offset:512
s_add_u32 m0, s51, 49152
v_mfma_f32_16x16x32_bf16 v[152:155], a[200:203], a[160:163], v[152:155]
buffer_load_dwordx4 v9, s[8:11], s40 offen lds
v_mfma_f32_16x16x32_bf16 v[156:159], a[204:207], a[160:163], v[156:159]
ds_read_b64_tr_b16 a[232:233], v6 offset:0
v_mfma_f32_16x16x32_bf16 v[160:163], a[176:179], a[164:167], v[160:163]
ds_read_b64_tr_b16 a[234:235], v6 offset:512
v_mfma_f32_16x16x32_bf16 v[164:167], a[180:183], a[164:167], v[164:167]
ds_read_b64_tr_b16 a[236:237], v7 offset:0
v_mfma_f32_16x16x32_bf16 v[168:171], a[184:187], a[164:167], v[168:171]
ds_read_b64_tr_b16 a[238:239], v7 offset:512
v_mfma_f32_16x16x32_bf16 v[172:175], a[188:191], a[164:167], v[172:175]
ds_read_b64_tr_b16 a[240:241], v4 offset:4096
s_add_u32 m0, s51, 53248
v_mfma_f32_16x16x32_bf16 v[176:179], a[192:195], a[164:167], v[176:179]
buffer_load_dwordx4 v9, s[8:11], s41 offen lds
v_mfma_f32_16x16x32_bf16 v[180:183], a[196:199], a[164:167], v[180:183]
ds_read_b64_tr_b16 a[242:243], v4 offset:4608
v_mfma_f32_16x16x32_bf16 v[184:187], a[200:203], a[164:167], v[184:187]
ds_read_b64_tr_b16 a[244:245], v5 offset:4096
v_mfma_f32_16x16x32_bf16 v[188:191], a[204:207], a[164:167], v[188:191]
ds_read_b64_tr_b16 a[246:247], v5 offset:4608
v_mfma_f32_16x16x32_bf16 v[192:195], a[176:179], a[168:171], v[192:195]
ds_read_b64_tr_b16 a[248:249], v6 offset:4096
v_mfma_f32_16x16x32_bf16 v[196:199], a[180:183], a[168:171], v[196:199]
ds_read_b64_tr_b16 a[250:251], v6 offset:4608
s_add_u32 m0, s51, 57344
v_mfma_f32_16x16x32_bf16 v[200:203], a[184:187], a[168:171], v[200:203]
buffer_load_dwordx4 v9, s[8:11], s42 offen lds
v_mfma_f32_16x16x32_bf16 v[204:207], a[188:191], a[168:171], v[204:207]
ds_read_b64_tr_b16 a[252:253], v7 offset:4096
v_mfma_f32_16x16x32_bf16 v[208:211], a[192:195], a[168:171], v[208:211]
ds_read_b64_tr_b16 a[254:255], v7 offset:4608
v_mfma_f32_16x16x32_bf16 v[212:215], a[196:199], a[168:171], v[212:215]
ds_read_b128 a[208:211], v2 offset:0
v_mfma_f32_16x16x32_bf16 v[216:219], a[200:203], a[168:171], v[216:219]
ds_read_b128 a[212:215], v2 offset:2048
v_mfma_f32_16x16x32_bf16 v[220:223], a[204:207], a[168:171], v[220:223]
ds_read_b128 a[216:219], v2 offset:4096
s_add_u32 m0, s51, 61440
v_mfma_f32_16x16x32_bf16 v[224:227], a[176:179], a[172:175], v[224:227]
buffer_load_dwordx4 v9, s[8:11], s43 offen lds
v_mfma_f32_16x16x32_bf16 v[228:231], a[180:183], a[172:175], v[228:231]
ds_read_b128 a[220:223], v2 offset:6144
v_add_u32 v9, 262144, v9
v_mfma_f32_16x16x32_bf16 v[232:235], a[184:187], a[172:175], v[232:235]
v_mfma_f32_16x16x32_bf16 v[236:239], a[188:191], a[172:175], v[236:239]
v_mfma_f32_16x16x32_bf16 v[240:243], a[192:195], a[172:175], v[240:243]
v_mfma_f32_16x16x32_bf16 v[244:247], a[196:199], a[172:175], v[244:247]
v_mfma_f32_16x16x32_bf16 v[248:251], a[200:203], a[172:175], v[248:251]
v_mfma_f32_16x16x32_bf16 v[252:255], a[204:207], a[172:175], v[252:255]
s_waitcnt vmcnt(12) lgkmcnt(0)
s_barrier
v_mfma_f32_16x16x32_bf16 v[128:131], a[224:227], a[208:211], v[128:131]
v_mfma_f32_16x16x32_bf16 v[132:135], a[228:231], a[208:211], v[132:135]
ds_read_b64_tr_b16 a[176:177], v4 offset:16384
ds_read_b64_tr_b16 a[178:179], v4 offset:16896
s_add_u32 m0, s51, 0
v_mfma_f32_16x16x32_bf16 v[136:139], a[232:235], a[208:211], v[136:139]
buffer_load_dwordx4 v9, s[8:11], s40 offen lds
v_mfma_f32_16x16x32_bf16 v[140:143], a[236:239], a[208:211], v[140:143]
ds_read_b64_tr_b16 a[180:181], v5 offset:16384
v_mfma_f32_16x16x32_bf16 v[144:147], a[240:243], a[208:211], v[144:147]
ds_read_b64_tr_b16 a[182:183], v5 offset:16896
s_add_u32 m0, s51, 4096
v_mfma_f32_16x16x32_bf16 v[148:151], a[244:247], a[208:211], v[148:151]
buffer_load_dwordx4 v9, s[8:11], s41 offen lds
v_mfma_f32_16x16x32_bf16 v[152:155], a[248:251], a[208:211], v[152:155]
ds_read_b64_tr_b16 a[184:185], v6 offset:16384
v_mfma_f32_16x16x32_bf16 v[156:159], a[252:255], a[208:211], v[156:159]
ds_read_b64_tr_b16 a[186:187], v6 offset:16896
v_mfma_f32_16x16x32_bf16 v[160:163], a[224:227], a[212:215], v[160:163]
ds_read_b64_tr_b16 a[188:189], v7 offset:16384
s_add_u32 m0, s51, 8192
v_mfma_f32_16x16x32_bf16 v[164:167], a[228:231], a[212:215], v[164:167]
buffer_load_dwordx4 v9, s[8:11], s42 offen lds
ds_read_b64_tr_b16 a[190:191], v7 offset:16896
v_mfma_f32_16x16x32_bf16 v[168:171], a[232:235], a[212:215], v[168:171]
ds_read_b64_tr_b16 a[192:193], v4 offset:20480
s_add_u32 m0, s51, 12288
v_mfma_f32_16x16x32_bf16 v[172:175], a[236:239], a[212:215], v[172:175]
buffer_load_dwordx4 v9, s[8:11], s43 offen lds
v_mfma_f32_16x16x32_bf16 v[176:179], a[240:243], a[212:215], v[176:179]
ds_read_b64_tr_b16 a[194:195], v4 offset:20992
v_add_u32 v9, 262144, v9
v_mfma_f32_16x16x32_bf16 v[180:183], a[244:247], a[212:215], v[180:183]
ds_read_b64_tr_b16 a[196:197], v5 offset:20480
v_mfma_f32_16x16x32_bf16 v[184:187], a[248:251], a[212:215], v[184:187]
ds_read_b64_tr_b16 a[198:199], v5 offset:20992
s_add_u32 m0, s50, 0
v_mfma_f32_16x16x32_bf16 v[188:191], a[252:255], a[212:215], v[188:191]
buffer_load_dwordx4 v8, s[4:7], s24 offen lds
v_mfma_f32_16x16x32_bf16 v[192:195], a[224:227], a[216:219], v[192:195]
ds_read_b64_tr_b16 a[200:201], v6 offset:20480
v_mfma_f32_16x16x32_bf16 v[196:199], a[228:231], a[216:219], v[196:199]
ds_read_b64_tr_b16 a[202:203], v6 offset:20992
s_add_u32 m0, s50, 4096
s_nop 0
buffer_load_dwordx4 v8, s[4:7], s25 offen lds
v_mfma_f32_16x16x32_bf16 v[200:203], a[232:235], a[216:219], v[200:203]
ds_read_b64_tr_b16 a[204:205], v7 offset:20480
v_mfma_f32_16x16x32_bf16 v[204:207], a[236:239], a[216:219], v[204:207]
ds_read_b64_tr_b16 a[206:207], v7 offset:20992
v_mfma_f32_16x16x32_bf16 v[208:211], a[240:243], a[216:219], v[208:211]
ds_read_b128 a[160:163], v3 offset:0
s_add_u32 m0, s50, 8192
v_mfma_f32_16x16x32_bf16 v[212:215], a[244:247], a[216:219], v[212:215]
buffer_load_dwordx4 v8, s[4:7], s26 offen lds
v_mfma_f32_16x16x32_bf16 v[216:219], a[248:251], a[216:219], v[216:219]
ds_read_b128 a[164:167], v3 offset:2048
v_mfma_f32_16x16x32_bf16 v[220:223], a[252:255], a[216:219], v[220:223]
ds_read_b128 a[168:171], v3 offset:4096
s_add_u32 m0, s50, 12288
v_mfma_f32_16x16x32_bf16 v[224:227], a[224:227], a[220:223], v[224:227]
buffer_load_dwordx4 v8, s[4:7], s27 offen lds
v_mfma_f32_16x16x32_bf16 v[228:231], a[228:231], a[220:223], v[228:231]
ds_read_b128 a[172:175], v3 offset:6144
v_add_u32 v8, 128, v8
v_mfma_f32_16x16x32_bf16 v[232:235], a[232:235], a[220:223], v[232:235]
v_mfma_f32_16x16x32_bf16 v[236:239], a[236:239], a[220:223], v[236:239]
v_mfma_f32_16x16x32_bf16 v[240:243], a[240:243], a[220:223], v[240:243]
v_mfma_f32_16x16x32_bf16 v[244:247], a[244:247], a[220:223], v[244:247]
v_mfma_f32_16x16x32_bf16 v[248:251], a[248:251], a[220:223], v[248:251]
v_mfma_f32_16x16x32_bf16 v[252:255], a[252:255], a[220:223], v[252:255]
s_waitcnt vmcnt(12) lgkmcnt(0)
s_barrier
v_mfma_f32_16x16x32_bf16 v[128:131], a[176:179], a[160:163], v[128:131]
s_add_u32 s50, s49, s51
s_add_u32 s49, s49, 32768
s_cmp_eq_u32 s49, 163840
v_mfma_f32_16x16x32_bf16 v[132:135], a[180:183], a[160:163], v[132:135]
s_cselect_b32 s49, 65536, s49
v_add_u32 v2, s49, v1
v_xor_b32 v3, 64, v2
v_mfma_f32_16x16x32_bf16 v[136:139], a[184:187], a[160:163], v[136:139]
ds_read_b64_tr_b16 a[224:225], v4 offset:32768
v_mfma_f32_16x16x32_bf16 v[140:143], a[188:191], a[160:163], v[140:143]
ds_read_b64_tr_b16 a[226:227], v4 offset:33280
v_mfma_f32_16x16x32_bf16 v[144:147], a[192:195], a[160:163], v[144:147]
ds_read_b64_tr_b16 a[228:229], v5 offset:32768
v_mfma_f32_16x16x32_bf16 v[148:151], a[196:199], a[160:163], v[148:151]
ds_read_b64_tr_b16 a[230:231], v5 offset:33280
s_add_u32 m0, s51, 16384
v_mfma_f32_16x16x32_bf16 v[152:155], a[200:203], a[160:163], v[152:155]
buffer_load_dwordx4 v9, s[8:11], s40 offen lds
v_mfma_f32_16x16x32_bf16 v[156:159], a[204:207], a[160:163], v[156:159]
ds_read_b64_tr_b16 a[232:233], v6 offset:32768
v_mfma_f32_16x16x32_bf16 v[160:163], a[176:179], a[164:167], v[160:163]
ds_read_b64_tr_b16 a[234:235], v6 offset:33280
v_mfma_f32_16x16x32_bf16 v[164:167], a[180:183], a[164:167], v[164:167]
ds_read_b64_tr_b16 a[236:237], v7 offset:32768
v_mfma_f32_16x16x32_bf16 v[168:171], a[184:187], a[164:167], v[168:171]
ds_read_b64_tr_b16 a[238:239], v7 offset:33280
v_mfma_f32_16x16x32_bf16 v[172:175], a[188:191], a[164:167], v[172:175]
ds_read_b64_tr_b16 a[240:241], v4 offset:36864
s_add_u32 m0, s51, 20480
v_mfma_f32_16x16x32_bf16 v[176:179], a[192:195], a[164:167], v[176:179]
buffer_load_dwordx4 v9, s[8:11], s41 offen lds
v_mfma_f32_16x16x32_bf16 v[180:183], a[196:199], a[164:167], v[180:183]
ds_read_b64_tr_b16 a[242:243], v4 offset:37376
v_mfma_f32_16x16x32_bf16 v[184:187], a[200:203], a[164:167], v[184:187]
ds_read_b64_tr_b16 a[244:245], v5 offset:36864
v_mfma_f32_16x16x32_bf16 v[188:191], a[204:207], a[164:167], v[188:191]
ds_read_b64_tr_b16 a[246:247], v5 offset:37376
v_mfma_f32_16x16x32_bf16 v[192:195], a[176:179], a[168:171], v[192:195]
ds_read_b64_tr_b16 a[248:249], v6 offset:36864
v_mfma_f32_16x16x32_bf16 v[196:199], a[180:183], a[168:171], v[196:199]
ds_read_b64_tr_b16 a[250:251], v6 offset:37376
s_add_u32 m0, s51, 24576
v_mfma_f32_16x16x32_bf16 v[200:203], a[184:187], a[168:171], v[200:203]
buffer_load_dwordx4 v9, s[8:11], s42 offen lds
v_mfma_f32_16x16x32_bf16 v[204:207], a[188:191], a[168:171], v[204:207]
ds_read_b64_tr_b16 a[252:253], v7 offset:36864
v_mfma_f32_16x16x32_bf16 v[208:211], a[192:195], a[168:171], v[208:211]
ds_read_b64_tr_b16 a[254:255], v7 offset:37376
v_mfma_f32_16x16x32_bf16 v[212:215], a[196:199], a[168:171], v[212:215]
ds_read_b128 a[208:211], v2 offset:0
v_mfma_f32_16x16x32_bf16 v[216:219], a[200:203], a[168:171], v[216:219]
ds_read_b128 a[212:215], v2 offset:2048
v_mfma_f32_16x16x32_bf16 v[220:223], a[204:207], a[168:171], v[220:223]
ds_read_b128 a[216:219], v2 offset:4096
s_add_u32 m0, s51, 28672
v_mfma_f32_16x16x32_bf16 v[224:227], a[176:179], a[172:175], v[224:227]
buffer_load_dwordx4 v9, s[8:11], s43 offen lds
v_mfma_f32_16x16x32_bf16 v[228:231], a[180:183], a[172:175], v[228:231]
ds_read_b128 a[220:223], v2 offset:6144
v_add_u32 v9, 262144, v9
v_mfma_f32_16x16x32_bf16 v[232:235], a[184:187], a[172:175], v[232:235]
v_mfma_f32_16x16x32_bf16 v[236:239], a[188:191], a[172:175], v[236:239]
v_mfma_f32_16x16x32_bf16 v[240:243], a[192:195], a[172:175], v[240:243]
v_mfma_f32_16x16x32_bf16 v[244:247], a[196:199], a[172:175], v[244:247]
v_mfma_f32_16x16x32_bf16 v[248:251], a[200:203], a[172:175], v[248:251]
v_mfma_f32_16x16x32_bf16 v[252:255], a[204:207], a[172:175], v[252:255]
s_waitcnt vmcnt(12) lgkmcnt(0)
s_barrier
v_mfma_f32_16x16x32_bf16 v[128:131], a[224:227], a[208:211], v[128:131]
v_mfma_f32_16x16x32_bf16 v[132:135], a[228:231], a[208:211], v[132:135]
ds_read_b64_tr_b16 a[176:177], v4 offset:49152
ds_read_b64_tr_b16 a[178:179], v4 offset:49664
s_add_u32 m0, s51, 32768
v_mfma_f32_16x16x32_bf16 v[136:139], a[232:235], a[208:211], v[136:139]
buffer_load_dwordx4 v9, s[8:11], s40 offen lds
v_mfma_f32_16x16x32_bf16 v[140:143], a[236:239], a[208:211], v[140:143]
ds_read_b64_tr_b16 a[180:181], v5 offset:49152
v_mfma_f32_16x16x32_bf16 v[144:147], a[240:243], a[208:211], v[144:147]
ds_read_b64_tr_b16 a[182:183], v5 offset:49664
s_add_u32 m0, s51, 36864
v_mfma_f32_16x16x32_bf16 v[148:151], a[244:247], a[208:211], v[148:151]
buffer_load_dwordx4 v9, s[8:11], s41 offen lds
v_mfma_f32_16x16x32_bf16 v[152:155], a[248:251], a[208:211], v[152:155]
ds_read_b64_tr_b16 a[184:185], v6 offset:49152
v_mfma_f32_16x16x32_bf16 v[156:159], a[252:255], a[208:211], v[156:159]
ds_read_b64_tr_b16 a[186:187], v6 offset:49664
s_add_u32 m0, s51, 40960
s_nop 0
buffer_load_dwordx4 v9, s[8:11], s42 offen lds
v_mfma_f32_16x16x32_bf16 v[160:163], a[224:227], a[212:215], v[160:163]
ds_read_b64_tr_b16 a[188:189], v7 offset:49152
v_mfma_f32_16x16x32_bf16 v[164:167], a[228:231], a[212:215], v[164:167]
ds_read_b64_tr_b16 a[190:191], v7 offset:49664
s_add_u32 m0, s51, 45056
v_mfma_f32_16x16x32_bf16 v[168:171], a[232:235], a[212:215], v[168:171]
buffer_load_dwordx4 v9, s[8:11], s43 offen lds
v_mfma_f32_16x16x32_bf16 v[172:175], a[236:239], a[212:215], v[172:175]
ds_read_b64_tr_b16 a[192:193], v4 offset:53248
v_add_u32 v9, 262144, v9
v_mfma_f32_16x16x32_bf16 v[176:179], a[240:243], a[212:215], v[176:179]
ds_read_b64_tr_b16 a[194:195], v4 offset:53760
v_mfma_f32_16x16x32_bf16 v[180:183], a[244:247], a[212:215], v[180:183]
ds_read_b64_tr_b16 a[196:197], v5 offset:53248
s_add_u32 m0, s50, 0
s_nop 0
buffer_load_dwordx4 v8, s[4:7], s24 offen lds
v_mfma_f32_16x16x32_bf16 v[184:187], a[248:251], a[212:215], v[184:187]
ds_read_b64_tr_b16 a[198:199], v5 offset:53760
v_mfma_f32_16x16x32_bf16 v[188:191], a[252:255], a[212:215], v[188:191]
ds_read_b64_tr_b16 a[200:201], v6 offset:53248
s_add_u32 m0, s50, 4096
v_mfma_f32_16x16x32_bf16 v[192:195], a[224:227], a[216:219], v[192:195]
buffer_load_dwordx4 v8, s[4:7], s25 offen lds
v_mfma_f32_16x16x32_bf16 v[196:199], a[228:231], a[216:219], v[196:199]
ds_read_b64_tr_b16 a[202:203], v6 offset:53760
v_mfma_f32_16x16x32_bf16 v[200:203], a[232:235], a[216:219], v[200:203]
ds_read_b64_tr_b16 a[204:205], v7 offset:53248
s_add_u32 m0, s50, 8192
v_mfma_f32_16x16x32_bf16 v[204:207], a[236:239], a[216:219], v[204:207]
buffer_load_dwordx4 v8, s[4:7], s26 offen lds
ds_read_b64_tr_b16 a[206:207], v7 offset:53760
v_mfma_f32_16x16x32_bf16 v[208:211], a[240:243], a[216:219], v[208:211]
ds_read_b128 a[160:163], v3 offset:0
s_add_u32 m0, s50, 12288
v_mfma_f32_16x16x32_bf16 v[212:215], a[244:247], a[216:219], v[212:215]
buffer_load_dwordx4 v8, s[4:7], s27 offen lds
v_mfma_f32_16x16x32_bf16 v[216:219], a[248:251], a[216:219], v[216:219]
ds_read_b128 a[164:167], v3 offset:2048
v_add_u32 v8, 128, v8
v_mfma_f32_16x16x32_bf16 v[220:223], a[252:255], a[216:219], v[220:223]
ds_read_b128 a[168:171], v3 offset:4096
v_mfma_f32_16x16x32_bf16 v[224:227], a[224:227], a[220:223], v[224:227]
buffer_load_dword v14, v15, s[20:23], s99 offen sc0 sc1
v_mfma_f32_16x16x32_bf16 v[228:231], a[228:231], a[220:223], v[228:231]
ds_read_b128 a[172:175], v3 offset:6144
v_mfma_f32_16x16x32_bf16 v[232:235], a[232:235], a[220:223], v[232:235]
v_mfma_f32_16x16x32_bf16 v[236:239], a[236:239], a[220:223], v[236:239]
v_mfma_f32_16x16x32_bf16 v[240:243], a[240:243], a[220:223], v[240:243]
v_mfma_f32_16x16x32_bf16 v[244:247], a[244:247], a[220:223], v[244:247]
v_mfma_f32_16x16x32_bf16 v[248:251], a[248:251], a[220:223], v[248:251]
v_mfma_f32_16x16x32_bf16 v[252:255], a[252:255], a[220:223], v[252:255]
s_waitcnt vmcnt(13) lgkmcnt(0)
s_barrier
v_mfma_f32_16x16x32_bf16 v[128:131], a[176:179], a[160:163], v[128:131]
s_add_u32 s50, s49, s51
s_add_u32 s49, s49, 32768
s_cmp_eq_u32 s49, 163840
v_mfma_f32_16x16x32_bf16 v[132:135], a[180:183], a[160:163], v[132:135]
s_cselect_b32 s49, 65536, s49
v_add_u32 v2, s49, v1
v_xor_b32 v3, 64, v2
v_mfma_f32_16x16x32_bf16 v[136:139], a[184:187], a[160:163], v[136:139]
ds_read_b64_tr_b16 a[224:225], v4 offset:0
v_mfma_f32_16x16x32_bf16 v[140:143], a[188:191], a[160:163], v[140:143]
ds_read_b64_tr_b16 a[226:227], v4 offset:512
v_mfma_f32_16x16x32_bf16 v[144:147], a[192:195], a[160:163], v[144:147]
ds_read_b64_tr_b16 a[228:229], v5 offset:0
v_mfma_f32_16x16x32_bf16 v[148:151], a[196:199], a[160:163], v[148:151]
ds_read_b64_tr_b16 a[230:231], v5 offset:512
s_add_u32 m0, s51, 49152
v_mfma_f32_16x16x32_bf16 v[152:155], a[200:203], a[160:163], v[152:155]
buffer_load_dwordx4 v9, s[8:11], s40 offen lds
v_mfma_f32_16x16x32_bf16 v[156:159], a[204:207], a[160:163], v[156:159]
ds_read_b64_tr_b16 a[232:233], v6 offset:0
v_mfma_f32_16x16x32_bf16 v[160:163], a[176:179], a[164:167], v[160:163]
ds_read_b64_tr_b16 a[234:235], v6 offset:512
v_mfma_f32_16x16x32_bf16 v[164:167], a[180:183], a[164:167], v[164:167]
ds_read_b64_tr_b16 a[236:237], v7 offset:0
v_mfma_f32_16x16x32_bf16 v[168:171], a[184:187], a[164:167], v[168:171]
ds_read_b64_tr_b16 a[238:239], v7 offset:512
v_mfma_f32_16x16x32_bf16 v[172:175], a[188:191], a[164:167], v[172:175]
ds_read_b64_tr_b16 a[240:241], v4 offset:4096
s_add_u32 m0, s51, 53248
v_mfma_f32_16x16x32_bf16 v[176:179], a[192:195], a[164:167], v[176:179]
buffer_load_dwordx4 v9, s[8:11], s41 offen lds
v_mfma_f32_16x16x32_bf16 v[180:183], a[196:199], a[164:167], v[180:183]
ds_read_b64_tr_b16 a[242:243], v4 offset:4608
v_mfma_f32_16x16x32_bf16 v[184:187], a[200:203], a[164:167], v[184:187]
ds_read_b64_tr_b16 a[244:245], v5 offset:4096
v_mfma_f32_16x16x32_bf16 v[188:191], a[204:207], a[164:167], v[188:191]
ds_read_b64_tr_b16 a[246:247], v5 offset:4608
v_mfma_f32_16x16x32_bf16 v[192:195], a[176:179], a[168:171], v[192:195]
ds_read_b64_tr_b16 a[248:249], v6 offset:4096
v_mfma_f32_16x16x32_bf16 v[196:199], a[180:183], a[168:171], v[196:199]
ds_read_b64_tr_b16 a[250:251], v6 offset:4608
s_add_u32 m0, s51, 57344
v_mfma_f32_16x16x32_bf16 v[200:203], a[184:187], a[168:171], v[200:203]
buffer_load_dwordx4 v9, s[8:11], s42 offen lds
v_mfma_f32_16x16x32_bf16 v[204:207], a[188:191], a[168:171], v[204:207]
ds_read_b64_tr_b16 a[252:253], v7 offset:4096
v_mfma_f32_16x16x32_bf16 v[208:211], a[192:195], a[168:171], v[208:211]
ds_read_b64_tr_b16 a[254:255], v7 offset:4608
v_mfma_f32_16x16x32_bf16 v[212:215], a[196:199], a[168:171], v[212:215]
ds_read_b128 a[208:211], v2 offset:0
v_mfma_f32_16x16x32_bf16 v[216:219], a[200:203], a[168:171], v[216:219]
ds_read_b128 a[212:215], v2 offset:2048
v_mfma_f32_16x16x32_bf16 v[220:223], a[204:207], a[168:171], v[220:223]
ds_read_b128 a[216:219], v2 offset:4096
s_add_u32 m0, s51, 61440
v_mfma_f32_16x16x32_bf16 v[224:227], a[176:179], a[172:175], v[224:227]
buffer_load_dwordx4 v9, s[8:11], s43 offen lds
v_mfma_f32_16x16x32_bf16 v[228:231], a[180:183], a[172:175], v[228:231]
ds_read_b128 a[220:223], v2 offset:6144
v_add_u32 v9, 262144, v9
v_mfma_f32_16x16x32_bf16 v[232:235], a[184:187], a[172:175], v[232:235]
v_mfma_f32_16x16x32_bf16 v[236:239], a[188:191], a[172:175], v[236:239]
v_mfma_f32_16x16x32_bf16 v[240:243], a[192:195], a[172:175], v[240:243]
v_mfma_f32_16x16x32_bf16 v[244:247], a[196:199], a[172:175], v[244:247]
v_mfma_f32_16x16x32_bf16 v[248:251], a[200:203], a[172:175], v[248:251]
v_mfma_f32_16x16x32_bf16 v[252:255], a[204:207], a[172:175], v[252:255]
s_waitcnt vmcnt(13) lgkmcnt(0)
s_barrier
v_mfma_f32_16x16x32_bf16 v[128:131], a[224:227], a[208:211], v[128:131]
v_mfma_f32_16x16x32_bf16 v[132:135], a[228:231], a[208:211], v[132:135]
ds_read_b64_tr_b16 a[176:177], v4 offset:16384
ds_read_b64_tr_b16 a[178:179], v4 offset:16896
s_add_u32 m0, s51, 0
v_mfma_f32_16x16x32_bf16 v[136:139], a[232:235], a[208:211], v[136:139]
buffer_load_dwordx4 v9, s[8:11], s40 offen lds
v_mfma_f32_16x16x32_bf16 v[140:143], a[236:239], a[208:211], v[140:143]
ds_read_b64_tr_b16 a[180:181], v5 offset:16384
v_mfma_f32_16x16x32_bf16 v[144:147], a[240:243], a[208:211], v[144:147]
ds_read_b64_tr_b16 a[182:183], v5 offset:16896
s_add_u32 m0, s51, 4096
v_mfma_f32_16x16x32_bf16 v[148:151], a[244:247], a[208:211], v[148:151]
buffer_load_dwordx4 v9, s[8:11], s41 offen lds
v_mfma_f32_16x16x32_bf16 v[152:155], a[248:251], a[208:211], v[152:155]
ds_read_b64_tr_b16 a[184:185], v6 offset:16384
v_mfma_f32_16x16x32_bf16 v[156:159], a[252:255], a[208:211], v[156:159]
ds_read_b64_tr_b16 a[186:187], v6 offset:16896
v_mfma_f32_16x16x32_bf16 v[160:163], a[224:227], a[212:215], v[160:163]
ds_read_b64_tr_b16 a[188:189], v7 offset:16384
s_add_u32 m0, s51, 8192
v_mfma_f32_16x16x32_bf16 v[164:167], a[228:231], a[212:215], v[164:167]
buffer_load_dwordx4 v9, s[8:11], s42 offen lds
ds_read_b64_tr_b16 a[190:191], v7 offset:16896
v_mfma_f32_16x16x32_bf16 v[168:171], a[232:235], a[212:215], v[168:171]
ds_read_b64_tr_b16 a[192:193], v4 offset:20480
s_add_u32 m0, s51, 12288
v_mfma_f32_16x16x32_bf16 v[172:175], a[236:239], a[212:215], v[172:175]
buffer_load_dwordx4 v9, s[8:11], s43 offen lds
v_mfma_f32_16x16x32_bf16 v[176:179], a[240:243], a[212:215], v[176:179]
ds_read_b64_tr_b16 a[194:195], v4 offset:20992
v_add_u32 v9, 262144, v9
v_mfma_f32_16x16x32_bf16 v[180:183], a[244:247], a[212:215], v[180:183]
ds_read_b64_tr_b16 a[196:197], v5 offset:20480
v_mfma_f32_16x16x32_bf16 v[184:187], a[248:251], a[212:215], v[184:187]
ds_read_b64_tr_b16 a[198:199], v5 offset:20992
s_add_u32 m0, s50, 0
v_mfma_f32_16x16x32_bf16 v[188:191], a[252:255], a[212:215], v[188:191]
buffer_load_dwordx4 v8, s[4:7], s24 offen lds
v_mfma_f32_16x16x32_bf16 v[192:195], a[224:227], a[216:219], v[192:195]
ds_read_b64_tr_b16 a[200:201], v6 offset:20480
v_mfma_f32_16x16x32_bf16 v[196:199], a[228:231], a[216:219], v[196:199]
ds_read_b64_tr_b16 a[202:203], v6 offset:20992
s_add_u32 m0, s50, 4096
s_nop 0
buffer_load_dwordx4 v8, s[4:7], s25 offen lds
v_mfma_f32_16x16x32_bf16 v[200:203], a[232:235], a[216:219], v[200:203]
ds_read_b64_tr_b16 a[204:205], v7 offset:20480
v_mfma_f32_16x16x32_bf16 v[204:207], a[236:239], a[216:219], v[204:207]
ds_read_b64_tr_b16 a[206:207], v7 offset:20992
v_mfma_f32_16x16x32_bf16 v[208:211], a[240:243], a[216:219], v[208:211]
ds_read_b128 a[160:163], v3 offset:0
s_add_u32 m0, s50, 8192
v_mfma_f32_16x16x32_bf16 v[212:215], a[244:247], a[216:219], v[212:215]
buffer_load_dwordx4 v8, s[4:7], s26 offen lds
v_mfma_f32_16x16x32_bf16 v[216:219], a[248:251], a[216:219], v[216:219]
ds_read_b128 a[164:167], v3 offset:2048
v_mfma_f32_16x16x32_bf16 v[220:223], a[252:255], a[216:219], v[220:223]
ds_read_b128 a[168:171], v3 offset:4096
s_add_u32 m0, s50, 12288
v_mfma_f32_16x16x32_bf16 v[224:227], a[224:227], a[220:223], v[224:227]
buffer_load_dwordx4 v8, s[4:7], s27 offen lds
v_mfma_f32_16x16x32_bf16 v[228:231], a[228:231], a[220:223], v[228:231]
ds_read_b128 a[172:175], v3 offset:6144
v_add_u32 v8, 128, v8
v_mfma_f32_16x16x32_bf16 v[232:235], a[232:235], a[220:223], v[232:235]
v_mfma_f32_16x16x32_bf16 v[236:239], a[236:239], a[220:223], v[236:239]
v_mfma_f32_16x16x32_bf16 v[240:243], a[240:243], a[220:223], v[240:243]
v_mfma_f32_16x16x32_bf16 v[244:247], a[244:247], a[220:223], v[244:247]
v_mfma_f32_16x16x32_bf16 v[248:251], a[248:251], a[220:223], v[248:251]
v_mfma_f32_16x16x32_bf16 v[252:255], a[252:255], a[220:223], v[252:255]
s_waitcnt vmcnt(12) lgkmcnt(0)
v_cmp_ne_u32 vcc, s89, v14
s_cbranch_vccnz LM_kvawait
LM_kvaret:
s_barrier
v_mfma_f32_16x16x32_bf16 v[128:131], a[176:179], a[160:163], v[128:131]
s_add_u32 s50, s49, s51
s_add_u32 s49, s49, 32768
s_cmp_eq_u32 s49, 163840
v_mfma_f32_16x16x32_bf16 v[132:135], a[180:183], a[160:163], v[132:135]
s_cselect_b32 s49, 65536, s49
v_add_u32 v2, s49, v1
v_xor_b32 v3, 64, v2
v_mfma_f32_16x16x32_bf16 v[136:139], a[184:187], a[160:163], v[136:139]
ds_read_b64_tr_b16 a[224:225], v4 offset:32768
s_add_u32 m0, s51, 16384
s_nop 0
buffer_load_dwordx4 v9, s[8:11], s40 offen lds
v_mfma_f32_16x16x32_bf16 v[140:143], a[188:191], a[160:163], v[140:143]
ds_read_b64_tr_b16 a[226:227], v4 offset:33280
v_mfma_f32_16x16x32_bf16 v[144:147], a[192:195], a[160:163], v[144:147]
ds_read_b64_tr_b16 a[228:229], v5 offset:32768
s_add_u32 m0, s51, 20480
v_mfma_f32_16x16x32_bf16 v[148:151], a[196:199], a[160:163], v[148:151]
buffer_load_dwordx4 v9, s[8:11], s41 offen lds
ds_read_b64_tr_b16 a[230:231], v5 offset:33280
s_add_u32 m0, s51, 24576
v_mfma_f32_16x16x32_bf16 v[152:155], a[200:203], a[160:163], v[152:155]
buffer_load_dwordx4 v9, s[8:11], s42 offen lds
v_mfma_f32_16x16x32_bf16 v[156:159], a[204:207], a[160:163], v[156:159]
ds_read_b64_tr_b16 a[232:233], v6 offset:32768
v_mfma_f32_16x16x32_bf16 v[160:163], a[176:179], a[164:167], v[160:163]
ds_read_b64_tr_b16 a[234:235], v6 offset:33280
s_add_u32 m0, s51, 28672
s_nop 0
buffer_load_dwordx4 v9, s[8:11], s43 offen lds
v_mfma_f32_16x16x32_bf16 v[164:167], a[180:183], a[164:167], v[164:167]
ds_read_b64_tr_b16 a[236:237], v7 offset:32768
v_add_u32 v9, 262144, v9
v_mfma_f32_16x16x32_bf16 v[168:171], a[184:187], a[164:167], v[168:171]
ds_read_b64_tr_b16 a[238:239], v7 offset:33280
s_add_u32 m0, s74, 65536
v_mfma_f32_16x16x32_bf16 v[172:175], a[188:191], a[164:167], v[172:175]
buffer_load_dwordx4 v12, s[12:15], s66 offen offset:0 sc1 lds
ds_read_b64_tr_b16 a[240:241], v4 offset:36864
v_mfma_f32_16x16x32_bf16 v[176:179], a[192:195], a[164:167], v[176:179]
buffer_load_dwordx4 v12, s[12:15], s66 offen offset:1024 sc1 lds
v_mfma_f32_16x16x32_bf16 v[180:183], a[196:199], a[164:167], v[180:183]
ds_read_b64_tr_b16 a[242:243], v4 offset:37376
v_mfma_f32_16x16x32_bf16 v[184:187], a[200:203], a[164:167], v[184:187]
ds_read_b64_tr_b16 a[244:245], v5 offset:36864
buffer_load_dwordx4 v12, s[12:15], s66 offen offset:2048 sc1 lds
v_mfma_f32_16x16x32_bf16 v[188:191], a[204:207], a[164:167], v[188:191]
ds_read_b64_tr_b16 a[246:247], v5 offset:37376
v_mfma_f32_16x16x32_bf16 v[192:195], a[176:179], a[168:171], v[192:195]
ds_read_b64_tr_b16 a[248:249], v6 offset:36864
v_mfma_f32_16x16x32_bf16 v[196:199], a[180:183], a[168:171], v[196:199]
buffer_load_dwordx4 v12, s[12:15], s66 offen offset:3072 sc1 lds
ds_read_b64_tr_b16 a[250:251], v6 offset:37376
s_add_u32 m0, s74, 81920
v_mfma_f32_16x16x32_bf16 v[200:203], a[184:187], a[168:171], v[200:203]
buffer_load_dwordx4 v13, s[12:15], s66 offen offset:0 sc1 lds
v_mfma_f32_16x16x32_bf16 v[204:207], a[188:191], a[168:171], v[204:207]
ds_read_b64_tr_b16 a[252:253], v7 offset:36864
v_mfma_f32_16x16x32_bf16 v[208:211], a[192:195], a[168:171], v[208:211]
ds_read_b64_tr_b16 a[254:255], v7 offset:37376
buffer_load_dwordx4 v13, s[12:15], s66 offen offset:1024 sc1 lds
v_mfma_f32_16x16x32_bf16 v[212:215], a[196:199], a[168:171], v[212:215]
ds_read_b128 a[208:211], v2 offset:0
v_mfma_f32_16x16x32_bf16 v[216:219], a[200:203], a[168:171], v[216:219]
ds_read_b128 a[212:215], v2 offset:2048
v_mfma_f32_16x16x32_bf16 v[220:223], a[204:207], a[168:171], v[220:223]
buffer_load_dwordx4 v13, s[12:15], s66 offen offset:2048 sc1 lds
ds_read_b128 a[216:219], v2 offset:4096
v_mfma_f32_16x16x32_bf16 v[224:227], a[176:179], a[172:175], v[224:227]
buffer_load_dwordx4 v13, s[12:15], s66 offen offset:3072 sc1 lds
v_mfma_f32_16x16x32_bf16 v[228:231], a[180:183], a[172:175], v[228:231]
ds_read_b128 a[220:223], v2 offset:6144
v_mfma_f32_16x16x32_bf16 v[232:235], a[184:187], a[172:175], v[232:235]
v_mfma_f32_16x16x32_bf16 v[236:239], a[188:191], a[172:175], v[236:239]
v_mfma_f32_16x16x32_bf16 v[240:243], a[192:195], a[172:175], v[240:243]
v_mfma_f32_16x16x32_bf16 v[244:247], a[196:199], a[172:175], v[244:247]
v_mfma_f32_16x16x32_bf16 v[248:251], a[200:203], a[172:175], v[248:251]
v_mfma_f32_16x16x32_bf16 v[252:255], a[204:207], a[172:175], v[252:255]
s_add_u32 s66, s66, 32768
s_cmp_eq_u32 s72, 1
s_cselect_b32 s66, s75, s66
s_waitcnt vmcnt(20) lgkmcnt(0)
s_barrier
v_mfma_f32_16x16x32_bf16 v[128:131], a[224:227], a[208:211], v[128:131]
v_mfma_f32_16x16x32_bf16 v[132:135], a[228:231], a[208:211], v[132:135]
ds_read_b64_tr_b16 a[176:177], v4 offset:49152
v_mfma_f32_16x16x32_bf16 v[136:139], a[232:235], a[208:211], v[136:139]
ds_read_b64_tr_b16 a[178:179], v4 offset:49664
v_mfma_f32_16x16x32_bf16 v[140:143], a[236:239], a[208:211], v[140:143]
ds_read_b64_tr_b16 a[180:181], v5 offset:49152
v_mfma_f32_16x16x32_bf16 v[144:147], a[240:243], a[208:211], v[144:147]
ds_read_b64_tr_b16 a[182:183], v5 offset:49664
v_mfma_f32_16x16x32_bf16 v[148:151], a[244:247], a[208:211], v[148:151]
v_mfma_f32_16x16x32_bf16 v[152:155], a[248:251], a[208:211], v[152:155]
ds_read_b64_tr_b16 a[184:185], v6 offset:49152
v_mfma_f32_16x16x32_bf16 v[156:159], a[252:255], a[208:211], v[156:159]
ds_read_b64_tr_b16 a[186:187], v6 offset:49664
v_mfma_f32_16x16x32_bf16 v[160:163], a[224:227], a[212:215], v[160:163]
ds_read_b64_tr_b16 a[188:189], v7 offset:49152
v_mfma_f32_16x16x32_bf16 v[164:167], a[228:231], a[212:215], v[164:167]
ds_read_b64_tr_b16 a[190:191], v7 offset:49664
v_mfma_f32_16x16x32_bf16 v[168:171], a[232:235], a[212:215], v[168:171]
v_mfma_f32_16x16x32_bf16 v[172:175], a[236:239], a[212:215], v[172:175]
ds_read_b64_tr_b16 a[192:193], v4 offset:53248
v_mfma_f32_16x16x32_bf16 v[176:179], a[240:243], a[212:215], v[176:179]
ds_read_b64_tr_b16 a[194:195], v4 offset:53760
v_mfma_f32_16x16x32_bf16 v[180:183], a[244:247], a[212:215], v[180:183]
ds_read_b64_tr_b16 a[196:197], v5 offset:53248
v_mfma_f32_16x16x32_bf16 v[184:187], a[248:251], a[212:215], v[184:187]
ds_read_b64_tr_b16 a[198:199], v5 offset:53760
v_mfma_f32_16x16x32_bf16 v[188:191], a[252:255], a[212:215], v[188:191]
v_mfma_f32_16x16x32_bf16 v[192:195], a[224:227], a[216:219], v[192:195]
ds_read_b64_tr_b16 a[200:201], v6 offset:53248
v_mfma_f32_16x16x32_bf16 v[196:199], a[228:231], a[216:219], v[196:199]
ds_read_b64_tr_b16 a[202:203], v6 offset:53760
v_mfma_f32_16x16x32_bf16 v[200:203], a[232:235], a[216:219], v[200:203]
ds_read_b64_tr_b16 a[204:205], v7 offset:53248
v_mfma_f32_16x16x32_bf16 v[204:207], a[236:239], a[216:219], v[204:207]
ds_read_b64_tr_b16 a[206:207], v7 offset:53760
v_mfma_f32_16x16x32_bf16 v[208:211], a[240:243], a[216:219], v[208:211]
v_mfma_f32_16x16x32_bf16 v[212:215], a[244:247], a[216:219], v[212:215]
ds_read_b128 a[160:163], v3 offset:0
v_mfma_f32_16x16x32_bf16 v[216:219], a[248:251], a[216:219], v[216:219]
ds_read_b128 a[164:167], v3 offset:2048
v_mfma_f32_16x16x32_bf16 v[220:223], a[252:255], a[216:219], v[220:223]
ds_read_b128 a[168:171], v3 offset:4096
v_mfma_f32_16x16x32_bf16 v[224:227], a[224:227], a[220:223], v[224:227]
ds_read_b128 a[172:175], v3 offset:6144
v_mfma_f32_16x16x32_bf16 v[228:231], a[228:231], a[220:223], v[228:231]
v_mfma_f32_16x16x32_bf16 v[232:235], a[232:235], a[220:223], v[232:235]
v_mfma_f32_16x16x32_bf16 v[236:239], a[236:239], a[220:223], v[236:239]
v_mfma_f32_16x16x32_bf16 v[240:243], a[240:243], a[220:223], v[240:243]
v_mfma_f32_16x16x32_bf16 v[244:247], a[244:247], a[220:223], v[244:247]
v_mfma_f32_16x16x32_bf16 v[248:251], a[248:251], a[220:223], v[248:251]
v_mfma_f32_16x16x32_bf16 v[252:255], a[252:255], a[220:223], v[252:255]
s_waitcnt vmcnt(12) lgkmcnt(0)
s_barrier
v_mfma_f32_16x16x32_bf16 v[128:131], a[176:179], a[160:163], v[128:131]
s_add_u32 s50, s49, s51
s_add_u32 s49, s49, 32768
s_cmp_eq_u32 s49, 163840
v_mfma_f32_16x16x32_bf16 v[132:135], a[180:183], a[160:163], v[132:135]
s_cselect_b32 s49, 65536, s49
v_add_u32 v2, s49, v1
v_xor_b32 v3, 64, v2
v_mfma_f32_16x16x32_bf16 v[136:139], a[184:187], a[160:163], v[136:139]
ds_read_b64_tr_b16 a[224:225], v4 offset:0
ds_read_b64_tr_b16 a[226:227], v4 offset:512
s_add_u32 m0, s74, 98304
v_mfma_f32_16x16x32_bf16 v[140:143], a[188:191], a[160:163], v[140:143]
buffer_load_dwordx4 v12, s[12:15], s66 offen offset:0 sc1 lds
v_mfma_f32_16x16x32_bf16 v[144:147], a[192:195], a[160:163], v[144:147]
ds_read_b64_tr_b16 a[228:229], v5 offset:0
v_mfma_f32_16x16x32_bf16 v[148:151], a[196:199], a[160:163], v[148:151]
ds_read_b64_tr_b16 a[230:231], v5 offset:512
v_mfma_f32_16x16x32_bf16 v[152:155], a[200:203], a[160:163], v[152:155]
buffer_load_dwordx4 v12, s[12:15], s66 offen offset:1024 sc1 lds
v_mfma_f32_16x16x32_bf16 v[156:159], a[204:207], a[160:163], v[156:159]
ds_read_b64_tr_b16 a[232:233], v6 offset:0
v_mfma_f32_16x16x32_bf16 v[160:163], a[176:179], a[164:167], v[160:163]
ds_read_b64_tr_b16 a[234:235], v6 offset:512
ds_read_b64_tr_b16 a[236:237], v7 offset:0
v_mfma_f32_16x16x32_bf16 v[164:167], a[180:183], a[164:167], v[164:167]
buffer_load_dwordx4 v12, s[12:15], s66 offen offset:2048 sc1 lds
v_mfma_f32_16x16x32_bf16 v[168:171], a[184:187], a[164:167], v[168:171]
ds_read_b64_tr_b16 a[238:239], v7 offset:512
v_mfma_f32_16x16x32_bf16 v[172:175], a[188:191], a[164:167], v[172:175]
ds_read_b64_tr_b16 a[240:241], v4 offset:4096
v_mfma_f32_16x16x32_bf16 v[176:179], a[192:195], a[164:167], v[176:179]
buffer_load_dwordx4 v12, s[12:15], s66 offen offset:3072 sc1 lds
v_mfma_f32_16x16x32_bf16 v[180:183], a[196:199], a[164:167], v[180:183]
ds_read_b64_tr_b16 a[242:243], v4 offset:4608
v_mfma_f32_16x16x32_bf16 v[184:187], a[200:203], a[164:167], v[184:187]
ds_read_b64_tr_b16 a[244:245], v5 offset:4096
ds_read_b64_tr_b16 a[246:247], v5 offset:4608
s_add_u32 m0, s74, 114688
v_mfma_f32_16x16x32_bf16 v[188:191], a[204:207], a[164:167], v[188:191]
buffer_load_dwordx4 v13, s[12:15], s66 offen offset:0 sc1 lds
v_mfma_f32_16x16x32_bf16 v[192:195], a[176:179], a[168:171], v[192:195]
ds_read_b64_tr_b16 a[248:249], v6 offset:4096
v_mfma_f32_16x16x32_bf16 v[196:199], a[180:183], a[168:171], v[196:199]
ds_read_b64_tr_b16 a[250:251], v6 offset:4608
v_mfma_f32_16x16x32_bf16 v[200:203], a[184:187], a[168:171], v[200:203]
buffer_load_dwordx4 v13, s[12:15], s66 offen offset:1024 sc1 lds
v_mfma_f32_16x16x32_bf16 v[204:207], a[188:191], a[168:171], v[204:207]
ds_read_b64_tr_b16 a[252:253], v7 offset:4096
v_mfma_f32_16x16x32_bf16 v[208:211], a[192:195], a[168:171], v[208:211]
ds_read_b64_tr_b16 a[254:255], v7 offset:4608
ds_read_b128 a[208:211], v2 offset:0
v_mfma_f32_16x16x32_bf16 v[212:215], a[196:199], a[168:171], v[212:215]
buffer_load_dwordx4 v13, s[12:15], s66 offen offset:2048 sc1 lds
v_mfma_f32_16x16x32_bf16 v[216:219], a[200:203], a[168:171], v[216:219]
ds_read_b128 a[212:215], v2 offset:2048
v_mfma_f32_16x16x32_bf16 v[220:223], a[204:207], a[168:171], v[220:223]
ds_read_b128 a[216:219], v2 offset:4096
v_mfma_f32_16x16x32_bf16 v[224:227], a[176:179], a[172:175], v[224:227]
buffer_load_dwordx4 v13, s[12:15], s66 offen offset:3072 sc1 lds
v_mfma_f32_16x16x32_bf16 v[228:231], a[180:183], a[172:175], v[228:231]
ds_read_b128 a[220:223], v2 offset:6144
v_mfma_f32_16x16x32_bf16 v[232:235], a[184:187], a[172:175], v[232:235]
v_mfma_f32_16x16x32_bf16 v[236:239], a[188:191], a[172:175], v[236:239]
v_mfma_f32_16x16x32_bf16 v[240:243], a[192:195], a[172:175], v[240:243]
v_mfma_f32_16x16x32_bf16 v[244:247], a[196:199], a[172:175], v[244:247]
v_mfma_f32_16x16x32_bf16 v[248:251], a[200:203], a[172:175], v[248:251]
v_mfma_f32_16x16x32_bf16 v[252:255], a[204:207], a[172:175], v[252:255]
s_add_u32 s66, s66, 32768
s_cmp_eq_u32 s72, 2
s_cselect_b32 s66, s75, s66
s_waitcnt vmcnt(8) lgkmcnt(0)
s_barrier
v_mfma_f32_16x16x32_bf16 v[128:131], a[224:227], a[208:211], v[128:131]
v_mfma_f32_16x16x32_bf16 v[132:135], a[228:231], a[208:211], v[132:135]
ds_read_b64_tr_b16 a[176:177], v4 offset:16384
v_mfma_f32_16x16x32_bf16 v[136:139], a[232:235], a[208:211], v[136:139]
ds_read_b64_tr_b16 a[178:179], v4 offset:16896
v_mfma_f32_16x16x32_bf16 v[140:143], a[236:239], a[208:211], v[140:143]
ds_read_b64_tr_b16 a[180:181], v5 offset:16384
v_mfma_f32_16x16x32_bf16 v[144:147], a[240:243], a[208:211], v[144:147]
ds_read_b64_tr_b16 a[182:183], v5 offset:16896
v_mfma_f32_16x16x32_bf16 v[148:151], a[244:247], a[208:211], v[148:151]
v_mfma_f32_16x16x32_bf16 v[152:155], a[248:251], a[208:211], v[152:155]
ds_read_b64_tr_b16 a[184:185], v6 offset:16384
v_mfma_f32_16x16x32_bf16 v[156:159], a[252:255], a[208:211], v[156:159]
ds_read_b64_tr_b16 a[186:187], v6 offset:16896
v_mfma_f32_16x16x32_bf16 v[160:163], a[224:227], a[212:215], v[160:163]
ds_read_b64_tr_b16 a[188:189], v7 offset:16384
v_mfma_f32_16x16x32_bf16 v[164:167], a[228:231], a[212:215], v[164:167]
ds_read_b64_tr_b16 a[190:191], v7 offset:16896
v_mfma_f32_16x16x32_bf16 v[168:171], a[232:235], a[212:215], v[168:171]
v_mfma_f32_16x16x32_bf16 v[172:175], a[236:239], a[212:215], v[172:175]
ds_read_b64_tr_b16 a[192:193], v4 offset:20480
v_mfma_f32_16x16x32_bf16 v[176:179], a[240:243], a[212:215], v[176:179]
ds_read_b64_tr_b16 a[194:195], v4 offset:20992
v_mfma_f32_16x16x32_bf16 v[180:183], a[244:247], a[212:215], v[180:183]
ds_read_b64_tr_b16 a[196:197], v5 offset:20480
v_mfma_f32_16x16x32_bf16 v[184:187], a[248:251], a[212:215], v[184:187]
ds_read_b64_tr_b16 a[198:199], v5 offset:20992
v_mfma_f32_16x16x32_bf16 v[188:191], a[252:255], a[212:215], v[188:191]
v_mfma_f32_16x16x32_bf16 v[192:195], a[224:227], a[216:219], v[192:195]
ds_read_b64_tr_b16 a[200:201], v6 offset:20480
v_mfma_f32_16x16x32_bf16 v[196:199], a[228:231], a[216:219], v[196:199]
ds_read_b64_tr_b16 a[202:203], v6 offset:20992
v_mfma_f32_16x16x32_bf16 v[200:203], a[232:235], a[216:219], v[200:203]
ds_read_b64_tr_b16 a[204:205], v7 offset:20480
v_mfma_f32_16x16x32_bf16 v[204:207], a[236:239], a[216:219], v[204:207]
ds_read_b64_tr_b16 a[206:207], v7 offset:20992
v_mfma_f32_16x16x32_bf16 v[208:211], a[240:243], a[216:219], v[208:211]
v_mfma_f32_16x16x32_bf16 v[212:215], a[244:247], a[216:219], v[212:215]
ds_read_b128 a[160:163], v3 offset:0
v_mfma_f32_16x16x32_bf16 v[216:219], a[248:251], a[216:219], v[216:219]
ds_read_b128 a[164:167], v3 offset:2048
v_mfma_f32_16x16x32_bf16 v[220:223], a[252:255], a[216:219], v[220:223]
ds_read_b128 a[168:171], v3 offset:4096
v_mfma_f32_16x16x32_bf16 v[224:227], a[224:227], a[220:223], v[224:227]
ds_read_b128 a[172:175], v3 offset:6144
v_mfma_f32_16x16x32_bf16 v[228:231], a[228:231], a[220:223], v[228:231]
v_mfma_f32_16x16x32_bf16 v[232:235], a[232:235], a[220:223], v[232:235]
v_mfma_f32_16x16x32_bf16 v[236:239], a[236:239], a[220:223], v[236:239]
v_mfma_f32_16x16x32_bf16 v[240:243], a[240:243], a[220:223], v[240:243]
v_mfma_f32_16x16x32_bf16 v[244:247], a[244:247], a[220:223], v[244:247]
v_mfma_f32_16x16x32_bf16 v[248:251], a[248:251], a[220:223], v[248:251]
v_mfma_f32_16x16x32_bf16 v[252:255], a[252:255], a[220:223], v[252:255]
s_waitcnt vmcnt(8) lgkmcnt(0)
s_barrier
v_mfma_f32_16x16x32_bf16 v[128:131], a[176:179], a[160:163], v[128:131]
s_add_u32 s50, s49, s51
s_add_u32 s49, s49, 32768
s_cmp_eq_u32 s49, 163840
v_mfma_f32_16x16x32_bf16 v[132:135], a[180:183], a[160:163], v[132:135]
s_cselect_b32 s49, 65536, s49
v_add_u32 v2, s49, v1
v_xor_b32 v3, 64, v2
v_mfma_f32_16x16x32_bf16 v[136:139], a[184:187], a[160:163], v[136:139]
s_add_u32 m0, s74, 131072
s_nop 0
buffer_load_dwordx4 v12, s[12:15], s66 offen offset:0 sc1 lds
v_mfma_f32_16x16x32_bf16 v[140:143], a[188:191], a[160:163], v[140:143]
buffer_load_dwordx4 v12, s[12:15], s66 offen offset:1024 sc1 lds
v_mfma_f32_16x16x32_bf16 v[144:147], a[192:195], a[160:163], v[144:147]
v_mfma_f32_16x16x32_bf16 v[148:151], a[196:199], a[160:163], v[148:151]
buffer_load_dwordx4 v12, s[12:15], s66 offen offset:2048 sc1 lds
v_mfma_f32_16x16x32_bf16 v[152:155], a[200:203], a[160:163], v[152:155]
buffer_load_dwordx4 v12, s[12:15], s66 offen offset:3072 sc1 lds
v_mfma_f32_16x16x32_bf16 v[156:159], a[204:207], a[160:163], v[156:159]
s_add_u32 m0, s74, 147456
v_mfma_f32_16x16x32_bf16 v[160:163], a[176:179], a[164:167], v[160:163]
buffer_load_dwordx4 v13, s[12:15], s66 offen offset:0 sc1 lds
v_mfma_f32_16x16x32_bf16 v[164:167], a[180:183], a[164:167], v[164:167]
buffer_load_dwordx4 v13, s[12:15], s66 offen offset:1024 sc1 lds
v_mfma_f32_16x16x32_bf16 v[168:171], a[184:187], a[164:167], v[168:171]
v_mfma_f32_16x16x32_bf16 v[172:175], a[188:191], a[164:167], v[172:175]
buffer_load_dwordx4 v13, s[12:15], s66 offen offset:2048 sc1 lds
v_mfma_f32_16x16x32_bf16 v[176:179], a[192:195], a[164:167], v[176:179]
buffer_load_dwordx4 v13, s[12:15], s66 offen offset:3072 sc1 lds
v_mfma_f32_16x16x32_bf16 v[180:183], a[196:199], a[164:167], v[180:183]
v_mfma_f32_16x16x32_bf16 v[184:187], a[200:203], a[164:167], v[184:187]
v_mfma_f32_16x16x32_bf16 v[188:191], a[204:207], a[164:167], v[188:191]
v_mfma_f32_16x16x32_bf16 v[192:195], a[176:179], a[168:171], v[192:195]
v_mfma_f32_16x16x32_bf16 v[196:199], a[180:183], a[168:171], v[196:199]
v_mfma_f32_16x16x32_bf16 v[200:203], a[184:187], a[168:171], v[200:203]
v_mfma_f32_16x16x32_bf16 v[204:207], a[188:191], a[168:171], v[204:207]
v_mfma_f32_16x16x32_bf16 v[208:211], a[192:195], a[168:171], v[208:211]
v_mfma_f32_16x16x32_bf16 v[212:215], a[196:199], a[168:171], v[212:215]
v_mfma_f32_16x16x32_bf16 v[216:219], a[200:203], a[168:171], v[216:219]
v_mfma_f32_16x16x32_bf16 v[220:223], a[204:207], a[168:171], v[220:223]
v_mfma_f32_16x16x32_bf16 v[224:227], a[176:179], a[172:175], v[224:227]
v_mfma_f32_16x16x32_bf16 v[228:231], a[180:183], a[172:175], v[228:231]
v_mfma_f32_16x16x32_bf16 v[232:235], a[184:187], a[172:175], v[232:235]
v_mfma_f32_16x16x32_bf16 v[236:239], a[188:191], a[172:175], v[236:239]
v_mfma_f32_16x16x32_bf16 v[240:243], a[192:195], a[172:175], v[240:243]
v_mfma_f32_16x16x32_bf16 v[244:247], a[196:199], a[172:175], v[244:247]
v_mfma_f32_16x16x32_bf16 v[248:251], a[200:203], a[172:175], v[248:251]
v_mfma_f32_16x16x32_bf16 v[252:255], a[204:207], a[172:175], v[252:255]
s_add_u32 s66, s66, 32768
s_cmp_eq_u32 s72, 3
s_cselect_b32 s66, s75, s66
s_nop 7
v_mov_b32 v14, 1035512379
s_lshr_b32 s53, s48, 1
s_lshl_b32 s53, s53, 15
s_and_b32 s54, s48, 1
s_lshl_b32 s54, s54, 12
s_add_u32 s53, s53, s54
v_add_u32 v2, s53, v12
s_lshl_b32 s54, s100, 20
s_add_u32 s53, s53, s54
s_lshl_b32 s54, s101, 16
s_add_u32 s53, s53, s54
s_add_u32 s53, s53, 33554432
v_pk_mul_f32 v[128:129], v[128:129], v[14:15] op_sel_hi:[1,0]
v_pk_mul_f32 v[130:131], v[130:131], v[14:15] op_sel_hi:[1,0]
v_pk_mul_f32 v[132:133], v[132:133], v[14:15] op_sel_hi:[1,0]
v_pk_mul_f32 v[134:135], v[134:135], v[14:15] op_sel_hi:[1,0]
v_cvt_pk_bf16_f32 v128, v128, v129
v_cvt_pk_bf16_f32 v129, v130, v131
v_cvt_pk_bf16_f32 v130, v132, v133
v_cvt_pk_bf16_f32 v131, v134, v135
buffer_store_dwordx4 v[128:131], v12, s[20:23], s53 offen offset:0 sc0 sc1
ds_write_b128 v2, v[128:131] offset:0
v_pk_mul_f32 v[136:137], v[136:137], v[14:15] op_sel_hi:[1,0]
v_pk_mul_f32 v[138:139], v[138:139], v[14:15] op_sel_hi:[1,0]
v_pk_mul_f32 v[140:141], v[140:141], v[14:15] op_sel_hi:[1,0]
v_pk_mul_f32 v[142:143], v[142:143], v[14:15] op_sel_hi:[1,0]
v_cvt_pk_bf16_f32 v136, v136, v137
v_cvt_pk_bf16_f32 v137, v138, v139
v_cvt_pk_bf16_f32 v138, v140, v141
v_cvt_pk_bf16_f32 v139, v142, v143
buffer_store_dwordx4 v[136:139], v12, s[20:23], s53 offen offset:1024 sc0 sc1
ds_write_b128 v2, v[136:139] offset:1024
v_pk_mul_f32 v[144:145], v[144:145], v[14:15] op_sel_hi:[1,0]
v_pk_mul_f32 v[146:147], v[146:147], v[14:15] op_sel_hi:[1,0]
v_pk_mul_f32 v[148:149], v[148:149], v[14:15] op_sel_hi:[1,0]
v_pk_mul_f32 v[150:151], v[150:151], v[14:15] op_sel_hi:[1,0]
v_cvt_pk_bf16_f32 v144, v144, v145
v_cvt_pk_bf16_f32 v145, v146, v147
v_cvt_pk_bf16_f32 v146, v148, v149
v_cvt_pk_bf16_f32 v147, v150, v151
buffer_store_dwordx4 v[144:147], v12, s[20:23], s53 offen offset:2048 sc0 sc1
ds_write_b128 v2, v[144:147] offset:2048
v_pk_mul_f32 v[152:153], v[152:153], v[14:15] op_sel_hi:[1,0]
v_pk_mul_f32 v[154:155], v[154:155], v[14:15] op_sel_hi:[1,0]
v_pk_mul_f32 v[156:157], v[156:157], v[14:15] op_sel_hi:[1,0]
v_pk_mul_f32 v[158:159], v[158:159], v[14:15] op_sel_hi:[1,0]
v_cvt_pk_bf16_f32 v152, v152, v153
v_cvt_pk_bf16_f32 v153, v154, v155
v_cvt_pk_bf16_f32 v154, v156, v157
v_cvt_pk_bf16_f32 v155, v158, v159
buffer_store_dwordx4 v[152:155], v12, s[20:23], s53 offen offset:3072 sc0 sc1
ds_write_b128 v2, v[152:155] offset:3072
s_add_u32 s53, s53, 8192
v_pk_mul_f32 v[160:161], v[160:161], v[14:15] op_sel_hi:[1,0]
v_pk_mul_f32 v[162:163], v[162:163], v[14:15] op_sel_hi:[1,0]
v_pk_mul_f32 v[164:165], v[164:165], v[14:15] op_sel_hi:[1,0]
v_pk_mul_f32 v[166:167], v[166:167], v[14:15] op_sel_hi:[1,0]
v_cvt_pk_bf16_f32 v160, v160, v161
v_cvt_pk_bf16_f32 v161, v162, v163
v_cvt_pk_bf16_f32 v162, v164, v165
v_cvt_pk_bf16_f32 v163, v166, v167
buffer_store_dwordx4 v[160:163], v12, s[20:23], s53 offen offset:0 sc0 sc1
ds_write_b128 v2, v[160:163] offset:8192
v_pk_mul_f32 v[168:169], v[168:169], v[14:15] op_sel_hi:[1,0]
v_pk_mul_f32 v[170:171], v[170:171], v[14:15] op_sel_hi:[1,0]
v_pk_mul_f32 v[172:173], v[172:173], v[14:15] op_sel_hi:[1,0]
v_pk_mul_f32 v[174:175], v[174:175], v[14:15] op_sel_hi:[1,0]
v_cvt_pk_bf16_f32 v168, v168, v169
v_cvt_pk_bf16_f32 v169, v170, v171
v_cvt_pk_bf16_f32 v170, v172, v173
v_cvt_pk_bf16_f32 v171, v174, v175
buffer_store_dwordx4 v[168:171], v12, s[20:23], s53 offen offset:1024 sc0 sc1
ds_write_b128 v2, v[168:171] offset:9216
v_pk_mul_f32 v[176:177], v[176:177], v[14:15] op_sel_hi:[1,0]
v_pk_mul_f32 v[178:179], v[178:179], v[14:15] op_sel_hi:[1,0]
v_pk_mul_f32 v[180:181], v[180:181], v[14:15] op_sel_hi:[1,0]
v_pk_mul_f32 v[182:183], v[182:183], v[14:15] op_sel_hi:[1,0]
v_cvt_pk_bf16_f32 v176, v176, v177
v_cvt_pk_bf16_f32 v177, v178, v179
v_cvt_pk_bf16_f32 v178, v180, v181
v_cvt_pk_bf16_f32 v179, v182, v183
buffer_store_dwordx4 v[176:179], v12, s[20:23], s53 offen offset:2048 sc0 sc1
ds_write_b128 v2, v[176:179] offset:10240
v_pk_mul_f32 v[184:185], v[184:185], v[14:15] op_sel_hi:[1,0]
v_pk_mul_f32 v[186:187], v[186:187], v[14:15] op_sel_hi:[1,0]
v_pk_mul_f32 v[188:189], v[188:189], v[14:15] op_sel_hi:[1,0]
v_pk_mul_f32 v[190:191], v[190:191], v[14:15] op_sel_hi:[1,0]
v_cvt_pk_bf16_f32 v184, v184, v185
v_cvt_pk_bf16_f32 v185, v186, v187
v_cvt_pk_bf16_f32 v186, v188, v189
v_cvt_pk_bf16_f32 v187, v190, v191
buffer_store_dwordx4 v[184:187], v12, s[20:23], s53 offen offset:3072 sc0 sc1
ds_write_b128 v2, v[184:187] offset:11264
s_add_u32 s53, s53, 8192
v_pk_mul_f32 v[192:193], v[192:193], v[14:15] op_sel_hi:[1,0]
v_pk_mul_f32 v[194:195], v[194:195], v[14:15] op_sel_hi:[1,0]
v_pk_mul_f32 v[196:197], v[196:197], v[14:15] op_sel_hi:[1,0]
v_pk_mul_f32 v[198:199], v[198:199], v[14:15] op_sel_hi:[1,0]
v_cvt_pk_bf16_f32 v192, v192, v193
v_cvt_pk_bf16_f32 v193, v194, v195
v_cvt_pk_bf16_f32 v194, v196, v197
v_cvt_pk_bf16_f32 v195, v198, v199
buffer_store_dwordx4 v[192:195], v12, s[20:23], s53 offen offset:0 sc0 sc1
ds_write_b128 v2, v[192:195] offset:16384
v_pk_mul_f32 v[200:201], v[200:201], v[14:15] op_sel_hi:[1,0]
v_pk_mul_f32 v[202:203], v[202:203], v[14:15] op_sel_hi:[1,0]
v_pk_mul_f32 v[204:205], v[204:205], v[14:15] op_sel_hi:[1,0]
v_pk_mul_f32 v[206:207], v[206:207], v[14:15] op_sel_hi:[1,0]
v_cvt_pk_bf16_f32 v200, v200, v201
v_cvt_pk_bf16_f32 v201, v202, v203
v_cvt_pk_bf16_f32 v202, v204, v205
v_cvt_pk_bf16_f32 v203, v206, v207
buffer_store_dwordx4 v[200:203], v12, s[20:23], s53 offen offset:1024 sc0 sc1
ds_write_b128 v2, v[200:203] offset:17408
v_pk_mul_f32 v[208:209], v[208:209], v[14:15] op_sel_hi:[1,0]
v_pk_mul_f32 v[210:211], v[210:211], v[14:15] op_sel_hi:[1,0]
v_pk_mul_f32 v[212:213], v[212:213], v[14:15] op_sel_hi:[1,0]
v_pk_mul_f32 v[214:215], v[214:215], v[14:15] op_sel_hi:[1,0]
v_cvt_pk_bf16_f32 v208, v208, v209
v_cvt_pk_bf16_f32 v209, v210, v211
v_cvt_pk_bf16_f32 v210, v212, v213
v_cvt_pk_bf16_f32 v211, v214, v215
buffer_store_dwordx4 v[208:211], v12, s[20:23], s53 offen offset:2048 sc0 sc1
ds_write_b128 v2, v[208:211] offset:18432
v_pk_mul_f32 v[216:217], v[216:217], v[14:15] op_sel_hi:[1,0]
v_pk_mul_f32 v[218:219], v[218:219], v[14:15] op_sel_hi:[1,0]
v_pk_mul_f32 v[220:221], v[220:221], v[14:15] op_sel_hi:[1,0]
v_pk_mul_f32 v[222:223], v[222:223], v[14:15] op_sel_hi:[1,0]
v_cvt_pk_bf16_f32 v216, v216, v217
v_cvt_pk_bf16_f32 v217, v218, v219
v_cvt_pk_bf16_f32 v218, v220, v221
v_cvt_pk_bf16_f32 v219, v222, v223
buffer_store_dwordx4 v[216:219], v12, s[20:23], s53 offen offset:3072 sc0 sc1
ds_write_b128 v2, v[216:219] offset:19456
s_add_u32 s53, s53, 8192
v_pk_mul_f32 v[224:225], v[224:225], v[14:15] op_sel_hi:[1,0]
v_pk_mul_f32 v[226:227], v[226:227], v[14:15] op_sel_hi:[1,0]
v_pk_mul_f32 v[228:229], v[228:229], v[14:15] op_sel_hi:[1,0]
v_pk_mul_f32 v[230:231], v[230:231], v[14:15] op_sel_hi:[1,0]
v_cvt_pk_bf16_f32 v224, v224, v225
v_cvt_pk_bf16_f32 v225, v226, v227
v_cvt_pk_bf16_f32 v226, v228, v229
v_cvt_pk_bf16_f32 v227, v230, v231
buffer_store_dwordx4 v[224:227], v12, s[20:23], s53 offen offset:0 sc0 sc1
ds_write_b128 v2, v[224:227] offset:24576
v_pk_mul_f32 v[232:233], v[232:233], v[14:15] op_sel_hi:[1,0]
v_pk_mul_f32 v[234:235], v[234:235], v[14:15] op_sel_hi:[1,0]
v_pk_mul_f32 v[236:237], v[236:237], v[14:15] op_sel_hi:[1,0]
v_pk_mul_f32 v[238:239], v[238:239], v[14:15] op_sel_hi:[1,0]
v_cvt_pk_bf16_f32 v232, v232, v233
v_cvt_pk_bf16_f32 v233, v234, v235
v_cvt_pk_bf16_f32 v234, v236, v237
v_cvt_pk_bf16_f32 v235, v238, v239
buffer_store_dwordx4 v[232:235], v12, s[20:23], s53 offen offset:1024 sc0 sc1
ds_write_b128 v2, v[232:235] offset:25600
v_pk_mul_f32 v[240:241], v[240:241], v[14:15] op_sel_hi:[1,0]
v_pk_mul_f32 v[242:243], v[242:243], v[14:15] op_sel_hi:[1,0]
v_pk_mul_f32 v[244:245], v[244:245], v[14:15] op_sel_hi:[1,0]
v_pk_mul_f32 v[246:247], v[246:247], v[14:15] op_sel_hi:[1,0]
v_cvt_pk_bf16_f32 v240, v240, v241
v_cvt_pk_bf16_f32 v241, v242, v243
v_cvt_pk_bf16_f32 v242, v244, v245
v_cvt_pk_bf16_f32 v243, v246, v247
buffer_store_dwordx4 v[240:243], v12, s[20:23], s53 offen offset:2048 sc0 sc1
ds_write_b128 v2, v[240:243] offset:26624
v_pk_mul_f32 v[248:249], v[248:249], v[14:15] op_sel_hi:[1,0]
v_pk_mul_f32 v[250:251], v[250:251], v[14:15] op_sel_hi:[1,0]
v_pk_mul_f32 v[252:253], v[252:253], v[14:15] op_sel_hi:[1,0]
v_pk_mul_f32 v[254:255], v[254:255], v[14:15] op_sel_hi:[1,0]
v_cvt_pk_bf16_f32 v248, v248, v249
v_cvt_pk_bf16_f32 v249, v250, v251
v_cvt_pk_bf16_f32 v250, v252, v253
v_cvt_pk_bf16_f32 v251, v254, v255
buffer_store_dwordx4 v[248:251], v12, s[20:23], s53 offen offset:3072 sc0 sc1
ds_write_b128 v2, v[248:251] offset:27648
s_lshl_b32 s54, s48, 14
v_add_u32 v3, s54, v12
s_waitcnt lgkmcnt(0)
s_barrier
ds_read_b128 a[0:3], v3 offset:0
ds_read_b128 a[4:7], v3 offset:1024
ds_read_b128 a[8:11], v3 offset:2048
ds_read_b128 a[12:15], v3 offset:3072
ds_read_b128 a[16:19], v3 offset:4096
ds_read_b128 a[20:23], v3 offset:5120
ds_read_b128 a[24:27], v3 offset:6144
ds_read_b128 a[28:31], v3 offset:7168
ds_read_b128 a[32:35], v3 offset:8192
ds_read_b128 a[36:39], v3 offset:9216
ds_read_b128 a[40:43], v3 offset:10240
ds_read_b128 a[44:47], v3 offset:11264
ds_read_b128 a[48:51], v3 offset:12288
ds_read_b128 a[52:55], v3 offset:13312
ds_read_b128 a[56:59], v3 offset:14336
ds_read_b128 a[60:63], v3 offset:15360
s_add_u32 s68, s74, 32768
s_add_u32 s69, s74, 65536
s_add_u32 s70, s74, 98304
v_subrev_u32 v1, s74, v12
v_lshrrev_b32 v19, 4, v12
v_and_b32 v16, 15, v19
v_lshrrev_b32 v17, 4, v19
v_lshlrev_b32 v17, 2, v17
v_add_u32 v18, 0, v17
v_cmp_le_u32 s[32:33], v18, v16
v_add_u32 v18, 1, v17
v_cmp_le_u32 s[34:35], v18, v16
v_add_u32 v18, 2, v17
v_cmp_le_u32 s[36:37], v18, v16
v_add_u32 v18, 3, v17
v_cmp_le_u32 s[38:39], v18, v16
v_mbcnt_lo_u32_b32 v15, -1, 0
v_and_b32 v14, 6, v15
v_and_b32 v15, 1, v15
v_lshl_add_u32 v15, v14, 1, v15
v_lshlrev_b32 v15, 2, v15
s_waitcnt vmcnt(24) lgkmcnt(0)
s_barrier
s_add_u32 m0, s74, 0
s_nop 0
buffer_load_dwordx4 v12, s[12:15], s66 offen offset:0 sc1 lds
buffer_load_dwordx4 v12, s[12:15], s66 offen offset:1024 sc1 lds
buffer_load_dwordx4 v12, s[12:15], s66 offen offset:2048 sc1 lds
buffer_load_dwordx4 v12, s[12:15], s66 offen offset:3072 sc1 lds
s_add_u32 m0, s74, 16384
s_nop 0
buffer_load_dwordx4 v13, s[12:15], s66 offen offset:0 sc1 lds
buffer_load_dwordx4 v13, s[12:15], s66 offen offset:1024 sc1 lds
buffer_load_dwordx4 v13, s[12:15], s66 offen offset:2048 sc1 lds
buffer_load_dwordx4 v13, s[12:15], s66 offen offset:3072 sc1 lds
s_add_u32 s66, s66, 32768
s_cmp_eq_u32 s72, 4
s_cselect_b32 s66, s75, s66
s_branch L2_seg
LM_kvawait:
s_mov_b32 s53, 0
LM_kvaloop:
buffer_load_dword v14, v15, s[20:23], s99 offen sc0 sc1
s_add_u32 s53, s53, 1
s_waitcnt vmcnt(0)
s_cmp_gt_u32 s53, 200000
s_cbranch_scc1 LM_kvaret
v_cmp_ne_u32 vcc, s89, v14
s_cbranch_vccz LM_kvaret
s_sleep 2
s_branch LM_kvaloop
LM_qb:
s_waitcnt vmcnt(12) lgkmcnt(0)
s_barrier
v_mfma_f32_16x16x32_bf16 v[128:131], a[224:227], a[208:211], 0
v_mfma_f32_16x16x32_bf16 v[132:135], a[228:231], a[208:211], 0
ds_read_b64_tr_b16 a[176:177], v4 offset:16384
ds_read_b64_tr_b16 a[178:179], v4 offset:16896
s_add_u32 m0, s51, 0
v_mfma_f32_16x16x32_bf16 v[136:139], a[232:235], a[208:211], 0
buffer_load_dwordx4 v9, s[8:11], s40 offen lds
v_mfma_f32_16x16x32_bf16 v[140:143], a[236:239], a[208:211], 0
ds_read_b64_tr_b16 a[180:181], v5 offset:16384
v_mfma_f32_16x16x32_bf16 v[144:147], a[240:243], a[208:211], 0
ds_read_b64_tr_b16 a[182:183], v5 offset:16896
s_add_u32 m0, s51, 4096
v_mfma_f32_16x16x32_bf16 v[148:151], a[244:247], a[208:211], 0
buffer_load_dwordx4 v9, s[8:11], s41 offen lds
v_mfma_f32_16x16x32_bf16 v[152:155], a[248:251], a[208:211], 0
ds_read_b64_tr_b16 a[184:185], v6 offset:16384
v_mfma_f32_16x16x32_bf16 v[156:159], a[252:255], a[208:211], 0
ds_read_b64_tr_b16 a[186:187], v6 offset:16896
v_mfma_f32_16x16x32_bf16 v[160:163], a[224:227], a[212:215], 0
ds_read_b64_tr_b16 a[188:189], v7 offset:16384
s_add_u32 m0, s51, 8192
v_mfma_f32_16x16x32_bf16 v[164:167], a[228:231], a[212:215], 0
buffer_load_dwordx4 v9, s[8:11], s42 offen lds
ds_read_b64_tr_b16 a[190:191], v7 offset:16896
v_mfma_f32_16x16x32_bf16 v[168:171], a[232:235], a[212:215], 0
ds_read_b64_tr_b16 a[192:193], v4 offset:20480
s_add_u32 m0, s51, 12288
v_mfma_f32_16x16x32_bf16 v[172:175], a[236:239], a[212:215], 0
buffer_load_dwordx4 v9, s[8:11], s43 offen lds
v_mfma_f32_16x16x32_bf16 v[176:179], a[240:243], a[212:215], 0
ds_read_b64_tr_b16 a[194:195], v4 offset:20992
v_add_u32 v9, 262144, v9
v_mfma_f32_16x16x32_bf16 v[180:183], a[244:247], a[212:215], 0
ds_read_b64_tr_b16 a[196:197], v5 offset:20480
v_mfma_f32_16x16x32_bf16 v[184:187], a[248:251], a[212:215], 0
ds_read_b64_tr_b16 a[198:199], v5 offset:20992
s_add_u32 m0, s50, 0
v_mfma_f32_16x16x32_bf16 v[188:191], a[252:255], a[212:215], 0
buffer_load_dwordx4 v8, s[4:7], s24 offen lds
v_mfma_f32_16x16x32_bf16 v[192:195], a[224:227], a[216:219], 0
ds_read_b64_tr_b16 a[200:201], v6 offset:20480
v_mfma_f32_16x16x32_bf16 v[196:199], a[228:231], a[216:219], 0
ds_read_b64_tr_b16 a[202:203], v6 offset:20992
s_add_u32 m0, s50, 4096
s_nop 0
buffer_load_dwordx4 v8, s[4:7], s25 offen lds
v_mfma_f32_16x16x32_bf16 v[200:203], a[232:235], a[216:219], 0
ds_read_b64_tr_b16 a[204:205], v7 offset:20480
v_mfma_f32_16x16x32_bf16 v[204:207], a[236:239], a[216:219], 0
ds_read_b64_tr_b16 a[206:207], v7 offset:20992
v_mfma_f32_16x16x32_bf16 v[208:211], a[240:243], a[216:219], 0
ds_read_b128 a[160:163], v3 offset:0
s_add_u32 m0, s50, 8192
v_mfma_f32_16x16x32_bf16 v[212:215], a[244:247], a[216:219], 0
buffer_load_dwordx4 v8, s[4:7], s26 offen lds
v_mfma_f32_16x16x32_bf16 v[216:219], a[248:251], a[216:219], 0
ds_read_b128 a[164:167], v3 offset:2048
v_mfma_f32_16x16x32_bf16 v[220:223], a[252:255], a[216:219], 0
ds_read_b128 a[168:171], v3 offset:4096
s_add_u32 m0, s50, 12288
v_mfma_f32_16x16x32_bf16 v[224:227], a[224:227], a[220:223], 0
buffer_load_dwordx4 v8, s[4:7], s27 offen lds
v_mfma_f32_16x16x32_bf16 v[228:231], a[228:231], a[220:223], 0
ds_read_b128 a[172:175], v3 offset:6144
v_add_u32 v8, 128, v8
v_mfma_f32_16x16x32_bf16 v[232:235], a[232:235], a[220:223], 0
v_mfma_f32_16x16x32_bf16 v[236:239], a[236:239], a[220:223], 0
v_mfma_f32_16x16x32_bf16 v[240:243], a[240:243], a[220:223], 0
v_mfma_f32_16x16x32_bf16 v[244:247], a[244:247], a[220:223], 0
v_mfma_f32_16x16x32_bf16 v[248:251], a[248:251], a[220:223], 0
v_mfma_f32_16x16x32_bf16 v[252:255], a[252:255], a[220:223], 0
s_waitcnt vmcnt(12) lgkmcnt(0)
s_barrier
v_mfma_f32_16x16x32_bf16 v[128:131], a[176:179], a[160:163], v[128:131]
s_add_u32 s50, s49, s51
s_add_u32 s49, s49, 32768
s_cmp_eq_u32 s49, 163840
v_mfma_f32_16x16x32_bf16 v[132:135], a[180:183], a[160:163], v[132:135]
s_cselect_b32 s49, 65536, s49
v_add_u32 v2, s49, v1
v_xor_b32 v3, 64, v2
v_mfma_f32_16x16x32_bf16 v[136:139], a[184:187], a[160:163], v[136:139]
ds_read_b64_tr_b16 a[224:225], v4 offset:32768
v_mfma_f32_16x16x32_bf16 v[140:143], a[188:191], a[160:163], v[140:143]
ds_read_b64_tr_b16 a[226:227], v4 offset:33280
v_mfma_f32_16x16x32_bf16 v[144:147], a[192:195], a[160:163], v[144:147]
ds_read_b64_tr_b16 a[228:229], v5 offset:32768
v_mfma_f32_16x16x32_bf16 v[148:151], a[196:199], a[160:163], v[148:151]
ds_read_b64_tr_b16 a[230:231], v5 offset:33280
s_add_u32 m0, s51, 16384
v_mfma_f32_16x16x32_bf16 v[152:155], a[200:203], a[160:163], v[152:155]
buffer_load_dwordx4 v9, s[8:11], s40 offen lds
v_mfma_f32_16x16x32_bf16 v[156:159], a[204:207], a[160:163], v[156:159]
ds_read_b64_tr_b16 a[232:233], v6 offset:32768
v_mfma_f32_16x16x32_bf16 v[160:163], a[176:179], a[164:167], v[160:163]
ds_read_b64_tr_b16 a[234:235], v6 offset:33280
v_mfma_f32_16x16x32_bf16 v[164:167], a[180:183], a[164:167], v[164:167]
ds_read_b64_tr_b16 a[236:237], v7 offset:32768
v_mfma_f32_16x16x32_bf16 v[168:171], a[184:187], a[164:167], v[168:171]
ds_read_b64_tr_b16 a[238:239], v7 offset:33280
v_mfma_f32_16x16x32_bf16 v[172:175], a[188:191], a[164:167], v[172:175]
ds_read_b64_tr_b16 a[240:241], v4 offset:36864
s_add_u32 m0, s51, 20480
v_mfma_f32_16x16x32_bf16 v[176:179], a[192:195], a[164:167], v[176:179]
buffer_load_dwordx4 v9, s[8:11], s41 offen lds
v_mfma_f32_16x16x32_bf16 v[180:183], a[196:199], a[164:167], v[180:183]
ds_read_b64_tr_b16 a[242:243], v4 offset:37376
v_mfma_f32_16x16x32_bf16 v[184:187], a[200:203], a[164:167], v[184:187]
ds_read_b64_tr_b16 a[244:245], v5 offset:36864
v_mfma_f32_16x16x32_bf16 v[188:191], a[204:207], a[164:167], v[188:191]
ds_read_b64_tr_b16 a[246:247], v5 offset:37376
v_mfma_f32_16x16x32_bf16 v[192:195], a[176:179], a[168:171], v[192:195]
ds_read_b64_tr_b16 a[248:249], v6 offset:36864
v_mfma_f32_16x16x32_bf16 v[196:199], a[180:183], a[168:171], v[196:199]
ds_read_b64_tr_b16 a[250:251], v6 offset:37376
s_add_u32 m0, s51, 24576
v_mfma_f32_16x16x32_bf16 v[200:203], a[184:187], a[168:171], v[200:203]
buffer_load_dwordx4 v9, s[8:11], s42 offen lds
v_mfma_f32_16x16x32_bf16 v[204:207], a[188:191], a[168:171], v[204:207]
ds_read_b64_tr_b16 a[252:253], v7 offset:36864
v_mfma_f32_16x16x32_bf16 v[208:211], a[192:195], a[168:171], v[208:211]
ds_read_b64_tr_b16 a[254:255], v7 offset:37376
v_mfma_f32_16x16x32_bf16 v[212:215], a[196:199], a[168:171], v[212:215]
ds_read_b128 a[208:211], v2 offset:0
v_mfma_f32_16x16x32_bf16 v[216:219], a[200:203], a[168:171], v[216:219]
ds_read_b128 a[212:215], v2 offset:2048
v_mfma_f32_16x16x32_bf16 v[220:223], a[204:207], a[168:171], v[220:223]
ds_read_b128 a[216:219], v2 offset:4096
s_add_u32 m0, s51, 28672
v_mfma_f32_16x16x32_bf16 v[224:227], a[176:179], a[172:175], v[224:227]
buffer_load_dwordx4 v9, s[8:11], s43 offen lds
v_mfma_f32_16x16x32_bf16 v[228:231], a[180:183], a[172:175], v[228:231]
ds_read_b128 a[220:223], v2 offset:6144
v_add_u32 v9, 262144, v9
v_mfma_f32_16x16x32_bf16 v[232:235], a[184:187], a[172:175], v[232:235]
v_mfma_f32_16x16x32_bf16 v[236:239], a[188:191], a[172:175], v[236:239]
v_mfma_f32_16x16x32_bf16 v[240:243], a[192:195], a[172:175], v[240:243]
v_mfma_f32_16x16x32_bf16 v[244:247], a[196:199], a[172:175], v[244:247]
v_mfma_f32_16x16x32_bf16 v[248:251], a[200:203], a[172:175], v[248:251]
v_mfma_f32_16x16x32_bf16 v[252:255], a[204:207], a[172:175], v[252:255]
s_waitcnt vmcnt(12) lgkmcnt(0)
s_barrier
v_mfma_f32_16x16x32_bf16 v[128:131], a[224:227], a[208:211], v[128:131]
v_mfma_f32_16x16x32_bf16 v[132:135], a[228:231], a[208:211], v[132:135]
ds_read_b64_tr_b16 a[176:177], v4 offset:49152
ds_read_b64_tr_b16 a[178:179], v4 offset:49664
s_add_u32 m0, s51, 32768
v_mfma_f32_16x16x32_bf16 v[136:139], a[232:235], a[208:211], v[136:139]
buffer_load_dwordx4 v9, s[8:11], s40 offen lds
v_mfma_f32_16x16x32_bf16 v[140:143], a[236:239], a[208:211], v[140:143]
ds_read_b64_tr_b16 a[180:181], v5 offset:49152
v_mfma_f32_16x16x32_bf16 v[144:147], a[240:243], a[208:211], v[144:147]
ds_read_b64_tr_b16 a[182:183], v5 offset:49664
s_add_u32 m0, s51, 36864
v_mfma_f32_16x16x32_bf16 v[148:151], a[244:247], a[208:211], v[148:151]
buffer_load_dwordx4 v9, s[8:11], s41 offen lds
v_mfma_f32_16x16x32_bf16 v[152:155], a[248:251], a[208:211], v[152:155]
ds_read_b64_tr_b16 a[184:185], v6 offset:49152
v_mfma_f32_16x16x32_bf16 v[156:159], a[252:255], a[208:211], v[156:159]
ds_read_b64_tr_b16 a[186:187], v6 offset:49664
v_mfma_f32_16x16x32_bf16 v[160:163], a[224:227], a[212:215], v[160:163]
ds_read_b64_tr_b16 a[188:189], v7 offset:49152
s_add_u32 m0, s51, 40960
v_mfma_f32_16x16x32_bf16 v[164:167], a[228:231], a[212:215], v[164:167]
buffer_load_dwordx4 v9, s[8:11], s42 offen lds
ds_read_b64_tr_b16 a[190:191], v7 offset:49664
v_mfma_f32_16x16x32_bf16 v[168:171], a[232:235], a[212:215], v[168:171]
ds_read_b64_tr_b16 a[192:193], v4 offset:53248
s_add_u32 m0, s51, 45056
v_mfma_f32_16x16x32_bf16 v[172:175], a[236:239], a[212:215], v[172:175]
buffer_load_dwordx4 v9, s[8:11], s43 offen lds
v_mfma_f32_16x16x32_bf16 v[176:179], a[240:243], a[212:215], v[176:179]
ds_read_b64_tr_b16 a[194:195], v4 offset:53760
v_add_u32 v9, 262144, v9
v_mfma_f32_16x16x32_bf16 v[180:183], a[244:247], a[212:215], v[180:183]
ds_read_b64_tr_b16 a[196:197], v5 offset:53248
v_mfma_f32_16x16x32_bf16 v[184:187], a[248:251], a[212:215], v[184:187]
ds_read_b64_tr_b16 a[198:199], v5 offset:53760
s_add_u32 m0, s50, 0
v_mfma_f32_16x16x32_bf16 v[188:191], a[252:255], a[212:215], v[188:191]
buffer_load_dwordx4 v8, s[4:7], s24 offen lds
v_mfma_f32_16x16x32_bf16 v[192:195], a[224:227], a[216:219], v[192:195]
ds_read_b64_tr_b16 a[200:201], v6 offset:53248
v_mfma_f32_16x16x32_bf16 v[196:199], a[228:231], a[216:219], v[196:199]
ds_read_b64_tr_b16 a[202:203], v6 offset:53760
s_add_u32 m0, s50, 4096
s_nop 0
buffer_load_dwordx4 v8, s[4:7], s25 offen lds
v_mfma_f32_16x16x32_bf16 v[200:203], a[232:235], a[216:219], v[200:203]
ds_read_b64_tr_b16 a[204:205], v7 offset:53248
v_mfma_f32_16x16x32_bf16 v[204:207], a[236:239], a[216:219], v[204:207]
ds_read_b64_tr_b16 a[206:207], v7 offset:53760
v_mfma_f32_16x16x32_bf16 v[208:211], a[240:243], a[216:219], v[208:211]
ds_read_b128 a[160:163], v3 offset:0
s_add_u32 m0, s50, 8192
v_mfma_f32_16x16x32_bf16 v[212:215], a[244:247], a[216:219], v[212:215]
buffer_load_dwordx4 v8, s[4:7], s26 offen lds
v_mfma_f32_16x16x32_bf16 v[216:219], a[248:251], a[216:219], v[216:219]
ds_read_b128 a[164:167], v3 offset:2048
v_mfma_f32_16x16x32_bf16 v[220:223], a[252:255], a[216:219], v[220:223]
ds_read_b128 a[168:171], v3 offset:4096
s_add_u32 m0, s50, 12288
v_mfma_f32_16x16x32_bf16 v[224:227], a[224:227], a[220:223], v[224:227]
buffer_load_dwordx4 v8, s[4:7], s27 offen lds
v_mfma_f32_16x16x32_bf16 v[228:231], a[228:231], a[220:223], v[228:231]
ds_read_b128 a[172:175], v3 offset:6144
v_add_u32 v8, 128, v8
v_mfma_f32_16x16x32_bf16 v[232:235], a[232:235], a[220:223], v[232:235]
v_mfma_f32_16x16x32_bf16 v[236:239], a[236:239], a[220:223], v[236:239]
v_mfma_f32_16x16x32_bf16 v[240:243], a[240:243], a[220:223], v[240:243]
v_mfma_f32_16x16x32_bf16 v[244:247], a[244:247], a[220:223], v[244:247]
v_mfma_f32_16x16x32_bf16 v[248:251], a[248:251], a[220:223], v[248:251]
v_mfma_f32_16x16x32_bf16 v[252:255], a[252:255], a[220:223], v[252:255]
s_waitcnt vmcnt(12) lgkmcnt(0)
s_barrier
v_mfma_f32_16x16x32_bf16 v[128:131], a[176:179], a[160:163], v[128:131]
s_add_u32 s50, s49, s51
s_add_u32 s49, s49, 32768
s_cmp_eq_u32 s49, 163840
v_mfma_f32_16x16x32_bf16 v[132:135], a[180:183], a[160:163], v[132:135]
s_cselect_b32 s49, 65536, s49
v_add_u32 v2, s49, v1
v_xor_b32 v3, 64, v2
v_mfma_f32_16x16x32_bf16 v[136:139], a[184:187], a[160:163], v[136:139]
ds_read_b64_tr_b16 a[224:225], v4 offset:0
v_mfma_f32_16x16x32_bf16 v[140:143], a[188:191], a[160:163], v[140:143]
ds_read_b64_tr_b16 a[226:227], v4 offset:512
v_mfma_f32_16x16x32_bf16 v[144:147], a[192:195], a[160:163], v[144:147]
ds_read_b64_tr_b16 a[228:229], v5 offset:0
v_mfma_f32_16x16x32_bf16 v[148:151], a[196:199], a[160:163], v[148:151]
ds_read_b64_tr_b16 a[230:231], v5 offset:512
s_add_u32 m0, s51, 49152
v_mfma_f32_16x16x32_bf16 v[152:155], a[200:203], a[160:163], v[152:155]
buffer_load_dwordx4 v9, s[8:11], s40 offen lds
v_mfma_f32_16x16x32_bf16 v[156:159], a[204:207], a[160:163], v[156:159]
ds_read_b64_tr_b16 a[232:233], v6 offset:0
v_mfma_f32_16x16x32_bf16 v[160:163], a[176:179], a[164:167], v[160:163]
ds_read_b64_tr_b16 a[234:235], v6 offset:512
v_mfma_f32_16x16x32_bf16 v[164:167], a[180:183], a[164:167], v[164:167]
ds_read_b64_tr_b16 a[236:237], v7 offset:0
v_mfma_f32_16x16x32_bf16 v[168:171], a[184:187], a[164:167], v[168:171]
ds_read_b64_tr_b16 a[238:239], v7 offset:512
v_mfma_f32_16x16x32_bf16 v[172:175], a[188:191], a[164:167], v[172:175]
ds_read_b64_tr_b16 a[240:241], v4 offset:4096
s_add_u32 m0, s51, 53248
v_mfma_f32_16x16x32_bf16 v[176:179], a[192:195], a[164:167], v[176:179]
buffer_load_dwordx4 v9, s[8:11], s41 offen lds
v_mfma_f32_16x16x32_bf16 v[180:183], a[196:199], a[164:167], v[180:183]
ds_read_b64_tr_b16 a[242:243], v4 offset:4608
v_mfma_f32_16x16x32_bf16 v[184:187], a[200:203], a[164:167], v[184:187]
ds_read_b64_tr_b16 a[244:245], v5 offset:4096
v_mfma_f32_16x16x32_bf16 v[188:191], a[204:207], a[164:167], v[188:191]
ds_read_b64_tr_b16 a[246:247], v5 offset:4608
v_mfma_f32_16x16x32_bf16 v[192:195], a[176:179], a[168:171], v[192:195]
ds_read_b64_tr_b16 a[248:249], v6 offset:4096
v_mfma_f32_16x16x32_bf16 v[196:199], a[180:183], a[168:171], v[196:199]
ds_read_b64_tr_b16 a[250:251], v6 offset:4608
s_add_u32 m0, s51, 57344
v_mfma_f32_16x16x32_bf16 v[200:203], a[184:187], a[168:171], v[200:203]
buffer_load_dwordx4 v9, s[8:11], s42 offen lds
v_mfma_f32_16x16x32_bf16 v[204:207], a[188:191], a[168:171], v[204:207]
ds_read_b64_tr_b16 a[252:253], v7 offset:4096
v_mfma_f32_16x16x32_bf16 v[208:211], a[192:195], a[168:171], v[208:211]
ds_read_b64_tr_b16 a[254:255], v7 offset:4608
v_mfma_f32_16x16x32_bf16 v[212:215], a[196:199], a[168:171], v[212:215]
ds_read_b128 a[208:211], v2 offset:0
v_mfma_f32_16x16x32_bf16 v[216:219], a[200:203], a[168:171], v[216:219]
ds_read_b128 a[212:215], v2 offset:2048
v_mfma_f32_16x16x32_bf16 v[220:223], a[204:207], a[168:171], v[220:223]
ds_read_b128 a[216:219], v2 offset:4096
s_add_u32 m0, s51, 61440
v_mfma_f32_16x16x32_bf16 v[224:227], a[176:179], a[172:175], v[224:227]
buffer_load_dwordx4 v9, s[8:11], s43 offen lds
v_mfma_f32_16x16x32_bf16 v[228:231], a[180:183], a[172:175], v[228:231]
ds_read_b128 a[220:223], v2 offset:6144
v_add_u32 v9, 262144, v9
v_mfma_f32_16x16x32_bf16 v[232:235], a[184:187], a[172:175], v[232:235]
v_mfma_f32_16x16x32_bf16 v[236:239], a[188:191], a[172:175], v[236:239]
v_mfma_f32_16x16x32_bf16 v[240:243], a[192:195], a[172:175], v[240:243]
v_mfma_f32_16x16x32_bf16 v[244:247], a[196:199], a[172:175], v[244:247]
v_mfma_f32_16x16x32_bf16 v[248:251], a[200:203], a[172:175], v[248:251]
v_mfma_f32_16x16x32_bf16 v[252:255], a[204:207], a[172:175], v[252:255]
s_waitcnt vmcnt(12) lgkmcnt(0)
s_barrier
v_mfma_f32_16x16x32_bf16 v[128:131], a[224:227], a[208:211], v[128:131]
v_mfma_f32_16x16x32_bf16 v[132:135], a[228:231], a[208:211], v[132:135]
ds_read_b64_tr_b16 a[176:177], v4 offset:16384
ds_read_b64_tr_b16 a[178:179], v4 offset:16896
s_add_u32 m0, s51, 0
v_mfma_f32_16x16x32_bf16 v[136:139], a[232:235], a[208:211], v[136:139]
buffer_load_dwordx4 v9, s[8:11], s40 offen lds
v_mfma_f32_16x16x32_bf16 v[140:143], a[236:239], a[208:211], v[140:143]
ds_read_b64_tr_b16 a[180:181], v5 offset:16384
v_mfma_f32_16x16x32_bf16 v[144:147], a[240:243], a[208:211], v[144:147]
ds_read_b64_tr_b16 a[182:183], v5 offset:16896
s_add_u32 m0, s51, 4096
v_mfma_f32_16x16x32_bf16 v[148:151], a[244:247], a[208:211], v[148:151]
buffer_load_dwordx4 v9, s[8:11], s41 offen lds
v_mfma_f32_16x16x32_bf16 v[152:155], a[248:251], a[208:211], v[152:155]
ds_read_b64_tr_b16 a[184:185], v6 offset:16384
v_mfma_f32_16x16x32_bf16 v[156:159], a[252:255], a[208:211], v[156:159]
ds_read_b64_tr_b16 a[186:187], v6 offset:16896
v_mfma_f32_16x16x32_bf16 v[160:163], a[224:227], a[212:215], v[160:163]
ds_read_b64_tr_b16 a[188:189], v7 offset:16384
s_add_u32 m0, s51, 8192
v_mfma_f32_16x16x32_bf16 v[164:167], a[228:231], a[212:215], v[164:167]
buffer_load_dwordx4 v9, s[8:11], s42 offen lds
ds_read_b64_tr_b16 a[190:191], v7 offset:16896
v_mfma_f32_16x16x32_bf16 v[168:171], a[232:235], a[212:215], v[168:171]
ds_read_b64_tr_b16 a[192:193], v4 offset:20480
s_add_u32 m0, s51, 12288
v_mfma_f32_16x16x32_bf16 v[172:175], a[236:239], a[212:215], v[172:175]
buffer_load_dwordx4 v9, s[8:11], s43 offen lds
v_mfma_f32_16x16x32_bf16 v[176:179], a[240:243], a[212:215], v[176:179]
ds_read_b64_tr_b16 a[194:195], v4 offset:20992
v_add_u32 v9, 262144, v9
v_mfma_f32_16x16x32_bf16 v[180:183], a[244:247], a[212:215], v[180:183]
ds_read_b64_tr_b16 a[196:197], v5 offset:20480
v_mfma_f32_16x16x32_bf16 v[184:187], a[248:251], a[212:215], v[184:187]
ds_read_b64_tr_b16 a[198:199], v5 offset:20992
s_add_u32 m0, s50, 0
v_mfma_f32_16x16x32_bf16 v[188:191], a[252:255], a[212:215], v[188:191]
buffer_load_dwordx4 v8, s[4:7], s24 offen lds
v_mfma_f32_16x16x32_bf16 v[192:195], a[224:227], a[216:219], v[192:195]
ds_read_b64_tr_b16 a[200:201], v6 offset:20480
v_mfma_f32_16x16x32_bf16 v[196:199], a[228:231], a[216:219], v[196:199]
ds_read_b64_tr_b16 a[202:203], v6 offset:20992
s_add_u32 m0, s50, 4096
s_nop 0
buffer_load_dwordx4 v8, s[4:7], s25 offen lds
v_mfma_f32_16x16x32_bf16 v[200:203], a[232:235], a[216:219], v[200:203]
ds_read_b64_tr_b16 a[204:205], v7 offset:20480
v_mfma_f32_16x16x32_bf16 v[204:207], a[236:239], a[216:219], v[204:207]
ds_read_b64_tr_b16 a[206:207], v7 offset:20992
v_mfma_f32_16x16x32_bf16 v[208:211], a[240:243], a[216:219], v[208:211]
ds_read_b128 a[160:163], v3 offset:0
s_add_u32 m0, s50, 8192
v_mfma_f32_16x16x32_bf16 v[212:215], a[244:247], a[216:219], v[212:215]
buffer_load_dwordx4 v8, s[4:7], s26 offen lds
v_mfma_f32_16x16x32_bf16 v[216:219], a[248:251], a[216:219], v[216:219]
ds_read_b128 a[164:167], v3 offset:2048
v_mfma_f32_16x16x32_bf16 v[220:223], a[252:255], a[216:219], v[220:223]
ds_read_b128 a[168:171], v3 offset:4096
s_add_u32 m0, s50, 12288
v_mfma_f32_16x16x32_bf16 v[224:227], a[224:227], a[220:223], v[224:227]
buffer_load_dwordx4 v8, s[4:7], s27 offen lds
v_mfma_f32_16x16x32_bf16 v[228:231], a[228:231], a[220:223], v[228:231]
ds_read_b128 a[172:175], v3 offset:6144
v_add_u32 v8, 128, v8
v_mfma_f32_16x16x32_bf16 v[232:235], a[232:235], a[220:223], v[232:235]
v_mfma_f32_16x16x32_bf16 v[236:239], a[236:239], a[220:223], v[236:239]
v_mfma_f32_16x16x32_bf16 v[240:243], a[240:243], a[220:223], v[240:243]
v_mfma_f32_16x16x32_bf16 v[244:247], a[244:247], a[220:223], v[244:247]
v_mfma_f32_16x16x32_bf16 v[248:251], a[248:251], a[220:223], v[248:251]
v_mfma_f32_16x16x32_bf16 v[252:255], a[252:255], a[220:223], v[252:255]
s_waitcnt vmcnt(12) lgkmcnt(0)
s_barrier
v_mfma_f32_16x16x32_bf16 v[128:131], a[176:179], a[160:163], v[128:131]
s_add_u32 s50, s49, s51
s_add_u32 s49, s49, 32768
s_cmp_eq_u32 s49, 163840
v_mfma_f32_16x16x32_bf16 v[132:135], a[180:183], a[160:163], v[132:135]
s_cselect_b32 s49, 65536, s49
v_add_u32 v2, s49, v1
v_xor_b32 v3, 64, v2
v_mfma_f32_16x16x32_bf16 v[136:139], a[184:187], a[160:163], v[136:139]
ds_read_b64_tr_b16 a[224:225], v4 offset:32768
v_mfma_f32_16x16x32_bf16 v[140:143], a[188:191], a[160:163], v[140:143]
ds_read_b64_tr_b16 a[226:227], v4 offset:33280
v_mfma_f32_16x16x32_bf16 v[144:147], a[192:195], a[160:163], v[144:147]
ds_read_b64_tr_b16 a[228:229], v5 offset:32768
v_mfma_f32_16x16x32_bf16 v[148:151], a[196:199], a[160:163], v[148:151]
ds_read_b64_tr_b16 a[230:231], v5 offset:33280
s_add_u32 m0, s51, 16384
v_mfma_f32_16x16x32_bf16 v[152:155], a[200:203], a[160:163], v[152:155]
buffer_load_dwordx4 v9, s[8:11], s40 offen lds
v_mfma_f32_16x16x32_bf16 v[156:159], a[204:207], a[160:163], v[156:159]
ds_read_b64_tr_b16 a[232:233], v6 offset:32768
v_mfma_f32_16x16x32_bf16 v[160:163], a[176:179], a[164:167], v[160:163]
ds_read_b64_tr_b16 a[234:235], v6 offset:33280
v_mfma_f32_16x16x32_bf16 v[164:167], a[180:183], a[164:167], v[164:167]
ds_read_b64_tr_b16 a[236:237], v7 offset:32768
v_mfma_f32_16x16x32_bf16 v[168:171], a[184:187], a[164:167], v[168:171]
ds_read_b64_tr_b16 a[238:239], v7 offset:33280
v_mfma_f32_16x16x32_bf16 v[172:175], a[188:191], a[164:167], v[172:175]
ds_read_b64_tr_b16 a[240:241], v4 offset:36864
s_add_u32 m0, s51, 20480
v_mfma_f32_16x16x32_bf16 v[176:179], a[192:195], a[164:167], v[176:179]
buffer_load_dwordx4 v9, s[8:11], s41 offen lds
v_mfma_f32_16x16x32_bf16 v[180:183], a[196:199], a[164:167], v[180:183]
ds_read_b64_tr_b16 a[242:243], v4 offset:37376
v_mfma_f32_16x16x32_bf16 v[184:187], a[200:203], a[164:167], v[184:187]
ds_read_b64_tr_b16 a[244:245], v5 offset:36864
v_mfma_f32_16x16x32_bf16 v[188:191], a[204:207], a[164:167], v[188:191]
ds_read_b64_tr_b16 a[246:247], v5 offset:37376
v_mfma_f32_16x16x32_bf16 v[192:195], a[176:179], a[168:171], v[192:195]
ds_read_b64_tr_b16 a[248:249], v6 offset:36864
v_mfma_f32_16x16x32_bf16 v[196:199], a[180:183], a[168:171], v[196:199]
ds_read_b64_tr_b16 a[250:251], v6 offset:37376
s_add_u32 m0, s51, 24576
v_mfma_f32_16x16x32_bf16 v[200:203], a[184:187], a[168:171], v[200:203]
buffer_load_dwordx4 v9, s[8:11], s42 offen lds
v_mfma_f32_16x16x32_bf16 v[204:207], a[188:191], a[168:171], v[204:207]
ds_read_b64_tr_b16 a[252:253], v7 offset:36864
v_mfma_f32_16x16x32_bf16 v[208:211], a[192:195], a[168:171], v[208:211]
ds_read_b64_tr_b16 a[254:255], v7 offset:37376
v_mfma_f32_16x16x32_bf16 v[212:215], a[196:199], a[168:171], v[212:215]
ds_read_b128 a[208:211], v2 offset:0
v_mfma_f32_16x16x32_bf16 v[216:219], a[200:203], a[168:171], v[216:219]
ds_read_b128 a[212:215], v2 offset:2048
v_mfma_f32_16x16x32_bf16 v[220:223], a[204:207], a[168:171], v[220:223]
ds_read_b128 a[216:219], v2 offset:4096
s_add_u32 m0, s51, 28672
v_mfma_f32_16x16x32_bf16 v[224:227], a[176:179], a[172:175], v[224:227]
buffer_load_dwordx4 v9, s[8:11], s43 offen lds
v_mfma_f32_16x16x32_bf16 v[228:231], a[180:183], a[172:175], v[228:231]
ds_read_b128 a[220:223], v2 offset:6144
v_add_u32 v9, 262144, v9
v_mfma_f32_16x16x32_bf16 v[232:235], a[184:187], a[172:175], v[232:235]
v_mfma_f32_16x16x32_bf16 v[236:239], a[188:191], a[172:175], v[236:239]
v_mfma_f32_16x16x32_bf16 v[240:243], a[192:195], a[172:175], v[240:243]
v_mfma_f32_16x16x32_bf16 v[244:247], a[196:199], a[172:175], v[244:247]
v_mfma_f32_16x16x32_bf16 v[248:251], a[200:203], a[172:175], v[248:251]
v_mfma_f32_16x16x32_bf16 v[252:255], a[204:207], a[172:175], v[252:255]
s_waitcnt vmcnt(12) lgkmcnt(0)
s_barrier
v_mfma_f32_16x16x32_bf16 v[128:131], a[224:227], a[208:211], v[128:131]
v_mfma_f32_16x16x32_bf16 v[132:135], a[228:231], a[208:211], v[132:135]
ds_read_b64_tr_b16 a[176:177], v4 offset:49152
ds_read_b64_tr_b16 a[178:179], v4 offset:49664
s_add_u32 m0, s51, 32768
v_mfma_f32_16x16x32_bf16 v[136:139], a[232:235], a[208:211], v[136:139]
buffer_load_dwordx4 v9, s[8:11], s40 offen lds
v_mfma_f32_16x16x32_bf16 v[140:143], a[236:239], a[208:211], v[140:143]
ds_read_b64_tr_b16 a[180:181], v5 offset:49152
v_mfma_f32_16x16x32_bf16 v[144:147], a[240:243], a[208:211], v[144:147]
ds_read_b64_tr_b16 a[182:183], v5 offset:49664
s_add_u32 m0, s51, 36864
v_mfma_f32_16x16x32_bf16 v[148:151], a[244:247], a[208:211], v[148:151]
buffer_load_dwordx4 v9, s[8:11], s41 offen lds
v_mfma_f32_16x16x32_bf16 v[152:155], a[248:251], a[208:211], v[152:155]
ds_read_b64_tr_b16 a[184:185], v6 offset:49152
v_mfma_f32_16x16x32_bf16 v[156:159], a[252:255], a[208:211], v[156:159]
ds_read_b64_tr_b16 a[186:187], v6 offset:49664
s_add_u32 m0, s51, 40960
s_nop 0
buffer_load_dwordx4 v9, s[8:11], s42 offen lds
v_mfma_f32_16x16x32_bf16 v[160:163], a[224:227], a[212:215], v[160:163]
ds_read_b64_tr_b16 a[188:189], v7 offset:49152
v_mfma_f32_16x16x32_bf16 v[164:167], a[228:231], a[212:215], v[164:167]
ds_read_b64_tr_b16 a[190:191], v7 offset:49664
s_add_u32 m0, s51, 45056
v_mfma_f32_16x16x32_bf16 v[168:171], a[232:235], a[212:215], v[168:171]
buffer_load_dwordx4 v9, s[8:11], s43 offen lds
v_mfma_f32_16x16x32_bf16 v[172:175], a[236:239], a[212:215], v[172:175]
ds_read_b64_tr_b16 a[192:193], v4 offset:53248
v_add_u32 v9, 262144, v9
v_mfma_f32_16x16x32_bf16 v[176:179], a[240:243], a[212:215], v[176:179]
ds_read_b64_tr_b16 a[194:195], v4 offset:53760
v_mfma_f32_16x16x32_bf16 v[180:183], a[244:247], a[212:215], v[180:183]
ds_read_b64_tr_b16 a[196:197], v5 offset:53248
s_add_u32 m0, s50, 0
s_nop 0
buffer_load_dwordx4 v8, s[4:7], s24 offen lds
v_mfma_f32_16x16x32_bf16 v[184:187], a[248:251], a[212:215], v[184:187]
ds_read_b64_tr_b16 a[198:199], v5 offset:53760
v_mfma_f32_16x16x32_bf16 v[188:191], a[252:255], a[212:215], v[188:191]
ds_read_b64_tr_b16 a[200:201], v6 offset:53248
s_add_u32 m0, s50, 4096
v_mfma_f32_16x16x32_bf16 v[192:195], a[224:227], a[216:219], v[192:195]
buffer_load_dwordx4 v8, s[4:7], s25 offen lds
v_mfma_f32_16x16x32_bf16 v[196:199], a[228:231], a[216:219], v[196:199]
ds_read_b64_tr_b16 a[202:203], v6 offset:53760
v_mfma_f32_16x16x32_bf16 v[200:203], a[232:235], a[216:219], v[200:203]
ds_read_b64_tr_b16 a[204:205], v7 offset:53248
s_add_u32 m0, s50, 8192
v_mfma_f32_16x16x32_bf16 v[204:207], a[236:239], a[216:219], v[204:207]
buffer_load_dwordx4 v8, s[4:7], s26 offen lds
ds_read_b64_tr_b16 a[206:207], v7 offset:53760
v_mfma_f32_16x16x32_bf16 v[208:211], a[240:243], a[216:219], v[208:211]
ds_read_b128 a[160:163], v3 offset:0
s_add_u32 m0, s50, 12288
v_mfma_f32_16x16x32_bf16 v[212:215], a[244:247], a[216:219], v[212:215]
buffer_load_dwordx4 v8, s[4:7], s27 offen lds
v_mfma_f32_16x16x32_bf16 v[216:219], a[248:251], a[216:219], v[216:219]
ds_read_b128 a[164:167], v3 offset:2048
v_add_u32 v8, 128, v8
v_mfma_f32_16x16x32_bf16 v[220:223], a[252:255], a[216:219], v[220:223]
ds_read_b128 a[168:171], v3 offset:4096
v_mfma_f32_16x16x32_bf16 v[224:227], a[224:227], a[220:223], v[224:227]
buffer_load_dword v14, v15, s[20:23], s99 offen sc0 sc1
v_mfma_f32_16x16x32_bf16 v[228:231], a[228:231], a[220:223], v[228:231]
ds_read_b128 a[172:175], v3 offset:6144
v_mfma_f32_16x16x32_bf16 v[232:235], a[232:235], a[220:223], v[232:235]
v_mfma_f32_16x16x32_bf16 v[236:239], a[236:239], a[220:223], v[236:239]
v_mfma_f32_16x16x32_bf16 v[240:243], a[240:243], a[220:223], v[240:243]
v_mfma_f32_16x16x32_bf16 v[244:247], a[244:247], a[220:223], v[244:247]
v_mfma_f32_16x16x32_bf16 v[248:251], a[248:251], a[220:223], v[248:251]
v_mfma_f32_16x16x32_bf16 v[252:255], a[252:255], a[220:223], v[252:255]
s_waitcnt vmcnt(13) lgkmcnt(0)
s_barrier
v_mfma_f32_16x16x32_bf16 v[128:131], a[176:179], a[160:163], v[128:131]
s_add_u32 s50, s49, s51
s_add_u32 s49, s49, 32768
s_cmp_eq_u32 s49, 163840
v_mfma_f32_16x16x32_bf16 v[132:135], a[180:183], a[160:163], v[132:135]
s_cselect_b32 s49, 65536, s49
v_add_u32 v2, s49, v1
v_xor_b32 v3, 64, v2
v_mfma_f32_16x16x32_bf16 v[136:139], a[184:187], a[160:163], v[136:139]
ds_read_b64_tr_b16 a[224:225], v4 offset:0
ds_read_b64_tr_b16 a[226:227], v4 offset:512
v_mfma_f32_16x16x32_bf16 v[140:143], a[188:191], a[160:163], v[140:143]
ds_read_b64_tr_b16 a[228:229], v5 offset:0
s_add_u32 m0, s51, 49152
v_mfma_f32_16x16x32_bf16 v[144:147], a[192:195], a[160:163], v[144:147]
buffer_load_dwordx4 v9, s[8:11], s40 offen lds
v_mfma_f32_16x16x32_bf16 v[148:151], a[196:199], a[160:163], v[148:151]
ds_read_b64_tr_b16 a[230:231], v5 offset:512
v_mfma_f32_16x16x32_bf16 v[152:155], a[200:203], a[160:163], v[152:155]
ds_read_b64_tr_b16 a[232:233], v6 offset:0
v_mfma_f32_16x16x32_bf16 v[156:159], a[204:207], a[160:163], v[156:159]
ds_read_b64_tr_b16 a[234:235], v6 offset:512
v_mfma_f32_16x16x32_bf16 v[160:163], a[176:179], a[164:167], v[160:163]
ds_read_b64_tr_b16 a[236:237], v7 offset:0
s_add_u32 m0, s51, 53248
v_mfma_f32_16x16x32_bf16 v[164:167], a[180:183], a[164:167], v[164:167]
buffer_load_dwordx4 v9, s[8:11], s41 offen lds
v_mfma_f32_16x16x32_bf16 v[168:171], a[184:187], a[164:167], v[168:171]
ds_read_b64_tr_b16 a[238:239], v7 offset:512
v_mfma_f32_16x16x32_bf16 v[172:175], a[188:191], a[164:167], v[172:175]
ds_read_b64_tr_b16 a[240:241], v4 offset:4096
v_mfma_f32_16x16x32_bf16 v[176:179], a[192:195], a[164:167], v[176:179]
ds_read_b64_tr_b16 a[242:243], v4 offset:4608
v_mfma_f32_16x16x32_bf16 v[180:183], a[196:199], a[164:167], v[180:183]
ds_read_b64_tr_b16 a[244:245], v5 offset:4096
s_add_u32 m0, s51, 57344
v_mfma_f32_16x16x32_bf16 v[184:187], a[200:203], a[164:167], v[184:187]
buffer_load_dwordx4 v9, s[8:11], s42 offen lds
v_mfma_f32_16x16x32_bf16 v[188:191], a[204:207], a[164:167], v[188:191]
ds_read_b64_tr_b16 a[246:247], v5 offset:4608
v_mfma_f32_16x16x32_bf16 v[192:195], a[176:179], a[168:171], v[192:195]
ds_read_b64_tr_b16 a[248:249], v6 offset:4096
v_mfma_f32_16x16x32_bf16 v[196:199], a[180:183], a[168:171], v[196:199]
ds_read_b64_tr_b16 a[250:251], v6 offset:4608
v_mfma_f32_16x16x32_bf16 v[200:203], a[184:187], a[168:171], v[200:203]
ds_read_b64_tr_b16 a[252:253], v7 offset:4096
s_add_u32 m0, s51, 61440
v_mfma_f32_16x16x32_bf16 v[204:207], a[188:191], a[168:171], v[204:207]
buffer_load_dwordx4 v9, s[8:11], s43 offen lds
v_mfma_f32_16x16x32_bf16 v[208:211], a[192:195], a[168:171], v[208:211]
ds_read_b64_tr_b16 a[254:255], v7 offset:4608
v_add_u32 v9, 262144, v9
v_mfma_f32_16x16x32_bf16 v[212:215], a[196:199], a[168:171], v[212:215]
ds_read_b128 a[208:211], v2 offset:0
v_mfma_f32_16x16x32_bf16 v[216:219], a[200:203], a[168:171], v[216:219]
ds_read_b128 a[212:215], v2 offset:2048
v_mfma_f32_16x16x32_bf16 v[220:223], a[204:207], a[168:171], v[220:223]
ds_read_b128 a[216:219], v2 offset:4096
v_mfma_f32_16x16x32_bf16 v[224:227], a[176:179], a[172:175], v[224:227]
buffer_load_dword v16, v17, s[20:23], s97 offen sc0 sc1
v_mfma_f32_16x16x32_bf16 v[228:231], a[180:183], a[172:175], v[228:231]
ds_read_b128 a[220:223], v2 offset:6144
v_mfma_f32_16x16x32_bf16 v[232:235], a[184:187], a[172:175], v[232:235]
v_mfma_f32_16x16x32_bf16 v[236:239], a[188:191], a[172:175], v[236:239]
v_mfma_f32_16x16x32_bf16 v[240:243], a[192:195], a[172:175], v[240:243]
v_mfma_f32_16x16x32_bf16 v[244:247], a[196:199], a[172:175], v[244:247]
v_mfma_f32_16x16x32_bf16 v[248:251], a[200:203], a[172:175], v[248:251]
v_mfma_f32_16x16x32_bf16 v[252:255], a[204:207], a[172:175], v[252:255]
s_waitcnt vmcnt(14) lgkmcnt(0)
s_barrier
v_mfma_f32_16x16x32_bf16 v[128:131], a[224:227], a[208:211], v[128:131]
v_mfma_f32_16x16x32_bf16 v[132:135], a[228:231], a[208:211], v[132:135]
ds_read_b64_tr_b16 a[176:177], v4 offset:16384
ds_read_b64_tr_b16 a[178:179], v4 offset:16896
s_add_u32 m0, s51, 0
v_mfma_f32_16x16x32_bf16 v[136:139], a[232:235], a[208:211], v[136:139]
buffer_load_dwordx4 v9, s[8:11], s40 offen lds
v_mfma_f32_16x16x32_bf16 v[140:143], a[236:239], a[208:211], v[140:143]
ds_read_b64_tr_b16 a[180:181], v5 offset:16384
v_mfma_f32_16x16x32_bf16 v[144:147], a[240:243], a[208:211], v[144:147]
ds_read_b64_tr_b16 a[182:183], v5 offset:16896
s_add_u32 m0, s51, 4096
v_mfma_f32_16x16x32_bf16 v[148:151], a[244:247], a[208:211], v[148:151]
buffer_load_dwordx4 v9, s[8:11], s41 offen lds
v_mfma_f32_16x16x32_bf16 v[152:155], a[248:251], a[208:211], v[152:155]
ds_read_b64_tr_b16 a[184:185], v6 offset:16384
v_mfma_f32_16x16x32_bf16 v[156:159], a[252:255], a[208:211], v[156:159]
ds_read_b64_tr_b16 a[186:187], v6 offset:16896
v_mfma_f32_16x16x32_bf16 v[160:163], a[224:227], a[212:215], v[160:163]
ds_read_b64_tr_b16 a[188:189], v7 offset:16384
s_add_u32 m0, s51, 8192
v_mfma_f32_16x16x32_bf16 v[164:167], a[228:231], a[212:215], v[164:167]
buffer_load_dwordx4 v9, s[8:11], s42 offen lds
ds_read_b64_tr_b16 a[190:191], v7 offset:16896
v_mfma_f32_16x16x32_bf16 v[168:171], a[232:235], a[212:215], v[168:171]
ds_read_b64_tr_b16 a[192:193], v4 offset:20480
s_add_u32 m0, s51, 12288
v_mfma_f32_16x16x32_bf16 v[172:175], a[236:239], a[212:215], v[172:175]
buffer_load_dwordx4 v9, s[8:11], s43 offen lds
v_mfma_f32_16x16x32_bf16 v[176:179], a[240:243], a[212:215], v[176:179]
ds_read_b64_tr_b16 a[194:195], v4 offset:20992
v_add_u32 v9, 262144, v9
v_mfma_f32_16x16x32_bf16 v[180:183], a[244:247], a[212:215], v[180:183]
ds_read_b64_tr_b16 a[196:197], v5 offset:20480
v_mfma_f32_16x16x32_bf16 v[184:187], a[248:251], a[212:215], v[184:187]
ds_read_b64_tr_b16 a[198:199], v5 offset:20992
s_add_u32 m0, s50, 0
v_mfma_f32_16x16x32_bf16 v[188:191], a[252:255], a[212:215], v[188:191]
buffer_load_dwordx4 v8, s[4:7], s24 offen lds
v_mfma_f32_16x16x32_bf16 v[192:195], a[224:227], a[216:219], v[192:195]
ds_read_b64_tr_b16 a[200:201], v6 offset:20480
v_mfma_f32_16x16x32_bf16 v[196:199], a[228:231], a[216:219], v[196:199]
ds_read_b64_tr_b16 a[202:203], v6 offset:20992
s_add_u32 m0, s50, 4096
s_nop 0
buffer_load_dwordx4 v8, s[4:7], s25 offen lds
v_mfma_f32_16x16x32_bf16 v[200:203], a[232:235], a[216:219], v[200:203]
ds_read_b64_tr_b16 a[204:205], v7 offset:20480
v_mfma_f32_16x16x32_bf16 v[204:207], a[236:239], a[216:219], v[204:207]
ds_read_b64_tr_b16 a[206:207], v7 offset:20992
v_mfma_f32_16x16x32_bf16 v[208:211], a[240:243], a[216:219], v[208:211]
ds_read_b128 a[160:163], v3 offset:0
s_add_u32 m0, s50, 8192
v_mfma_f32_16x16x32_bf16 v[212:215], a[244:247], a[216:219], v[212:215]
buffer_load_dwordx4 v8, s[4:7], s26 offen lds
v_mfma_f32_16x16x32_bf16 v[216:219], a[248:251], a[216:219], v[216:219]
ds_read_b128 a[164:167], v3 offset:2048
v_mfma_f32_16x16x32_bf16 v[220:223], a[252:255], a[216:219], v[220:223]
ds_read_b128 a[168:171], v3 offset:4096
s_add_u32 m0, s50, 12288
v_mfma_f32_16x16x32_bf16 v[224:227], a[224:227], a[220:223], v[224:227]
buffer_load_dwordx4 v8, s[4:7], s27 offen lds
v_mfma_f32_16x16x32_bf16 v[228:231], a[228:231], a[220:223], v[228:231]
ds_read_b128 a[172:175], v3 offset:6144
v_add_u32 v8, 128, v8
v_mfma_f32_16x16x32_bf16 v[232:235], a[232:235], a[220:223], v[232:235]
v_mfma_f32_16x16x32_bf16 v[236:239], a[236:239], a[220:223], v[236:239]
v_mfma_f32_16x16x32_bf16 v[240:243], a[240:243], a[220:223], v[240:243]
v_mfma_f32_16x16x32_bf16 v[244:247], a[244:247], a[220:223], v[244:247]
v_mfma_f32_16x16x32_bf16 v[248:251], a[248:251], a[220:223], v[248:251]
v_mfma_f32_16x16x32_bf16 v[252:255], a[252:255], a[220:223], v[252:255]
s_waitcnt vmcnt(13) lgkmcnt(0)
v_cmp_ne_u32 vcc, s89, v14
s_cbranch_vccnz LM_kvbwait
LM_kvbret:
s_barrier
v_mfma_f32_16x16x32_bf16 v[128:131], a[176:179], a[160:163], v[128:131]
s_add_u32 s50, s49, s51
s_add_u32 s49, s49, 32768
s_cmp_eq_u32 s49, 163840
v_mfma_f32_16x16x32_bf16 v[132:135], a[180:183], a[160:163], v[132:135]
s_cselect_b32 s49, 65536, s49
v_add_u32 v2, s49, v1
v_xor_b32 v3, 64, v2
v_mfma_f32_16x16x32_bf16 v[136:139], a[184:187], a[160:163], v[136:139]
ds_read_b64_tr_b16 a[224:225], v4 offset:32768
s_add_u32 m0, s51, 16384
s_nop 0
buffer_load_dwordx4 v9, s[8:11], s40 offen lds
v_mfma_f32_16x16x32_bf16 v[140:143], a[188:191], a[160:163], v[140:143]
ds_read_b64_tr_b16 a[226:227], v4 offset:33280
v_mfma_f32_16x16x32_bf16 v[144:147], a[192:195], a[160:163], v[144:147]
ds_read_b64_tr_b16 a[228:229], v5 offset:32768
s_add_u32 m0, s51, 20480
v_mfma_f32_16x16x32_bf16 v[148:151], a[196:199], a[160:163], v[148:151]
buffer_load_dwordx4 v9, s[8:11], s41 offen lds
ds_read_b64_tr_b16 a[230:231], v5 offset:33280
s_add_u32 m0, s51, 24576
v_mfma_f32_16x16x32_bf16 v[152:155], a[200:203], a[160:163], v[152:155]
buffer_load_dwordx4 v9, s[8:11], s42 offen lds
v_mfma_f32_16x16x32_bf16 v[156:159], a[204:207], a[160:163], v[156:159]
ds_read_b64_tr_b16 a[232:233], v6 offset:32768
v_mfma_f32_16x16x32_bf16 v[160:163], a[176:179], a[164:167], v[160:163]
ds_read_b64_tr_b16 a[234:235], v6 offset:33280
s_add_u32 m0, s51, 28672
s_nop 0
buffer_load_dwordx4 v9, s[8:11], s43 offen lds
v_mfma_f32_16x16x32_bf16 v[164:167], a[180:183], a[164:167], v[164:167]
ds_read_b64_tr_b16 a[236:237], v7 offset:32768
v_add_u32 v9, 262144, v9
v_mfma_f32_16x16x32_bf16 v[168:171], a[184:187], a[164:167], v[168:171]
ds_read_b64_tr_b16 a[238:239], v7 offset:33280
s_add_u32 m0, s74, 65536
v_mfma_f32_16x16x32_bf16 v[172:175], a[188:191], a[164:167], v[172:175]
buffer_load_dwordx4 v12, s[12:15], s66 offen offset:0 sc1 lds
ds_read_b64_tr_b16 a[240:241], v4 offset:36864
v_mfma_f32_16x16x32_bf16 v[176:179], a[192:195], a[164:167], v[176:179]
buffer_load_dwordx4 v12, s[12:15], s66 offen offset:1024 sc1 lds
v_mfma_f32_16x16x32_bf16 v[180:183], a[196:199], a[164:167], v[180:183]
ds_read_b64_tr_b16 a[242:243], v4 offset:37376
v_mfma_f32_16x16x32_bf16 v[184:187], a[200:203], a[164:167], v[184:187]
ds_read_b64_tr_b16 a[244:245], v5 offset:36864
buffer_load_dwordx4 v12, s[12:15], s66 offen offset:2048 sc1 lds
v_mfma_f32_16x16x32_bf16 v[188:191], a[204:207], a[164:167], v[188:191]
ds_read_b64_tr_b16 a[246:247], v5 offset:37376
v_mfma_f32_16x16x32_bf16 v[192:195], a[176:179], a[168:171], v[192:195]
ds_read_b64_tr_b16 a[248:249], v6 offset:36864
v_mfma_f32_16x16x32_bf16 v[196:199], a[180:183], a[168:171], v[196:199]
buffer_load_dwordx4 v12, s[12:15], s66 offen offset:3072 sc1 lds
ds_read_b64_tr_b16 a[250:251], v6 offset:37376
s_add_u32 m0, s74, 81920
v_mfma_f32_16x16x32_bf16 v[200:203], a[184:187], a[168:171], v[200:203]
buffer_load_dwordx4 v13, s[12:15], s66 offen offset:0 sc1 lds
v_mfma_f32_16x16x32_bf16 v[204:207], a[188:191], a[168:171], v[204:207]
ds_read_b64_tr_b16 a[252:253], v7 offset:36864
v_mfma_f32_16x16x32_bf16 v[208:211], a[192:195], a[168:171], v[208:211]
ds_read_b64_tr_b16 a[254:255], v7 offset:37376
buffer_load_dwordx4 v13, s[12:15], s66 offen offset:1024 sc1 lds
v_mfma_f32_16x16x32_bf16 v[212:215], a[196:199], a[168:171], v[212:215]
ds_read_b128 a[208:211], v2 offset:0
v_mfma_f32_16x16x32_bf16 v[216:219], a[200:203], a[168:171], v[216:219]
ds_read_b128 a[212:215], v2 offset:2048
v_mfma_f32_16x16x32_bf16 v[220:223], a[204:207], a[168:171], v[220:223]
buffer_load_dwordx4 v13, s[12:15], s66 offen offset:2048 sc1 lds
ds_read_b128 a[216:219], v2 offset:4096
v_mfma_f32_16x16x32_bf16 v[224:227], a[176:179], a[172:175], v[224:227]
buffer_load_dwordx4 v13, s[12:15], s66 offen offset:3072 sc1 lds
v_mfma_f32_16x16x32_bf16 v[228:231], a[180:183], a[172:175], v[228:231]
ds_read_b128 a[220:223], v2 offset:6144
v_mfma_f32_16x16x32_bf16 v[232:235], a[184:187], a[172:175], v[232:235]
v_mfma_f32_16x16x32_bf16 v[236:239], a[188:191], a[172:175], v[236:239]
v_mfma_f32_16x16x32_bf16 v[240:243], a[192:195], a[172:175], v[240:243]
v_mfma_f32_16x16x32_bf16 v[244:247], a[196:199], a[172:175], v[244:247]
v_mfma_f32_16x16x32_bf16 v[248:251], a[200:203], a[172:175], v[248:251]
v_mfma_f32_16x16x32_bf16 v[252:255], a[204:207], a[172:175], v[252:255]
s_add_u32 s66, s66, 32768
s_cmp_eq_u32 s72, 1
s_cselect_b32 s66, s75, s66
s_waitcnt vmcnt(20) lgkmcnt(0)
s_cmp_eq_u32 s80, 4
s_cbranch_scc1 LM_qret
v_cmp_ne_u32 vcc, s89, v16
s_cbranch_vccnz LM_qwait
LM_qret:
s_barrier
v_mfma_f32_16x16x32_bf16 v[128:131], a[224:227], a[208:211], v[128:131]
v_mfma_f32_16x16x32_bf16 v[132:135], a[228:231], a[208:211], v[132:135]
ds_read_b64_tr_b16 a[176:177], v4 offset:49152
ds_read_b64_tr_b16 a[178:179], v4 offset:49664
v_mfma_f32_16x16x32_bf16 v[136:139], a[232:235], a[208:211], v[136:139]
buffer_load_dwordx4 a[0:3], v12, s[20:23], s96 offen offset:0 sc1
v_mfma_f32_16x16x32_bf16 v[140:143], a[236:239], a[208:211], v[140:143]
ds_read_b64_tr_b16 a[180:181], v5 offset:49152
v_mfma_f32_16x16x32_bf16 v[144:147], a[240:243], a[208:211], v[144:147]
ds_read_b64_tr_b16 a[182:183], v5 offset:49664
v_mfma_f32_16x16x32_bf16 v[148:151], a[244:247], a[208:211], v[148:151]
buffer_load_dwordx4 a[4:7], v12, s[20:23], s96 offen offset:1024 sc1
v_mfma_f32_16x16x32_bf16 v[152:155], a[248:251], a[208:211], v[152:155]
ds_read_b64_tr_b16 a[184:185], v6 offset:49152
v_mfma_f32_16x16x32_bf16 v[156:159], a[252:255], a[208:211], v[156:159]
ds_read_b64_tr_b16 a[186:187], v6 offset:49664
v_mfma_f32_16x16x32_bf16 v[160:163], a[224:227], a[212:215], v[160:163]
ds_read_b64_tr_b16 a[188:189], v7 offset:49152
v_mfma_f32_16x16x32_bf16 v[164:167], a[228:231], a[212:215], v[164:167]
buffer_load_dwordx4 a[8:11], v12, s[20:23], s96 offen offset:2048 sc1
ds_read_b64_tr_b16 a[190:191], v7 offset:49664
v_mfma_f32_16x16x32_bf16 v[168:171], a[232:235], a[212:215], v[168:171]
ds_read_b64_tr_b16 a[192:193], v4 offset:53248
v_mfma_f32_16x16x32_bf16 v[172:175], a[236:239], a[212:215], v[172:175]
buffer_load_dwordx4 a[12:15], v12, s[20:23], s96 offen offset:3072 sc1
v_mfma_f32_16x16x32_bf16 v[176:179], a[240:243], a[212:215], v[176:179]
ds_read_b64_tr_b16 a[194:195], v4 offset:53760
v_mfma_f32_16x16x32_bf16 v[180:183], a[244:247], a[212:215], v[180:183]
ds_read_b64_tr_b16 a[196:197], v5 offset:53248
v_mfma_f32_16x16x32_bf16 v[184:187], a[248:251], a[212:215], v[184:187]
ds_read_b64_tr_b16 a[198:199], v5 offset:53760
s_add_u32 s96, s96, 4096
v_mfma_f32_16x16x32_bf16 v[188:191], a[252:255], a[212:215], v[188:191]
buffer_load_dwordx4 a[16:19], v12, s[20:23], s96 offen offset:0 sc1
v_mfma_f32_16x16x32_bf16 v[192:195], a[224:227], a[216:219], v[192:195]
ds_read_b64_tr_b16 a[200:201], v6 offset:53248
v_mfma_f32_16x16x32_bf16 v[196:199], a[228:231], a[216:219], v[196:199]
ds_read_b64_tr_b16 a[202:203], v6 offset:53760
buffer_load_dwordx4 a[20:23], v12, s[20:23], s96 offen offset:1024 sc1
v_mfma_f32_16x16x32_bf16 v[200:203], a[232:235], a[216:219], v[200:203]
ds_read_b64_tr_b16 a[204:205], v7 offset:53248
v_mfma_f32_16x16x32_bf16 v[204:207], a[236:239], a[216:219], v[204:207]
ds_read_b64_tr_b16 a[206:207], v7 offset:53760
v_mfma_f32_16x16x32_bf16 v[208:211], a[240:243], a[216:219], v[208:211]
ds_read_b128 a[160:163], v3 offset:0
v_mfma_f32_16x16x32_bf16 v[212:215], a[244:247], a[216:219], v[212:215]
buffer_load_dwordx4 a[24:27], v12, s[20:23], s96 offen offset:2048 sc1
v_mfma_f32_16x16x32_bf16 v[216:219], a[248:251], a[216:219], v[216:219]
ds_read_b128 a[164:167], v3 offset:2048
v_mfma_f32_16x16x32_bf16 v[220:223], a[252:255], a[216:219], v[220:223]
ds_read_b128 a[168:171], v3 offset:4096
v_mfma_f32_16x16x32_bf16 v[224:227], a[224:227], a[220:223], v[224:227]
buffer_load_dwordx4 a[28:31], v12, s[20:23], s96 offen offset:3072 sc1
v_mfma_f32_16x16x32_bf16 v[228:231], a[228:231], a[220:223], v[228:231]
ds_read_b128 a[172:175], v3 offset:6144
v_mfma_f32_16x16x32_bf16 v[232:235], a[232:235], a[220:223], v[232:235]
v_mfma_f32_16x16x32_bf16 v[236:239], a[236:239], a[220:223], v[236:239]
v_mfma_f32_16x16x32_bf16 v[240:243], a[240:243], a[220:223], v[240:243]
v_mfma_f32_16x16x32_bf16 v[244:247], a[244:247], a[220:223], v[244:247]
v_mfma_f32_16x16x32_bf16 v[248:251], a[248:251], a[220:223], v[248:251]
v_mfma_f32_16x16x32_bf16 v[252:255], a[252:255], a[220:223], v[252:255]
s_waitcnt vmcnt(20) lgkmcnt(0)
s_barrier
v_mfma_f32_16x16x32_bf16 v[128:131], a[176:179], a[160:163], v[128:131]
s_add_u32 s50, s49, s51
s_add_u32 s49, s49, 32768
s_cmp_eq_u32 s49, 163840
v_mfma_f32_16x16x32_bf16 v[132:135], a[180:183], a[160:163], v[132:135]
s_cselect_b32 s49, 65536, s49
v_add_u32 v2, s49, v1
v_xor_b32 v3, 64, v2
v_mfma_f32_16x16x32_bf16 v[136:139], a[184:187], a[160:163], v[136:139]
ds_read_b64_tr_b16 a[224:225], v4 offset:0
ds_read_b64_tr_b16 a[226:227], v4 offset:512
s_add_u32 m0, s74, 98304
v_mfma_f32_16x16x32_bf16 v[140:143], a[188:191], a[160:163], v[140:143]
buffer_load_dwordx4 v12, s[12:15], s66 offen offset:0 sc1 lds
v_mfma_f32_16x16x32_bf16 v[144:147], a[192:195], a[160:163], v[144:147]
ds_read_b64_tr_b16 a[228:229], v5 offset:0
v_mfma_f32_16x16x32_bf16 v[148:151], a[196:199], a[160:163], v[148:151]
ds_read_b64_tr_b16 a[230:231], v5 offset:512
v_mfma_f32_16x16x32_bf16 v[152:155], a[200:203], a[160:163], v[152:155]
buffer_load_dwordx4 v12, s[12:15], s66 offen offset:1024 sc1 lds
v_mfma_f32_16x16x32_bf16 v[156:159], a[204:207], a[160:163], v[156:159]
ds_read_b64_tr_b16 a[232:233], v6 offset:0
v_mfma_f32_16x16x32_bf16 v[160:163], a[176:179], a[164:167], v[160:163]
ds_read_b64_tr_b16 a[234:235], v6 offset:512
ds_read_b64_tr_b16 a[236:237], v7 offset:0
v_mfma_f32_16x16x32_bf16 v[164:167], a[180:183], a[164:167], v[164:167]
buffer_load_dwordx4 v12, s[12:15], s66 offen offset:2048 sc1 lds
v_mfma_f32_16x16x32_bf16 v[168:171], a[184:187], a[164:167], v[168:171]
ds_read_b64_tr_b16 a[238:239], v7 offset:512
v_mfma_f32_16x16x32_bf16 v[172:175], a[188:191], a[164:167], v[172:175]
ds_read_b64_tr_b16 a[240:241], v4 offset:4096
v_mfma_f32_16x16x32_bf16 v[176:179], a[192:195], a[164:167], v[176:179]
buffer_load_dwordx4 v12, s[12:15], s66 offen offset:3072 sc1 lds
v_mfma_f32_16x16x32_bf16 v[180:183], a[196:199], a[164:167], v[180:183]
ds_read_b64_tr_b16 a[242:243], v4 offset:4608
v_mfma_f32_16x16x32_bf16 v[184:187], a[200:203], a[164:167], v[184:187]
ds_read_b64_tr_b16 a[244:245], v5 offset:4096
ds_read_b64_tr_b16 a[246:247], v5 offset:4608
s_add_u32 m0, s74, 114688
v_mfma_f32_16x16x32_bf16 v[188:191], a[204:207], a[164:167], v[188:191]
buffer_load_dwordx4 v13, s[12:15], s66 offen offset:0 sc1 lds
v_mfma_f32_16x16x32_bf16 v[192:195], a[176:179], a[168:171], v[192:195]
ds_read_b64_tr_b16 a[248:249], v6 offset:4096
v_mfma_f32_16x16x32_bf16 v[196:199], a[180:183], a[168:171], v[196:199]
ds_read_b64_tr_b16 a[250:251], v6 offset:4608
v_mfma_f32_16x16x32_bf16 v[200:203], a[184:187], a[168:171], v[200:203]
buffer_load_dwordx4 v13, s[12:15], s66 offen offset:1024 sc1 lds
v_mfma_f32_16x16x32_bf16 v[204:207], a[188:191], a[168:171], v[204:207]
ds_read_b64_tr_b16 a[252:253], v7 offset:4096
v_mfma_f32_16x16x32_bf16 v[208:211], a[192:195], a[168:171], v[208:211]
ds_read_b64_tr_b16 a[254:255], v7 offset:4608
ds_read_b128 a[208:211], v2 offset:0
v_mfma_f32_16x16x32_bf16 v[212:215], a[196:199], a[168:171], v[212:215]
buffer_load_dwordx4 v13, s[12:15], s66 offen offset:2048 sc1 lds
v_mfma_f32_16x16x32_bf16 v[216:219], a[200:203], a[168:171], v[216:219]
ds_read_b128 a[212:215], v2 offset:2048
v_mfma_f32_16x16x32_bf16 v[220:223], a[204:207], a[168:171], v[220:223]
ds_read_b128 a[216:219], v2 offset:4096
v_mfma_f32_16x16x32_bf16 v[224:227], a[176:179], a[172:175], v[224:227]
buffer_load_dwordx4 v13, s[12:15], s66 offen offset:3072 sc1 lds
v_mfma_f32_16x16x32_bf16 v[228:231], a[180:183], a[172:175], v[228:231]
ds_read_b128 a[220:223], v2 offset:6144
v_mfma_f32_16x16x32_bf16 v[232:235], a[184:187], a[172:175], v[232:235]
v_mfma_f32_16x16x32_bf16 v[236:239], a[188:191], a[172:175], v[236:239]
v_mfma_f32_16x16x32_bf16 v[240:243], a[192:195], a[172:175], v[240:243]
v_mfma_f32_16x16x32_bf16 v[244:247], a[196:199], a[172:175], v[244:247]
v_mfma_f32_16x16x32_bf16 v[248:251], a[200:203], a[172:175], v[248:251]
v_mfma_f32_16x16x32_bf16 v[252:255], a[204:207], a[172:175], v[252:255]
s_add_u32 s66, s66, 32768
s_cmp_eq_u32 s72, 2
s_cselect_b32 s66, s75, s66
s_waitcnt vmcnt(16) lgkmcnt(0)
s_barrier
v_mfma_f32_16x16x32_bf16 v[128:131], a[224:227], a[208:211], v[128:131]
v_mfma_f32_16x16x32_bf16 v[132:135], a[228:231], a[208:211], v[132:135]
ds_read_b64_tr_b16 a[176:177], v4 offset:16384
ds_read_b64_tr_b16 a[178:179], v4 offset:16896
s_add_u32 s96, s96, 4096
v_mfma_f32_16x16x32_bf16 v[136:139], a[232:235], a[208:211], v[136:139]
buffer_load_dwordx4 a[32:35], v12, s[20:23], s96 offen offset:0 sc1
v_mfma_f32_16x16x32_bf16 v[140:143], a[236:239], a[208:211], v[140:143]
ds_read_b64_tr_b16 a[180:181], v5 offset:16384
v_mfma_f32_16x16x32_bf16 v[144:147], a[240:243], a[208:211], v[144:147]
ds_read_b64_tr_b16 a[182:183], v5 offset:16896
v_mfma_f32_16x16x32_bf16 v[148:151], a[244:247], a[208:211], v[148:151]
buffer_load_dwordx4 a[36:39], v12, s[20:23], s96 offen offset:1024 sc1
v_mfma_f32_16x16x32_bf16 v[152:155], a[248:251], a[208:211], v[152:155]
ds_read_b64_tr_b16 a[184:185], v6 offset:16384
v_mfma_f32_16x16x32_bf16 v[156:159], a[252:255], a[208:211], v[156:159]
ds_read_b64_tr_b16 a[186:187], v6 offset:16896
v_mfma_f32_16x16x32_bf16 v[160:163], a[224:227], a[212:215], v[160:163]
ds_read_b64_tr_b16 a[188:189], v7 offset:16384
v_mfma_f32_16x16x32_bf16 v[164:167], a[228:231], a[212:215], v[164:167]
buffer_load_dwordx4 a[40:43], v12, s[20:23], s96 offen offset:2048 sc1
ds_read_b64_tr_b16 a[190:191], v7 offset:16896
v_mfma_f32_16x16x32_bf16 v[168:171], a[232:235], a[212:215], v[168:171]
ds_read_b64_tr_b16 a[192:193], v4 offset:20480
v_mfma_f32_16x16x32_bf16 v[172:175], a[236:239], a[212:215], v[172:175]
buffer_load_dwordx4 a[44:47], v12, s[20:23], s96 offen offset:3072 sc1
v_mfma_f32_16x16x32_bf16 v[176:179], a[240:243], a[212:215], v[176:179]
ds_read_b64_tr_b16 a[194:195], v4 offset:20992
v_mfma_f32_16x16x32_bf16 v[180:183], a[244:247], a[212:215], v[180:183]
ds_read_b64_tr_b16 a[196:197], v5 offset:20480
v_mfma_f32_16x16x32_bf16 v[184:187], a[248:251], a[212:215], v[184:187]
ds_read_b64_tr_b16 a[198:199], v5 offset:20992
s_add_u32 s96, s96, 4096
v_mfma_f32_16x16x32_bf16 v[188:191], a[252:255], a[212:215], v[188:191]
buffer_load_dwordx4 a[48:51], v12, s[20:23], s96 offen offset:0 sc1
v_mfma_f32_16x16x32_bf16 v[192:195], a[224:227], a[216:219], v[192:195]
ds_read_b64_tr_b16 a[200:201], v6 offset:20480
v_mfma_f32_16x16x32_bf16 v[196:199], a[228:231], a[216:219], v[196:199]
ds_read_b64_tr_b16 a[202:203], v6 offset:20992
buffer_load_dwordx4 a[52:55], v12, s[20:23], s96 offen offset:1024 sc1
v_mfma_f32_16x16x32_bf16 v[200:203], a[232:235], a[216:219], v[200:203]
ds_read_b64_tr_b16 a[204:205], v7 offset:20480
v_mfma_f32_16x16x32_bf16 v[204:207], a[236:239], a[216:219], v[204:207]
ds_read_b64_tr_b16 a[206:207], v7 offset:20992
v_mfma_f32_16x16x32_bf16 v[208:211], a[240:243], a[216:219], v[208:211]
ds_read_b128 a[160:163], v3 offset:0
v_mfma_f32_16x16x32_bf16 v[212:215], a[244:247], a[216:219], v[212:215]
buffer_load_dwordx4 a[56:59], v12, s[20:23], s96 offen offset:2048 sc1
v_mfma_f32_16x16x32_bf16 v[216:219], a[248:251], a[216:219], v[216:219]
ds_read_b128 a[164:167], v3 offset:2048
v_mfma_f32_16x16x32_bf16 v[220:223], a[252:255], a[216:219], v[220:223]
ds_read_b128 a[168:171], v3 offset:4096
v_mfma_f32_16x16x32_bf16 v[224:227], a[224:227], a[220:223], v[224:227]
buffer_load_dwordx4 a[60:63], v12, s[20:23], s96 offen offset:3072 sc1
v_mfma_f32_16x16x32_bf16 v[228:231], a[228:231], a[220:223], v[228:231]
ds_read_b128 a[172:175], v3 offset:6144
v_mfma_f32_16x16x32_bf16 v[232:235], a[232:235], a[220:223], v[232:235]
v_mfma_f32_16x16x32_bf16 v[236:239], a[236:239], a[220:223], v[236:239]
v_mfma_f32_16x16x32_bf16 v[240:243], a[240:243], a[220:223], v[240:243]
v_mfma_f32_16x16x32_bf16 v[244:247], a[244:247], a[220:223], v[244:247]
v_mfma_f32_16x16x32_bf16 v[248:251], a[248:251], a[220:223], v[248:251]
v_mfma_f32_16x16x32_bf16 v[252:255], a[252:255], a[220:223], v[252:255]
s_waitcnt vmcnt(16) lgkmcnt(0)
s_barrier
v_mfma_f32_16x16x32_bf16 v[128:131], a[176:179], a[160:163], v[128:131]
s_add_u32 s50, s49, s51
s_add_u32 s49, s49, 32768
s_cmp_eq_u32 s49, 163840
v_mfma_f32_16x16x32_bf16 v[132:135], a[180:183], a[160:163], v[132:135]
s_cselect_b32 s49, 65536, s49
v_add_u32 v2, s49, v1
v_xor_b32 v3, 64, v2
v_mfma_f32_16x16x32_bf16 v[136:139], a[184:187], a[160:163], v[136:139]
s_add_u32 m0, s74, 131072
s_nop 0
buffer_load_dwordx4 v12, s[12:15], s66 offen offset:0 sc1 lds
v_mfma_f32_16x16x32_bf16 v[140:143], a[188:191], a[160:163], v[140:143]
buffer_load_dwordx4 v12, s[12:15], s66 offen offset:1024 sc1 lds
v_mfma_f32_16x16x32_bf16 v[144:147], a[192:195], a[160:163], v[144:147]
v_mfma_f32_16x16x32_bf16 v[148:151], a[196:199], a[160:163], v[148:151]
buffer_load_dwordx4 v12, s[12:15], s66 offen offset:2048 sc1 lds
v_mfma_f32_16x16x32_bf16 v[152:155], a[200:203], a[160:163], v[152:155]
buffer_load_dwordx4 v12, s[12:15], s66 offen offset:3072 sc1 lds
v_mfma_f32_16x16x32_bf16 v[156:159], a[204:207], a[160:163], v[156:159]
s_add_u32 m0, s74, 147456
v_mfma_f32_16x16x32_bf16 v[160:163], a[176:179], a[164:167], v[160:163]
buffer_load_dwordx4 v13, s[12:15], s66 offen offset:0 sc1 lds
v_mfma_f32_16x16x32_bf16 v[164:167], a[180:183], a[164:167], v[164:167]
buffer_load_dwordx4 v13, s[12:15], s66 offen offset:1024 sc1 lds
v_mfma_f32_16x16x32_bf16 v[168:171], a[184:187], a[164:167], v[168:171]
v_mfma_f32_16x16x32_bf16 v[172:175], a[188:191], a[164:167], v[172:175]
buffer_load_dwordx4 v13, s[12:15], s66 offen offset:2048 sc1 lds
v_mfma_f32_16x16x32_bf16 v[176:179], a[192:195], a[164:167], v[176:179]
buffer_load_dwordx4 v13, s[12:15], s66 offen offset:3072 sc1 lds
v_mfma_f32_16x16x32_bf16 v[180:183], a[196:199], a[164:167], v[180:183]
v_mfma_f32_16x16x32_bf16 v[184:187], a[200:203], a[164:167], v[184:187]
v_mfma_f32_16x16x32_bf16 v[188:191], a[204:207], a[164:167], v[188:191]
v_mfma_f32_16x16x32_bf16 v[192:195], a[176:179], a[168:171], v[192:195]
v_mfma_f32_16x16x32_bf16 v[196:199], a[180:183], a[168:171], v[196:199]
v_mfma_f32_16x16x32_bf16 v[200:203], a[184:187], a[168:171], v[200:203]
v_mfma_f32_16x16x32_bf16 v[204:207], a[188:191], a[168:171], v[204:207]
v_mfma_f32_16x16x32_bf16 v[208:211], a[192:195], a[168:171], v[208:211]
v_mfma_f32_16x16x32_bf16 v[212:215], a[196:199], a[168:171], v[212:215]
v_mfma_f32_16x16x32_bf16 v[216:219], a[200:203], a[168:171], v[216:219]
v_mfma_f32_16x16x32_bf16 v[220:223], a[204:207], a[168:171], v[220:223]
v_mfma_f32_16x16x32_bf16 v[224:227], a[176:179], a[172:175], v[224:227]
v_mfma_f32_16x16x32_bf16 v[228:231], a[180:183], a[172:175], v[228:231]
v_mfma_f32_16x16x32_bf16 v[232:235], a[184:187], a[172:175], v[232:235]
v_mfma_f32_16x16x32_bf16 v[236:239], a[188:191], a[172:175], v[236:239]
v_mfma_f32_16x16x32_bf16 v[240:243], a[192:195], a[172:175], v[240:243]
v_mfma_f32_16x16x32_bf16 v[244:247], a[196:199], a[172:175], v[244:247]
v_mfma_f32_16x16x32_bf16 v[248:251], a[200:203], a[172:175], v[248:251]
v_mfma_f32_16x16x32_bf16 v[252:255], a[204:207], a[172:175], v[252:255]
s_add_u32 s66, s66, 32768
s_cmp_eq_u32 s72, 3
s_cselect_b32 s66, s75, s66
s_nop 7
v_mov_b32 v14, 1035512379
s_lshr_b32 s53, s48, 1
s_lshl_b32 s53, s53, 15
s_and_b32 s54, s48, 1
s_lshl_b32 s54, s54, 12
s_add_u32 s53, s53, s54
v_add_u32 v2, s53, v12
v_pk_mul_f32 v[128:129], v[128:129], v[14:15] op_sel_hi:[1,0]
v_pk_mul_f32 v[130:131], v[130:131], v[14:15] op_sel_hi:[1,0]
v_pk_mul_f32 v[132:133], v[132:133], v[14:15] op_sel_hi:[1,0]
v_pk_mul_f32 v[134:135], v[134:135], v[14:15] op_sel_hi:[1,0]
v_cvt_pk_bf16_f32 v128, v128, v129
v_cvt_pk_bf16_f32 v129, v130, v131
v_cvt_pk_bf16_f32 v130, v132, v133
v_cvt_pk_bf16_f32 v131, v134, v135
ds_write_b128 v2, v[128:131] offset:0
v_pk_mul_f32 v[136:137], v[136:137], v[14:15] op_sel_hi:[1,0]
v_pk_mul_f32 v[138:139], v[138:139], v[14:15] op_sel_hi:[1,0]
v_pk_mul_f32 v[140:141], v[140:141], v[14:15] op_sel_hi:[1,0]
v_pk_mul_f32 v[142:143], v[142:143], v[14:15] op_sel_hi:[1,0]
v_cvt_pk_bf16_f32 v136, v136, v137
v_cvt_pk_bf16_f32 v137, v138, v139
v_cvt_pk_bf16_f32 v138, v140, v141
v_cvt_pk_bf16_f32 v139, v142, v143
ds_write_b128 v2, v[136:139] offset:1024
v_pk_mul_f32 v[144:145], v[144:145], v[14:15] op_sel_hi:[1,0]
v_pk_mul_f32 v[146:147], v[146:147], v[14:15] op_sel_hi:[1,0]
v_pk_mul_f32 v[148:149], v[148:149], v[14:15] op_sel_hi:[1,0]
v_pk_mul_f32 v[150:151], v[150:151], v[14:15] op_sel_hi:[1,0]
v_cvt_pk_bf16_f32 v144, v144, v145
v_cvt_pk_bf16_f32 v145, v146, v147
v_cvt_pk_bf16_f32 v146, v148, v149
v_cvt_pk_bf16_f32 v147, v150, v151
ds_write_b128 v2, v[144:147] offset:2048
v_pk_mul_f32 v[152:153], v[152:153], v[14:15] op_sel_hi:[1,0]
v_pk_mul_f32 v[154:155], v[154:155], v[14:15] op_sel_hi:[1,0]
v_pk_mul_f32 v[156:157], v[156:157], v[14:15] op_sel_hi:[1,0]
v_pk_mul_f32 v[158:159], v[158:159], v[14:15] op_sel_hi:[1,0]
v_cvt_pk_bf16_f32 v152, v152, v153
v_cvt_pk_bf16_f32 v153, v154, v155
v_cvt_pk_bf16_f32 v154, v156, v157
v_cvt_pk_bf16_f32 v155, v158, v159
ds_write_b128 v2, v[152:155] offset:3072
v_pk_mul_f32 v[160:161], v[160:161], v[14:15] op_sel_hi:[1,0]
v_pk_mul_f32 v[162:163], v[162:163], v[14:15] op_sel_hi:[1,0]
v_pk_mul_f32 v[164:165], v[164:165], v[14:15] op_sel_hi:[1,0]
v_pk_mul_f32 v[166:167], v[166:167], v[14:15] op_sel_hi:[1,0]
v_cvt_pk_bf16_f32 v160, v160, v161
v_cvt_pk_bf16_f32 v161, v162, v163
v_cvt_pk_bf16_f32 v162, v164, v165
v_cvt_pk_bf16_f32 v163, v166, v167
ds_write_b128 v2, v[160:163] offset:8192
v_pk_mul_f32 v[168:169], v[168:169], v[14:15] op_sel_hi:[1,0]
v_pk_mul_f32 v[170:171], v[170:171], v[14:15] op_sel_hi:[1,0]
v_pk_mul_f32 v[172:173], v[172:173], v[14:15] op_sel_hi:[1,0]
v_pk_mul_f32 v[174:175], v[174:175], v[14:15] op_sel_hi:[1,0]
v_cvt_pk_bf16_f32 v168, v168, v169
v_cvt_pk_bf16_f32 v169, v170, v171
v_cvt_pk_bf16_f32 v170, v172, v173
v_cvt_pk_bf16_f32 v171, v174, v175
ds_write_b128 v2, v[168:171] offset:9216
v_pk_mul_f32 v[176:177], v[176:177], v[14:15] op_sel_hi:[1,0]
v_pk_mul_f32 v[178:179], v[178:179], v[14:15] op_sel_hi:[1,0]
v_pk_mul_f32 v[180:181], v[180:181], v[14:15] op_sel_hi:[1,0]
v_pk_mul_f32 v[182:183], v[182:183], v[14:15] op_sel_hi:[1,0]
v_cvt_pk_bf16_f32 v176, v176, v177
v_cvt_pk_bf16_f32 v177, v178, v179
v_cvt_pk_bf16_f32 v178, v180, v181
v_cvt_pk_bf16_f32 v179, v182, v183
ds_write_b128 v2, v[176:179] offset:10240
v_pk_mul_f32 v[184:185], v[184:185], v[14:15] op_sel_hi:[1,0]
v_pk_mul_f32 v[186:187], v[186:187], v[14:15] op_sel_hi:[1,0]
v_pk_mul_f32 v[188:189], v[188:189], v[14:15] op_sel_hi:[1,0]
v_pk_mul_f32 v[190:191], v[190:191], v[14:15] op_sel_hi:[1,0]
v_cvt_pk_bf16_f32 v184, v184, v185
v_cvt_pk_bf16_f32 v185, v186, v187
v_cvt_pk_bf16_f32 v186, v188, v189
v_cvt_pk_bf16_f32 v187, v190, v191
ds_write_b128 v2, v[184:187] offset:11264
v_pk_mul_f32 v[192:193], v[192:193], v[14:15] op_sel_hi:[1,0]
v_pk_mul_f32 v[194:195], v[194:195], v[14:15] op_sel_hi:[1,0]
v_pk_mul_f32 v[196:197], v[196:197], v[14:15] op_sel_hi:[1,0]
v_pk_mul_f32 v[198:199], v[198:199], v[14:15] op_sel_hi:[1,0]
v_cvt_pk_bf16_f32 v192, v192, v193
v_cvt_pk_bf16_f32 v193, v194, v195
v_cvt_pk_bf16_f32 v194, v196, v197
v_cvt_pk_bf16_f32 v195, v198, v199
ds_write_b128 v2, v[192:195] offset:16384
v_pk_mul_f32 v[200:201], v[200:201], v[14:15] op_sel_hi:[1,0]
v_pk_mul_f32 v[202:203], v[202:203], v[14:15] op_sel_hi:[1,0]
v_pk_mul_f32 v[204:205], v[204:205], v[14:15] op_sel_hi:[1,0]
v_pk_mul_f32 v[206:207], v[206:207], v[14:15] op_sel_hi:[1,0]
v_cvt_pk_bf16_f32 v200, v200, v201
v_cvt_pk_bf16_f32 v201, v202, v203
v_cvt_pk_bf16_f32 v202, v204, v205
v_cvt_pk_bf16_f32 v203, v206, v207
ds_write_b128 v2, v[200:203] offset:17408
v_pk_mul_f32 v[208:209], v[208:209], v[14:15] op_sel_hi:[1,0]
v_pk_mul_f32 v[210:211], v[210:211], v[14:15] op_sel_hi:[1,0]
v_pk_mul_f32 v[212:213], v[212:213], v[14:15] op_sel_hi:[1,0]
v_pk_mul_f32 v[214:215], v[214:215], v[14:15] op_sel_hi:[1,0]
v_cvt_pk_bf16_f32 v208, v208, v209
v_cvt_pk_bf16_f32 v209, v210, v211
v_cvt_pk_bf16_f32 v210, v212, v213
v_cvt_pk_bf16_f32 v211, v214, v215
ds_write_b128 v2, v[208:211] offset:18432
v_pk_mul_f32 v[216:217], v[216:217], v[14:15] op_sel_hi:[1,0]
v_pk_mul_f32 v[218:219], v[218:219], v[14:15] op_sel_hi:[1,0]
v_pk_mul_f32 v[220:221], v[220:221], v[14:15] op_sel_hi:[1,0]
v_pk_mul_f32 v[222:223], v[222:223], v[14:15] op_sel_hi:[1,0]
v_cvt_pk_bf16_f32 v216, v216, v217
v_cvt_pk_bf16_f32 v217, v218, v219
v_cvt_pk_bf16_f32 v218, v220, v221
v_cvt_pk_bf16_f32 v219, v222, v223
ds_write_b128 v2, v[216:219] offset:19456
v_pk_mul_f32 v[224:225], v[224:225], v[14:15] op_sel_hi:[1,0]
v_pk_mul_f32 v[226:227], v[226:227], v[14:15] op_sel_hi:[1,0]
v_pk_mul_f32 v[228:229], v[228:229], v[14:15] op_sel_hi:[1,0]
v_pk_mul_f32 v[230:231], v[230:231], v[14:15] op_sel_hi:[1,0]
v_cvt_pk_bf16_f32 v224, v224, v225
v_cvt_pk_bf16_f32 v225, v226, v227
v_cvt_pk_bf16_f32 v226, v228, v229
v_cvt_pk_bf16_f32 v227, v230, v231
ds_write_b128 v2, v[224:227] offset:24576
v_pk_mul_f32 v[232:233], v[232:233], v[14:15] op_sel_hi:[1,0]
v_pk_mul_f32 v[234:235], v[234:235], v[14:15] op_sel_hi:[1,0]
v_pk_mul_f32 v[236:237], v[236:237], v[14:15] op_sel_hi:[1,0]
v_pk_mul_f32 v[238:239], v[238:239], v[14:15] op_sel_hi:[1,0]
v_cvt_pk_bf16_f32 v232, v232, v233
v_cvt_pk_bf16_f32 v233, v234, v235
v_cvt_pk_bf16_f32 v234, v236, v237
v_cvt_pk_bf16_f32 v235, v238, v239
ds_write_b128 v2, v[232:235] offset:25600
v_pk_mul_f32 v[240:241], v[240:241], v[14:15] op_sel_hi:[1,0]
v_pk_mul_f32 v[242:243], v[242:243], v[14:15] op_sel_hi:[1,0]
v_pk_mul_f32 v[244:245], v[244:245], v[14:15] op_sel_hi:[1,0]
v_pk_mul_f32 v[246:247], v[246:247], v[14:15] op_sel_hi:[1,0]
v_cvt_pk_bf16_f32 v240, v240, v241
v_cvt_pk_bf16_f32 v241, v242, v243
v_cvt_pk_bf16_f32 v242, v244, v245
v_cvt_pk_bf16_f32 v243, v246, v247
ds_write_b128 v2, v[240:243] offset:26624
v_pk_mul_f32 v[248:249], v[248:249], v[14:15] op_sel_hi:[1,0]
v_pk_mul_f32 v[250:251], v[250:251], v[14:15] op_sel_hi:[1,0]
v_pk_mul_f32 v[252:253], v[252:253], v[14:15] op_sel_hi:[1,0]
v_pk_mul_f32 v[254:255], v[254:255], v[14:15] op_sel_hi:[1,0]
v_cvt_pk_bf16_f32 v248, v248, v249
v_cvt_pk_bf16_f32 v249, v250, v251
v_cvt_pk_bf16_f32 v250, v252, v253
v_cvt_pk_bf16_f32 v251, v254, v255
ds_write_b128 v2, v[248:251] offset:27648
s_lshl_b32 s54, s48, 14
v_add_u32 v3, s54, v12
s_waitcnt lgkmcnt(0)
s_barrier
ds_read_b128 a[192:195], v3 offset:0
ds_read_b128 a[196:199], v3 offset:1024
ds_read_b128 a[200:203], v3 offset:2048
ds_read_b128 a[204:207], v3 offset:3072
ds_read_b128 a[208:211], v3 offset:4096
ds_read_b128 a[212:215], v3 offset:5120
ds_read_b128 a[216:219], v3 offset:6144
ds_read_b128 a[220:223], v3 offset:7168
ds_read_b128 a[224:227], v3 offset:8192
ds_read_b128 a[228:231], v3 offset:9216
ds_read_b128 a[232:235], v3 offset:10240
ds_read_b128 a[236:239], v3 offset:11264
ds_read_b128 a[240:243], v3 offset:12288
ds_read_b128 a[244:247], v3 offset:13312
ds_read_b128 a[248:251], v3 offset:14336
ds_read_b128 a[252:255], v3 offset:15360
s_add_u32 s68, s74, 32768
s_add_u32 s69, s74, 65536
s_add_u32 s70, s74, 98304
v_subrev_u32 v1, s74, v12
v_lshrrev_b32 v19, 4, v12
v_and_b32 v16, 15, v19
v_lshrrev_b32 v17, 4, v19
v_lshlrev_b32 v17, 2, v17
v_add_u32 v18, 0, v17
v_cmp_le_u32 s[32:33], v18, v16
v_add_u32 v18, 1, v17
v_cmp_le_u32 s[34:35], v18, v16
v_add_u32 v18, 2, v17
v_cmp_le_u32 s[36:37], v18, v16
v_add_u32 v18, 3, v17
v_cmp_le_u32 s[38:39], v18, v16
v_mbcnt_lo_u32_b32 v15, -1, 0
v_and_b32 v14, 6, v15
v_and_b32 v15, 1, v15
v_lshl_add_u32 v15, v14, 1, v15
v_lshlrev_b32 v15, 2, v15
s_waitcnt vmcnt(8) lgkmcnt(0)
s_barrier
s_cmp_lg_u32 s80, 4
s_cbranch_scc1 LM_qkeep
v_accvgpr_mov_b32 a0, a192
v_accvgpr_mov_b32 a1, a193
v_accvgpr_mov_b32 a2, a194
v_accvgpr_mov_b32 a3, a195
v_accvgpr_mov_b32 a4, a196
v_accvgpr_mov_b32 a5, a197
v_accvgpr_mov_b32 a6, a198
v_accvgpr_mov_b32 a7, a199
v_accvgpr_mov_b32 a8, a200
v_accvgpr_mov_b32 a9, a201
v_accvgpr_mov_b32 a10, a202
v_accvgpr_mov_b32 a11, a203
v_accvgpr_mov_b32 a12, a204
v_accvgpr_mov_b32 a13, a205
v_accvgpr_mov_b32 a14, a206
v_accvgpr_mov_b32 a15, a207
v_accvgpr_mov_b32 a16, a208
v_accvgpr_mov_b32 a17, a209
v_accvgpr_mov_b32 a18, a210
v_accvgpr_mov_b32 a19, a211
v_accvgpr_mov_b32 a20, a212
v_accvgpr_mov_b32 a21, a213
v_accvgpr_mov_b32 a22, a214
v_accvgpr_mov_b32 a23, a215
v_accvgpr_mov_b32 a24, a216
v_accvgpr_mov_b32 a25, a217
v_accvgpr_mov_b32 a26, a218
v_accvgpr_mov_b32 a27, a219
v_accvgpr_mov_b32 a28, a220
v_accvgpr_mov_b32 a29, a221
v_accvgpr_mov_b32 a30, a222
v_accvgpr_mov_b32 a31, a223
v_accvgpr_mov_b32 a32, a224
v_accvgpr_mov_b32 a33, a225
v_accvgpr_mov_b32 a34, a226
v_accvgpr_mov_b32 a35, a227
v_accvgpr_mov_b32 a36, a228
v_accvgpr_mov_b32 a37, a229
v_accvgpr_mov_b32 a38, a230
v_accvgpr_mov_b32 a39, a231
v_accvgpr_mov_b32 a40, a232
v_accvgpr_mov_b32 a41, a233
v_accvgpr_mov_b32 a42, a234
v_accvgpr_mov_b32 a43, a235
v_accvgpr_mov_b32 a44, a236
v_accvgpr_mov_b32 a45, a237
v_accvgpr_mov_b32 a46, a238
v_accvgpr_mov_b32 a47, a239
v_accvgpr_mov_b32 a48, a240
v_accvgpr_mov_b32 a49, a241
v_accvgpr_mov_b32 a50, a242
v_accvgpr_mov_b32 a51, a243
v_accvgpr_mov_b32 a52, a244
v_accvgpr_mov_b32 a53, a245
v_accvgpr_mov_b32 a54, a246
v_accvgpr_mov_b32 a55, a247
v_accvgpr_mov_b32 a56, a248
v_accvgpr_mov_b32 a57, a249
v_accvgpr_mov_b32 a58, a250
v_accvgpr_mov_b32 a59, a251
v_accvgpr_mov_b32 a60, a252
v_accvgpr_mov_b32 a61, a253
v_accvgpr_mov_b32 a62, a254
v_accvgpr_mov_b32 a63, a255
LM_qkeep:
s_add_u32 m0, s74, 0
s_nop 0
buffer_load_dwordx4 v12, s[12:15], s66 offen offset:0 sc1 lds
buffer_load_dwordx4 v12, s[12:15], s66 offen offset:1024 sc1 lds
buffer_load_dwordx4 v12, s[12:15], s66 offen offset:2048 sc1 lds
buffer_load_dwordx4 v12, s[12:15], s66 offen offset:3072 sc1 lds
s_add_u32 m0, s74, 16384
s_nop 0
buffer_load_dwordx4 v13, s[12:15], s66 offen offset:0 sc1 lds
buffer_load_dwordx4 v13, s[12:15], s66 offen offset:1024 sc1 lds
buffer_load_dwordx4 v13, s[12:15], s66 offen offset:2048 sc1 lds
buffer_load_dwordx4 v13, s[12:15], s66 offen offset:3072 sc1 lds
s_add_u32 s66, s66, 32768
s_cmp_eq_u32 s72, 4
s_cselect_b32 s66, s75, s66
s_branch L2_seg
LM_kvbwait:
s_mov_b32 s53, 0
LM_kvbloop:
buffer_load_dword v14, v15, s[20:23], s99 offen sc0 sc1
s_add_u32 s53, s53, 1
s_waitcnt vmcnt(0)
s_cmp_gt_u32 s53, 200000
s_cbranch_scc1 LM_kvbret
v_cmp_ne_u32 vcc, s89, v14
s_cbranch_vccz LM_kvbret
s_sleep 2
s_branch LM_kvbloop
LM_qwait:
s_mov_b32 s53, 0
LM_qloop:
buffer_load_dword v16, v17, s[20:23], s97 offen sc0 sc1
s_add_u32 s53, s53, 1
s_waitcnt vmcnt(0)
s_cmp_gt_u32 s53, 200000
s_cbranch_scc1 LM_qret
v_cmp_ne_u32 vcc, s89, v16
s_cbranch_vccz LM_qret
s_sleep 2
s_branch LM_qloop
LM_gKwait:
s_mov_b32 s53, 0
LM_gKloop:
buffer_load_dword v14, v15, s[20:23], s58 offen sc0 sc1
s_add_u32 s53, s53, 1
s_waitcnt vmcnt(0)
s_cmp_gt_u32 s53, 200000
s_cbranch_scc1 LM_gKret
v_cmp_ne_u32 vcc, s89, v14
s_cbranch_vccz LM_gKret
s_sleep 2
s_branch LM_gKloop
LM_tagKwait:
s_mov_b32 s53, 0
LM_tagKloop:
buffer_load_dword v14, v15, s[76:79], 0 offen sc0 sc1
s_add_u32 s53, s53, 1
s_waitcnt vmcnt(0)
s_cmp_gt_u32 s53, 200000
s_cbranch_scc1 LM_tagKret
v_readfirstlane_b32 s89, v14
s_nop 0
s_cmp_lg_u32 s89, 0
s_cbranch_scc1 LM_tagKret
s_sleep 2
s_branch LM_tagKloop
LM_gVwait:
s_mov_b32 s53, 0
LM_gVloop:
buffer_load_dword v14, v15, s[20:23], s58 offen sc0 sc1
s_add_u32 s53, s53, 1
s_waitcnt vmcnt(0)
s_cmp_gt_u32 s53, 200000
s_cbranch_scc1 LM_gVret
v_cmp_ne_u32 vcc, s89, v14
s_cbranch_vccz LM_gVret
s_sleep 2
s_branch LM_gVloop
LM_tagVwait:
s_mov_b32 s53, 0
LM_tagVloop:
buffer_load_dword v14, v15, s[76:79], 0 offen sc0 sc1
s_add_u32 s53, s53, 1
s_waitcnt vmcnt(0)
s_cmp_gt_u32 s53, 200000
s_cbranch_scc1 LM_tagVret
v_readfirstlane_b32 s89, v14
s_nop 0
s_cmp_lg_u32 s89, 0
s_cbranch_scc1 LM_tagVret
s_sleep 2
s_branch LM_tagVloop
LA_ren1A0:
v_mov_b32 v229, v172
v_mov_b32 v228, v172
s_nop 1
v_permlane32_swap_b32 v229, v228
v_frexp_exp_i32_f32 v228, v228
v_max_i32 v228, 0, v228
v_sub_u32 v229, 0, v228
v_ldexp_f32 v226, 1.0, v229
v_cvt_f32_i32 v228, v228
v_sub_f32 v176, v176, v228
v_sub_f32 v177, v177, v228
v_sub_f32 v178, v178, v228
v_sub_f32 v179, v179, v228
v_sub_f32 v180, v180, v228
v_sub_f32 v181, v181, v228
v_sub_f32 v182, v182, v228
v_sub_f32 v183, v183, v228
v_sub_f32 v184, v184, v228
v_sub_f32 v185, v185, v228
v_sub_f32 v186, v186, v228
v_sub_f32 v187, v187, v228
v_sub_f32 v188, v188, v228
v_sub_f32 v189, v189, v228
v_sub_f32 v190, v190, v228
v_sub_f32 v191, v191, v228
s_mov_b32 s19, 1
s_branch LA_ren1retA0
LA_ren2A0:
v_mul_f32 v160, v160, v226
v_mul_f32 v161, v161, v226
v_mul_f32 v162, v162, v226
v_mul_f32 v163, v163, v226
v_mul_f32 v164, v164, v226
v_mul_f32 v165, v165, v226
v_mul_f32 v166, v166, v226
v_mul_f32 v167, v167, v226
v_mul_f32 v168, v168, v226
v_mul_f32 v169, v169, v226
v_mul_f32 v170, v170, v226
v_mul_f32 v171, v171, v226
v_mul_f32 v172, v172, v226
v_mul_f32 v173, v173, v226
v_mul_f32 v174, v174, v226
v_mul_f32 v175, v175, v226
s_mov_b32 s19, 0
s_nop 0
s_branch LA_ren2retA0
LA_ren1A1:
v_mov_b32 v229, v172
v_mov_b32 v228, v172
s_nop 1
v_permlane32_swap_b32 v229, v228
v_frexp_exp_i32_f32 v228, v228
v_max_i32 v228, 0, v228
v_sub_u32 v229, 0, v228
v_ldexp_f32 v226, 1.0, v229
v_cvt_f32_i32 v228, v228
v_sub_f32 v176, v176, v228
v_sub_f32 v177, v177, v228
v_sub_f32 v178, v178, v228
v_sub_f32 v179, v179, v228
v_sub_f32 v180, v180, v228
v_sub_f32 v181, v181, v228
v_sub_f32 v182, v182, v228
v_sub_f32 v183, v183, v228
v_sub_f32 v184, v184, v228
v_sub_f32 v185, v185, v228
v_sub_f32 v186, v186, v228
v_sub_f32 v187, v187, v228
v_sub_f32 v188, v188, v228
v_sub_f32 v189, v189, v228
v_sub_f32 v190, v190, v228
v_sub_f32 v191, v191, v228
s_mov_b32 s19, 1
s_branch LA_ren1retA1
LA_ren2A1:
v_mul_f32 v160, v160, v226
v_mul_f32 v161, v161, v226
v_mul_f32 v162, v162, v226
v_mul_f32 v163, v163, v226
v_mul_f32 v164, v164, v226
v_mul_f32 v165, v165, v226
v_mul_f32 v166, v166, v226
v_mul_f32 v167, v167, v226
v_mul_f32 v168, v168, v226
v_mul_f32 v169, v169, v226
v_mul_f32 v170, v170, v226
v_mul_f32 v171, v171, v226
v_mul_f32 v172, v172, v226
v_mul_f32 v173, v173, v226
v_mul_f32 v174, v174, v226
v_mul_f32 v175, v175, v226
s_mov_b32 s19, 0
s_nop 0
s_branch LA_ren2retA1
LA_ren1A2:
v_mov_b32 v229, v172
v_mov_b32 v228, v172
s_nop 1
v_permlane32_swap_b32 v229, v228
v_frexp_exp_i32_f32 v228, v228
v_max_i32 v228, 0, v228
v_sub_u32 v229, 0, v228
v_ldexp_f32 v226, 1.0, v229
v_cvt_f32_i32 v228, v228
v_sub_f32 v176, v176, v228
v_sub_f32 v177, v177, v228
v_sub_f32 v178, v178, v228
v_sub_f32 v179, v179, v228
v_sub_f32 v180, v180, v228
v_sub_f32 v181, v181, v228
v_sub_f32 v182, v182, v228
v_sub_f32 v183, v183, v228
v_sub_f32 v184, v184, v228
v_sub_f32 v185, v185, v228
v_sub_f32 v186, v186, v228
v_sub_f32 v187, v187, v228
v_sub_f32 v188, v188, v228
v_sub_f32 v189, v189, v228
v_sub_f32 v190, v190, v228
v_sub_f32 v191, v191, v228
s_mov_b32 s19, 1
s_branch LA_ren1retA2
LA_ren2A2:
v_mul_f32 v160, v160, v226
v_mul_f32 v161, v161, v226
v_mul_f32 v162, v162, v226
v_mul_f32 v163, v163, v226
v_mul_f32 v164, v164, v226
v_mul_f32 v165, v165, v226
v_mul_f32 v166, v166, v226
v_mul_f32 v167, v167, v226
v_mul_f32 v168, v168, v226
v_mul_f32 v169, v169, v226
v_mul_f32 v170, v170, v226
v_mul_f32 v171, v171, v226
v_mul_f32 v172, v172, v226
v_mul_f32 v173, v173, v226
v_mul_f32 v174, v174, v226
v_mul_f32 v175, v175, v226
s_mov_b32 s19, 0
s_nop 0
s_branch LA_ren2retA2
LA_ren1A3:
v_mov_b32 v229, v172
v_mov_b32 v228, v172
s_nop 1
v_permlane32_swap_b32 v229, v228
v_frexp_exp_i32_f32 v228, v228
v_max_i32 v228, 0, v228
v_sub_u32 v229, 0, v228
v_ldexp_f32 v226, 1.0, v229
v_cvt_f32_i32 v228, v228
v_sub_f32 v176, v176, v228
v_sub_f32 v177, v177, v228
v_sub_f32 v178, v178, v228
v_sub_f32 v179, v179, v228
v_sub_f32 v180, v180, v228
v_sub_f32 v181, v181, v228
v_sub_f32 v182, v182, v228
v_sub_f32 v183, v183, v228
v_sub_f32 v184, v184, v228
v_sub_f32 v185, v185, v228
v_sub_f32 v186, v186, v228
v_sub_f32 v187, v187, v228
v_sub_f32 v188, v188, v228
v_sub_f32 v189, v189, v228
v_sub_f32 v190, v190, v228
v_sub_f32 v191, v191, v228
s_mov_b32 s19, 1
s_branch LA_ren1retA3
LA_ren2A3:
v_mul_f32 v160, v160, v226
v_mul_f32 v161, v161, v226
v_mul_f32 v162, v162, v226
v_mul_f32 v163, v163, v226
v_mul_f32 v164, v164, v226
v_mul_f32 v165, v165, v226
v_mul_f32 v166, v166, v226
v_mul_f32 v167, v167, v226
v_mul_f32 v168, v168, v226
v_mul_f32 v169, v169, v226
v_mul_f32 v170, v170, v226
v_mul_f32 v171, v171, v226
v_mul_f32 v172, v172, v226
v_mul_f32 v173, v173, v226
v_mul_f32 v174, v174, v226
v_mul_f32 v175, v175, v226
s_mov_b32 s19, 0
s_nop 0
s_branch LA_ren2retA3
L2_seg:
v_add_u32 v2, s70, v1
v_add_u32 v3, s69, v1
ds_read_b128 a[128:131], v3 offset:0
ds_read_b128 a[132:135], v3 offset:1024
ds_read_b128 a[136:139], v3 offset:2048
ds_read_b128 a[140:143], v3 offset:3072
ds_read_b128 a[144:147], v3 offset:4096
ds_read_b128 a[148:151], v3 offset:5120
ds_read_b128 a[152:155], v3 offset:6144
ds_read_b128 a[156:159], v3 offset:7168
v_mov_b64 v[80:81], 0
v_mov_b64 v[82:83], 0
v_mov_b64 v[84:85], 0
v_mov_b64 v[86:87], 0
v_mov_b64 v[88:89], 0
v_mov_b64 v[90:91], 0
v_mov_b64 v[92:93], 0
v_mov_b64 v[94:95], 0
v_mov_b32 v6, 0
v_mov_b32 v8, 0
v_mov_b32 v7, 0
v_mov_b32 v9, 0
s_lshl_b32 s65, s61, 2
s_add_u32 s65, s65, s48
s_sub_u32 s64, s63, 1
s_min_u32 s64, s64, s65
s_sub_u32 s67, s62, s71
s_mov_b64 s[16:17], 0
s_sub_u32 s90, s72, 4
s_bitset1_b64 s[16:17], s90
s_sub_u32 s90, s87, 4
s_bitset1_b64 s[16:17], s90
s_cmp_lg_u32 s80, 0
s_cbranch_scc1 L2_noaf
s_add_u32 s90, s90, 1
s_bitset1_b64 s[16:17], s90
s_add_u32 s90, s90, 1
s_bitset1_b64 s[16:17], s90
s_add_u32 s90, s90, 1
s_bitset1_b64 s[16:17], s90
s_bitset1_b64 s[16:17], s18
L2_noaf:
s_bitset1_b64 s[16:17], s45
s_sub_u32 s90, s45, 3
s_bitset1_b64 s[16:17], s90
s_sub_u32 s90, s65, s67
s_sub_u32 s90, s90, 1
s_bitset1_b64 s[16:17], s90
s_sub_u32 s90, s64, s67
s_bitset1_b64 s[16:17], s90
s_cmp_gt_u32 s62, s65
s_cbranch_scc1 L2_nowork
s_cmp_lg_u32 s62, s65
s_cbranch_scc1 L2_pre_nomask
v_mov_b32 v16, 0xff800000
v_cndmask_b32 v80, v16, v80, s[32:33]
v_cndmask_b32 v92, v16, v92, s[32:33]
v_mov_b32 v88, 0xff800000
v_cndmask_b32 v81, v16, v81, s[34:35]
v_cndmask_b32 v93, v16, v93, s[34:35]
v_mov_b32 v89, 0xff800000
v_cndmask_b32 v82, v16, v82, s[36:37]
v_cndmask_b32 v94, v16, v94, s[36:37]
v_mov_b32 v90, 0xff800000
v_cndmask_b32 v83, v16, v83, s[38:39]
v_cndmask_b32 v95, v16, v95, s[38:39]
v_mov_b32 v91, 0xff800000
s_nop 1
L2_pre_nomask:
s_waitcnt lgkmcnt(7)
v_mfma_f32_16x16x32_bf16 v[96:99], a[128:131], a[0:3], v[80:83]
v_mov_b64 v[254:255], 0
v_mov_b64 v[252:253], 0
v_mfma_f32_16x16x32_bf16 v[100:103], a[128:131], a[32:35], v[84:87]
ds_read_b128 a[128:131], v3 offset:8192
v_mov_b64 v[250:251], 0
s_waitcnt lgkmcnt(7)
v_mfma_f32_16x16x32_bf16 v[96:99], a[132:135], a[4:7], v[96:99]
v_mov_b64 v[248:249], 0
v_mov_b64 v[246:247], 0
v_mfma_f32_16x16x32_bf16 v[100:103], a[132:135], a[36:39], v[100:103]
ds_read_b128 a[132:135], v3 offset:9216
v_mov_b64 v[244:245], 0
s_waitcnt lgkmcnt(7)
v_mfma_f32_16x16x32_bf16 v[96:99], a[136:139], a[8:11], v[96:99]
v_mov_b64 v[242:243], 0
v_mov_b64 v[240:241], 0
v_mfma_f32_16x16x32_bf16 v[100:103], a[136:139], a[40:43], v[100:103]
ds_read_b128 a[136:139], v3 offset:10240
v_mov_b64 v[238:239], 0
s_waitcnt lgkmcnt(7)
v_mfma_f32_16x16x32_bf16 v[96:99], a[140:143], a[12:15], v[96:99]
v_mov_b64 v[236:237], 0
v_mov_b64 v[234:235], 0
v_mfma_f32_16x16x32_bf16 v[100:103], a[140:143], a[44:47], v[100:103]
ds_read_b128 a[140:143], v3 offset:11264
v_mov_b64 v[232:233], 0
s_waitcnt lgkmcnt(7)
v_mfma_f32_16x16x32_bf16 v[96:99], a[144:147], a[16:19], v[96:99]
v_mov_b64 v[230:231], 0
v_mov_b64 v[228:229], 0
v_mfma_f32_16x16x32_bf16 v[100:103], a[144:147], a[48:51], v[100:103]
ds_read_b128 a[144:147], v3 offset:12288
v_mov_b64 v[226:227], 0
s_waitcnt lgkmcnt(7)
v_mfma_f32_16x16x32_bf16 v[96:99], a[148:151], a[20:23], v[96:99]
v_mov_b64 v[224:225], 0
v_mov_b64 v[222:223], 0
v_mfma_f32_16x16x32_bf16 v[100:103], a[148:151], a[52:55], v[100:103]
ds_read_b128 a[148:151], v3 offset:13312
v_mov_b64 v[220:221], 0
s_waitcnt lgkmcnt(7)
v_mfma_f32_16x16x32_bf16 v[96:99], a[152:155], a[24:27], v[96:99]
v_mov_b64 v[218:219], 0
v_mov_b64 v[216:217], 0
v_mfma_f32_16x16x32_bf16 v[100:103], a[152:155], a[56:59], v[100:103]
ds_read_b128 a[152:155], v3 offset:14336
v_mov_b64 v[214:215], 0
s_waitcnt lgkmcnt(7)
v_mfma_f32_16x16x32_bf16 v[96:99], a[156:159], a[28:31], v[96:99]
v_mov_b64 v[212:213], 0
v_mov_b64 v[210:211], 0
v_mfma_f32_16x16x32_bf16 v[100:103], a[156:159], a[60:63], v[100:103]
ds_read_b128 a[156:159], v3 offset:15360
v_mov_b64 v[208:209], 0
s_waitcnt lgkmcnt(7)
v_mfma_f32_16x16x32_bf16 v[104:107], a[128:131], a[0:3], v[88:91]
v_mov_b64 v[206:207], 0
v_mov_b64 v[204:205], 0
v_mfma_f32_16x16x32_bf16 v[108:111], a[128:131], a[32:35], v[92:95]
v_mov_b64 v[202:203], 0
v_mov_b64 v[200:201], 0
s_waitcnt lgkmcnt(6)
v_mfma_f32_16x16x32_bf16 v[104:107], a[132:135], a[4:7], v[104:107]
v_mov_b64 v[198:199], 0
v_mov_b64 v[196:197], 0
v_mfma_f32_16x16x32_bf16 v[108:111], a[132:135], a[36:39], v[108:111]
v_mov_b64 v[194:195], 0
v_mov_b64 v[192:193], 0
s_waitcnt lgkmcnt(5)
v_mfma_f32_16x16x32_bf16 v[104:107], a[136:139], a[8:11], v[104:107]
v_mov_b64 v[190:191], 0
v_mov_b64 v[188:189], 0
v_mfma_f32_16x16x32_bf16 v[108:111], a[136:139], a[40:43], v[108:111]
v_mov_b64 v[186:187], 0
v_mov_b64 v[184:185], 0
s_waitcnt lgkmcnt(4)
v_mfma_f32_16x16x32_bf16 v[104:107], a[140:143], a[12:15], v[104:107]
v_mov_b64 v[182:183], 0
v_mov_b64 v[180:181], 0
v_mfma_f32_16x16x32_bf16 v[108:111], a[140:143], a[44:47], v[108:111]
v_mov_b64 v[178:179], 0
v_mov_b64 v[176:177], 0
s_waitcnt lgkmcnt(3)
v_mfma_f32_16x16x32_bf16 v[104:107], a[144:147], a[16:19], v[104:107]
v_mov_b64 v[174:175], 0
v_mov_b64 v[172:173], 0
v_mfma_f32_16x16x32_bf16 v[108:111], a[144:147], a[48:51], v[108:111]
v_mov_b64 v[170:171], 0
v_mov_b64 v[168:169], 0
s_waitcnt lgkmcnt(2)
v_mfma_f32_16x16x32_bf16 v[104:107], a[148:151], a[20:23], v[104:107]
v_mov_b64 v[166:167], 0
v_mov_b64 v[164:165], 0
v_mfma_f32_16x16x32_bf16 v[108:111], a[148:151], a[52:55], v[108:111]
v_mov_b64 v[162:163], 0
v_mov_b64 v[160:161], 0
s_waitcnt lgkmcnt(1)
v_mfma_f32_16x16x32_bf16 v[104:107], a[152:155], a[24:27], v[104:107]
v_mov_b64 v[158:159], 0
v_mov_b64 v[156:157], 0
v_mfma_f32_16x16x32_bf16 v[108:111], a[152:155], a[56:59], v[108:111]
v_mov_b64 v[154:155], 0
v_mov_b64 v[152:153], 0
s_waitcnt lgkmcnt(0)
v_mfma_f32_16x16x32_bf16 v[104:107], a[156:159], a[28:31], v[104:107]
v_mov_b64 v[150:151], 0
v_mov_b64 v[148:149], 0
v_mfma_f32_16x16x32_bf16 v[108:111], a[156:159], a[60:63], v[108:111]
v_mov_b64 v[146:147], 0
v_mov_b64 v[144:145], 0
v_mov_b64 v[128:129], 0
v_mov_b64 v[130:131], 0
v_mov_b64 v[132:133], 0
v_mov_b64 v[134:135], 0
v_mov_b64 v[136:137], 0
v_mov_b64 v[138:139], 0
v_mov_b64 v[140:141], 0
v_mov_b64 v[142:143], 0
ds_read_b128 a[128:131], v2 offset:0
ds_read_b128 a[132:135], v2 offset:1024
ds_read_b128 a[136:139], v2 offset:2048
ds_read_b128 a[140:143], v2 offset:3072
ds_read_b128 a[144:147], v2 offset:4096
ds_read_b128 a[148:151], v2 offset:5120
s_nop 1
v_max3_f32 v16, v96, v97, v98
v_max3_f32 v16, v16, v99, v104
v_max3_f32 v16, v16, v105, v106
v_max_f32 v16, v16, v107
v_max3_f32 v18, v100, v101, v102
v_max3_f32 v18, v18, v103, v108
v_max3_f32 v18, v18, v109, v110
v_max_f32 v18, v18, v111
v_mov_b32 v17, v16
v_mov_b32 v19, v18
s_nop 1
v_permlane16_swap_b32 v16, v17
v_permlane16_swap_b32 v18, v19
v_max_f32 v16, v16, v17
v_max_f32 v18, v18, v19
v_mov_b32 v17, v16
v_mov_b32 v19, v18
s_nop 1
v_permlane32_swap_b32 v16, v17
v_permlane32_swap_b32 v18, v19
v_max_f32 v16, v16, v17
v_max_f32 v18, v18, v19
v_add_f32 v8, v8, v16
v_sub_f32 v80, v80, v16
v_sub_f32 v112, v96, v16
v_sub_f32 v81, v81, v16
v_sub_f32 v113, v97, v16
v_sub_f32 v82, v82, v16
v_sub_f32 v114, v98, v16
v_sub_f32 v83, v83, v16
v_sub_f32 v115, v99, v16
v_sub_f32 v88, v88, v16
v_sub_f32 v120, v104, v16
v_sub_f32 v89, v89, v16
v_sub_f32 v121, v105, v16
v_sub_f32 v90, v90, v16
v_sub_f32 v122, v106, v16
v_sub_f32 v91, v91, v16
v_sub_f32 v123, v107, v16
v_exp_f32 v112, v112
v_exp_f32 v113, v113
v_exp_f32 v114, v114
v_exp_f32 v115, v115
v_exp_f32 v120, v120
v_exp_f32 v121, v121
v_exp_f32 v122, v122
v_exp_f32 v123, v123
s_nop 0
v_add_f32 v4, v112, v113
v_add_f32 v4, v4, v114
v_add_f32 v4, v4, v115
v_add_f32 v4, v4, v120
v_add_f32 v4, v4, v121
v_add_f32 v4, v4, v122
v_add_f32 v4, v4, v123
v_add_f32 v9, v9, v18
v_sub_f32 v84, v84, v18
v_sub_f32 v116, v100, v18
v_sub_f32 v85, v85, v18
v_sub_f32 v117, v101, v18
v_sub_f32 v86, v86, v18
v_sub_f32 v118, v102, v18
v_sub_f32 v87, v87, v18
v_sub_f32 v119, v103, v18
v_sub_f32 v92, v92, v18
v_sub_f32 v124, v108, v18
v_sub_f32 v93, v93, v18
v_sub_f32 v125, v109, v18
v_sub_f32 v94, v94, v18
v_sub_f32 v126, v110, v18
v_sub_f32 v95, v95, v18
v_sub_f32 v127, v111, v18
v_exp_f32 v116, v116
v_exp_f32 v117, v117
v_exp_f32 v118, v118
v_exp_f32 v119, v119
v_exp_f32 v124, v124
v_exp_f32 v125, v125
v_exp_f32 v126, v126
v_exp_f32 v127, v127
s_nop 0
v_add_f32 v5, v116, v117
v_add_f32 v5, v5, v118
v_add_f32 v5, v5, v119
v_add_f32 v5, v5, v124
v_add_f32 v5, v5, v125
v_add_f32 v5, v5, v126
v_add_f32 v5, v5, v127
s_waitcnt lgkmcnt(0)
s_cmp_lg_u32 s80, 2
s_cbranch_scc1 L2_next
s_waitcnt vmcnt(0)
s_barrier
s_cmp_lg_u32 s48, 0
s_cbranch_scc1 L2_next
v_mov_b32 v18, s89
v_mov_b32 v19, 0
s_mov_b64 exec, 1
buffer_store_dword v18, v19, s[20:23], s19 offen sc0 sc1
s_mov_b64 exec, -1
s_branch L2_next
.p2align 6
L2_full:
v_mfma_f32_16x16x32_bf16 v[96:99], a[128:131], a[0:3], v[80:83]
ds_read_b128 a[152:155], v2 offset:6144
v_cvt_pk_bf16_f32 v72, v112, v113
v_mfma_f32_16x16x32_bf16 v[100:103], a[128:131], a[32:35], v[84:87]
s_waitcnt lgkmcnt(4)
s_mov_b32 m0, s68
v_mfma_f32_16x16x32_bf16 v[96:99], a[132:135], a[4:7], v[96:99]
ds_read_b128 a[156:159], v2 offset:7168
v_cvt_pk_bf16_f32 v73, v114, v115
v_mfma_f32_16x16x32_bf16 v[100:103], a[132:135], a[36:39], v[100:103]
buffer_load_dwordx4 v12, s[12:15], s66 offen offset:0 sc1 lds
v_mfma_f32_16x16x32_bf16 v[96:99], a[136:139], a[8:11], v[96:99]
ds_read_b128 a[128:131], v2 offset:8192
v_cvt_pk_bf16_f32 v74, v120, v121
v_mfma_f32_16x16x32_bf16 v[100:103], a[136:139], a[40:43], v[100:103]
s_waitcnt lgkmcnt(4)
v_add_u32 v3, s69, v1
v_mfma_f32_16x16x32_bf16 v[96:99], a[140:143], a[12:15], v[96:99]
ds_read_b128 a[132:135], v2 offset:9216
v_cvt_pk_bf16_f32 v75, v122, v123
v_mfma_f32_16x16x32_bf16 v[100:103], a[140:143], a[44:47], v[100:103]
buffer_load_dwordx4 v12, s[12:15], s66 offen offset:1024 sc1 lds
v_mfma_f32_16x16x32_bf16 v[96:99], a[144:147], a[16:19], v[96:99]
ds_read_b128 a[136:139], v2 offset:10240
v_cvt_pk_bf16_f32 v76, v116, v117
v_mfma_f32_16x16x32_bf16 v[100:103], a[144:147], a[48:51], v[100:103]
s_waitcnt lgkmcnt(4)
v_mfma_f32_16x16x32_bf16 v[96:99], a[148:151], a[20:23], v[96:99]
ds_read_b128 a[140:143], v2 offset:11264
v_cvt_pk_bf16_f32 v77, v118, v119
v_mfma_f32_16x16x32_bf16 v[100:103], a[148:151], a[52:55], v[100:103]
buffer_load_dwordx4 v12, s[12:15], s66 offen offset:2048 sc1 lds
v_mfma_f32_16x16x32_bf16 v[96:99], a[152:155], a[24:27], v[96:99]
ds_read_b128 a[144:147], v2 offset:12288
v_cvt_pk_bf16_f32 v78, v124, v125
v_mfma_f32_16x16x32_bf16 v[100:103], a[152:155], a[56:59], v[100:103]
s_waitcnt lgkmcnt(4)
v_mfma_f32_16x16x32_bf16 v[96:99], a[156:159], a[28:31], v[96:99]
ds_read_b128 a[148:151], v2 offset:13312
v_cvt_pk_bf16_f32 v79, v126, v127
v_mfma_f32_16x16x32_bf16 v[100:103], a[156:159], a[60:63], v[100:103]
buffer_load_dwordx4 v12, s[12:15], s66 offen offset:3072 sc1 lds
v_mfma_f32_16x16x32_bf16 v[104:107], a[128:131], a[0:3], v[88:91]
ds_read_b128 a[152:155], v2 offset:14336
v_add_f32 v6, v6, v4
v_mfma_f32_16x16x32_bf16 v[108:111], a[128:131], a[32:35], v[92:95]
s_waitcnt lgkmcnt(4)
v_mfma_f32_16x16x32_bf16 v[104:107], a[132:135], a[4:7], v[104:107]
ds_read_b128 a[156:159], v2 offset:15360
v_add_f32 v7, v7, v5
v_mfma_f32_16x16x32_bf16 v[108:111], a[132:135], a[36:39], v[108:111]
s_add_u32 s73, s70, 32768
v_exp_f32 v112, v96
v_mfma_f32_16x16x32_bf16 v[104:107], a[136:139], a[8:11], v[104:107]
ds_read_b128 a[128:131], v3 offset:16384
v_mfma_f32_16x16x32_bf16 v[108:111], a[136:139], a[40:43], v[108:111]
s_waitcnt lgkmcnt(4)
v_exp_f32 v113, v97
v_mfma_f32_16x16x32_bf16 v[104:107], a[140:143], a[12:15], v[104:107]
ds_read_b128 a[132:135], v3 offset:17408
v_add_f32 v4, v112, v113
v_mfma_f32_16x16x32_bf16 v[108:111], a[140:143], a[44:47], v[108:111]
s_cmp_eq_u32 s73, s86
v_exp_f32 v114, v98
v_mfma_f32_16x16x32_bf16 v[104:107], a[144:147], a[16:19], v[104:107]
ds_read_b128 a[136:139], v3 offset:18432
v_add_f32 v4, v4, v114
v_mfma_f32_16x16x32_bf16 v[108:111], a[144:147], a[48:51], v[108:111]
s_waitcnt lgkmcnt(4)
v_exp_f32 v115, v99
v_mfma_f32_16x16x32_bf16 v[104:107], a[148:151], a[20:23], v[104:107]
ds_read_b128 a[140:143], v3 offset:19456
v_add_f32 v4, v4, v115
v_mfma_f32_16x16x32_bf16 v[108:111], a[148:151], a[52:55], v[108:111]
s_cselect_b32 s73, s74, s73
v_exp_f32 v116, v100
v_mfma_f32_16x16x32_bf16 v[104:107], a[152:155], a[24:27], v[104:107]
ds_read_b128 a[144:147], v3 offset:20480
v_add_u32 v2, s73, v1
v_mfma_f32_16x16x32_bf16 v[108:111], a[152:155], a[56:59], v[108:111]
s_waitcnt lgkmcnt(4)
v_exp_f32 v117, v101
v_mfma_f32_16x16x32_bf16 v[104:107], a[156:159], a[28:31], v[104:107]
ds_read_b128 a[148:151], v3 offset:21504
v_add_f32 v5, v116, v117
v_mfma_f32_16x16x32_bf16 v[108:111], a[156:159], a[60:63], v[108:111]
s_add_u32 s71, s71, 1
v_exp_f32 v118, v102
v_mfma_f32_16x16x32_bf16 v[128:131], a[128:131], v[72:75], v[128:131]
ds_read_b128 a[152:155], v3 offset:22528
v_add_f32 v5, v5, v118
v_mfma_f32_16x16x32_bf16 v[132:135], a[128:131], v[76:79], v[132:135]
s_waitcnt lgkmcnt(4)
v_exp_f32 v119, v103
v_mfma_f32_16x16x32_bf16 v[136:139], a[132:135], v[72:75], v[136:139]
ds_read_b128 a[156:159], v3 offset:23552
v_add_f32 v5, v5, v119
v_mfma_f32_16x16x32_bf16 v[140:143], a[132:135], v[76:79], v[140:143]
v_exp_f32 v120, v104
v_mfma_f32_16x16x32_bf16 v[144:147], a[136:139], v[72:75], v[144:147]
ds_read_b128 a[128:131], v3 offset:24576
v_add_f32 v4, v4, v120
v_mfma_f32_16x16x32_bf16 v[148:151], a[136:139], v[76:79], v[148:151]
s_waitcnt lgkmcnt(4)
v_exp_f32 v121, v105
v_mfma_f32_16x16x32_bf16 v[152:155], a[140:143], v[72:75], v[152:155]
ds_read_b128 a[132:135], v3 offset:25600
v_add_f32 v4, v4, v121
v_mfma_f32_16x16x32_bf16 v[156:159], a[140:143], v[76:79], v[156:159]
v_exp_f32 v122, v106
v_mfma_f32_16x16x32_bf16 v[160:163], a[144:147], v[72:75], v[160:163]
ds_read_b128 a[136:139], v3 offset:26624
v_add_f32 v4, v4, v122
v_mfma_f32_16x16x32_bf16 v[164:167], a[144:147], v[76:79], v[164:167]
s_waitcnt lgkmcnt(4)
v_exp_f32 v123, v107
v_mfma_f32_16x16x32_bf16 v[168:171], a[148:151], v[72:75], v[168:171]
ds_read_b128 a[140:143], v3 offset:27648
v_add_f32 v4, v4, v123
v_mfma_f32_16x16x32_bf16 v[172:175], a[148:151], v[76:79], v[172:175]
v_exp_f32 v124, v108
v_mfma_f32_16x16x32_bf16 v[176:179], a[152:155], v[72:75], v[176:179]
ds_read_b128 a[144:147], v3 offset:28672
v_add_f32 v5, v5, v124
v_mfma_f32_16x16x32_bf16 v[180:183], a[152:155], v[76:79], v[180:183]
s_waitcnt lgkmcnt(4)
v_exp_f32 v125, v109
v_mfma_f32_16x16x32_bf16 v[184:187], a[156:159], v[72:75], v[184:187]
ds_read_b128 a[148:151], v3 offset:29696
v_add_f32 v5, v5, v125
v_mfma_f32_16x16x32_bf16 v[188:191], a[156:159], v[76:79], v[188:191]
s_add_u32 m0, s68, 16384
v_exp_f32 v126, v110
v_mfma_f32_16x16x32_bf16 v[192:195], a[128:131], v[72:75], v[192:195]
ds_read_b128 a[152:155], v3 offset:30720
v_add_f32 v5, v5, v126
v_mfma_f32_16x16x32_bf16 v[196:199], a[128:131], v[76:79], v[196:199]
s_waitcnt lgkmcnt(4)
v_exp_f32 v127, v111
v_mfma_f32_16x16x32_bf16 v[200:203], a[132:135], v[72:75], v[200:203]
ds_read_b128 a[156:159], v3 offset:31744
v_add_f32 v5, v5, v127
v_mfma_f32_16x16x32_bf16 v[204:207], a[132:135], v[76:79], v[204:207]
s_waitcnt vmcnt(16)
s_barrier
v_mfma_f32_16x16x32_bf16 v[208:211], a[136:139], v[72:75], v[208:211]
ds_read_b128 a[128:131], v2 offset:0
s_waitcnt lgkmcnt(4)
v_mfma_f32_16x16x32_bf16 v[212:215], a[136:139], v[76:79], v[212:215]
buffer_load_dwordx4 v13, s[12:15], s66 offen offset:0 sc1 lds
v_mfma_f32_16x16x32_bf16 v[216:219], a[140:143], v[72:75], v[216:219]
ds_read_b128 a[132:135], v2 offset:1024
v_max_f32 v16, v4, v5
v_mfma_f32_16x16x32_bf16 v[220:223], a[140:143], v[76:79], v[220:223]
buffer_load_dwordx4 v13, s[12:15], s66 offen offset:1024 sc1 lds
v_mfma_f32_16x16x32_bf16 v[224:227], a[144:147], v[72:75], v[224:227]
ds_read_b128 a[136:139], v2 offset:2048
s_waitcnt lgkmcnt(4)
v_mfma_f32_16x16x32_bf16 v[228:231], a[144:147], v[76:79], v[228:231]
buffer_load_dwordx4 v13, s[12:15], s66 offen offset:2048 sc1 lds
v_mfma_f32_16x16x32_bf16 v[232:235], a[148:151], v[72:75], v[232:235]
ds_read_b128 a[140:143], v2 offset:3072
v_cmp_lt_f32 vcc, s81, v16
v_mfma_f32_16x16x32_bf16 v[236:239], a[148:151], v[76:79], v[236:239]
buffer_load_dwordx4 v13, s[12:15], s66 offen offset:3072 sc1 lds
v_mfma_f32_16x16x32_bf16 v[240:243], a[152:155], v[72:75], v[240:243]
ds_read_b128 a[144:147], v2 offset:4096
s_waitcnt lgkmcnt(4)
v_mfma_f32_16x16x32_bf16 v[244:247], a[152:155], v[76:79], v[244:247]
s_mov_b32 s68, s69
s_mov_b32 s69, s70
s_mov_b32 s70, s73
v_mfma_f32_16x16x32_bf16 v[248:251], a[156:159], v[72:75], v[248:251]
ds_read_b128 a[148:151], v2 offset:5120
s_add_u32 s66, s66, 32768
v_mfma_f32_16x16x32_bf16 v[252:255], a[156:159], v[76:79], v[252:255]
s_bitcmp1_b64 s[16:17], s71
s_cbranch_vccnz L2_rare0
L2_rareret0:
s_cbranch_scc0 L2_full
L2_hand:
s_add_u32 s90, s71, 4
s_cmp_eq_u32 s90, s72
s_cselect_b32 s66, s75, s66
s_cmp_ge_u32 s90, s87
s_cselect_b32 s14, 0, s14
s_cmp_lg_u32 s90, s87
s_cbranch_scc1 L2_nocpF
s_getpc_b64 s[76:77]
Lpw_tF:
s_add_u32 s76, s76, L2_segend-Lpw_tF
s_addc_u32 s77, s77, 0
s_mov_b32 s78, L_text_end-L2_segend
s_mov_b32 s79, 0x20000
s_lshr_b32 s90, s2, 1
s_and_b32 s90, s90, 60
s_add_u32 s90, s90, s48
s_lshl_b32 s90, s90, 10
buffer_load_dwordx4 a[176:179], v12, s[76:79], s90 offen
L2_nocpF:
s_cmp_eq_u32 s71, s18
s_cbranch_scc0 L2_nopbF
s_cmp_lg_u32 s48, 0
s_cbranch_scc1 L2_nopbF
v_mov_b32 v18, s89
v_mov_b32 v19, 0
s_mov_b64 exec, 1
buffer_store_dword v18, v19, s[20:23], s19 offen sc0 sc1
buffer_store_dword v18, v19, s[20:23], s98 offen sc0 sc1
s_mov_b64 exec, -1
L2_nopbF:
s_add_u32 s90, s71, 3
s_cmp_eq_u32 s90, s45
s_cbranch_scc0 L2_nolF
buffer_load_dword v14, v15, s[20:23], s99 offen offset:8 sc0 sc1
L2_nolF:
s_cmp_eq_u32 s71, s45
s_cbranch_scc0 L2_nocF
s_mov_b32 s90, 0
L2_chkF:
v_cmp_ne_u32 vcc, s89, v14
s_cbranch_vccz L2_nocF
s_cmp_gt_u32 s90, 200000
s_cbranch_scc1 L2_nocF
s_sleep 2
buffer_load_dword v14, v15, s[20:23], s99 offen offset:8 sc0 sc1
s_add_u32 s90, s90, 1
s_waitcnt vmcnt(0)
s_branch L2_chkF
L2_nocF:
s_cmp_eq_u32 s80, 0
s_cbranch_scc1 L2_afetchF
L2_nopubF:
L2_next:
s_add_u32 s62, s71, s67
s_cmp_ge_u32 s62, s64
s_cbranch_scc1 L2_pv
s_add_u32 s90, s62, 1
s_cmp_lg_u32 s90, s65
s_cbranch_scc1 L2_full
v_mov_b32 v16, 0xff800000
v_cndmask_b32 v80, v16, v80, s[32:33]
v_cndmask_b32 v92, v16, v92, s[32:33]
v_mov_b32 v88, 0xff800000
v_cndmask_b32 v81, v16, v81, s[34:35]
v_cndmask_b32 v93, v16, v93, s[34:35]
v_mov_b32 v89, 0xff800000
v_cndmask_b32 v82, v16, v82, s[36:37]
v_cndmask_b32 v94, v16, v94, s[36:37]
v_mov_b32 v90, 0xff800000
v_cndmask_b32 v83, v16, v83, s[38:39]
v_cndmask_b32 v95, v16, v95, s[38:39]
v_mov_b32 v91, 0xff800000
s_nop 1
s_branch L2_full
L2_pv:
s_waitcnt lgkmcnt(0)
v_add_u32 v3, s69, v1
s_mov_b32 m0, s68
ds_read_b128 a[128:131], v3 offset:16384
ds_read_b128 a[132:135], v3 offset:17408
ds_read_b128 a[136:139], v3 offset:18432
ds_read_b128 a[140:143], v3 offset:19456
ds_read_b128 a[144:147], v3 offset:20480
ds_read_b128 a[148:151], v3 offset:21504
v_cvt_pk_bf16_f32 v72, v112, v113
v_cvt_pk_bf16_f32 v73, v114, v115
v_cvt_pk_bf16_f32 v74, v120, v121
v_cvt_pk_bf16_f32 v75, v122, v123
v_cvt_pk_bf16_f32 v76, v116, v117
v_cvt_pk_bf16_f32 v77, v118, v119
v_cvt_pk_bf16_f32 v78, v124, v125
v_cvt_pk_bf16_f32 v79, v126, v127
v_add_f32 v6, v6, v4
v_add_f32 v7, v7, v5
s_waitcnt lgkmcnt(5)
v_mfma_f32_16x16x32_bf16 v[128:131], a[128:131], v[72:75], v[128:131]
ds_read_b128 a[152:155], v3 offset:22528
v_mfma_f32_16x16x32_bf16 v[132:135], a[128:131], v[76:79], v[132:135]
buffer_load_dwordx4 v12, s[12:15], s66 offen offset:0 sc1 lds
s_waitcnt lgkmcnt(5)
v_mfma_f32_16x16x32_bf16 v[136:139], a[132:135], v[72:75], v[136:139]
ds_read_b128 a[156:159], v3 offset:23552
v_mfma_f32_16x16x32_bf16 v[140:143], a[132:135], v[76:79], v[140:143]
s_add_u32 s73, s70, 32768
s_cmp_eq_u32 s73, s86
s_cselect_b32 s73, s74, s73
s_waitcnt lgkmcnt(5)
v_mfma_f32_16x16x32_bf16 v[144:147], a[136:139], v[72:75], v[144:147]
ds_read_b128 a[128:131], v3 offset:24576
v_mfma_f32_16x16x32_bf16 v[148:151], a[136:139], v[76:79], v[148:151]
buffer_load_dwordx4 v12, s[12:15], s66 offen offset:1024 sc1 lds
s_waitcnt lgkmcnt(5)
v_mfma_f32_16x16x32_bf16 v[152:155], a[140:143], v[72:75], v[152:155]
ds_read_b128 a[132:135], v3 offset:25600
v_mfma_f32_16x16x32_bf16 v[156:159], a[140:143], v[76:79], v[156:159]
s_add_u32 s71, s71, 1
s_waitcnt lgkmcnt(5)
v_mfma_f32_16x16x32_bf16 v[160:163], a[144:147], v[72:75], v[160:163]
ds_read_b128 a[136:139], v3 offset:26624
v_mfma_f32_16x16x32_bf16 v[164:167], a[144:147], v[76:79], v[164:167]
buffer_load_dwordx4 v12, s[12:15], s66 offen offset:2048 sc1 lds
s_waitcnt lgkmcnt(5)
v_mfma_f32_16x16x32_bf16 v[168:171], a[148:151], v[72:75], v[168:171]
ds_read_b128 a[140:143], v3 offset:27648
v_mfma_f32_16x16x32_bf16 v[172:175], a[148:151], v[76:79], v[172:175]
s_waitcnt lgkmcnt(5)
v_mfma_f32_16x16x32_bf16 v[176:179], a[152:155], v[72:75], v[176:179]
ds_read_b128 a[144:147], v3 offset:28672
v_mfma_f32_16x16x32_bf16 v[180:183], a[152:155], v[76:79], v[180:183]
buffer_load_dwordx4 v12, s[12:15], s66 offen offset:3072 sc1 lds
s_waitcnt lgkmcnt(5)
v_mfma_f32_16x16x32_bf16 v[184:187], a[156:159], v[72:75], v[184:187]
ds_read_b128 a[148:151], v3 offset:29696
v_mfma_f32_16x16x32_bf16 v[188:191], a[156:159], v[76:79], v[188:191]
s_add_u32 m0, s68, 16384
s_waitcnt lgkmcnt(5)
v_mfma_f32_16x16x32_bf16 v[192:195], a[128:131], v[72:75], v[192:195]
ds_read_b128 a[152:155], v3 offset:30720
v_mfma_f32_16x16x32_bf16 v[196:199], a[128:131], v[76:79], v[196:199]
s_waitcnt lgkmcnt(5)
v_mfma_f32_16x16x32_bf16 v[200:203], a[132:135], v[72:75], v[200:203]
ds_read_b128 a[156:159], v3 offset:31744
v_mfma_f32_16x16x32_bf16 v[204:207], a[132:135], v[76:79], v[204:207]
s_waitcnt vmcnt(16)
s_barrier
s_waitcnt lgkmcnt(5)
v_mfma_f32_16x16x32_bf16 v[208:211], a[136:139], v[72:75], v[208:211]
v_mfma_f32_16x16x32_bf16 v[212:215], a[136:139], v[76:79], v[212:215]
buffer_load_dwordx4 v13, s[12:15], s66 offen offset:0 sc1 lds
s_waitcnt lgkmcnt(4)
v_mfma_f32_16x16x32_bf16 v[216:219], a[140:143], v[72:75], v[216:219]
v_mfma_f32_16x16x32_bf16 v[220:223], a[140:143], v[76:79], v[220:223]
buffer_load_dwordx4 v13, s[12:15], s66 offen offset:1024 sc1 lds
s_waitcnt lgkmcnt(3)
v_mfma_f32_16x16x32_bf16 v[224:227], a[144:147], v[72:75], v[224:227]
v_mfma_f32_16x16x32_bf16 v[228:231], a[144:147], v[76:79], v[228:231]
buffer_load_dwordx4 v13, s[12:15], s66 offen offset:2048 sc1 lds
s_waitcnt lgkmcnt(2)
v_mfma_f32_16x16x32_bf16 v[232:235], a[148:151], v[72:75], v[232:235]
v_mfma_f32_16x16x32_bf16 v[236:239], a[148:151], v[76:79], v[236:239]
buffer_load_dwordx4 v13, s[12:15], s66 offen offset:3072 sc1 lds
s_waitcnt lgkmcnt(1)
v_mfma_f32_16x16x32_bf16 v[240:243], a[152:155], v[72:75], v[240:243]
v_mfma_f32_16x16x32_bf16 v[244:247], a[152:155], v[76:79], v[244:247]
s_mov_b32 s68, s69
s_mov_b32 s69, s70
s_mov_b32 s70, s73
s_waitcnt lgkmcnt(0)
v_mfma_f32_16x16x32_bf16 v[248:251], a[156:159], v[72:75], v[248:251]
s_add_u32 s66, s66, 32768
v_mfma_f32_16x16x32_bf16 v[252:255], a[156:159], v[76:79], v[252:255]
s_add_u32 s90, s71, 4
s_cmp_eq_u32 s90, s72
s_cselect_b32 s66, s75, s66
s_cmp_ge_u32 s90, s87
s_cselect_b32 s14, 0, s14
s_cmp_lg_u32 s90, s87
s_cbranch_scc1 L2_nocpP
s_getpc_b64 s[76:77]
Lpw_tP:
s_add_u32 s76, s76, L2_segend-Lpw_tP
s_addc_u32 s77, s77, 0
s_mov_b32 s78, L_text_end-L2_segend
s_mov_b32 s79, 0x20000
s_lshr_b32 s90, s2, 1
s_and_b32 s90, s90, 60
s_add_u32 s90, s90, s48
s_lshl_b32 s90, s90, 10
buffer_load_dwordx4 a[176:179], v12, s[76:79], s90 offen
L2_nocpP:
s_cmp_eq_u32 s71, s18
s_cbranch_scc0 L2_nopbP
s_cmp_lg_u32 s48, 0
s_cbranch_scc1 L2_nopbP
v_mov_b32 v18, s89
v_mov_b32 v19, 0
s_mov_b64 exec, 1
buffer_store_dword v18, v19, s[20:23], s19 offen sc0 sc1
buffer_store_dword v18, v19, s[20:23], s98 offen sc0 sc1
s_mov_b64 exec, -1
L2_nopbP:
s_add_u32 s90, s71, 3
s_cmp_eq_u32 s90, s45
s_cbranch_scc0 L2_nolP
buffer_load_dword v14, v15, s[20:23], s99 offen offset:8 sc0 sc1
L2_nolP:
s_cmp_eq_u32 s71, s45
s_cbranch_scc0 L2_nocP
s_mov_b32 s90, 0
L2_chkP:
v_cmp_ne_u32 vcc, s89, v14
s_cbranch_vccz L2_nocP
s_cmp_gt_u32 s90, 200000
s_cbranch_scc1 L2_nocP
s_sleep 2
buffer_load_dword v14, v15, s[20:23], s99 offen offset:8 sc0 sc1
s_add_u32 s90, s90, 1
s_waitcnt vmcnt(0)
s_branch L2_chkP
L2_nocP:
s_cmp_eq_u32 s80, 0
s_cbranch_scc1 L2_afetchP
L2_nopubP:
L2_idlechk:
s_add_u32 s62, s71, s67
s_cmp_ge_u32 s62, s63
s_cbranch_scc1 L2_segend
s_mov_b32 m0, s68
s_add_u32 s73, s70, 32768
buffer_load_dwordx4 v12, s[12:15], s66 offen offset:0 sc1 lds
buffer_load_dwordx4 v12, s[12:15], s66 offen offset:1024 sc1 lds
buffer_load_dwordx4 v12, s[12:15], s66 offen offset:2048 sc1 lds
buffer_load_dwordx4 v12, s[12:15], s66 offen offset:3072 sc1 lds
s_cmp_eq_u32 s73, s86
s_cselect_b32 s73, s74, s73
s_add_u32 s71, s71, 1
s_add_u32 m0, s68, 16384
s_waitcnt vmcnt(16)
s_barrier
buffer_load_dwordx4 v13, s[12:15], s66 offen offset:0 sc1 lds
buffer_load_dwordx4 v13, s[12:15], s66 offen offset:1024 sc1 lds
buffer_load_dwordx4 v13, s[12:15], s66 offen offset:2048 sc1 lds
buffer_load_dwordx4 v13, s[12:15], s66 offen offset:3072 sc1 lds
s_mov_b32 s68, s69
s_mov_b32 s69, s70
s_mov_b32 s70, s73
s_add_u32 s66, s66, 32768
s_add_u32 s90, s71, 4
s_cmp_eq_u32 s90, s72
s_cselect_b32 s66, s75, s66
s_cmp_ge_u32 s90, s87
s_cselect_b32 s14, 0, s14
s_cmp_lg_u32 s90, s87
s_cbranch_scc1 L2_nocpI
s_getpc_b64 s[76:77]
Lpw_tI:
s_add_u32 s76, s76, L2_segend-Lpw_tI
s_addc_u32 s77, s77, 0
s_mov_b32 s78, L_text_end-L2_segend
s_mov_b32 s79, 0x20000
s_lshr_b32 s90, s2, 1
s_and_b32 s90, s90, 60
s_add_u32 s90, s90, s48
s_lshl_b32 s90, s90, 10
buffer_load_dwordx4 a[176:179], v12, s[76:79], s90 offen
L2_nocpI:
s_cmp_eq_u32 s71, s18
s_cbranch_scc0 L2_nopbI
s_cmp_lg_u32 s48, 0
s_cbranch_scc1 L2_nopbI
v_mov_b32 v18, s89
v_mov_b32 v19, 0
s_mov_b64 exec, 1
buffer_store_dword v18, v19, s[20:23], s19 offen sc0 sc1
buffer_store_dword v18, v19, s[20:23], s98 offen sc0 sc1
s_mov_b64 exec, -1
L2_nopbI:
s_add_u32 s90, s71, 3
s_cmp_eq_u32 s90, s45
s_cbranch_scc0 L2_nolI
buffer_load_dword v14, v15, s[20:23], s99 offen offset:8 sc0 sc1
L2_nolI:
s_cmp_eq_u32 s71, s45
s_cbranch_scc0 L2_nocI
s_mov_b32 s90, 0
L2_chkI:
v_cmp_ne_u32 vcc, s89, v14
s_cbranch_vccz L2_nocI
s_cmp_gt_u32 s90, 200000
s_cbranch_scc1 L2_nocI
s_sleep 2
buffer_load_dword v14, v15, s[20:23], s99 offen offset:8 sc0 sc1
s_add_u32 s90, s90, 1
s_waitcnt vmcnt(0)
s_branch L2_chkI
L2_nocI:
s_cmp_eq_u32 s80, 0
s_cbranch_scc1 L2_afetchI
L2_nopubI:
s_branch L2_idlechk
L2_nowork:
s_waitcnt lgkmcnt(0)
v_mov_b64 v[128:129], 0
v_mov_b64 v[130:131], 0
v_mov_b64 v[132:133], 0
v_mov_b64 v[134:135], 0
v_mov_b64 v[136:137], 0
v_mov_b64 v[138:139], 0
v_mov_b64 v[140:141], 0
v_mov_b64 v[142:143], 0
v_mov_b64 v[144:145], 0
v_mov_b64 v[146:147], 0
v_mov_b64 v[148:149], 0
v_mov_b64 v[150:151], 0
v_mov_b64 v[152:153], 0
v_mov_b64 v[154:155], 0
v_mov_b64 v[156:157], 0
v_mov_b64 v[158:159], 0
v_mov_b64 v[160:161], 0
v_mov_b64 v[162:163], 0
v_mov_b64 v[164:165], 0
v_mov_b64 v[166:167], 0
v_mov_b64 v[168:169], 0
v_mov_b64 v[170:171], 0
v_mov_b64 v[172:173], 0
v_mov_b64 v[174:175], 0
v_mov_b64 v[176:177], 0
v_mov_b64 v[178:179], 0
v_mov_b64 v[180:181], 0
v_mov_b64 v[182:183], 0
v_mov_b64 v[184:185], 0
v_mov_b64 v[186:187], 0
v_mov_b64 v[188:189], 0
v_mov_b64 v[190:191], 0
v_mov_b64 v[192:193], 0
v_mov_b64 v[194:195], 0
v_mov_b64 v[196:197], 0
v_mov_b64 v[198:199], 0
v_mov_b64 v[200:201], 0
v_mov_b64 v[202:203], 0
v_mov_b64 v[204:205], 0
v_mov_b64 v[206:207], 0
v_mov_b64 v[208:209], 0
v_mov_b64 v[210:211], 0
v_mov_b64 v[212:213], 0
v_mov_b64 v[214:215], 0
v_mov_b64 v[216:217], 0
v_mov_b64 v[218:219], 0
v_mov_b64 v[220:221], 0
v_mov_b64 v[222:223], 0
v_mov_b64 v[224:225], 0
v_mov_b64 v[226:227], 0
v_mov_b64 v[228:229], 0
v_mov_b64 v[230:231], 0
v_mov_b64 v[232:233], 0
v_mov_b64 v[234:235], 0
v_mov_b64 v[236:237], 0
v_mov_b64 v[238:239], 0
v_mov_b64 v[240:241], 0
v_mov_b64 v[242:243], 0
v_mov_b64 v[244:245], 0
v_mov_b64 v[246:247], 0
v_mov_b64 v[248:249], 0
v_mov_b64 v[250:251], 0
v_mov_b64 v[252:253], 0
v_mov_b64 v[254:255], 0
v_mov_b32 v8, 0xf149f2ca
v_mov_b32 v9, 0xf149f2ca
s_branch L2_idlechk
L2_rare0:
s_nop 7
v_max3_f32 v16, v96, v97, v98
v_max3_f32 v16, v16, v99, v104
v_max3_f32 v16, v16, v105, v106
v_max_f32 v16, v16, v107
v_max3_f32 v18, v100, v101, v102
v_max3_f32 v18, v18, v103, v108
v_max3_f32 v18, v18, v109, v110
v_max_f32 v18, v18, v111
v_mov_b32 v17, v16
v_mov_b32 v19, v18
s_nop 1
v_permlane16_swap_b32 v16, v17
v_permlane16_swap_b32 v18, v19
v_max_f32 v16, v16, v17
v_max_f32 v18, v18, v19
v_mov_b32 v17, v16
v_mov_b32 v19, v18
s_nop 1
v_permlane32_swap_b32 v16, v17
v_permlane32_swap_b32 v18, v19
v_max_f32 v16, v16, v17
v_max_f32 v18, v18, v19
v_max_f32 v16, 0, v16
v_sub_f32 v17, 0, v16
v_exp_f32 v17, v17
v_add_f32 v8, v8, v16
v_sub_f32 v80, v80, v16
v_sub_f32 v112, v96, v16
v_sub_f32 v81, v81, v16
v_sub_f32 v113, v97, v16
v_sub_f32 v82, v82, v16
v_sub_f32 v114, v98, v16
v_sub_f32 v83, v83, v16
v_sub_f32 v115, v99, v16
v_sub_f32 v88, v88, v16
v_sub_f32 v120, v104, v16
v_sub_f32 v89, v89, v16
v_sub_f32 v121, v105, v16
v_sub_f32 v90, v90, v16
v_sub_f32 v122, v106, v16
v_sub_f32 v91, v91, v16
v_sub_f32 v123, v107, v16
v_exp_f32 v112, v112
v_exp_f32 v113, v113
v_exp_f32 v114, v114
v_exp_f32 v115, v115
v_exp_f32 v120, v120
v_exp_f32 v121, v121
v_exp_f32 v122, v122
v_exp_f32 v123, v123
v_mul_f32 v6, v6, v17
v_mul_f32 v128, v128, v17
v_mul_f32 v129, v129, v17
v_mul_f32 v130, v130, v17
v_mul_f32 v131, v131, v17
v_mul_f32 v136, v136, v17
v_mul_f32 v137, v137, v17
v_mul_f32 v138, v138, v17
v_mul_f32 v139, v139, v17
v_mul_f32 v144, v144, v17
v_mul_f32 v145, v145, v17
v_mul_f32 v146, v146, v17
v_mul_f32 v147, v147, v17
v_mul_f32 v152, v152, v17
v_mul_f32 v153, v153, v17
v_mul_f32 v154, v154, v17
v_mul_f32 v155, v155, v17
v_mul_f32 v160, v160, v17
v_mul_f32 v161, v161, v17
v_mul_f32 v162, v162, v17
v_mul_f32 v163, v163, v17
v_mul_f32 v168, v168, v17
v_mul_f32 v169, v169, v17
v_mul_f32 v170, v170, v17
v_mul_f32 v171, v171, v17
v_mul_f32 v176, v176, v17
v_mul_f32 v177, v177, v17
v_mul_f32 v178, v178, v17
v_mul_f32 v179, v179, v17
v_mul_f32 v184, v184, v17
v_mul_f32 v185, v185, v17
v_mul_f32 v186, v186, v17
v_mul_f32 v187, v187, v17
v_mul_f32 v192, v192, v17
v_mul_f32 v193, v193, v17
v_mul_f32 v194, v194, v17
v_mul_f32 v195, v195, v17
v_mul_f32 v200, v200, v17
v_mul_f32 v201, v201, v17
v_mul_f32 v202, v202, v17
v_mul_f32 v203, v203, v17
v_mul_f32 v208, v208, v17
v_mul_f32 v209, v209, v17
v_mul_f32 v210, v210, v17
v_mul_f32 v211, v211, v17
v_mul_f32 v216, v216, v17
v_mul_f32 v217, v217, v17
v_mul_f32 v218, v218, v17
v_mul_f32 v219, v219, v17
v_mul_f32 v224, v224, v17
v_mul_f32 v225, v225, v17
v_mul_f32 v226, v226, v17
v_mul_f32 v227, v227, v17
v_mul_f32 v232, v232, v17
v_mul_f32 v233, v233, v17
v_mul_f32 v234, v234, v17
v_mul_f32 v235, v235, v17
v_mul_f32 v240, v240, v17
v_mul_f32 v241, v241, v17
v_mul_f32 v242, v242, v17
v_mul_f32 v243, v243, v17
v_mul_f32 v248, v248, v17
v_mul_f32 v249, v249, v17
v_mul_f32 v250, v250, v17
v_mul_f32 v251, v251, v17
v_add_f32 v4, v112, v113
v_add_f32 v4, v4, v114
v_add_f32 v4, v4, v115
v_add_f32 v4, v4, v120
v_add_f32 v4, v4, v121
v_add_f32 v4, v4, v122
v_add_f32 v4, v4, v123
v_max_f32 v18, 0, v18
v_sub_f32 v19, 0, v18
v_exp_f32 v19, v19
v_add_f32 v9, v9, v18
v_sub_f32 v84, v84, v18
v_sub_f32 v116, v100, v18
v_sub_f32 v85, v85, v18
v_sub_f32 v117, v101, v18
v_sub_f32 v86, v86, v18
v_sub_f32 v118, v102, v18
v_sub_f32 v87, v87, v18
v_sub_f32 v119, v103, v18
v_sub_f32 v92, v92, v18
v_sub_f32 v124, v108, v18
v_sub_f32 v93, v93, v18
v_sub_f32 v125, v109, v18
v_sub_f32 v94, v94, v18
v_sub_f32 v126, v110, v18
v_sub_f32 v95, v95, v18
v_sub_f32 v127, v111, v18
v_exp_f32 v116, v116
v_exp_f32 v117, v117
v_exp_f32 v118, v118
v_exp_f32 v119, v119
v_exp_f32 v124, v124
v_exp_f32 v125, v125
v_exp_f32 v126, v126
v_exp_f32 v127, v127
v_mul_f32 v7, v7, v19
v_mul_f32 v132, v132, v19
v_mul_f32 v133, v133, v19
v_mul_f32 v134, v134, v19
v_mul_f32 v135, v135, v19
v_mul_f32 v140, v140, v19
v_mul_f32 v141, v141, v19
v_mul_f32 v142, v142, v19
v_mul_f32 v143, v143, v19
v_mul_f32 v148, v148, v19
v_mul_f32 v149, v149, v19
v_mul_f32 v150, v150, v19
v_mul_f32 v151, v151, v19
v_mul_f32 v156, v156, v19
v_mul_f32 v157, v157, v19
v_mul_f32 v158, v158, v19
v_mul_f32 v159, v159, v19
v_mul_f32 v164, v164, v19
v_mul_f32 v165, v165, v19
v_mul_f32 v166, v166, v19
v_mul_f32 v167, v167, v19
v_mul_f32 v172, v172, v19
v_mul_f32 v173, v173, v19
v_mul_f32 v174, v174, v19
v_mul_f32 v175, v175, v19
v_mul_f32 v180, v180, v19
v_mul_f32 v181, v181, v19
v_mul_f32 v182, v182, v19
v_mul_f32 v183, v183, v19
v_mul_f32 v188, v188, v19
v_mul_f32 v189, v189, v19
v_mul_f32 v190, v190, v19
v_mul_f32 v191, v191, v19
v_mul_f32 v196, v196, v19
v_mul_f32 v197, v197, v19
v_mul_f32 v198, v198, v19
v_mul_f32 v199, v199, v19
v_mul_f32 v204, v204, v19
v_mul_f32 v205, v205, v19
v_mul_f32 v206, v206, v19
v_mul_f32 v207, v207, v19
v_mul_f32 v212, v212, v19
v_mul_f32 v213, v213, v19
v_mul_f32 v214, v214, v19
v_mul_f32 v215, v215, v19
v_mul_f32 v220, v220, v19
v_mul_f32 v221, v221, v19
v_mul_f32 v222, v222, v19
v_mul_f32 v223, v223, v19
v_mul_f32 v228, v228, v19
v_mul_f32 v229, v229, v19
v_mul_f32 v230, v230, v19
v_mul_f32 v231, v231, v19
v_mul_f32 v236, v236, v19
v_mul_f32 v237, v237, v19
v_mul_f32 v238, v238, v19
v_mul_f32 v239, v239, v19
v_mul_f32 v244, v244, v19
v_mul_f32 v245, v245, v19
v_mul_f32 v246, v246, v19
v_mul_f32 v247, v247, v19
v_mul_f32 v252, v252, v19
v_mul_f32 v253, v253, v19
v_mul_f32 v254, v254, v19
v_mul_f32 v255, v255, v19
v_add_f32 v5, v116, v117
v_add_f32 v5, v5, v118
v_add_f32 v5, v5, v119
v_add_f32 v5, v5, v124
v_add_f32 v5, v5, v125
v_add_f32 v5, v5, v126
v_add_f32 v5, v5, v127
s_branch L2_rareret0
L2_afetchF:
s_add_u32 s90, s71, 3
s_cmp_lt_u32 s90, s87
s_cbranch_scc1 L2_nopubF
s_cmp_eq_u32 s88, 2
s_cbranch_scc1 L2_nopubF
s_cmp_eq_u32 s88, 0
s_cbranch_scc1 L2_aflF
s_waitcnt vmcnt(8)
v_readfirstlane_b32 s90, v14
s_nop 0
s_cmp_eq_u32 s90, s89
s_cbranch_scc0 L2_aflF
s_add_u32 s90, s83, 16384
buffer_load_dwordx4 v[20:23], v12, s[20:23], s90 offen sc0 sc1
s_mov_b32 s90, s83
buffer_load_dwordx4 v[24:27], v12, s[20:23], s90 offen offset:0 sc0 sc1
buffer_load_dwordx4 v[28:31], v12, s[20:23], s90 offen offset:1024 sc0 sc1
buffer_load_dwordx4 v[32:35], v12, s[20:23], s90 offen offset:2048 sc0 sc1
buffer_load_dwordx4 v[36:39], v12, s[20:23], s90 offen offset:3072 sc0 sc1
s_add_u32 s90, s90, 4096
buffer_load_dwordx4 v[40:43], v12, s[20:23], s90 offen offset:0 sc0 sc1
buffer_load_dwordx4 v[44:47], v12, s[20:23], s90 offen offset:1024 sc0 sc1
buffer_load_dwordx4 v[48:51], v12, s[20:23], s90 offen offset:2048 sc0 sc1
buffer_load_dwordx4 v[52:55], v12, s[20:23], s90 offen offset:3072 sc0 sc1
s_add_u32 s90, s90, 4096
buffer_load_dwordx4 v[56:59], v12, s[20:23], s90 offen offset:0 sc0 sc1
buffer_load_dwordx4 v[60:63], v12, s[20:23], s90 offen offset:1024 sc0 sc1
buffer_load_dwordx4 v[64:67], v12, s[20:23], s90 offen offset:2048 sc0 sc1
buffer_load_dwordx4 v[68:71], v12, s[20:23], s90 offen offset:3072 sc0 sc1
s_add_u32 s90, s90, 4096
buffer_load_dwordx4 a[160:163], v12, s[20:23], s90 offen offset:0 sc0 sc1
buffer_load_dwordx4 a[164:167], v12, s[20:23], s90 offen offset:1024 sc0 sc1
buffer_load_dwordx4 a[168:171], v12, s[20:23], s90 offen offset:2048 sc0 sc1
buffer_load_dwordx4 a[172:175], v12, s[20:23], s90 offen offset:3072 sc0 sc1
s_mov_b32 s88, 2
s_branch L2_nopubF
L2_aflF:
v_mov_b32 v15, 0
buffer_load_dword v14, v15, s[20:23], s84 offen sc0 sc1
s_mov_b32 s88, 1
s_branch L2_nopubF
L2_afetchP:
s_add_u32 s90, s71, 3
s_cmp_lt_u32 s90, s87
s_cbranch_scc1 L2_nopubP
s_cmp_eq_u32 s88, 2
s_cbranch_scc1 L2_nopubP
s_cmp_eq_u32 s88, 0
s_cbranch_scc1 L2_aflP
s_waitcnt vmcnt(8)
v_readfirstlane_b32 s90, v14
s_nop 0
s_cmp_eq_u32 s90, s89
s_cbranch_scc0 L2_aflP
s_add_u32 s90, s83, 16384
buffer_load_dwordx4 v[20:23], v12, s[20:23], s90 offen sc0 sc1
s_mov_b32 s90, s83
buffer_load_dwordx4 v[24:27], v12, s[20:23], s90 offen offset:0 sc0 sc1
buffer_load_dwordx4 v[28:31], v12, s[20:23], s90 offen offset:1024 sc0 sc1
buffer_load_dwordx4 v[32:35], v12, s[20:23], s90 offen offset:2048 sc0 sc1
buffer_load_dwordx4 v[36:39], v12, s[20:23], s90 offen offset:3072 sc0 sc1
s_add_u32 s90, s90, 4096
buffer_load_dwordx4 v[40:43], v12, s[20:23], s90 offen offset:0 sc0 sc1
buffer_load_dwordx4 v[44:47], v12, s[20:23], s90 offen offset:1024 sc0 sc1
buffer_load_dwordx4 v[48:51], v12, s[20:23], s90 offen offset:2048 sc0 sc1
buffer_load_dwordx4 v[52:55], v12, s[20:23], s90 offen offset:3072 sc0 sc1
s_add_u32 s90, s90, 4096
buffer_load_dwordx4 v[56:59], v12, s[20:23], s90 offen offset:0 sc0 sc1
buffer_load_dwordx4 v[60:63], v12, s[20:23], s90 offen offset:1024 sc0 sc1
buffer_load_dwordx4 v[64:67], v12, s[20:23], s90 offen offset:2048 sc0 sc1
buffer_load_dwordx4 v[68:71], v12, s[20:23], s90 offen offset:3072 sc0 sc1
s_add_u32 s90, s90, 4096
buffer_load_dwordx4 a[160:163], v12, s[20:23], s90 offen offset:0 sc0 sc1
buffer_load_dwordx4 a[164:167], v12, s[20:23], s90 offen offset:1024 sc0 sc1
buffer_load_dwordx4 a[168:171], v12, s[20:23], s90 offen offset:2048 sc0 sc1
buffer_load_dwordx4 a[172:175], v12, s[20:23], s90 offen offset:3072 sc0 sc1
s_mov_b32 s88, 2
s_branch L2_nopubP
L2_aflP:
v_mov_b32 v15, 0
buffer_load_dword v14, v15, s[20:23], s84 offen sc0 sc1
s_mov_b32 s88, 1
s_branch L2_nopubP
L2_afetchI:
s_add_u32 s90, s71, 3
s_cmp_lt_u32 s90, s87
s_cbranch_scc1 L2_nopubI
s_cmp_eq_u32 s88, 2
s_cbranch_scc1 L2_nopubI
s_cmp_eq_u32 s88, 0
s_cbranch_scc1 L2_aflI
s_waitcnt vmcnt(8)
v_readfirstlane_b32 s90, v14
s_nop 0
s_cmp_eq_u32 s90, s89
s_cbranch_scc0 L2_aflI
s_add_u32 s90, s83, 16384
buffer_load_dwordx4 v[20:23], v12, s[20:23], s90 offen sc0 sc1
s_mov_b32 s90, s83
buffer_load_dwordx4 v[24:27], v12, s[20:23], s90 offen offset:0 sc0 sc1
buffer_load_dwordx4 v[28:31], v12, s[20:23], s90 offen offset:1024 sc0 sc1
buffer_load_dwordx4 v[32:35], v12, s[20:23], s90 offen offset:2048 sc0 sc1
buffer_load_dwordx4 v[36:39], v12, s[20:23], s90 offen offset:3072 sc0 sc1
s_add_u32 s90, s90, 4096
buffer_load_dwordx4 v[40:43], v12, s[20:23], s90 offen offset:0 sc0 sc1
buffer_load_dwordx4 v[44:47], v12, s[20:23], s90 offen offset:1024 sc0 sc1
buffer_load_dwordx4 v[48:51], v12, s[20:23], s90 offen offset:2048 sc0 sc1
buffer_load_dwordx4 v[52:55], v12, s[20:23], s90 offen offset:3072 sc0 sc1
s_add_u32 s90, s90, 4096
buffer_load_dwordx4 v[56:59], v12, s[20:23], s90 offen offset:0 sc0 sc1
buffer_load_dwordx4 v[60:63], v12, s[20:23], s90 offen offset:1024 sc0 sc1
buffer_load_dwordx4 v[64:67], v12, s[20:23], s90 offen offset:2048 sc0 sc1
buffer_load_dwordx4 v[68:71], v12, s[20:23], s90 offen offset:3072 sc0 sc1
s_add_u32 s90, s90, 4096
buffer_load_dwordx4 a[160:163], v12, s[20:23], s90 offen offset:0 sc0 sc1
buffer_load_dwordx4 a[164:167], v12, s[20:23], s90 offen offset:1024 sc0 sc1
buffer_load_dwordx4 a[168:171], v12, s[20:23], s90 offen offset:2048 sc0 sc1
buffer_load_dwordx4 a[172:175], v12, s[20:23], s90 offen offset:3072 sc0 sc1
s_mov_b32 s88, 2
s_branch L2_nopubI
L2_aflI:
v_mov_b32 v15, 0
buffer_load_dword v14, v15, s[20:23], s84 offen sc0 sc1
s_mov_b32 s88, 1
s_branch L2_nopubI
L2_segend:
s_nop 7
s_cmp_eq_u32 s80, 1
s_cbranch_scc0 L2_final
s_add_u32 s82, s83, 16384
buffer_store_dwordx4 v[6:9], v12, s[20:23], s82 offen sc0 sc1
s_mov_b32 s82, s83
v_cvt_pk_bf16_f32 v24, v128, v129
v_cvt_pk_bf16_f32 v25, v130, v131
v_cvt_pk_bf16_f32 v26, v132, v133
v_cvt_pk_bf16_f32 v27, v134, v135
buffer_store_dwordx4 v[24:27], v12, s[20:23], s82 offen offset:0 sc0 sc1
v_accvgpr_mov_b32 a0, a192
v_accvgpr_mov_b32 a1, a193
v_accvgpr_mov_b32 a2, a194
v_accvgpr_mov_b32 a3, a195
v_cvt_pk_bf16_f32 v28, v136, v137
v_cvt_pk_bf16_f32 v29, v138, v139
v_cvt_pk_bf16_f32 v30, v140, v141
v_cvt_pk_bf16_f32 v31, v142, v143
buffer_store_dwordx4 v[28:31], v12, s[20:23], s82 offen offset:1024 sc0 sc1
v_accvgpr_mov_b32 a4, a196
v_accvgpr_mov_b32 a5, a197
v_accvgpr_mov_b32 a6, a198
v_accvgpr_mov_b32 a7, a199
v_cvt_pk_bf16_f32 v32, v144, v145
v_cvt_pk_bf16_f32 v33, v146, v147
v_cvt_pk_bf16_f32 v34, v148, v149
v_cvt_pk_bf16_f32 v35, v150, v151
buffer_store_dwordx4 v[32:35], v12, s[20:23], s82 offen offset:2048 sc0 sc1
v_accvgpr_mov_b32 a8, a200
v_accvgpr_mov_b32 a9, a201
v_accvgpr_mov_b32 a10, a202
v_accvgpr_mov_b32 a11, a203
v_cvt_pk_bf16_f32 v36, v152, v153
v_cvt_pk_bf16_f32 v37, v154, v155
v_cvt_pk_bf16_f32 v38, v156, v157
v_cvt_pk_bf16_f32 v39, v158, v159
buffer_store_dwordx4 v[36:39], v12, s[20:23], s82 offen offset:3072 sc0 sc1
v_accvgpr_mov_b32 a12, a204
v_accvgpr_mov_b32 a13, a205
v_accvgpr_mov_b32 a14, a206
v_accvgpr_mov_b32 a15, a207
s_add_u32 s82, s82, 4096
v_cvt_pk_bf16_f32 v40, v160, v161
v_cvt_pk_bf16_f32 v41, v162, v163
v_cvt_pk_bf16_f32 v42, v164, v165
v_cvt_pk_bf16_f32 v43, v166, v167
buffer_store_dwordx4 v[40:43], v12, s[20:23], s82 offen offset:0 sc0 sc1
v_accvgpr_mov_b32 a16, a208
v_accvgpr_mov_b32 a17, a209
v_accvgpr_mov_b32 a18, a210
v_accvgpr_mov_b32 a19, a211
v_cvt_pk_bf16_f32 v44, v168, v169
v_cvt_pk_bf16_f32 v45, v170, v171
v_cvt_pk_bf16_f32 v46, v172, v173
v_cvt_pk_bf16_f32 v47, v174, v175
buffer_store_dwordx4 v[44:47], v12, s[20:23], s82 offen offset:1024 sc0 sc1
v_accvgpr_mov_b32 a20, a212
v_accvgpr_mov_b32 a21, a213
v_accvgpr_mov_b32 a22, a214
v_accvgpr_mov_b32 a23, a215
v_cvt_pk_bf16_f32 v48, v176, v177
v_cvt_pk_bf16_f32 v49, v178, v179
v_cvt_pk_bf16_f32 v50, v180, v181
v_cvt_pk_bf16_f32 v51, v182, v183
buffer_store_dwordx4 v[48:51], v12, s[20:23], s82 offen offset:2048 sc0 sc1
v_accvgpr_mov_b32 a24, a216
v_accvgpr_mov_b32 a25, a217
v_accvgpr_mov_b32 a26, a218
v_accvgpr_mov_b32 a27, a219
v_cvt_pk_bf16_f32 v52, v184, v185
v_cvt_pk_bf16_f32 v53, v186, v187
v_cvt_pk_bf16_f32 v54, v188, v189
v_cvt_pk_bf16_f32 v55, v190, v191
buffer_store_dwordx4 v[52:55], v12, s[20:23], s82 offen offset:3072 sc0 sc1
v_accvgpr_mov_b32 a28, a220
v_accvgpr_mov_b32 a29, a221
v_accvgpr_mov_b32 a30, a222
v_accvgpr_mov_b32 a31, a223
s_add_u32 s82, s82, 4096
v_cvt_pk_bf16_f32 v56, v192, v193
v_cvt_pk_bf16_f32 v57, v194, v195
v_cvt_pk_bf16_f32 v58, v196, v197
v_cvt_pk_bf16_f32 v59, v198, v199
buffer_store_dwordx4 v[56:59], v12, s[20:23], s82 offen offset:0 sc0 sc1
v_accvgpr_mov_b32 a32, a224
v_accvgpr_mov_b32 a33, a225
v_accvgpr_mov_b32 a34, a226
v_accvgpr_mov_b32 a35, a227
v_cvt_pk_bf16_f32 v60, v200, v201
v_cvt_pk_bf16_f32 v61, v202, v203
v_cvt_pk_bf16_f32 v62, v204, v205
v_cvt_pk_bf16_f32 v63, v206, v207
buffer_store_dwordx4 v[60:63], v12, s[20:23], s82 offen offset:1024 sc0 sc1
v_accvgpr_mov_b32 a36, a228
v_accvgpr_mov_b32 a37, a229
v_accvgpr_mov_b32 a38, a230
v_accvgpr_mov_b32 a39, a231
v_cvt_pk_bf16_f32 v64, v208, v209
v_cvt_pk_bf16_f32 v65, v210, v211
v_cvt_pk_bf16_f32 v66, v212, v213
v_cvt_pk_bf16_f32 v67, v214, v215
buffer_store_dwordx4 v[64:67], v12, s[20:23], s82 offen offset:2048 sc0 sc1
v_accvgpr_mov_b32 a40, a232
v_accvgpr_mov_b32 a41, a233
v_accvgpr_mov_b32 a42, a234
v_accvgpr_mov_b32 a43, a235
v_cvt_pk_bf16_f32 v68, v216, v217
v_cvt_pk_bf16_f32 v69, v218, v219
v_cvt_pk_bf16_f32 v70, v220, v221
v_cvt_pk_bf16_f32 v71, v222, v223
buffer_store_dwordx4 v[68:71], v12, s[20:23], s82 offen offset:3072 sc0 sc1
v_accvgpr_mov_b32 a44, a236
v_accvgpr_mov_b32 a45, a237
v_accvgpr_mov_b32 a46, a238
v_accvgpr_mov_b32 a47, a239
s_add_u32 s82, s82, 4096
v_cvt_pk_bf16_f32 v24, v224, v225
v_cvt_pk_bf16_f32 v25, v226, v227
v_cvt_pk_bf16_f32 v26, v228, v229
v_cvt_pk_bf16_f32 v27, v230, v231
buffer_store_dwordx4 v[24:27], v12, s[20:23], s82 offen offset:0 sc0 sc1
v_accvgpr_mov_b32 a48, a240
v_accvgpr_mov_b32 a49, a241
v_accvgpr_mov_b32 a50, a242
v_accvgpr_mov_b32 a51, a243
v_cvt_pk_bf16_f32 v28, v232, v233
v_cvt_pk_bf16_f32 v29, v234, v235
v_cvt_pk_bf16_f32 v30, v236, v237
v_cvt_pk_bf16_f32 v31, v238, v239
buffer_store_dwordx4 v[28:31], v12, s[20:23], s82 offen offset:1024 sc0 sc1
v_accvgpr_mov_b32 a52, a244
v_accvgpr_mov_b32 a53, a245
v_accvgpr_mov_b32 a54, a246
v_accvgpr_mov_b32 a55, a247
v_cvt_pk_bf16_f32 v32, v240, v241
v_cvt_pk_bf16_f32 v33, v242, v243
v_cvt_pk_bf16_f32 v34, v244, v245
v_cvt_pk_bf16_f32 v35, v246, v247
buffer_store_dwordx4 v[32:35], v12, s[20:23], s82 offen offset:2048 sc0 sc1
v_accvgpr_mov_b32 a56, a248
v_accvgpr_mov_b32 a57, a249
v_accvgpr_mov_b32 a58, a250
v_accvgpr_mov_b32 a59, a251
v_cvt_pk_bf16_f32 v36, v248, v249
v_cvt_pk_bf16_f32 v37, v250, v251
v_cvt_pk_bf16_f32 v38, v252, v253
v_cvt_pk_bf16_f32 v39, v254, v255
buffer_store_dwordx4 v[36:39], v12, s[20:23], s82 offen offset:3072 sc0 sc1
v_accvgpr_mov_b32 a60, a252
v_accvgpr_mov_b32 a61, a253
v_accvgpr_mov_b32 a62, a254
v_accvgpr_mov_b32 a63, a255
s_mov_b32 s80, 2
s_mov_b32 s61, s85
s_mov_b32 s62, 0
s_add_u32 s63, s61, 1
s_lshl_b32 s63, s63, 2
s_branch L2_seg
L2_final:
s_mov_b32 s81, 0xffff0000
s_cmp_eq_u32 s80, 0
s_cbranch_scc0 L2_norm
s_cmp_eq_u32 s88, 2
s_cbranch_scc1 L2_have
s_mov_b32 s92, 0
L2_poll:
v_mov_b32 v15, 0
buffer_load_dword v14, v15, s[20:23], s84 offen sc0 sc1
s_add_u32 s92, s92, 1
s_waitcnt vmcnt(0)
v_readfirstlane_b32 s91, v14
s_cmp_gt_u32 s92, 200000
s_cbranch_scc1 L2_polled
s_cmp_eq_u32 s91, s89
s_cbranch_scc1 L2_polled
s_sleep 2
s_branch L2_poll
L2_polled:
s_add_u32 s90, s83, 16384
buffer_load_dwordx4 v[20:23], v12, s[20:23], s90 offen sc0 sc1
s_mov_b32 s90, s83
buffer_load_dwordx4 v[24:27], v12, s[20:23], s90 offen offset:0 sc0 sc1
buffer_load_dwordx4 v[28:31], v12, s[20:23], s90 offen offset:1024 sc0 sc1
buffer_load_dwordx4 v[32:35], v12, s[20:23], s90 offen offset:2048 sc0 sc1
buffer_load_dwordx4 v[36:39], v12, s[20:23], s90 offen offset:3072 sc0 sc1
s_add_u32 s90, s90, 4096
buffer_load_dwordx4 v[40:43], v12, s[20:23], s90 offen offset:0 sc0 sc1
buffer_load_dwordx4 v[44:47], v12, s[20:23], s90 offen offset:1024 sc0 sc1
buffer_load_dwordx4 v[48:51], v12, s[20:23], s90 offen offset:2048 sc0 sc1
buffer_load_dwordx4 v[52:55], v12, s[20:23], s90 offen offset:3072 sc0 sc1
s_add_u32 s90, s90, 4096
buffer_load_dwordx4 v[56:59], v12, s[20:23], s90 offen offset:0 sc0 sc1
buffer_load_dwordx4 v[60:63], v12, s[20:23], s90 offen offset:1024 sc0 sc1
buffer_load_dwordx4 v[64:67], v12, s[20:23], s90 offen offset:2048 sc0 sc1
buffer_load_dwordx4 v[68:71], v12, s[20:23], s90 offen offset:3072 sc0 sc1
s_add_u32 s90, s90, 4096
buffer_load_dwordx4 a[160:163], v12, s[20:23], s90 offen offset:0 sc0 sc1
buffer_load_dwordx4 a[164:167], v12, s[20:23], s90 offen offset:1024 sc0 sc1
buffer_load_dwordx4 a[168:171], v12, s[20:23], s90 offen offset:2048 sc0 sc1
buffer_load_dwordx4 a[172:175], v12, s[20:23], s90 offen offset:3072 sc0 sc1
s_mov_b32 s88, 2
L2_have:
s_waitcnt vmcnt(0)
v_max_f32 v16, v8, v22
v_sub_f32 v4, v8, v16
v_sub_f32 v22, v22, v16
v_exp_f32 v4, v4
v_exp_f32 v22, v22
s_nop 0
v_mul_f32 v6, v6, v4
v_fmac_f32 v6, v20, v22
v_max_f32 v16, v9, v23
v_sub_f32 v5, v9, v16
v_sub_f32 v23, v23, v16
v_exp_f32 v5, v5
v_exp_f32 v23, v23
s_nop 0
v_mul_f32 v7, v7, v5
v_fmac_f32 v7, v21, v23
v_mov_b32 v18, v6
v_mov_b32 v19, v7
s_nop 1
v_permlane16_swap_b32 v6, v18
v_permlane16_swap_b32 v7, v19
v_add_f32 v6, v6, v18
v_add_f32 v7, v7, v19
v_mov_b32 v18, v6
v_mov_b32 v19, v7
s_nop 1
v_permlane32_swap_b32 v6, v18
v_permlane32_swap_b32 v7, v19
v_add_f32 v6, v6, v18
v_add_f32 v7, v7, v19
v_rcp_f32 v6, v6
v_rcp_f32 v7, v7
s_nop 0
v_mul_f32 v4, v4, v6
v_mul_f32 v22, v22, v6
v_mul_f32 v5, v5, v7
v_mul_f32 v23, v23, v7
v_lshlrev_b32 v96, 16, v24
v_and_b32 v97, s81, v24
v_lshlrev_b32 v98, 16, v25
v_and_b32 v99, s81, v25
v_lshlrev_b32 v100, 16, v26
v_and_b32 v101, s81, v26
v_lshlrev_b32 v102, 16, v27
v_and_b32 v103, s81, v27
v_pk_mul_f32 v[128:129], v[128:129], v[4:5] op_sel_hi:[1,0]
v_pk_fma_f32 v[128:129], v[96:97], v[22:23], v[128:129] op_sel_hi:[1,0,1]
v_pk_mul_f32 v[130:131], v[130:131], v[4:5] op_sel_hi:[1,0]
v_pk_fma_f32 v[130:131], v[98:99], v[22:23], v[130:131] op_sel_hi:[1,0,1]
v_pk_mul_f32 v[132:133], v[132:133], v[4:5] op_sel:[0,1] op_sel_hi:[1,1]
v_pk_fma_f32 v[132:133], v[100:101], v[22:23], v[132:133] op_sel:[0,1,0] op_sel_hi:[1,1,1]
v_pk_mul_f32 v[134:135], v[134:135], v[4:5] op_sel:[0,1] op_sel_hi:[1,1]
v_pk_fma_f32 v[134:135], v[102:103], v[22:23], v[134:135] op_sel:[0,1,0] op_sel_hi:[1,1,1]
v_lshlrev_b32 v96, 16, v28
v_and_b32 v97, s81, v28
v_lshlrev_b32 v98, 16, v29
v_and_b32 v99, s81, v29
v_lshlrev_b32 v100, 16, v30
v_and_b32 v101, s81, v30
v_lshlrev_b32 v102, 16, v31
v_and_b32 v103, s81, v31
v_pk_mul_f32 v[136:137], v[136:137], v[4:5] op_sel_hi:[1,0]
v_pk_fma_f32 v[136:137], v[96:97], v[22:23], v[136:137] op_sel_hi:[1,0,1]
v_pk_mul_f32 v[138:139], v[138:139], v[4:5] op_sel_hi:[1,0]
v_pk_fma_f32 v[138:139], v[98:99], v[22:23], v[138:139] op_sel_hi:[1,0,1]
v_pk_mul_f32 v[140:141], v[140:141], v[4:5] op_sel:[0,1] op_sel_hi:[1,1]
v_pk_fma_f32 v[140:141], v[100:101], v[22:23], v[140:141] op_sel:[0,1,0] op_sel_hi:[1,1,1]
v_pk_mul_f32 v[142:143], v[142:143], v[4:5] op_sel:[0,1] op_sel_hi:[1,1]
v_pk_fma_f32 v[142:143], v[102:103], v[22:23], v[142:143] op_sel:[0,1,0] op_sel_hi:[1,1,1]
v_lshlrev_b32 v96, 16, v32
v_and_b32 v97, s81, v32
v_lshlrev_b32 v98, 16, v33
v_and_b32 v99, s81, v33
v_lshlrev_b32 v100, 16, v34
v_and_b32 v101, s81, v34
v_lshlrev_b32 v102, 16, v35
v_and_b32 v103, s81, v35
v_pk_mul_f32 v[144:145], v[144:145], v[4:5] op_sel_hi:[1,0]
v_pk_fma_f32 v[144:145], v[96:97], v[22:23], v[144:145] op_sel_hi:[1,0,1]
v_pk_mul_f32 v[146:147], v[146:147], v[4:5] op_sel_hi:[1,0]
v_pk_fma_f32 v[146:147], v[98:99], v[22:23], v[146:147] op_sel_hi:[1,0,1]
v_pk_mul_f32 v[148:149], v[148:149], v[4:5] op_sel:[0,1] op_sel_hi:[1,1]
v_pk_fma_f32 v[148:149], v[100:101], v[22:23], v[148:149] op_sel:[0,1,0] op_sel_hi:[1,1,1]
v_pk_mul_f32 v[150:151], v[150:151], v[4:5] op_sel:[0,1] op_sel_hi:[1,1]
v_pk_fma_f32 v[150:151], v[102:103], v[22:23], v[150:151] op_sel:[0,1,0] op_sel_hi:[1,1,1]
v_lshlrev_b32 v96, 16, v36
v_and_b32 v97, s81, v36
v_lshlrev_b32 v98, 16, v37
v_and_b32 v99, s81, v37
v_lshlrev_b32 v100, 16, v38
v_and_b32 v101, s81, v38
v_lshlrev_b32 v102, 16, v39
v_and_b32 v103, s81, v39
v_pk_mul_f32 v[152:153], v[152:153], v[4:5] op_sel_hi:[1,0]
v_pk_fma_f32 v[152:153], v[96:97], v[22:23], v[152:153] op_sel_hi:[1,0,1]
v_pk_mul_f32 v[154:155], v[154:155], v[4:5] op_sel_hi:[1,0]
v_pk_fma_f32 v[154:155], v[98:99], v[22:23], v[154:155] op_sel_hi:[1,0,1]
v_pk_mul_f32 v[156:157], v[156:157], v[4:5] op_sel:[0,1] op_sel_hi:[1,1]
v_pk_fma_f32 v[156:157], v[100:101], v[22:23], v[156:157] op_sel:[0,1,0] op_sel_hi:[1,1,1]
v_pk_mul_f32 v[158:159], v[158:159], v[4:5] op_sel:[0,1] op_sel_hi:[1,1]
v_pk_fma_f32 v[158:159], v[102:103], v[22:23], v[158:159] op_sel:[0,1,0] op_sel_hi:[1,1,1]
v_lshlrev_b32 v96, 16, v40
v_and_b32 v97, s81, v40
v_lshlrev_b32 v98, 16, v41
v_and_b32 v99, s81, v41
v_lshlrev_b32 v100, 16, v42
v_and_b32 v101, s81, v42
v_lshlrev_b32 v102, 16, v43
v_and_b32 v103, s81, v43
v_pk_mul_f32 v[160:161], v[160:161], v[4:5] op_sel_hi:[1,0]
v_pk_fma_f32 v[160:161], v[96:97], v[22:23], v[160:161] op_sel_hi:[1,0,1]
v_pk_mul_f32 v[162:163], v[162:163], v[4:5] op_sel_hi:[1,0]
v_pk_fma_f32 v[162:163], v[98:99], v[22:23], v[162:163] op_sel_hi:[1,0,1]
v_pk_mul_f32 v[164:165], v[164:165], v[4:5] op_sel:[0,1] op_sel_hi:[1,1]
v_pk_fma_f32 v[164:165], v[100:101], v[22:23], v[164:165] op_sel:[0,1,0] op_sel_hi:[1,1,1]
v_pk_mul_f32 v[166:167], v[166:167], v[4:5] op_sel:[0,1] op_sel_hi:[1,1]
v_pk_fma_f32 v[166:167], v[102:103], v[22:23], v[166:167] op_sel:[0,1,0] op_sel_hi:[1,1,1]
v_lshlrev_b32 v96, 16, v44
v_and_b32 v97, s81, v44
v_lshlrev_b32 v98, 16, v45
v_and_b32 v99, s81, v45
v_lshlrev_b32 v100, 16, v46
v_and_b32 v101, s81, v46
v_lshlrev_b32 v102, 16, v47
v_and_b32 v103, s81, v47
v_pk_mul_f32 v[168:169], v[168:169], v[4:5] op_sel_hi:[1,0]
v_pk_fma_f32 v[168:169], v[96:97], v[22:23], v[168:169] op_sel_hi:[1,0,1]
v_pk_mul_f32 v[170:171], v[170:171], v[4:5] op_sel_hi:[1,0]
v_pk_fma_f32 v[170:171], v[98:99], v[22:23], v[170:171] op_sel_hi:[1,0,1]
v_pk_mul_f32 v[172:173], v[172:173], v[4:5] op_sel:[0,1] op_sel_hi:[1,1]
v_pk_fma_f32 v[172:173], v[100:101], v[22:23], v[172:173] op_sel:[0,1,0] op_sel_hi:[1,1,1]
v_pk_mul_f32 v[174:175], v[174:175], v[4:5] op_sel:[0,1] op_sel_hi:[1,1]
v_pk_fma_f32 v[174:175], v[102:103], v[22:23], v[174:175] op_sel:[0,1,0] op_sel_hi:[1,1,1]
v_lshlrev_b32 v96, 16, v48
v_and_b32 v97, s81, v48
v_lshlrev_b32 v98, 16, v49
v_and_b32 v99, s81, v49
v_lshlrev_b32 v100, 16, v50
v_and_b32 v101, s81, v50
v_lshlrev_b32 v102, 16, v51
v_and_b32 v103, s81, v51
v_pk_mul_f32 v[176:177], v[176:177], v[4:5] op_sel_hi:[1,0]
v_pk_fma_f32 v[176:177], v[96:97], v[22:23], v[176:177] op_sel_hi:[1,0,1]
v_pk_mul_f32 v[178:179], v[178:179], v[4:5] op_sel_hi:[1,0]
v_pk_fma_f32 v[178:179], v[98:99], v[22:23], v[178:179] op_sel_hi:[1,0,1]
v_pk_mul_f32 v[180:181], v[180:181], v[4:5] op_sel:[0,1] op_sel_hi:[1,1]
v_pk_fma_f32 v[180:181], v[100:101], v[22:23], v[180:181] op_sel:[0,1,0] op_sel_hi:[1,1,1]
v_pk_mul_f32 v[182:183], v[182:183], v[4:5] op_sel:[0,1] op_sel_hi:[1,1]
v_pk_fma_f32 v[182:183], v[102:103], v[22:23], v[182:183] op_sel:[0,1,0] op_sel_hi:[1,1,1]
v_lshlrev_b32 v96, 16, v52
v_and_b32 v97, s81, v52
v_lshlrev_b32 v98, 16, v53
v_and_b32 v99, s81, v53
v_lshlrev_b32 v100, 16, v54
v_and_b32 v101, s81, v54
v_lshlrev_b32 v102, 16, v55
v_and_b32 v103, s81, v55
v_pk_mul_f32 v[184:185], v[184:185], v[4:5] op_sel_hi:[1,0]
v_pk_fma_f32 v[184:185], v[96:97], v[22:23], v[184:185] op_sel_hi:[1,0,1]
v_pk_mul_f32 v[186:187], v[186:187], v[4:5] op_sel_hi:[1,0]
v_pk_fma_f32 v[186:187], v[98:99], v[22:23], v[186:187] op_sel_hi:[1,0,1]
v_pk_mul_f32 v[188:189], v[188:189], v[4:5] op_sel:[0,1] op_sel_hi:[1,1]
v_pk_fma_f32 v[188:189], v[100:101], v[22:23], v[188:189] op_sel:[0,1,0] op_sel_hi:[1,1,1]
v_pk_mul_f32 v[190:191], v[190:191], v[4:5] op_sel:[0,1] op_sel_hi:[1,1]
v_pk_fma_f32 v[190:191], v[102:103], v[22:23], v[190:191] op_sel:[0,1,0] op_sel_hi:[1,1,1]
v_lshlrev_b32 v96, 16, v56
v_and_b32 v97, s81, v56
v_lshlrev_b32 v98, 16, v57
v_and_b32 v99, s81, v57
v_lshlrev_b32 v100, 16, v58
v_and_b32 v101, s81, v58
v_lshlrev_b32 v102, 16, v59
v_and_b32 v103, s81, v59
v_pk_mul_f32 v[192:193], v[192:193], v[4:5] op_sel_hi:[1,0]
v_pk_fma_f32 v[192:193], v[96:97], v[22:23], v[192:193] op_sel_hi:[1,0,1]
v_pk_mul_f32 v[194:195], v[194:195], v[4:5] op_sel_hi:[1,0]
v_pk_fma_f32 v[194:195], v[98:99], v[22:23], v[194:195] op_sel_hi:[1,0,1]
v_pk_mul_f32 v[196:197], v[196:197], v[4:5] op_sel:[0,1] op_sel_hi:[1,1]
v_pk_fma_f32 v[196:197], v[100:101], v[22:23], v[196:197] op_sel:[0,1,0] op_sel_hi:[1,1,1]
v_pk_mul_f32 v[198:199], v[198:199], v[4:5] op_sel:[0,1] op_sel_hi:[1,1]
v_pk_fma_f32 v[198:199], v[102:103], v[22:23], v[198:199] op_sel:[0,1,0] op_sel_hi:[1,1,1]
v_lshlrev_b32 v96, 16, v60
v_and_b32 v97, s81, v60
v_lshlrev_b32 v98, 16, v61
v_and_b32 v99, s81, v61
v_lshlrev_b32 v100, 16, v62
v_and_b32 v101, s81, v62
v_lshlrev_b32 v102, 16, v63
v_and_b32 v103, s81, v63
v_pk_mul_f32 v[200:201], v[200:201], v[4:5] op_sel_hi:[1,0]
v_pk_fma_f32 v[200:201], v[96:97], v[22:23], v[200:201] op_sel_hi:[1,0,1]
v_pk_mul_f32 v[202:203], v[202:203], v[4:5] op_sel_hi:[1,0]
v_pk_fma_f32 v[202:203], v[98:99], v[22:23], v[202:203] op_sel_hi:[1,0,1]
v_pk_mul_f32 v[204:205], v[204:205], v[4:5] op_sel:[0,1] op_sel_hi:[1,1]
v_pk_fma_f32 v[204:205], v[100:101], v[22:23], v[204:205] op_sel:[0,1,0] op_sel_hi:[1,1,1]
v_pk_mul_f32 v[206:207], v[206:207], v[4:5] op_sel:[0,1] op_sel_hi:[1,1]
v_pk_fma_f32 v[206:207], v[102:103], v[22:23], v[206:207] op_sel:[0,1,0] op_sel_hi:[1,1,1]
v_lshlrev_b32 v96, 16, v64
v_and_b32 v97, s81, v64
v_lshlrev_b32 v98, 16, v65
v_and_b32 v99, s81, v65
v_lshlrev_b32 v100, 16, v66
v_and_b32 v101, s81, v66
v_lshlrev_b32 v102, 16, v67
v_and_b32 v103, s81, v67
v_pk_mul_f32 v[208:209], v[208:209], v[4:5] op_sel_hi:[1,0]
v_pk_fma_f32 v[208:209], v[96:97], v[22:23], v[208:209] op_sel_hi:[1,0,1]
v_pk_mul_f32 v[210:211], v[210:211], v[4:5] op_sel_hi:[1,0]
v_pk_fma_f32 v[210:211], v[98:99], v[22:23], v[210:211] op_sel_hi:[1,0,1]
v_pk_mul_f32 v[212:213], v[212:213], v[4:5] op_sel:[0,1] op_sel_hi:[1,1]
v_pk_fma_f32 v[212:213], v[100:101], v[22:23], v[212:213] op_sel:[0,1,0] op_sel_hi:[1,1,1]
v_pk_mul_f32 v[214:215], v[214:215], v[4:5] op_sel:[0,1] op_sel_hi:[1,1]
v_pk_fma_f32 v[214:215], v[102:103], v[22:23], v[214:215] op_sel:[0,1,0] op_sel_hi:[1,1,1]
v_lshlrev_b32 v96, 16, v68
v_and_b32 v97, s81, v68
v_lshlrev_b32 v98, 16, v69
v_and_b32 v99, s81, v69
v_lshlrev_b32 v100, 16, v70
v_and_b32 v101, s81, v70
v_lshlrev_b32 v102, 16, v71
v_and_b32 v103, s81, v71
v_pk_mul_f32 v[216:217], v[216:217], v[4:5] op_sel_hi:[1,0]
v_pk_fma_f32 v[216:217], v[96:97], v[22:23], v[216:217] op_sel_hi:[1,0,1]
v_pk_mul_f32 v[218:219], v[218:219], v[4:5] op_sel_hi:[1,0]
v_pk_fma_f32 v[218:219], v[98:99], v[22:23], v[218:219] op_sel_hi:[1,0,1]
v_pk_mul_f32 v[220:221], v[220:221], v[4:5] op_sel:[0,1] op_sel_hi:[1,1]
v_pk_fma_f32 v[220:221], v[100:101], v[22:23], v[220:221] op_sel:[0,1,0] op_sel_hi:[1,1,1]
v_pk_mul_f32 v[222:223], v[222:223], v[4:5] op_sel:[0,1] op_sel_hi:[1,1]
v_pk_fma_f32 v[222:223], v[102:103], v[22:23], v[222:223] op_sel:[0,1,0] op_sel_hi:[1,1,1]
v_accvgpr_read_b32 v112, a160
v_accvgpr_read_b32 v113, a161
v_accvgpr_read_b32 v114, a162
v_accvgpr_read_b32 v115, a163
v_lshlrev_b32 v96, 16, v112
v_and_b32 v97, s81, v112
v_lshlrev_b32 v98, 16, v113
v_and_b32 v99, s81, v113
v_lshlrev_b32 v100, 16, v114
v_and_b32 v101, s81, v114
v_lshlrev_b32 v102, 16, v115
v_and_b32 v103, s81, v115
v_pk_mul_f32 v[224:225], v[224:225], v[4:5] op_sel_hi:[1,0]
v_pk_fma_f32 v[224:225], v[96:97], v[22:23], v[224:225] op_sel_hi:[1,0,1]
v_pk_mul_f32 v[226:227], v[226:227], v[4:5] op_sel_hi:[1,0]
v_pk_fma_f32 v[226:227], v[98:99], v[22:23], v[226:227] op_sel_hi:[1,0,1]
v_pk_mul_f32 v[228:229], v[228:229], v[4:5] op_sel:[0,1] op_sel_hi:[1,1]
v_pk_fma_f32 v[228:229], v[100:101], v[22:23], v[228:229] op_sel:[0,1,0] op_sel_hi:[1,1,1]
v_pk_mul_f32 v[230:231], v[230:231], v[4:5] op_sel:[0,1] op_sel_hi:[1,1]
v_pk_fma_f32 v[230:231], v[102:103], v[22:23], v[230:231] op_sel:[0,1,0] op_sel_hi:[1,1,1]
v_accvgpr_read_b32 v112, a164
v_accvgpr_read_b32 v113, a165
v_accvgpr_read_b32 v114, a166
v_accvgpr_read_b32 v115, a167
v_lshlrev_b32 v96, 16, v112
v_and_b32 v97, s81, v112
v_lshlrev_b32 v98, 16, v113
v_and_b32 v99, s81, v113
v_lshlrev_b32 v100, 16, v114
v_and_b32 v101, s81, v114
v_lshlrev_b32 v102, 16, v115
v_and_b32 v103, s81, v115
v_pk_mul_f32 v[232:233], v[232:233], v[4:5] op_sel_hi:[1,0]
v_pk_fma_f32 v[232:233], v[96:97], v[22:23], v[232:233] op_sel_hi:[1,0,1]
v_pk_mul_f32 v[234:235], v[234:235], v[4:5] op_sel_hi:[1,0]
v_pk_fma_f32 v[234:235], v[98:99], v[22:23], v[234:235] op_sel_hi:[1,0,1]
v_pk_mul_f32 v[236:237], v[236:237], v[4:5] op_sel:[0,1] op_sel_hi:[1,1]
v_pk_fma_f32 v[236:237], v[100:101], v[22:23], v[236:237] op_sel:[0,1,0] op_sel_hi:[1,1,1]
v_pk_mul_f32 v[238:239], v[238:239], v[4:5] op_sel:[0,1] op_sel_hi:[1,1]
v_pk_fma_f32 v[238:239], v[102:103], v[22:23], v[238:239] op_sel:[0,1,0] op_sel_hi:[1,1,1]
v_accvgpr_read_b32 v112, a168
v_accvgpr_read_b32 v113, a169
v_accvgpr_read_b32 v114, a170
v_accvgpr_read_b32 v115, a171
v_lshlrev_b32 v96, 16, v112
v_and_b32 v97, s81, v112
v_lshlrev_b32 v98, 16, v113
v_and_b32 v99, s81, v113
v_lshlrev_b32 v100, 16, v114
v_and_b32 v101, s81, v114
v_lshlrev_b32 v102, 16, v115
v_and_b32 v103, s81, v115
v_pk_mul_f32 v[240:241], v[240:241], v[4:5] op_sel_hi:[1,0]
v_pk_fma_f32 v[240:241], v[96:97], v[22:23], v[240:241] op_sel_hi:[1,0,1]
v_pk_mul_f32 v[242:243], v[242:243], v[4:5] op_sel_hi:[1,0]
v_pk_fma_f32 v[242:243], v[98:99], v[22:23], v[242:243] op_sel_hi:[1,0,1]
v_pk_mul_f32 v[244:245], v[244:245], v[4:5] op_sel:[0,1] op_sel_hi:[1,1]
v_pk_fma_f32 v[244:245], v[100:101], v[22:23], v[244:245] op_sel:[0,1,0] op_sel_hi:[1,1,1]
v_pk_mul_f32 v[246:247], v[246:247], v[4:5] op_sel:[0,1] op_sel_hi:[1,1]
v_pk_fma_f32 v[246:247], v[102:103], v[22:23], v[246:247] op_sel:[0,1,0] op_sel_hi:[1,1,1]
v_accvgpr_read_b32 v112, a172
v_accvgpr_read_b32 v113, a173
v_accvgpr_read_b32 v114, a174
v_accvgpr_read_b32 v115, a175
v_lshlrev_b32 v96, 16, v112
v_and_b32 v97, s81, v112
v_lshlrev_b32 v98, 16, v113
v_and_b32 v99, s81, v113
v_lshlrev_b32 v100, 16, v114
v_and_b32 v101, s81, v114
v_lshlrev_b32 v102, 16, v115
v_and_b32 v103, s81, v115
v_pk_mul_f32 v[248:249], v[248:249], v[4:5] op_sel_hi:[1,0]
v_pk_fma_f32 v[248:249], v[96:97], v[22:23], v[248:249] op_sel_hi:[1,0,1]
v_pk_mul_f32 v[250:251], v[250:251], v[4:5] op_sel_hi:[1,0]
v_pk_fma_f32 v[250:251], v[98:99], v[22:23], v[250:251] op_sel_hi:[1,0,1]
v_pk_mul_f32 v[252:253], v[252:253], v[4:5] op_sel:[0,1] op_sel_hi:[1,1]
v_pk_fma_f32 v[252:253], v[100:101], v[22:23], v[252:253] op_sel:[0,1,0] op_sel_hi:[1,1,1]
v_pk_mul_f32 v[254:255], v[254:255], v[4:5] op_sel:[0,1] op_sel_hi:[1,1]
v_pk_fma_f32 v[254:255], v[102:103], v[22:23], v[254:255] op_sel:[0,1,0] op_sel_hi:[1,1,1]
s_branch L2_store
L2_norm:
v_mov_b32 v18, v6
v_mov_b32 v19, v7
s_nop 1
v_permlane16_swap_b32 v6, v18
v_permlane16_swap_b32 v7, v19
v_add_f32 v6, v6, v18
v_add_f32 v7, v7, v19
v_mov_b32 v18, v6
v_mov_b32 v19, v7
s_nop 1
v_permlane32_swap_b32 v6, v18
v_permlane32_swap_b32 v7, v19
v_add_f32 v6, v6, v18
v_add_f32 v7, v7, v19
v_rcp_f32 v6, v6
v_rcp_f32 v7, v7
s_nop 0
v_pk_mul_f32 v[128:129], v[128:129], v[6:7] op_sel_hi:[1,0]
v_pk_mul_f32 v[130:131], v[130:131], v[6:7] op_sel_hi:[1,0]
v_pk_mul_f32 v[132:133], v[132:133], v[6:7] op_sel:[0,1] op_sel_hi:[1,1]
v_pk_mul_f32 v[134:135], v[134:135], v[6:7] op_sel:[0,1] op_sel_hi:[1,1]
v_pk_mul_f32 v[136:137], v[136:137], v[6:7] op_sel_hi:[1,0]
v_pk_mul_f32 v[138:139], v[138:139], v[6:7] op_sel_hi:[1,0]
v_pk_mul_f32 v[140:141], v[140:141], v[6:7] op_sel:[0,1] op_sel_hi:[1,1]
v_pk_mul_f32 v[142:143], v[142:143], v[6:7] op_sel:[0,1] op_sel_hi:[1,1]
v_pk_mul_f32 v[144:145], v[144:145], v[6:7] op_sel_hi:[1,0]
v_pk_mul_f32 v[146:147], v[146:147], v[6:7] op_sel_hi:[1,0]
v_pk_mul_f32 v[148:149], v[148:149], v[6:7] op_sel:[0,1] op_sel_hi:[1,1]
v_pk_mul_f32 v[150:151], v[150:151], v[6:7] op_sel:[0,1] op_sel_hi:[1,1]
v_pk_mul_f32 v[152:153], v[152:153], v[6:7] op_sel_hi:[1,0]
v_pk_mul_f32 v[154:155], v[154:155], v[6:7] op_sel_hi:[1,0]
v_pk_mul_f32 v[156:157], v[156:157], v[6:7] op_sel:[0,1] op_sel_hi:[1,1]
v_pk_mul_f32 v[158:159], v[158:159], v[6:7] op_sel:[0,1] op_sel_hi:[1,1]
v_pk_mul_f32 v[160:161], v[160:161], v[6:7] op_sel_hi:[1,0]
v_pk_mul_f32 v[162:163], v[162:163], v[6:7] op_sel_hi:[1,0]
v_pk_mul_f32 v[164:165], v[164:165], v[6:7] op_sel:[0,1] op_sel_hi:[1,1]
v_pk_mul_f32 v[166:167], v[166:167], v[6:7] op_sel:[0,1] op_sel_hi:[1,1]
v_pk_mul_f32 v[168:169], v[168:169], v[6:7] op_sel_hi:[1,0]
v_pk_mul_f32 v[170:171], v[170:171], v[6:7] op_sel_hi:[1,0]
v_pk_mul_f32 v[172:173], v[172:173], v[6:7] op_sel:[0,1] op_sel_hi:[1,1]
v_pk_mul_f32 v[174:175], v[174:175], v[6:7] op_sel:[0,1] op_sel_hi:[1,1]
v_pk_mul_f32 v[176:177], v[176:177], v[6:7] op_sel_hi:[1,0]
v_pk_mul_f32 v[178:179], v[178:179], v[6:7] op_sel_hi:[1,0]
v_pk_mul_f32 v[180:181], v[180:181], v[6:7] op_sel:[0,1] op_sel_hi:[1,1]
v_pk_mul_f32 v[182:183], v[182:183], v[6:7] op_sel:[0,1] op_sel_hi:[1,1]
v_pk_mul_f32 v[184:185], v[184:185], v[6:7] op_sel_hi:[1,0]
v_pk_mul_f32 v[186:187], v[186:187], v[6:7] op_sel_hi:[1,0]
v_pk_mul_f32 v[188:189], v[188:189], v[6:7] op_sel:[0,1] op_sel_hi:[1,1]
v_pk_mul_f32 v[190:191], v[190:191], v[6:7] op_sel:[0,1] op_sel_hi:[1,1]
v_pk_mul_f32 v[192:193], v[192:193], v[6:7] op_sel_hi:[1,0]
v_pk_mul_f32 v[194:195], v[194:195], v[6:7] op_sel_hi:[1,0]
v_pk_mul_f32 v[196:197], v[196:197], v[6:7] op_sel:[0,1] op_sel_hi:[1,1]
v_pk_mul_f32 v[198:199], v[198:199], v[6:7] op_sel:[0,1] op_sel_hi:[1,1]
v_pk_mul_f32 v[200:201], v[200:201], v[6:7] op_sel_hi:[1,0]
v_pk_mul_f32 v[202:203], v[202:203], v[6:7] op_sel_hi:[1,0]
v_pk_mul_f32 v[204:205], v[204:205], v[6:7] op_sel:[0,1] op_sel_hi:[1,1]
v_pk_mul_f32 v[206:207], v[206:207], v[6:7] op_sel:[0,1] op_sel_hi:[1,1]
v_pk_mul_f32 v[208:209], v[208:209], v[6:7] op_sel_hi:[1,0]
v_pk_mul_f32 v[210:211], v[210:211], v[6:7] op_sel_hi:[1,0]
v_pk_mul_f32 v[212:213], v[212:213], v[6:7] op_sel:[0,1] op_sel_hi:[1,1]
v_pk_mul_f32 v[214:215], v[214:215], v[6:7] op_sel:[0,1] op_sel_hi:[1,1]
v_pk_mul_f32 v[216:217], v[216:217], v[6:7] op_sel_hi:[1,0]
v_pk_mul_f32 v[218:219], v[218:219], v[6:7] op_sel_hi:[1,0]
v_pk_mul_f32 v[220:221], v[220:221], v[6:7] op_sel:[0,1] op_sel_hi:[1,1]
v_pk_mul_f32 v[222:223], v[222:223], v[6:7] op_sel:[0,1] op_sel_hi:[1,1]
v_pk_mul_f32 v[224:225], v[224:225], v[6:7] op_sel_hi:[1,0]
v_pk_mul_f32 v[226:227], v[226:227], v[6:7] op_sel_hi:[1,0]
v_pk_mul_f32 v[228:229], v[228:229], v[6:7] op_sel:[0,1] op_sel_hi:[1,1]
v_pk_mul_f32 v[230:231], v[230:231], v[6:7] op_sel:[0,1] op_sel_hi:[1,1]
v_pk_mul_f32 v[232:233], v[232:233], v[6:7] op_sel_hi:[1,0]
v_pk_mul_f32 v[234:235], v[234:235], v[6:7] op_sel_hi:[1,0]
v_pk_mul_f32 v[236:237], v[236:237], v[6:7] op_sel:[0,1] op_sel_hi:[1,1]
v_pk_mul_f32 v[238:239], v[238:239], v[6:7] op_sel:[0,1] op_sel_hi:[1,1]
v_pk_mul_f32 v[240:241], v[240:241], v[6:7] op_sel_hi:[1,0]
v_pk_mul_f32 v[242:243], v[242:243], v[6:7] op_sel_hi:[1,0]
v_pk_mul_f32 v[244:245], v[244:245], v[6:7] op_sel:[0,1] op_sel_hi:[1,1]
v_pk_mul_f32 v[246:247], v[246:247], v[6:7] op_sel:[0,1] op_sel_hi:[1,1]
v_pk_mul_f32 v[248:249], v[248:249], v[6:7] op_sel_hi:[1,0]
v_pk_mul_f32 v[250:251], v[250:251], v[6:7] op_sel_hi:[1,0]
v_pk_mul_f32 v[252:253], v[252:253], v[6:7] op_sel:[0,1] op_sel_hi:[1,1]
v_pk_mul_f32 v[254:255], v[254:255], v[6:7] op_sel:[0,1] op_sel_hi:[1,1]
L2_store:
s_waitcnt vmcnt(0)
s_barrier
s_and_b32 s26, s2, 7
s_lshr_b32 s27, s2, 3
s_and_b32 s28, s27, 1
s_lshl_b32 s28, s28, 3
s_add_u32 s49, s26, s28
s_lshr_b32 s50, s27, 1
s_lshl_b32 s57, s48, 13
s_lshl_b32 s51, s49, 18
s_add_u32 s51, s51, s57
s_add_u32 s51, s51, 69337088
s_mov_b32 s55, 1400897536
s_mov_b32 s56, 0
s_add_u32 m0, s57, 0
s_nop 0
buffer_load_dwordx4 v12, s[20:23], s51 offen offset:0 sc1 lds
buffer_load_dwordx4 v12, s[20:23], s51 offen offset:1024 sc1 lds
buffer_load_dwordx4 v12, s[20:23], s51 offen offset:2048 sc1 lds
buffer_load_dwordx4 v12, s[20:23], s51 offen offset:3072 sc1 lds
s_add_u32 s51, s51, 4096
s_add_u32 m0, s57, 4096
s_nop 0
buffer_load_dwordx4 v12, s[20:23], s51 offen offset:0 sc1 lds
buffer_load_dwordx4 v12, s[20:23], s51 offen offset:1024 sc1 lds
buffer_load_dwordx4 v12, s[20:23], s51 offen offset:2048 sc1 lds
buffer_load_dwordx4 v12, s[20:23], s51 offen offset:3072 sc1 lds
s_add_u32 s51, s51, 28672
s_add_u32 m0, s57, 32768
s_nop 0
buffer_load_dwordx4 v12, s[20:23], s51 offen offset:0 sc1 lds
buffer_load_dwordx4 v12, s[20:23], s51 offen offset:1024 sc1 lds
buffer_load_dwordx4 v12, s[20:23], s51 offen offset:2048 sc1 lds
buffer_load_dwordx4 v12, s[20:23], s51 offen offset:3072 sc1 lds
s_add_u32 s51, s51, 4096
s_add_u32 m0, s57, 36864
s_nop 0
buffer_load_dwordx4 v12, s[20:23], s51 offen offset:0 sc1 lds
buffer_load_dwordx4 v12, s[20:23], s51 offen offset:1024 sc1 lds
buffer_load_dwordx4 v12, s[20:23], s51 offen offset:2048 sc1 lds
buffer_load_dwordx4 v12, s[20:23], s51 offen offset:3072 sc1 lds
s_add_u32 s51, s51, 28672
s_add_u32 m0, s57, 65536
s_nop 0
buffer_load_dwordx4 v12, s[20:23], s51 offen offset:0 sc1 lds
buffer_load_dwordx4 v12, s[20:23], s51 offen offset:1024 sc1 lds
buffer_load_dwordx4 v12, s[20:23], s51 offen offset:2048 sc1 lds
buffer_load_dwordx4 v12, s[20:23], s51 offen offset:3072 sc1 lds
s_add_u32 s51, s51, 4096
s_add_u32 m0, s57, 69632
s_nop 0
buffer_load_dwordx4 v12, s[20:23], s51 offen offset:0 sc1 lds
buffer_load_dwordx4 v12, s[20:23], s51 offen offset:1024 sc1 lds
buffer_load_dwordx4 v12, s[20:23], s51 offen offset:2048 sc1 lds
buffer_load_dwordx4 v12, s[20:23], s51 offen offset:3072 sc1 lds
s_add_u32 s51, s51, 28672
s_add_u32 m0, s57, 98304
s_nop 0
buffer_load_dwordx4 v12, s[20:23], s51 offen offset:0 sc1 lds
buffer_load_dwordx4 v12, s[20:23], s51 offen offset:1024 sc1 lds
buffer_load_dwordx4 v12, s[20:23], s51 offen offset:2048 sc1 lds
buffer_load_dwordx4 v12, s[20:23], s51 offen offset:3072 sc1 lds
s_add_u32 s51, s51, 4096
s_add_u32 m0, s57, 102400
s_nop 0
buffer_load_dwordx4 v12, s[20:23], s51 offen offset:0 sc1 lds
buffer_load_dwordx4 v12, s[20:23], s51 offen offset:1024 sc1 lds
buffer_load_dwordx4 v12, s[20:23], s51 offen offset:2048 sc1 lds
buffer_load_dwordx4 v12, s[20:23], s51 offen offset:3072 sc1 lds
s_add_u32 s51, s51, 28672
s_lshl_b32 s90, s61, 3
s_lshl_b32 s91, s48, 1
s_add_u32 s90, s90, s91
s_lshl_b32 s90, s90, 17
s_lshl_b32 s91, s60, 13
s_add_u32 s90, s90, s91
s_add_u32 s90, s90, 50331648
s_mov_b32 s66, s90
s_add_u32 s67, s90, 131072
v_cvt_pk_bf16_f32 v144, v144, v145
v_cvt_pk_bf16_f32 v145, v146, v147
v_cvt_pk_bf16_f32 v146, v152, v153
v_cvt_pk_bf16_f32 v147, v154, v155
v_cvt_pk_bf16_f32 v148, v148, v149
v_cvt_pk_bf16_f32 v149, v150, v151
v_cvt_pk_bf16_f32 v150, v156, v157
v_cvt_pk_bf16_f32 v151, v158, v159
v_cvt_pk_bf16_f32 v160, v160, v161
v_cvt_pk_bf16_f32 v161, v162, v163
v_cvt_pk_bf16_f32 v162, v168, v169
v_cvt_pk_bf16_f32 v163, v170, v171
v_cvt_pk_bf16_f32 v164, v164, v165
v_cvt_pk_bf16_f32 v165, v166, v167
v_cvt_pk_bf16_f32 v166, v172, v173
v_cvt_pk_bf16_f32 v167, v174, v175
v_cvt_pk_bf16_f32 v176, v176, v177
v_cvt_pk_bf16_f32 v177, v178, v179
v_cvt_pk_bf16_f32 v178, v184, v185
v_cvt_pk_bf16_f32 v179, v186, v187
v_cvt_pk_bf16_f32 v180, v180, v181
v_cvt_pk_bf16_f32 v181, v182, v183
v_cvt_pk_bf16_f32 v182, v188, v189
v_cvt_pk_bf16_f32 v183, v190, v191
v_cvt_pk_bf16_f32 v192, v192, v193
v_cvt_pk_bf16_f32 v193, v194, v195
v_cvt_pk_bf16_f32 v194, v200, v201
v_cvt_pk_bf16_f32 v195, v202, v203
v_cvt_pk_bf16_f32 v196, v196, v197
v_cvt_pk_bf16_f32 v197, v198, v199
v_cvt_pk_bf16_f32 v198, v204, v205
v_cvt_pk_bf16_f32 v199, v206, v207
v_cvt_pk_bf16_f32 v208, v208, v209
v_cvt_pk_bf16_f32 v209, v210, v211
v_cvt_pk_bf16_f32 v210, v216, v217
v_cvt_pk_bf16_f32 v211, v218, v219
v_cvt_pk_bf16_f32 v212, v212, v213
v_cvt_pk_bf16_f32 v213, v214, v215
v_cvt_pk_bf16_f32 v214, v220, v221
v_cvt_pk_bf16_f32 v215, v222, v223
v_cvt_pk_bf16_f32 v224, v224, v225
v_cvt_pk_bf16_f32 v225, v226, v227
v_cvt_pk_bf16_f32 v226, v232, v233
v_cvt_pk_bf16_f32 v227, v234, v235
v_cvt_pk_bf16_f32 v228, v228, v229
v_cvt_pk_bf16_f32 v229, v230, v231
v_cvt_pk_bf16_f32 v230, v236, v237
v_cvt_pk_bf16_f32 v231, v238, v239
v_cvt_pk_bf16_f32 v240, v240, v241
v_cvt_pk_bf16_f32 v241, v242, v243
v_cvt_pk_bf16_f32 v242, v248, v249
v_cvt_pk_bf16_f32 v243, v250, v251
v_cvt_pk_bf16_f32 v244, v244, v245
v_cvt_pk_bf16_f32 v245, v246, v247
v_cvt_pk_bf16_f32 v246, v252, v253
v_cvt_pk_bf16_f32 v247, v254, v255
v_cvt_pk_bf16_f32 v152, v128, v129
v_cvt_pk_bf16_f32 v153, v130, v131
v_cvt_pk_bf16_f32 v154, v136, v137
v_cvt_pk_bf16_f32 v155, v138, v139
v_cvt_pk_bf16_f32 v156, v132, v133
v_cvt_pk_bf16_f32 v157, v134, v135
v_cvt_pk_bf16_f32 v158, v140, v141
v_cvt_pk_bf16_f32 v159, v142, v143
s_lshl_b32 s58, s61, 7
s_lshl_b32 s90, s60, 2
s_add_u32 s58, s58, s90
s_add_u32 s58, s58, 109092864
s_load_dwordx2 s[40:41], s[0:1], 16
s_load_dwordx4 s[44:47], s[0:1], 64
v_mov_b32 v1, v12
v_lshrrev_b32 v15, 4, v12
v_add_u32 v2, 0, v1
v_add_u32 v3, 32768, v1
v_accvgpr_read_b32 v32, a64
v_accvgpr_read_b32 v48, a80
v_accvgpr_read_b32 v33, a65
v_accvgpr_read_b32 v49, a80
v_accvgpr_read_b32 v34, a66
v_accvgpr_read_b32 v50, a80
v_accvgpr_read_b32 v35, a67
v_accvgpr_read_b32 v51, a80
v_accvgpr_read_b32 v36, a68
v_accvgpr_read_b32 v52, a80
v_accvgpr_read_b32 v37, a69
v_accvgpr_read_b32 v53, a80
v_accvgpr_read_b32 v38, a70
v_accvgpr_read_b32 v54, a80
v_accvgpr_read_b32 v39, a71
v_accvgpr_read_b32 v55, a80
v_accvgpr_read_b32 v40, a72
v_accvgpr_read_b32 v56, a80
v_accvgpr_read_b32 v41, a73
v_accvgpr_read_b32 v57, a80
v_accvgpr_read_b32 v42, a74
v_accvgpr_read_b32 v58, a80
v_accvgpr_read_b32 v43, a75
v_accvgpr_read_b32 v59, a80
v_accvgpr_read_b32 v44, a76
v_accvgpr_read_b32 v60, a80
v_accvgpr_read_b32 v45, a77
v_accvgpr_read_b32 v61, a80
v_accvgpr_read_b32 v46, a78
v_accvgpr_read_b32 v62, a80
v_accvgpr_read_b32 v47, a79
v_accvgpr_read_b32 v63, a80
v_accvgpr_read_b32 v16, a81
v_accvgpr_read_b32 v17, a82
v_accvgpr_read_b32 v18, a83
v_accvgpr_read_b32 v19, a84
v_accvgpr_read_b32 v20, a85
v_accvgpr_read_b32 v21, a86
v_accvgpr_read_b32 v22, a87
v_accvgpr_read_b32 v23, a88
v_mov_b64 v[24:25], 0
v_mov_b64 v[136:137], 0
v_mov_b64 v[26:27], 0
v_mov_b64 v[138:139], 0
v_mov_b64 v[28:29], 0
v_mov_b64 v[140:141], 0
v_mov_b64 v[30:31], 0
v_mov_b64 v[142:143], 0
s_waitcnt vmcnt(24) lgkmcnt(0)
s_barrier
ds_read_b128 v[96:99], v2 offset:0
ds_read_b128 v[100:103], v2 offset:1024
ds_read_b128 v[112:115], v2 offset:2048
ds_read_b128 v[116:119], v2 offset:3072
ds_read_b128 v[104:107], v2 offset:4096
ds_read_b128 v[108:111], v2 offset:5120
s_waitcnt lgkmcnt(4)
v_mfma_f32_32x32x16_bf16 v[64:79], v[96:99], v[16:19], v[48:63]
v_mfma_f32_32x32x16_bf16 v[64:79], v[100:103], v[20:23], v[64:79]
s_waitcnt lgkmcnt(0)
s_nop 9
s_waitcnt lgkmcnt(2)
v_mfma_f32_32x32x16_bf16 v[80:95], v[104:107], v[16:19], v[48:63]
ds_read_b128 v[96:99], v2 offset:8192
buffer_store_dwordx4 v[152:155], v1, s[20:23], s66 offen offset:0 sc0 sc1
v_exp_f32 v64, v64
v_exp_f32 v65, v65
v_exp_f32 v66, v66
v_exp_f32 v67, v67
v_mfma_f32_32x32x16_bf16 v[80:95], v[108:111], v[20:23], v[80:95]
ds_read_b128 v[100:103], v2 offset:9216
buffer_store_dwordx4 v[144:147], v1, s[20:23], s66 offen offset:1024 sc0 sc1
v_exp_f32 v72, v72
v_exp_f32 v73, v73
v_exp_f32 v74, v74
v_exp_f32 v75, v75
v_mfma_f32_32x32x16_bf16 v[32:47], v[136:139], v[24:27], v[32:47]
ds_read_b128 v[120:123], v2 offset:6144
buffer_store_dwordx4 v[160:163], v1, s[20:23], s66 offen offset:2048 sc0 sc1
v_cvt_pk_bf16_f32 v24, v64, v65
v_cvt_pk_bf16_f32 v25, v66, v67
v_cvt_pk_bf16_f32 v26, v72, v73
v_cvt_pk_bf16_f32 v27, v74, v75
v_exp_f32 v68, v68
v_exp_f32 v69, v69
v_exp_f32 v70, v70
v_exp_f32 v71, v71
v_mfma_f32_32x32x16_bf16 v[32:47], v[140:143], v[28:31], v[32:47]
ds_read_b128 v[124:127], v2 offset:7168
v_exp_f32 v76, v76
v_exp_f32 v77, v77
v_exp_f32 v78, v78
v_exp_f32 v79, v79
v_cvt_pk_bf16_f32 v28, v68, v69
v_cvt_pk_bf16_f32 v29, v70, v71
v_cvt_pk_bf16_f32 v30, v76, v77
v_cvt_pk_bf16_f32 v31, v78, v79
s_waitcnt lgkmcnt(2)
v_mfma_f32_32x32x16_bf16 v[64:79], v[96:99], v[16:19], v[48:63]
ds_read_b128 v[104:107], v2 offset:12288
buffer_store_dwordx4 v[176:179], v1, s[20:23], s66 offen offset:3072 sc0 sc1
s_add_u32 s66, s66, 4096
v_exp_f32 v80, v80
v_exp_f32 v81, v81
v_exp_f32 v82, v82
v_exp_f32 v83, v83
v_mfma_f32_32x32x16_bf16 v[64:79], v[100:103], v[20:23], v[64:79]
ds_read_b128 v[108:111], v2 offset:13312
buffer_store_dwordx4 v[156:159], v1, s[20:23], s67 offen offset:0 sc0 sc1
v_exp_f32 v88, v88
v_exp_f32 v89, v89
v_exp_f32 v90, v90
v_exp_f32 v91, v91
v_mfma_f32_32x32x16_bf16 v[32:47], v[112:115], v[24:27], v[32:47]
ds_read_b128 v[128:131], v2 offset:10240
buffer_store_dwordx4 v[148:151], v1, s[20:23], s67 offen offset:1024 sc0 sc1
v_cvt_pk_bf16_f32 v24, v80, v81
v_cvt_pk_bf16_f32 v25, v82, v83
v_cvt_pk_bf16_f32 v26, v88, v89
v_cvt_pk_bf16_f32 v27, v90, v91
v_exp_f32 v84, v84
v_exp_f32 v85, v85
v_exp_f32 v86, v86
v_exp_f32 v87, v87
v_mfma_f32_32x32x16_bf16 v[32:47], v[116:119], v[28:31], v[32:47]
ds_read_b128 v[132:135], v2 offset:11264
v_exp_f32 v92, v92
v_exp_f32 v93, v93
v_exp_f32 v94, v94
v_exp_f32 v95, v95
v_cvt_pk_bf16_f32 v28, v84, v85
v_cvt_pk_bf16_f32 v29, v86, v87
v_cvt_pk_bf16_f32 v30, v92, v93
v_cvt_pk_bf16_f32 v31, v94, v95
s_waitcnt lgkmcnt(2)
v_mfma_f32_32x32x16_bf16 v[80:95], v[104:107], v[16:19], v[48:63]
ds_read_b128 v[96:99], v2 offset:16384
buffer_store_dwordx4 v[164:167], v1, s[20:23], s67 offen offset:2048 sc0 sc1
v_exp_f32 v64, v64
v_exp_f32 v65, v65
v_exp_f32 v66, v66
v_exp_f32 v67, v67
v_mfma_f32_32x32x16_bf16 v[80:95], v[108:111], v[20:23], v[80:95]
ds_read_b128 v[100:103], v2 offset:17408
buffer_store_dwordx4 v[180:183], v1, s[20:23], s67 offen offset:3072 sc0 sc1
s_add_u32 s67, s67, 4096
v_exp_f32 v72, v72
v_exp_f32 v73, v73
v_exp_f32 v74, v74
v_exp_f32 v75, v75
v_cmp_lt_f32 vcc, s55, v44
s_cmp_lg_u32 vcc_hi, 0
s_cbranch_scc1 LA_ren1F
LA_ren1retF:
v_mfma_f32_32x32x16_bf16 v[32:47], v[120:123], v[24:27], v[32:47]
ds_read_b128 v[136:139], v2 offset:14336
buffer_store_dwordx4 v[192:195], v1, s[20:23], s66 offen offset:0 sc0 sc1
v_cvt_pk_bf16_f32 v24, v64, v65
v_cvt_pk_bf16_f32 v25, v66, v67
v_cvt_pk_bf16_f32 v26, v72, v73
v_cvt_pk_bf16_f32 v27, v74, v75
v_exp_f32 v68, v68
v_exp_f32 v69, v69
v_exp_f32 v70, v70
v_exp_f32 v71, v71
v_mfma_f32_32x32x16_bf16 v[32:47], v[124:127], v[28:31], v[32:47]
ds_read_b128 v[140:143], v2 offset:15360
v_exp_f32 v76, v76
v_exp_f32 v77, v77
v_exp_f32 v78, v78
v_exp_f32 v79, v79
v_cvt_pk_bf16_f32 v28, v68, v69
v_cvt_pk_bf16_f32 v29, v70, v71
v_cvt_pk_bf16_f32 v30, v76, v77
v_cvt_pk_bf16_f32 v31, v78, v79
s_waitcnt lgkmcnt(2)
v_mfma_f32_32x32x16_bf16 v[64:79], v[96:99], v[16:19], v[48:63]
ds_read_b128 v[104:107], v2 offset:20480
buffer_store_dwordx4 v[208:211], v1, s[20:23], s66 offen offset:1024 sc0 sc1
v_exp_f32 v80, v80
v_exp_f32 v81, v81
v_exp_f32 v82, v82
v_exp_f32 v83, v83
v_mfma_f32_32x32x16_bf16 v[64:79], v[100:103], v[20:23], v[64:79]
ds_read_b128 v[108:111], v2 offset:21504
buffer_store_dwordx4 v[224:227], v1, s[20:23], s66 offen offset:2048 sc0 sc1
v_exp_f32 v88, v88
v_exp_f32 v89, v89
v_exp_f32 v90, v90
v_exp_f32 v91, v91
v_mfma_f32_32x32x16_bf16 v[32:47], v[128:131], v[24:27], v[32:47]
ds_read_b128 v[112:115], v2 offset:18432
buffer_store_dwordx4 v[240:243], v1, s[20:23], s66 offen offset:3072 sc0 sc1
v_cvt_pk_bf16_f32 v24, v80, v81
v_cvt_pk_bf16_f32 v25, v82, v83
v_cvt_pk_bf16_f32 v26, v88, v89
v_cvt_pk_bf16_f32 v27, v90, v91
v_exp_f32 v84, v84
v_exp_f32 v85, v85
v_exp_f32 v86, v86
v_exp_f32 v87, v87
v_mfma_f32_32x32x16_bf16 v[32:47], v[132:135], v[28:31], v[32:47]
ds_read_b128 v[116:119], v2 offset:19456
v_exp_f32 v92, v92
v_exp_f32 v93, v93
v_exp_f32 v94, v94
v_exp_f32 v95, v95
v_cvt_pk_bf16_f32 v28, v84, v85
v_cvt_pk_bf16_f32 v29, v86, v87
v_cvt_pk_bf16_f32 v30, v92, v93
v_cvt_pk_bf16_f32 v31, v94, v95
s_waitcnt lgkmcnt(2)
v_mfma_f32_32x32x16_bf16 v[80:95], v[104:107], v[16:19], v[48:63]
ds_read_b128 v[96:99], v2 offset:24576
buffer_store_dwordx4 v[196:199], v1, s[20:23], s67 offen offset:0 sc0 sc1
v_exp_f32 v64, v64
v_exp_f32 v65, v65
v_exp_f32 v66, v66
v_exp_f32 v67, v67
v_mfma_f32_32x32x16_bf16 v[80:95], v[108:111], v[20:23], v[80:95]
ds_read_b128 v[100:103], v2 offset:25600
buffer_store_dwordx4 v[212:215], v1, s[20:23], s67 offen offset:1024 sc0 sc1
v_exp_f32 v72, v72
v_exp_f32 v73, v73
v_exp_f32 v74, v74
v_exp_f32 v75, v75
v_mfma_f32_32x32x16_bf16 v[32:47], v[136:139], v[24:27], v[32:47]
ds_read_b128 v[120:123], v2 offset:22528
buffer_store_dwordx4 v[228:231], v1, s[20:23], s67 offen offset:2048 sc0 sc1
v_cvt_pk_bf16_f32 v24, v64, v65
v_cvt_pk_bf16_f32 v25, v66, v67
v_cvt_pk_bf16_f32 v26, v72, v73
v_cvt_pk_bf16_f32 v27, v74, v75
v_exp_f32 v68, v68
v_exp_f32 v69, v69
v_exp_f32 v70, v70
v_exp_f32 v71, v71
v_mfma_f32_32x32x16_bf16 v[32:47], v[140:143], v[28:31], v[32:47]
ds_read_b128 v[124:127], v2 offset:23552
v_exp_f32 v76, v76
v_exp_f32 v77, v77
v_exp_f32 v78, v78
v_exp_f32 v79, v79
v_cvt_pk_bf16_f32 v28, v68, v69
v_cvt_pk_bf16_f32 v29, v70, v71
v_cvt_pk_bf16_f32 v30, v76, v77
v_cvt_pk_bf16_f32 v31, v78, v79
s_waitcnt lgkmcnt(2)
v_mfma_f32_32x32x16_bf16 v[64:79], v[96:99], v[16:19], v[48:63]
ds_read_b128 v[104:107], v2 offset:28672
buffer_store_dwordx4 v[244:247], v1, s[20:23], s67 offen offset:3072 sc0 sc1
v_exp_f32 v80, v80
v_exp_f32 v81, v81
v_exp_f32 v82, v82
v_exp_f32 v83, v83
v_mfma_f32_32x32x16_bf16 v[64:79], v[100:103], v[20:23], v[64:79]
ds_read_b128 v[108:111], v2 offset:29696
v_exp_f32 v88, v88
v_exp_f32 v89, v89
v_exp_f32 v90, v90
v_exp_f32 v91, v91
s_cmp_lg_u32 s56, 0
s_cbranch_scc1 LA_ren2F
LA_ren2retF:
v_mfma_f32_32x32x16_bf16 v[32:47], v[112:115], v[24:27], v[32:47]
ds_read_b128 v[128:131], v2 offset:26624
v_cvt_pk_bf16_f32 v24, v80, v81
v_cvt_pk_bf16_f32 v25, v82, v83
v_cvt_pk_bf16_f32 v26, v88, v89
v_cvt_pk_bf16_f32 v27, v90, v91
v_exp_f32 v84, v84
v_exp_f32 v85, v85
v_exp_f32 v86, v86
v_exp_f32 v87, v87
v_mfma_f32_32x32x16_bf16 v[32:47], v[116:119], v[28:31], v[32:47]
ds_read_b128 v[132:135], v2 offset:27648
v_exp_f32 v92, v92
v_exp_f32 v93, v93
v_exp_f32 v94, v94
v_exp_f32 v95, v95
v_cvt_pk_bf16_f32 v28, v84, v85
v_cvt_pk_bf16_f32 v29, v86, v87
v_cvt_pk_bf16_f32 v30, v92, v93
v_cvt_pk_bf16_f32 v31, v94, v95
s_waitcnt vmcnt(16) lgkmcnt(2)
s_barrier
v_mfma_f32_32x32x16_bf16 v[80:95], v[104:107], v[16:19], v[48:63]
ds_read_b128 v[96:99], v3 offset:0
v_exp_f32 v64, v64
v_exp_f32 v65, v65
v_exp_f32 v66, v66
v_exp_f32 v67, v67
v_mfma_f32_32x32x16_bf16 v[80:95], v[108:111], v[20:23], v[80:95]
ds_read_b128 v[100:103], v3 offset:1024
v_exp_f32 v72, v72
v_exp_f32 v73, v73
v_exp_f32 v74, v74
v_exp_f32 v75, v75
v_mfma_f32_32x32x16_bf16 v[32:47], v[120:123], v[24:27], v[32:47]
ds_read_b128 v[136:139], v2 offset:30720
v_cvt_pk_bf16_f32 v24, v64, v65
v_cvt_pk_bf16_f32 v25, v66, v67
v_cvt_pk_bf16_f32 v26, v72, v73
v_cvt_pk_bf16_f32 v27, v74, v75
v_exp_f32 v68, v68
v_exp_f32 v69, v69
v_exp_f32 v70, v70
v_exp_f32 v71, v71
v_mfma_f32_32x32x16_bf16 v[32:47], v[124:127], v[28:31], v[32:47]
ds_read_b128 v[140:143], v2 offset:31744
v_exp_f32 v76, v76
v_exp_f32 v77, v77
v_exp_f32 v78, v78
v_exp_f32 v79, v79
v_cvt_pk_bf16_f32 v28, v68, v69
v_cvt_pk_bf16_f32 v29, v70, v71
v_cvt_pk_bf16_f32 v30, v76, v77
v_cvt_pk_bf16_f32 v31, v78, v79
s_waitcnt lgkmcnt(2)
v_mfma_f32_32x32x16_bf16 v[64:79], v[96:99], v[16:19], v[48:63]
ds_read_b128 v[104:107], v3 offset:4096
v_exp_f32 v80, v80
v_exp_f32 v81, v81
v_exp_f32 v82, v82
v_exp_f32 v83, v83
v_mfma_f32_32x32x16_bf16 v[64:79], v[100:103], v[20:23], v[64:79]
ds_read_b128 v[108:111], v3 offset:5120
v_exp_f32 v88, v88
v_exp_f32 v89, v89
v_exp_f32 v90, v90
v_exp_f32 v91, v91
v_mfma_f32_32x32x16_bf16 v[32:47], v[128:131], v[24:27], v[32:47]
ds_read_b128 v[112:115], v3 offset:2048
v_cvt_pk_bf16_f32 v24, v80, v81
v_cvt_pk_bf16_f32 v25, v82, v83
v_cvt_pk_bf16_f32 v26, v88, v89
v_cvt_pk_bf16_f32 v27, v90, v91
v_exp_f32 v84, v84
v_exp_f32 v85, v85
v_exp_f32 v86, v86
v_exp_f32 v87, v87
v_mfma_f32_32x32x16_bf16 v[32:47], v[132:135], v[28:31], v[32:47]
ds_read_b128 v[116:119], v3 offset:3072
v_exp_f32 v92, v92
v_exp_f32 v93, v93
v_exp_f32 v94, v94
v_exp_f32 v95, v95
v_cvt_pk_bf16_f32 v28, v84, v85
v_cvt_pk_bf16_f32 v29, v86, v87
v_cvt_pk_bf16_f32 v30, v92, v93
v_cvt_pk_bf16_f32 v31, v94, v95
v_add_u32 v2, 32768, v1
v_add_u32 v3, 65536, v1
s_waitcnt lgkmcnt(2)
v_mfma_f32_32x32x16_bf16 v[80:95], v[104:107], v[16:19], v[48:63]
ds_read_b128 v[96:99], v2 offset:8192
v_exp_f32 v64, v64
v_exp_f32 v65, v65
v_exp_f32 v66, v66
v_exp_f32 v67, v67
v_mfma_f32_32x32x16_bf16 v[80:95], v[108:111], v[20:23], v[80:95]
ds_read_b128 v[100:103], v2 offset:9216
v_exp_f32 v72, v72
v_exp_f32 v73, v73
v_exp_f32 v74, v74
v_exp_f32 v75, v75
v_mfma_f32_32x32x16_bf16 v[32:47], v[136:139], v[24:27], v[32:47]
ds_read_b128 v[120:123], v2 offset:6144
v_cvt_pk_bf16_f32 v24, v64, v65
v_cvt_pk_bf16_f32 v25, v66, v67
v_cvt_pk_bf16_f32 v26, v72, v73
v_cvt_pk_bf16_f32 v27, v74, v75
v_exp_f32 v68, v68
v_exp_f32 v69, v69
v_exp_f32 v70, v70
v_exp_f32 v71, v71
v_mfma_f32_32x32x16_bf16 v[32:47], v[140:143], v[28:31], v[32:47]
ds_read_b128 v[124:127], v2 offset:7168
v_exp_f32 v76, v76
v_exp_f32 v77, v77
v_exp_f32 v78, v78
v_exp_f32 v79, v79
v_cvt_pk_bf16_f32 v28, v68, v69
v_cvt_pk_bf16_f32 v29, v70, v71
v_cvt_pk_bf16_f32 v30, v76, v77
v_cvt_pk_bf16_f32 v31, v78, v79
s_waitcnt lgkmcnt(2)
v_mfma_f32_32x32x16_bf16 v[64:79], v[96:99], v[16:19], v[48:63]
ds_read_b128 v[104:107], v2 offset:12288
v_exp_f32 v80, v80
v_exp_f32 v81, v81
v_exp_f32 v82, v82
v_exp_f32 v83, v83
v_mfma_f32_32x32x16_bf16 v[64:79], v[100:103], v[20:23], v[64:79]
ds_read_b128 v[108:111], v2 offset:13312
v_exp_f32 v88, v88
v_exp_f32 v89, v89
v_exp_f32 v90, v90
v_exp_f32 v91, v91
v_mfma_f32_32x32x16_bf16 v[32:47], v[112:115], v[24:27], v[32:47]
ds_read_b128 v[128:131], v2 offset:10240
v_cvt_pk_bf16_f32 v24, v80, v81
v_cvt_pk_bf16_f32 v25, v82, v83
v_cvt_pk_bf16_f32 v26, v88, v89
v_cvt_pk_bf16_f32 v27, v90, v91
v_exp_f32 v84, v84
v_exp_f32 v85, v85
v_exp_f32 v86, v86
v_exp_f32 v87, v87
v_mfma_f32_32x32x16_bf16 v[32:47], v[116:119], v[28:31], v[32:47]
ds_read_b128 v[132:135], v2 offset:11264
v_exp_f32 v92, v92
v_exp_f32 v93, v93
v_exp_f32 v94, v94
v_exp_f32 v95, v95
v_cvt_pk_bf16_f32 v28, v84, v85
v_cvt_pk_bf16_f32 v29, v86, v87
v_cvt_pk_bf16_f32 v30, v92, v93
v_cvt_pk_bf16_f32 v31, v94, v95
s_waitcnt vmcnt(0) lgkmcnt(2)
s_barrier
s_cmp_lg_u32 s48, 0
s_cbranch_scc1 LT_npC
v_mov_b32 v10, s89
v_mov_b32 v11, 0
s_mov_b64 exec, 1
buffer_store_dword v10, v11, s[20:23], s58 offen sc0 sc1
s_mov_b64 exec, -1
LT_npC:
v_mfma_f32_32x32x16_bf16 v[80:95], v[104:107], v[16:19], v[48:63]
ds_read_b128 v[96:99], v2 offset:16384
v_exp_f32 v64, v64
v_exp_f32 v65, v65
v_exp_f32 v66, v66
v_exp_f32 v67, v67
v_mfma_f32_32x32x16_bf16 v[80:95], v[108:111], v[20:23], v[80:95]
ds_read_b128 v[100:103], v2 offset:17408
v_exp_f32 v72, v72
v_exp_f32 v73, v73
v_exp_f32 v74, v74
v_exp_f32 v75, v75
v_cmp_lt_f32 vcc, s55, v44
s_cmp_lg_u32 vcc_hi, 0
s_cbranch_scc1 LA_ren1G
LA_ren1retG:
v_mfma_f32_32x32x16_bf16 v[32:47], v[120:123], v[24:27], v[32:47]
ds_read_b128 v[136:139], v2 offset:14336
v_cvt_pk_bf16_f32 v24, v64, v65
v_cvt_pk_bf16_f32 v25, v66, v67
v_cvt_pk_bf16_f32 v26, v72, v73
v_cvt_pk_bf16_f32 v27, v74, v75
v_exp_f32 v68, v68
v_exp_f32 v69, v69
v_exp_f32 v70, v70
v_exp_f32 v71, v71
v_mfma_f32_32x32x16_bf16 v[32:47], v[124:127], v[28:31], v[32:47]
ds_read_b128 v[140:143], v2 offset:15360
v_exp_f32 v76, v76
v_exp_f32 v77, v77
v_exp_f32 v78, v78
v_exp_f32 v79, v79
v_cvt_pk_bf16_f32 v28, v68, v69
v_cvt_pk_bf16_f32 v29, v70, v71
v_cvt_pk_bf16_f32 v30, v76, v77
v_cvt_pk_bf16_f32 v31, v78, v79
s_waitcnt lgkmcnt(2)
v_mfma_f32_32x32x16_bf16 v[64:79], v[96:99], v[16:19], v[48:63]
ds_read_b128 v[104:107], v2 offset:20480
v_exp_f32 v80, v80
v_exp_f32 v81, v81
v_exp_f32 v82, v82
v_exp_f32 v83, v83
v_mfma_f32_32x32x16_bf16 v[64:79], v[100:103], v[20:23], v[64:79]
ds_read_b128 v[108:111], v2 offset:21504
v_exp_f32 v88, v88
v_exp_f32 v89, v89
v_exp_f32 v90, v90
v_exp_f32 v91, v91
v_mfma_f32_32x32x16_bf16 v[32:47], v[128:131], v[24:27], v[32:47]
ds_read_b128 v[112:115], v2 offset:18432
v_cvt_pk_bf16_f32 v24, v80, v81
v_cvt_pk_bf16_f32 v25, v82, v83
v_cvt_pk_bf16_f32 v26, v88, v89
v_cvt_pk_bf16_f32 v27, v90, v91
v_exp_f32 v84, v84
v_exp_f32 v85, v85
v_exp_f32 v86, v86
v_exp_f32 v87, v87
v_mfma_f32_32x32x16_bf16 v[32:47], v[132:135], v[28:31], v[32:47]
ds_read_b128 v[116:119], v2 offset:19456
v_exp_f32 v92, v92
v_exp_f32 v93, v93
v_exp_f32 v94, v94
v_exp_f32 v95, v95
v_cvt_pk_bf16_f32 v28, v84, v85
v_cvt_pk_bf16_f32 v29, v86, v87
v_cvt_pk_bf16_f32 v30, v92, v93
v_cvt_pk_bf16_f32 v31, v94, v95
s_waitcnt lgkmcnt(2)
v_mfma_f32_32x32x16_bf16 v[80:95], v[104:107], v[16:19], v[48:63]
ds_read_b128 v[96:99], v2 offset:24576
v_exp_f32 v64, v64
v_exp_f32 v65, v65
v_exp_f32 v66, v66
v_exp_f32 v67, v67
v_mfma_f32_32x32x16_bf16 v[80:95], v[108:111], v[20:23], v[80:95]
ds_read_b128 v[100:103], v2 offset:25600
v_exp_f32 v72, v72
v_exp_f32 v73, v73
v_exp_f32 v74, v74
v_exp_f32 v75, v75
v_mfma_f32_32x32x16_bf16 v[32:47], v[136:139], v[24:27], v[32:47]
ds_read_b128 v[120:123], v2 offset:22528
v_cvt_pk_bf16_f32 v24, v64, v65
v_cvt_pk_bf16_f32 v25, v66, v67
v_cvt_pk_bf16_f32 v26, v72, v73
v_cvt_pk_bf16_f32 v27, v74, v75
v_exp_f32 v68, v68
v_exp_f32 v69, v69
v_exp_f32 v70, v70
v_exp_f32 v71, v71
v_mfma_f32_32x32x16_bf16 v[32:47], v[140:143], v[28:31], v[32:47]
ds_read_b128 v[124:127], v2 offset:23552
v_exp_f32 v76, v76
v_exp_f32 v77, v77
v_exp_f32 v78, v78
v_exp_f32 v79, v79
v_cvt_pk_bf16_f32 v28, v68, v69
v_cvt_pk_bf16_f32 v29, v70, v71
v_cvt_pk_bf16_f32 v30, v76, v77
v_cvt_pk_bf16_f32 v31, v78, v79
s_waitcnt lgkmcnt(2)
v_mfma_f32_32x32x16_bf16 v[64:79], v[96:99], v[16:19], v[48:63]
ds_read_b128 v[104:107], v2 offset:28672
v_exp_f32 v80, v80
v_exp_f32 v81, v81
v_exp_f32 v82, v82
v_exp_f32 v83, v83
v_mfma_f32_32x32x16_bf16 v[64:79], v[100:103], v[20:23], v[64:79]
ds_read_b128 v[108:111], v2 offset:29696
v_exp_f32 v88, v88
v_exp_f32 v89, v89
v_exp_f32 v90, v90
v_exp_f32 v91, v91
s_cmp_lg_u32 s56, 0
s_cbranch_scc1 LA_ren2G
LA_ren2retG:
v_mfma_f32_32x32x16_bf16 v[32:47], v[112:115], v[24:27], v[32:47]
ds_read_b128 v[128:131], v2 offset:26624
v_cvt_pk_bf16_f32 v24, v80, v81
v_cvt_pk_bf16_f32 v25, v82, v83
v_cvt_pk_bf16_f32 v26, v88, v89
v_cvt_pk_bf16_f32 v27, v90, v91
v_exp_f32 v84, v84
v_exp_f32 v85, v85
v_exp_f32 v86, v86
v_exp_f32 v87, v87
v_mfma_f32_32x32x16_bf16 v[32:47], v[116:119], v[28:31], v[32:47]
ds_read_b128 v[132:135], v2 offset:27648
v_exp_f32 v92, v92
v_exp_f32 v93, v93
v_exp_f32 v94, v94
v_exp_f32 v95, v95
v_cvt_pk_bf16_f32 v28, v84, v85
v_cvt_pk_bf16_f32 v29, v86, v87
v_cvt_pk_bf16_f32 v30, v92, v93
v_cvt_pk_bf16_f32 v31, v94, v95
s_waitcnt lgkmcnt(2)
v_mfma_f32_32x32x16_bf16 v[80:95], v[104:107], v[16:19], v[48:63]
ds_read_b128 v[96:99], v3 offset:0
v_exp_f32 v64, v64
v_exp_f32 v65, v65
v_exp_f32 v66, v66
v_exp_f32 v67, v67
v_mfma_f32_32x32x16_bf16 v[80:95], v[108:111], v[20:23], v[80:95]
ds_read_b128 v[100:103], v3 offset:1024
v_exp_f32 v72, v72
v_exp_f32 v73, v73
v_exp_f32 v74, v74
v_exp_f32 v75, v75
v_mfma_f32_32x32x16_bf16 v[32:47], v[120:123], v[24:27], v[32:47]
ds_read_b128 v[136:139], v2 offset:30720
v_cvt_pk_bf16_f32 v24, v64, v65
v_cvt_pk_bf16_f32 v25, v66, v67
v_cvt_pk_bf16_f32 v26, v72, v73
v_cvt_pk_bf16_f32 v27, v74, v75
v_exp_f32 v68, v68
v_exp_f32 v69, v69
v_exp_f32 v70, v70
v_exp_f32 v71, v71
v_mfma_f32_32x32x16_bf16 v[32:47], v[124:127], v[28:31], v[32:47]
ds_read_b128 v[140:143], v2 offset:31744
v_exp_f32 v76, v76
v_exp_f32 v77, v77
v_exp_f32 v78, v78
v_exp_f32 v79, v79
v_cvt_pk_bf16_f32 v28, v68, v69
v_cvt_pk_bf16_f32 v29, v70, v71
v_cvt_pk_bf16_f32 v30, v76, v77
v_cvt_pk_bf16_f32 v31, v78, v79
s_waitcnt lgkmcnt(2)
v_mfma_f32_32x32x16_bf16 v[64:79], v[96:99], v[16:19], v[48:63]
ds_read_b128 v[104:107], v3 offset:4096
v_exp_f32 v80, v80
v_exp_f32 v81, v81
v_exp_f32 v82, v82
v_exp_f32 v83, v83
v_mfma_f32_32x32x16_bf16 v[64:79], v[100:103], v[20:23], v[64:79]
ds_read_b128 v[108:111], v3 offset:5120
v_exp_f32 v88, v88
v_exp_f32 v89, v89
v_exp_f32 v90, v90
v_exp_f32 v91, v91
v_mfma_f32_32x32x16_bf16 v[32:47], v[128:131], v[24:27], v[32:47]
ds_read_b128 v[112:115], v3 offset:2048
v_cvt_pk_bf16_f32 v24, v80, v81
v_cvt_pk_bf16_f32 v25, v82, v83
v_cvt_pk_bf16_f32 v26, v88, v89
v_cvt_pk_bf16_f32 v27, v90, v91
v_exp_f32 v84, v84
v_exp_f32 v85, v85
v_exp_f32 v86, v86
v_exp_f32 v87, v87
v_mfma_f32_32x32x16_bf16 v[32:47], v[132:135], v[28:31], v[32:47]
ds_read_b128 v[116:119], v3 offset:3072
v_exp_f32 v92, v92
v_exp_f32 v93, v93
v_exp_f32 v94, v94
v_exp_f32 v95, v95
v_cvt_pk_bf16_f32 v28, v84, v85
v_cvt_pk_bf16_f32 v29, v86, v87
v_cvt_pk_bf16_f32 v30, v92, v93
v_cvt_pk_bf16_f32 v31, v94, v95
v_add_u32 v2, 65536, v1
v_add_u32 v3, 98304, v1
s_and_b32 s26, s2, 3
s_lshr_b32 s27, s2, 3
s_and_b32 s28, s27, 3
s_lshr_b32 s29, s27, 2
s_and_b32 s30, s2, 4
s_lshl_b32 s30, s30, 1
s_add_u32 s29, s29, s30
s_mov_b32 s12, s46
s_mov_b32 s13, s47
s_mov_b32 s14, 3670016
s_mov_b32 s15, 0x20000
s_lshl_b32 s32, s29, 2
s_add_u32 s32, s32, s48
s_lshl_b32 s32, s32, 18
s_lshl_b32 s30, s26, 15
s_add_u32 s32, s32, s30
s_add_u32 s32, s32, 50331648
s_add_u32 s33, s32, 131072
s_lshl_b32 s34, s26, 5
s_add_u32 s34, s34, s48
s_mul_i32 s34, s34, 28672
s_mul_i32 s30, s28, 7168
s_add_u32 s34, s34, s30
s_add_u32 s34, s34, 112197632
s_mul_i32 s35, s48, 7168
s_lshl_b32 s62, s29, 7
s_lshl_b32 s30, s26, 4
s_add_u32 s62, s62, s30
s_add_u32 s62, s62, 109092864
s_mov_b32 s65, 109084672
s_lshl_b32 s30, s29, 2
s_add_u32 s30, s30, s28
s_lshl_b32 s30, s30, 2
s_add_u32 s31, s30, s48
s_mul_i32 s66, s31, 28672
s_lshl_b32 s68, s26, 10
s_add_u32 s66, s66, s68
s_add_u32 s66, s66, 100663296
s_lshl_b32 s68, s31, 4
s_lshl_b32 s31, s26, 2
s_add_u32 s68, s68, s31
s_add_u32 s68, s68, 109105152
s_add_u32 s30, s30, s26
s_lshl_b32 s72, s30, 4
s_add_u32 s72, s72, 109105152
s_mul_i32 s71, s30, 7
s_add_u32 s71, s71, s48
s_add_u32 s71, s71, s48
s_lshl_b32 s71, s71, 12
s_add_u32 s71, s71, 100663296
s_lshl_b32 s69, s29, 2
s_add_u32 s69, s69, s26
s_mul_i32 s69, s69, 57344
s_mul_i32 s31, s28, 224
s_add_u32 s69, s69, s31
s_lshl_b32 s31, s48, 6
s_add_u32 s69, s69, s31
s_add_u32 s69, s69, 896
s_and_b32 s26, s2, 7
s_lshl_b32 s26, s26, 2
s_cmp_lt_u32 s27, 28
s_cselect_b32 s63, 1, 0
s_min_u32 s27, s27, 27
s_mul_i32 s28, s27, 37
s_lshr_b32 s28, s28, 8
s_mul_i32 s29, s28, 7
s_sub_u32 s29, s27, s29
s_add_u32 s28, s28, s26
s_lshl_b32 s36, s28, 16
s_lshl_b32 s26, s48, 12
s_add_u32 s36, s36, s26
s_add_u32 s36, s36, 73400320
s_add_u32 s37, s36, 16384
s_add_u32 s38, s37, 16384
s_add_u32 s39, s38, 16384
s_lshl_b32 s64, s29, 16
s_lshl_b32 s26, s48, 14
s_add_u32 s64, s64, s26
s_add_u32 s64, s64, 115867648
s_mul_i32 s61, s28, 114688
s_lshl_b32 s26, s29, 7
s_add_u32 s61, s61, s26
s_lshr_b32 s70, s28, 1
s_lshl_b32 s70, s70, 7
s_add_u32 s70, s70, 109101056
v_mov_b32 v144, v1
v_add_u32 v145, 65536, v1
v_add_u32 v146, 131072, v1
v_and_b32 v14, 3, v15
v_lshlrev_b32 v14, 2, v14
v_and_b32 v160, 15, v15
v_mul_u32_u24 v147, 1792, v160
v_lshrrev_b32 v160, 4, v15
v_lshl_add_u32 v147, v160, 3, v147
v_lshrrev_b32 v160, 2, v15
v_and_b32 v152, 3, v15
v_lshlrev_b32 v152, 4, v152
v_lshl_add_u32 v152, v160, 7, v152
s_waitcnt lgkmcnt(2)
v_mfma_f32_32x32x16_bf16 v[80:95], v[104:107], v[16:19], v[48:63]
ds_read_b128 v[96:99], v2 offset:8192
v_exp_f32 v64, v64
v_exp_f32 v65, v65
v_exp_f32 v66, v66
v_exp_f32 v67, v67
v_mfma_f32_32x32x16_bf16 v[80:95], v[108:111], v[20:23], v[80:95]
ds_read_b128 v[100:103], v2 offset:9216
v_exp_f32 v72, v72
v_exp_f32 v73, v73
v_exp_f32 v74, v74
v_exp_f32 v75, v75
v_mfma_f32_32x32x16_bf16 v[32:47], v[136:139], v[24:27], v[32:47]
ds_read_b128 v[120:123], v2 offset:6144
v_cvt_pk_bf16_f32 v24, v64, v65
v_cvt_pk_bf16_f32 v25, v66, v67
v_cvt_pk_bf16_f32 v26, v72, v73
v_cvt_pk_bf16_f32 v27, v74, v75
v_exp_f32 v68, v68
v_exp_f32 v69, v69
v_exp_f32 v70, v70
v_exp_f32 v71, v71
v_mfma_f32_32x32x16_bf16 v[32:47], v[140:143], v[28:31], v[32:47]
ds_read_b128 v[124:127], v2 offset:7168
v_exp_f32 v76, v76
v_exp_f32 v77, v77
v_exp_f32 v78, v78
v_exp_f32 v79, v79
v_cvt_pk_bf16_f32 v28, v68, v69
v_cvt_pk_bf16_f32 v29, v70, v71
v_cvt_pk_bf16_f32 v30, v76, v77
v_cvt_pk_bf16_f32 v31, v78, v79
s_waitcnt lgkmcnt(2)
v_mfma_f32_32x32x16_bf16 v[64:79], v[96:99], v[16:19], v[48:63]
ds_read_b128 v[104:107], v2 offset:12288
v_exp_f32 v80, v80
v_exp_f32 v81, v81
v_exp_f32 v82, v82
v_exp_f32 v83, v83
v_mfma_f32_32x32x16_bf16 v[64:79], v[100:103], v[20:23], v[64:79]
ds_read_b128 v[108:111], v2 offset:13312
v_exp_f32 v88, v88
v_exp_f32 v89, v89
v_exp_f32 v90, v90
v_exp_f32 v91, v91
v_mfma_f32_32x32x16_bf16 v[32:47], v[112:115], v[24:27], v[32:47]
ds_read_b128 v[128:131], v2 offset:10240
v_cvt_pk_bf16_f32 v24, v80, v81
v_cvt_pk_bf16_f32 v25, v82, v83
v_cvt_pk_bf16_f32 v26, v88, v89
v_cvt_pk_bf16_f32 v27, v90, v91
v_exp_f32 v84, v84
v_exp_f32 v85, v85
v_exp_f32 v86, v86
v_exp_f32 v87, v87
v_mfma_f32_32x32x16_bf16 v[32:47], v[116:119], v[28:31], v[32:47]
ds_read_b128 v[132:135], v2 offset:11264
v_exp_f32 v92, v92
v_exp_f32 v93, v93
v_exp_f32 v94, v94
v_exp_f32 v95, v95
v_cvt_pk_bf16_f32 v28, v84, v85
v_cvt_pk_bf16_f32 v29, v86, v87
v_cvt_pk_bf16_f32 v30, v92, v93
v_cvt_pk_bf16_f32 v31, v94, v95
s_waitcnt lgkmcnt(2)
v_mfma_f32_32x32x16_bf16 v[80:95], v[104:107], v[16:19], v[48:63]
ds_read_b128 v[96:99], v2 offset:16384
v_exp_f32 v64, v64
v_exp_f32 v65, v65
v_exp_f32 v66, v66
v_exp_f32 v67, v67
v_mfma_f32_32x32x16_bf16 v[80:95], v[108:111], v[20:23], v[80:95]
ds_read_b128 v[100:103], v2 offset:17408
v_exp_f32 v72, v72
v_exp_f32 v73, v73
v_exp_f32 v74, v74
v_exp_f32 v75, v75
v_cmp_lt_f32 vcc, s55, v44
s_cmp_lg_u32 vcc_hi, 0
s_cbranch_scc1 LA_ren1H
LA_ren1retH:
v_mfma_f32_32x32x16_bf16 v[32:47], v[120:123], v[24:27], v[32:47]
ds_read_b128 v[136:139], v2 offset:14336
v_cvt_pk_bf16_f32 v24, v64, v65
v_cvt_pk_bf16_f32 v25, v66, v67
v_cvt_pk_bf16_f32 v26, v72, v73
v_cvt_pk_bf16_f32 v27, v74, v75
v_exp_f32 v68, v68
v_exp_f32 v69, v69
v_exp_f32 v70, v70
v_exp_f32 v71, v71
v_mfma_f32_32x32x16_bf16 v[32:47], v[124:127], v[28:31], v[32:47]
ds_read_b128 v[140:143], v2 offset:15360
v_exp_f32 v76, v76
v_exp_f32 v77, v77
v_exp_f32 v78, v78
v_exp_f32 v79, v79
v_cvt_pk_bf16_f32 v28, v68, v69
v_cvt_pk_bf16_f32 v29, v70, v71
v_cvt_pk_bf16_f32 v30, v76, v77
v_cvt_pk_bf16_f32 v31, v78, v79
s_waitcnt lgkmcnt(2)
v_mfma_f32_32x32x16_bf16 v[64:79], v[96:99], v[16:19], v[48:63]
ds_read_b128 v[104:107], v2 offset:20480
v_exp_f32 v80, v80
v_exp_f32 v81, v81
v_exp_f32 v82, v82
v_exp_f32 v83, v83
v_mfma_f32_32x32x16_bf16 v[64:79], v[100:103], v[20:23], v[64:79]
ds_read_b128 v[108:111], v2 offset:21504
v_exp_f32 v88, v88
v_exp_f32 v89, v89
v_exp_f32 v90, v90
v_exp_f32 v91, v91
v_mfma_f32_32x32x16_bf16 v[32:47], v[128:131], v[24:27], v[32:47]
ds_read_b128 v[112:115], v2 offset:18432
v_cvt_pk_bf16_f32 v24, v80, v81
v_cvt_pk_bf16_f32 v25, v82, v83
v_cvt_pk_bf16_f32 v26, v88, v89
v_cvt_pk_bf16_f32 v27, v90, v91
v_exp_f32 v84, v84
v_exp_f32 v85, v85
v_exp_f32 v86, v86
v_exp_f32 v87, v87
v_mfma_f32_32x32x16_bf16 v[32:47], v[132:135], v[28:31], v[32:47]
ds_read_b128 v[116:119], v2 offset:19456
v_exp_f32 v92, v92
v_exp_f32 v93, v93
v_exp_f32 v94, v94
v_exp_f32 v95, v95
v_cvt_pk_bf16_f32 v28, v84, v85
v_cvt_pk_bf16_f32 v29, v86, v87
v_cvt_pk_bf16_f32 v30, v92, v93
v_cvt_pk_bf16_f32 v31, v94, v95
s_waitcnt lgkmcnt(2)
v_mfma_f32_32x32x16_bf16 v[80:95], v[104:107], v[16:19], v[48:63]
ds_read_b128 v[96:99], v2 offset:24576
v_exp_f32 v64, v64
v_exp_f32 v65, v65
v_exp_f32 v66, v66
v_exp_f32 v67, v67
v_mfma_f32_32x32x16_bf16 v[80:95], v[108:111], v[20:23], v[80:95]
ds_read_b128 v[100:103], v2 offset:25600
v_exp_f32 v72, v72
v_exp_f32 v73, v73
v_exp_f32 v74, v74
v_exp_f32 v75, v75
v_mfma_f32_32x32x16_bf16 v[32:47], v[136:139], v[24:27], v[32:47]
ds_read_b128 v[120:123], v2 offset:22528
v_cvt_pk_bf16_f32 v24, v64, v65
v_cvt_pk_bf16_f32 v25, v66, v67
v_cvt_pk_bf16_f32 v26, v72, v73
v_cvt_pk_bf16_f32 v27, v74, v75
v_exp_f32 v68, v68
v_exp_f32 v69, v69
v_exp_f32 v70, v70
v_exp_f32 v71, v71
v_mfma_f32_32x32x16_bf16 v[32:47], v[140:143], v[28:31], v[32:47]
ds_read_b128 v[124:127], v2 offset:23552
v_exp_f32 v76, v76
v_exp_f32 v77, v77
v_exp_f32 v78, v78
v_exp_f32 v79, v79
v_cvt_pk_bf16_f32 v28, v68, v69
v_cvt_pk_bf16_f32 v29, v70, v71
v_cvt_pk_bf16_f32 v30, v76, v77
v_cvt_pk_bf16_f32 v31, v78, v79
s_waitcnt lgkmcnt(2)
v_mfma_f32_32x32x16_bf16 v[64:79], v[96:99], v[16:19], v[48:63]
ds_read_b128 v[104:107], v2 offset:28672
buffer_load_dword v13, v14, s[20:23], s62 offen sc0 sc1
v_exp_f32 v80, v80
v_exp_f32 v81, v81
v_exp_f32 v82, v82
v_exp_f32 v83, v83
v_mfma_f32_32x32x16_bf16 v[64:79], v[100:103], v[20:23], v[64:79]
ds_read_b128 v[108:111], v2 offset:29696
buffer_load_dwordx4 v[148:151], v152, s[20:23], s65 offen sc0 sc1
v_exp_f32 v88, v88
v_exp_f32 v89, v89
v_exp_f32 v90, v90
v_exp_f32 v91, v91
s_cmp_lg_u32 s56, 0
s_cbranch_scc1 LA_ren2H
LA_ren2retH:
v_mfma_f32_32x32x16_bf16 v[32:47], v[112:115], v[24:27], v[32:47]
ds_read_b128 v[128:131], v2 offset:26624
v_cvt_pk_bf16_f32 v24, v80, v81
v_cvt_pk_bf16_f32 v25, v82, v83
v_cvt_pk_bf16_f32 v26, v88, v89
v_cvt_pk_bf16_f32 v27, v90, v91
v_exp_f32 v84, v84
v_exp_f32 v85, v85
v_exp_f32 v86, v86
v_exp_f32 v87, v87
v_mfma_f32_32x32x16_bf16 v[32:47], v[116:119], v[28:31], v[32:47]
ds_read_b128 v[132:135], v2 offset:27648
v_exp_f32 v92, v92
v_exp_f32 v93, v93
v_exp_f32 v94, v94
v_exp_f32 v95, v95
v_cvt_pk_bf16_f32 v28, v84, v85
v_cvt_pk_bf16_f32 v29, v86, v87
v_cvt_pk_bf16_f32 v30, v92, v93
v_cvt_pk_bf16_f32 v31, v94, v95
s_waitcnt lgkmcnt(2)
s_barrier
v_mfma_f32_32x32x16_bf16 v[80:95], v[104:107], v[16:19], v[48:63]
ds_read_b128 v[96:99], v3 offset:0
v_exp_f32 v64, v64
v_exp_f32 v65, v65
v_exp_f32 v66, v66
v_exp_f32 v67, v67
v_mfma_f32_32x32x16_bf16 v[80:95], v[108:111], v[20:23], v[80:95]
ds_read_b128 v[100:103], v3 offset:1024
v_exp_f32 v72, v72
v_exp_f32 v73, v73
v_exp_f32 v74, v74
v_exp_f32 v75, v75
v_mfma_f32_32x32x16_bf16 v[32:47], v[120:123], v[24:27], v[32:47]
ds_read_b128 v[136:139], v2 offset:30720
v_cvt_pk_bf16_f32 v24, v64, v65
v_cvt_pk_bf16_f32 v25, v66, v67
v_cvt_pk_bf16_f32 v26, v72, v73
v_cvt_pk_bf16_f32 v27, v74, v75
v_exp_f32 v68, v68
v_exp_f32 v69, v69
v_exp_f32 v70, v70
v_exp_f32 v71, v71
v_mfma_f32_32x32x16_bf16 v[32:47], v[124:127], v[28:31], v[32:47]
ds_read_b128 v[140:143], v2 offset:31744
v_exp_f32 v76, v76
v_exp_f32 v77, v77
v_exp_f32 v78, v78
v_exp_f32 v79, v79
v_cvt_pk_bf16_f32 v28, v68, v69
v_cvt_pk_bf16_f32 v29, v70, v71
v_cvt_pk_bf16_f32 v30, v76, v77
v_cvt_pk_bf16_f32 v31, v78, v79
s_waitcnt lgkmcnt(2)
v_mfma_f32_32x32x16_bf16 v[64:79], v[96:99], v[16:19], v[48:63]
ds_read_b128 v[104:107], v3 offset:4096
v_exp_f32 v80, v80
v_exp_f32 v81, v81
v_exp_f32 v82, v82
v_exp_f32 v83, v83
v_mfma_f32_32x32x16_bf16 v[64:79], v[100:103], v[20:23], v[64:79]
ds_read_b128 v[108:111], v3 offset:5120
v_exp_f32 v88, v88
v_exp_f32 v89, v89
v_exp_f32 v90, v90
v_exp_f32 v91, v91
v_mfma_f32_32x32x16_bf16 v[32:47], v[128:131], v[24:27], v[32:47]
ds_read_b128 v[112:115], v3 offset:2048
v_cvt_pk_bf16_f32 v24, v80, v81
v_cvt_pk_bf16_f32 v25, v82, v83
v_cvt_pk_bf16_f32 v26, v88, v89
v_cvt_pk_bf16_f32 v27, v90, v91
v_exp_f32 v84, v84
v_exp_f32 v85, v85
v_exp_f32 v86, v86
v_exp_f32 v87, v87
v_mfma_f32_32x32x16_bf16 v[32:47], v[132:135], v[28:31], v[32:47]
ds_read_b128 v[116:119], v3 offset:3072
v_exp_f32 v92, v92
v_exp_f32 v93, v93
v_exp_f32 v94, v94
v_exp_f32 v95, v95
v_cvt_pk_bf16_f32 v28, v84, v85
v_cvt_pk_bf16_f32 v29, v86, v87
v_cvt_pk_bf16_f32 v30, v92, v93
v_cvt_pk_bf16_f32 v31, v94, v95
v_add_u32 v2, 98304, v1
v_add_u32 v3, 0, v1
s_waitcnt vmcnt(0)
v_xor_b32 v148, s89, v148
v_xor_b32 v149, s89, v149
v_xor_b32 v150, s89, v150
v_xor_b32 v151, s89, v151
v_xor_b32 v13, s89, v13
v_or3_b32 v13, v13, v148, v149
v_or3_b32 v13, v13, v150, v151
v_cmp_ne_u32 vcc, 0, v13
s_mov_b32 s60, 0
s_cbranch_vccnz LA_last
s_mov_b32 s60, 1
s_waitcnt lgkmcnt(2)
v_mfma_f32_32x32x16_bf16 v[80:95], v[104:107], v[16:19], v[48:63]
ds_read_b128 v[96:99], v2 offset:8192
s_add_u32 m0, s35, 131072
s_nop 0
buffer_load_dwordx4 v1, s[20:23], s34 offen offset:0 sc1 lds
buffer_load_dwordx4 v1, s[20:23], s34 offen offset:1024 sc1 lds
v_exp_f32 v64, v64
v_exp_f32 v65, v65
v_exp_f32 v66, v66
v_exp_f32 v67, v67
v_mfma_f32_32x32x16_bf16 v[80:95], v[108:111], v[20:23], v[80:95]
ds_read_b128 v[100:103], v2 offset:9216
buffer_load_dwordx4 v1, s[20:23], s34 offen offset:2048 sc1 lds
buffer_load_dwordx4 v1, s[20:23], s34 offen offset:3072 sc1 lds
s_add_u32 s34, s34, 4096
v_exp_f32 v72, v72
v_exp_f32 v73, v73
v_exp_f32 v74, v74
v_exp_f32 v75, v75
v_mfma_f32_32x32x16_bf16 v[32:47], v[136:139], v[24:27], v[32:47]
ds_read_b128 v[120:123], v2 offset:6144
s_add_u32 m0, s35, 135168
s_nop 0
buffer_load_dwordx4 v1, s[20:23], s34 offen offset:0 sc1 lds
buffer_load_dwordx4 v1, s[20:23], s34 offen offset:1024 sc1 lds
v_cvt_pk_bf16_f32 v24, v64, v65
v_cvt_pk_bf16_f32 v25, v66, v67
v_cvt_pk_bf16_f32 v26, v72, v73
v_cvt_pk_bf16_f32 v27, v74, v75
v_exp_f32 v68, v68
v_exp_f32 v69, v69
v_exp_f32 v70, v70
v_exp_f32 v71, v71
v_mfma_f32_32x32x16_bf16 v[32:47], v[140:143], v[28:31], v[32:47]
ds_read_b128 v[124:127], v2 offset:7168
v_exp_f32 v76, v76
v_exp_f32 v77, v77
v_exp_f32 v78, v78
v_exp_f32 v79, v79
v_cvt_pk_bf16_f32 v28, v68, v69
v_cvt_pk_bf16_f32 v29, v70, v71
v_cvt_pk_bf16_f32 v30, v76, v77
v_cvt_pk_bf16_f32 v31, v78, v79
s_waitcnt lgkmcnt(2)
v_mfma_f32_32x32x16_bf16 v[64:79], v[96:99], v[16:19], v[48:63]
ds_read_b128 v[104:107], v2 offset:12288
buffer_load_dwordx4 v1, s[20:23], s34 offen offset:2048 sc1 lds
s_add_u32 s34, s34, 110592
buffer_load_dwordx4 a[0:3], v1, s[20:23], s32 offen offset:0 sc1
v_exp_f32 v80, v80
v_exp_f32 v81, v81
v_exp_f32 v82, v82
v_exp_f32 v83, v83
v_mfma_f32_32x32x16_bf16 v[64:79], v[100:103], v[20:23], v[64:79]
ds_read_b128 v[108:111], v2 offset:13312
buffer_load_dwordx4 a[4:7], v1, s[20:23], s33 offen offset:0 sc1
buffer_load_dwordx4 a[8:11], v1, s[20:23], s32 offen offset:1024 sc1
v_exp_f32 v88, v88
v_exp_f32 v89, v89
v_exp_f32 v90, v90
v_exp_f32 v91, v91
v_mfma_f32_32x32x16_bf16 v[32:47], v[112:115], v[24:27], v[32:47]
ds_read_b128 v[128:131], v2 offset:10240
buffer_load_dwordx4 a[12:15], v1, s[20:23], s33 offen offset:1024 sc1
buffer_load_dwordx4 a[16:19], v1, s[20:23], s32 offen offset:2048 sc1
v_cvt_pk_bf16_f32 v24, v80, v81
v_cvt_pk_bf16_f32 v25, v82, v83
v_cvt_pk_bf16_f32 v26, v88, v89
v_cvt_pk_bf16_f32 v27, v90, v91
v_exp_f32 v84, v84
v_exp_f32 v85, v85
v_exp_f32 v86, v86
v_exp_f32 v87, v87
v_mfma_f32_32x32x16_bf16 v[32:47], v[116:119], v[28:31], v[32:47]
ds_read_b128 v[132:135], v2 offset:11264
v_exp_f32 v92, v92
v_exp_f32 v93, v93
v_exp_f32 v94, v94
v_exp_f32 v95, v95
v_cvt_pk_bf16_f32 v28, v84, v85
v_cvt_pk_bf16_f32 v29, v86, v87
v_cvt_pk_bf16_f32 v30, v92, v93
v_cvt_pk_bf16_f32 v31, v94, v95
s_waitcnt lgkmcnt(2)
v_mfma_f32_32x32x16_bf16 v[80:95], v[104:107], v[16:19], v[48:63]
ds_read_b128 v[96:99], v2 offset:16384
buffer_load_dwordx4 a[20:23], v1, s[20:23], s33 offen offset:2048 sc1
buffer_load_dwordx4 a[24:27], v1, s[20:23], s32 offen offset:3072 sc1
s_add_u32 s32, s32, 4096
v_exp_f32 v64, v64
v_exp_f32 v65, v65
v_exp_f32 v66, v66
v_exp_f32 v67, v67
v_mfma_f32_32x32x16_bf16 v[80:95], v[108:111], v[20:23], v[80:95]
ds_read_b128 v[100:103], v2 offset:17408
buffer_load_dwordx4 a[28:31], v1, s[20:23], s33 offen offset:3072 sc1
s_add_u32 s33, s33, 4096
s_add_u32 m0, s35, 0
s_nop 0
buffer_load_dwordx4 v1, s[20:23], s34 offen offset:0 sc1 lds
v_exp_f32 v72, v72
v_exp_f32 v73, v73
v_exp_f32 v74, v74
v_exp_f32 v75, v75
v_cmp_lt_f32 vcc, s55, v44
s_cmp_lg_u32 vcc_hi, 0
s_cbranch_scc1 LA_ren1E
LA_ren1retE:
v_mfma_f32_32x32x16_bf16 v[32:47], v[120:123], v[24:27], v[32:47]
ds_read_b128 v[136:139], v2 offset:14336
buffer_load_dwordx4 v1, s[20:23], s34 offen offset:1024 sc1 lds
buffer_load_dwordx4 v1, s[20:23], s34 offen offset:2048 sc1 lds
v_cvt_pk_bf16_f32 v24, v64, v65
v_cvt_pk_bf16_f32 v25, v66, v67
v_cvt_pk_bf16_f32 v26, v72, v73
v_cvt_pk_bf16_f32 v27, v74, v75
v_exp_f32 v68, v68
v_exp_f32 v69, v69
v_exp_f32 v70, v70
v_exp_f32 v71, v71
v_mfma_f32_32x32x16_bf16 v[32:47], v[124:127], v[28:31], v[32:47]
ds_read_b128 v[140:143], v2 offset:15360
v_exp_f32 v76, v76
v_exp_f32 v77, v77
v_exp_f32 v78, v78
v_exp_f32 v79, v79
v_cvt_pk_bf16_f32 v28, v68, v69
v_cvt_pk_bf16_f32 v29, v70, v71
v_cvt_pk_bf16_f32 v30, v76, v77
v_cvt_pk_bf16_f32 v31, v78, v79
s_waitcnt lgkmcnt(2)
v_mfma_f32_32x32x16_bf16 v[64:79], v[96:99], v[16:19], v[48:63]
ds_read_b128 v[104:107], v2 offset:20480
buffer_load_dwordx4 v1, s[20:23], s34 offen offset:3072 sc1 lds
s_add_u32 s34, s34, 4096
s_add_u32 m0, s35, 4096
s_nop 0
buffer_load_dwordx4 v1, s[20:23], s34 offen offset:0 sc1 lds
v_exp_f32 v80, v80
v_exp_f32 v81, v81
v_exp_f32 v82, v82
v_exp_f32 v83, v83
v_mfma_f32_32x32x16_bf16 v[64:79], v[100:103], v[20:23], v[64:79]
ds_read_b128 v[108:111], v2 offset:21504
buffer_load_dwordx4 v1, s[20:23], s34 offen offset:1024 sc1 lds
buffer_load_dwordx4 v1, s[20:23], s34 offen offset:2048 sc1 lds
s_add_u32 s34, s34, 110592
v_exp_f32 v88, v88
v_exp_f32 v89, v89
v_exp_f32 v90, v90
v_exp_f32 v91, v91
v_mfma_f32_32x32x16_bf16 v[32:47], v[128:131], v[24:27], v[32:47]
ds_read_b128 v[112:115], v2 offset:18432
buffer_load_dwordx4 a[32:35], v1, s[20:23], s32 offen offset:0 sc1
buffer_load_dwordx4 a[36:39], v1, s[20:23], s33 offen offset:0 sc1
v_cvt_pk_bf16_f32 v24, v80, v81
v_cvt_pk_bf16_f32 v25, v82, v83
v_cvt_pk_bf16_f32 v26, v88, v89
v_cvt_pk_bf16_f32 v27, v90, v91
v_exp_f32 v84, v84
v_exp_f32 v85, v85
v_exp_f32 v86, v86
v_exp_f32 v87, v87
v_mfma_f32_32x32x16_bf16 v[32:47], v[132:135], v[28:31], v[32:47]
ds_read_b128 v[116:119], v2 offset:19456
v_exp_f32 v92, v92
v_exp_f32 v93, v93
v_exp_f32 v94, v94
v_exp_f32 v95, v95
v_cvt_pk_bf16_f32 v28, v84, v85
v_cvt_pk_bf16_f32 v29, v86, v87
v_cvt_pk_bf16_f32 v30, v92, v93
v_cvt_pk_bf16_f32 v31, v94, v95
s_waitcnt lgkmcnt(2)
v_mfma_f32_32x32x16_bf16 v[80:95], v[104:107], v[16:19], v[48:63]
ds_read_b128 v[96:99], v2 offset:24576
buffer_load_dwordx4 a[40:43], v1, s[20:23], s32 offen offset:1024 sc1
buffer_load_dwordx4 a[44:47], v1, s[20:23], s33 offen offset:1024 sc1
v_exp_f32 v64, v64
v_exp_f32 v65, v65
v_exp_f32 v66, v66
v_exp_f32 v67, v67
v_mfma_f32_32x32x16_bf16 v[80:95], v[108:111], v[20:23], v[80:95]
ds_read_b128 v[100:103], v2 offset:25600
buffer_load_dwordx4 a[48:51], v1, s[20:23], s32 offen offset:2048 sc1
buffer_load_dwordx4 a[52:55], v1, s[20:23], s33 offen offset:2048 sc1
v_exp_f32 v72, v72
v_exp_f32 v73, v73
v_exp_f32 v74, v74
v_exp_f32 v75, v75
v_mfma_f32_32x32x16_bf16 v[32:47], v[136:139], v[24:27], v[32:47]
ds_read_b128 v[120:123], v2 offset:22528
buffer_load_dwordx4 a[56:59], v1, s[20:23], s32 offen offset:3072 sc1
s_add_u32 s32, s32, 4096
buffer_load_dwordx4 a[60:63], v1, s[20:23], s33 offen offset:3072 sc1
s_add_u32 s33, s33, 4096
v_cvt_pk_bf16_f32 v24, v64, v65
v_cvt_pk_bf16_f32 v25, v66, v67
v_cvt_pk_bf16_f32 v26, v72, v73
v_cvt_pk_bf16_f32 v27, v74, v75
v_exp_f32 v68, v68
v_exp_f32 v69, v69
v_exp_f32 v70, v70
v_exp_f32 v71, v71
v_mfma_f32_32x32x16_bf16 v[32:47], v[140:143], v[28:31], v[32:47]
ds_read_b128 v[124:127], v2 offset:23552
v_exp_f32 v76, v76
v_exp_f32 v77, v77
v_exp_f32 v78, v78
v_exp_f32 v79, v79
v_cvt_pk_bf16_f32 v28, v68, v69
v_cvt_pk_bf16_f32 v29, v70, v71
v_cvt_pk_bf16_f32 v30, v76, v77
v_cvt_pk_bf16_f32 v31, v78, v79
s_waitcnt lgkmcnt(2)
v_mfma_f32_32x32x16_bf16 v[64:79], v[96:99], v[16:19], v[48:63]
ds_read_b128 v[104:107], v2 offset:28672
s_add_u32 m0, s35, 32768
s_nop 0
buffer_load_dwordx4 v1, s[20:23], s34 offen offset:0 sc1 lds
buffer_load_dwordx4 v1, s[20:23], s34 offen offset:1024 sc1 lds
v_exp_f32 v80, v80
v_exp_f32 v81, v81
v_exp_f32 v82, v82
v_exp_f32 v83, v83
v_mfma_f32_32x32x16_bf16 v[64:79], v[100:103], v[20:23], v[64:79]
ds_read_b128 v[108:111], v2 offset:29696
buffer_load_dwordx4 v1, s[20:23], s34 offen offset:2048 sc1 lds
buffer_load_dwordx4 v1, s[20:23], s34 offen offset:3072 sc1 lds
s_add_u32 s34, s34, 4096
v_exp_f32 v88, v88
v_exp_f32 v89, v89
v_exp_f32 v90, v90
v_exp_f32 v91, v91
s_cmp_lg_u32 s56, 0
s_cbranch_scc1 LA_ren2E
LA_ren2retE:
v_mfma_f32_32x32x16_bf16 v[32:47], v[112:115], v[24:27], v[32:47]
ds_read_b128 v[128:131], v2 offset:26624
s_add_u32 m0, s35, 36864
s_nop 0
buffer_load_dwordx4 v1, s[20:23], s34 offen offset:0 sc1 lds
buffer_load_dwordx4 v1, s[20:23], s34 offen offset:1024 sc1 lds
v_cvt_pk_bf16_f32 v24, v80, v81
v_cvt_pk_bf16_f32 v25, v82, v83
v_cvt_pk_bf16_f32 v26, v88, v89
v_cvt_pk_bf16_f32 v27, v90, v91
v_exp_f32 v84, v84
v_exp_f32 v85, v85
v_exp_f32 v86, v86
v_exp_f32 v87, v87
v_mfma_f32_32x32x16_bf16 v[32:47], v[116:119], v[28:31], v[32:47]
ds_read_b128 v[132:135], v2 offset:27648
v_exp_f32 v92, v92
v_exp_f32 v93, v93
v_exp_f32 v94, v94
v_exp_f32 v95, v95
v_cvt_pk_bf16_f32 v28, v84, v85
v_cvt_pk_bf16_f32 v29, v86, v87
v_cvt_pk_bf16_f32 v30, v92, v93
v_cvt_pk_bf16_f32 v31, v94, v95
s_waitcnt lgkmcnt(2)
v_mfma_f32_32x32x16_bf16 v[80:95], v[104:107], v[16:19], v[48:63]
buffer_load_dwordx4 v1, s[20:23], s34 offen offset:2048 sc1 lds
s_add_u32 s34, s34, 110592
buffer_load_dwordx4 a[64:67], v1, s[20:23], s32 offen offset:0 sc1
v_exp_f32 v64, v64
v_exp_f32 v65, v65
v_exp_f32 v66, v66
v_exp_f32 v67, v67
v_mfma_f32_32x32x16_bf16 v[80:95], v[108:111], v[20:23], v[80:95]
buffer_load_dwordx4 a[68:71], v1, s[20:23], s33 offen offset:0 sc1
buffer_load_dwordx4 a[72:75], v1, s[20:23], s32 offen offset:1024 sc1
v_exp_f32 v72, v72
v_exp_f32 v73, v73
v_exp_f32 v74, v74
v_exp_f32 v75, v75
v_mfma_f32_32x32x16_bf16 v[32:47], v[120:123], v[24:27], v[32:47]
ds_read_b128 v[136:139], v2 offset:30720
buffer_load_dwordx4 a[76:79], v1, s[20:23], s33 offen offset:1024 sc1
buffer_load_dwordx4 a[80:83], v1, s[20:23], s32 offen offset:2048 sc1
v_cvt_pk_bf16_f32 v24, v64, v65
v_cvt_pk_bf16_f32 v25, v66, v67
v_cvt_pk_bf16_f32 v26, v72, v73
v_cvt_pk_bf16_f32 v27, v74, v75
v_exp_f32 v68, v68
v_exp_f32 v69, v69
v_exp_f32 v70, v70
v_exp_f32 v71, v71
v_mfma_f32_32x32x16_bf16 v[32:47], v[124:127], v[28:31], v[32:47]
ds_read_b128 v[140:143], v2 offset:31744
v_exp_f32 v76, v76
v_exp_f32 v77, v77
v_exp_f32 v78, v78
v_exp_f32 v79, v79
v_cvt_pk_bf16_f32 v28, v68, v69
v_cvt_pk_bf16_f32 v29, v70, v71
v_cvt_pk_bf16_f32 v30, v76, v77
v_cvt_pk_bf16_f32 v31, v78, v79
s_waitcnt lgkmcnt(0)
buffer_load_dwordx4 a[84:87], v1, s[20:23], s33 offen offset:2048 sc1
v_exp_f32 v80, v80
v_exp_f32 v81, v81
v_exp_f32 v82, v82
v_exp_f32 v83, v83
buffer_load_dwordx4 a[88:91], v1, s[20:23], s32 offen offset:3072 sc1
s_add_u32 s32, s32, 4096
v_exp_f32 v88, v88
v_exp_f32 v89, v89
v_exp_f32 v90, v90
v_exp_f32 v91, v91
v_mfma_f32_32x32x16_bf16 v[32:47], v[128:131], v[24:27], v[32:47]
buffer_load_dwordx4 a[92:95], v1, s[20:23], s33 offen offset:3072 sc1
s_add_u32 s33, s33, 4096
v_cvt_pk_bf16_f32 v24, v80, v81
v_cvt_pk_bf16_f32 v25, v82, v83
v_cvt_pk_bf16_f32 v26, v88, v89
v_cvt_pk_bf16_f32 v27, v90, v91
v_exp_f32 v84, v84
v_exp_f32 v85, v85
v_exp_f32 v86, v86
v_exp_f32 v87, v87
v_mfma_f32_32x32x16_bf16 v[32:47], v[132:135], v[28:31], v[32:47]
v_exp_f32 v92, v92
v_exp_f32 v93, v93
v_exp_f32 v94, v94
v_exp_f32 v95, v95
v_cvt_pk_bf16_f32 v28, v84, v85
v_cvt_pk_bf16_f32 v29, v86, v87
v_cvt_pk_bf16_f32 v30, v92, v93
v_cvt_pk_bf16_f32 v31, v94, v95
s_branch LA_done
LA_last:
s_waitcnt lgkmcnt(2)
v_mfma_f32_32x32x16_bf16 v[80:95], v[104:107], v[16:19], v[48:63]
ds_read_b128 v[96:99], v2 offset:8192
v_exp_f32 v64, v64
v_exp_f32 v65, v65
v_exp_f32 v66, v66
v_exp_f32 v67, v67
v_mfma_f32_32x32x16_bf16 v[80:95], v[108:111], v[20:23], v[80:95]
ds_read_b128 v[100:103], v2 offset:9216
v_exp_f32 v72, v72
v_exp_f32 v73, v73
v_exp_f32 v74, v74
v_exp_f32 v75, v75
v_mfma_f32_32x32x16_bf16 v[32:47], v[136:139], v[24:27], v[32:47]
ds_read_b128 v[120:123], v2 offset:6144
v_cvt_pk_bf16_f32 v24, v64, v65
v_cvt_pk_bf16_f32 v25, v66, v67
v_cvt_pk_bf16_f32 v26, v72, v73
v_cvt_pk_bf16_f32 v27, v74, v75
v_exp_f32 v68, v68
v_exp_f32 v69, v69
v_exp_f32 v70, v70
v_exp_f32 v71, v71
v_mfma_f32_32x32x16_bf16 v[32:47], v[140:143], v[28:31], v[32:47]
ds_read_b128 v[124:127], v2 offset:7168
v_exp_f32 v76, v76
v_exp_f32 v77, v77
v_exp_f32 v78, v78
v_exp_f32 v79, v79
v_cvt_pk_bf16_f32 v28, v68, v69
v_cvt_pk_bf16_f32 v29, v70, v71
v_cvt_pk_bf16_f32 v30, v76, v77
v_cvt_pk_bf16_f32 v31, v78, v79
s_waitcnt lgkmcnt(2)
v_mfma_f32_32x32x16_bf16 v[64:79], v[96:99], v[16:19], v[48:63]
ds_read_b128 v[104:107], v2 offset:12288
v_exp_f32 v80, v80
v_exp_f32 v81, v81
v_exp_f32 v82, v82
v_exp_f32 v83, v83
v_mfma_f32_32x32x16_bf16 v[64:79], v[100:103], v[20:23], v[64:79]
ds_read_b128 v[108:111], v2 offset:13312
v_exp_f32 v88, v88
v_exp_f32 v89, v89
v_exp_f32 v90, v90
v_exp_f32 v91, v91
v_mfma_f32_32x32x16_bf16 v[32:47], v[112:115], v[24:27], v[32:47]
ds_read_b128 v[128:131], v2 offset:10240
v_cvt_pk_bf16_f32 v24, v80, v81
v_cvt_pk_bf16_f32 v25, v82, v83
v_cvt_pk_bf16_f32 v26, v88, v89
v_cvt_pk_bf16_f32 v27, v90, v91
v_exp_f32 v84, v84
v_exp_f32 v85, v85
v_exp_f32 v86, v86
v_exp_f32 v87, v87
v_mfma_f32_32x32x16_bf16 v[32:47], v[116:119], v[28:31], v[32:47]
ds_read_b128 v[132:135], v2 offset:11264
v_exp_f32 v92, v92
v_exp_f32 v93, v93
v_exp_f32 v94, v94
v_exp_f32 v95, v95
v_cvt_pk_bf16_f32 v28, v84, v85
v_cvt_pk_bf16_f32 v29, v86, v87
v_cvt_pk_bf16_f32 v30, v92, v93
v_cvt_pk_bf16_f32 v31, v94, v95
s_waitcnt lgkmcnt(2)
v_mfma_f32_32x32x16_bf16 v[80:95], v[104:107], v[16:19], v[48:63]
ds_read_b128 v[96:99], v2 offset:16384
v_exp_f32 v64, v64
v_exp_f32 v65, v65
v_exp_f32 v66, v66
v_exp_f32 v67, v67
v_mfma_f32_32x32x16_bf16 v[80:95], v[108:111], v[20:23], v[80:95]
ds_read_b128 v[100:103], v2 offset:17408
v_exp_f32 v72, v72
v_exp_f32 v73, v73
v_exp_f32 v74, v74
v_exp_f32 v75, v75
v_cmp_lt_f32 vcc, s55, v44
s_cmp_lg_u32 vcc_hi, 0
s_cbranch_scc1 LA_ren1L
LA_ren1retL:
v_mfma_f32_32x32x16_bf16 v[32:47], v[120:123], v[24:27], v[32:47]
ds_read_b128 v[136:139], v2 offset:14336
v_cvt_pk_bf16_f32 v24, v64, v65
v_cvt_pk_bf16_f32 v25, v66, v67
v_cvt_pk_bf16_f32 v26, v72, v73
v_cvt_pk_bf16_f32 v27, v74, v75
v_exp_f32 v68, v68
v_exp_f32 v69, v69
v_exp_f32 v70, v70
v_exp_f32 v71, v71
v_mfma_f32_32x32x16_bf16 v[32:47], v[124:127], v[28:31], v[32:47]
ds_read_b128 v[140:143], v2 offset:15360
v_exp_f32 v76, v76
v_exp_f32 v77, v77
v_exp_f32 v78, v78
v_exp_f32 v79, v79
v_cvt_pk_bf16_f32 v28, v68, v69
v_cvt_pk_bf16_f32 v29, v70, v71
v_cvt_pk_bf16_f32 v30, v76, v77
v_cvt_pk_bf16_f32 v31, v78, v79
s_waitcnt lgkmcnt(2)
v_mfma_f32_32x32x16_bf16 v[64:79], v[96:99], v[16:19], v[48:63]
ds_read_b128 v[104:107], v2 offset:20480
v_exp_f32 v80, v80
v_exp_f32 v81, v81
v_exp_f32 v82, v82
v_exp_f32 v83, v83
v_mfma_f32_32x32x16_bf16 v[64:79], v[100:103], v[20:23], v[64:79]
ds_read_b128 v[108:111], v2 offset:21504
v_exp_f32 v88, v88
v_exp_f32 v89, v89
v_exp_f32 v90, v90
v_exp_f32 v91, v91
v_mfma_f32_32x32x16_bf16 v[32:47], v[128:131], v[24:27], v[32:47]
ds_read_b128 v[112:115], v2 offset:18432
v_cvt_pk_bf16_f32 v24, v80, v81
v_cvt_pk_bf16_f32 v25, v82, v83
v_cvt_pk_bf16_f32 v26, v88, v89
v_cvt_pk_bf16_f32 v27, v90, v91
v_exp_f32 v84, v84
v_exp_f32 v85, v85
v_exp_f32 v86, v86
v_exp_f32 v87, v87
v_mfma_f32_32x32x16_bf16 v[32:47], v[132:135], v[28:31], v[32:47]
ds_read_b128 v[116:119], v2 offset:19456
v_exp_f32 v92, v92
v_exp_f32 v93, v93
v_exp_f32 v94, v94
v_exp_f32 v95, v95
v_cvt_pk_bf16_f32 v28, v84, v85
v_cvt_pk_bf16_f32 v29, v86, v87
v_cvt_pk_bf16_f32 v30, v92, v93
v_cvt_pk_bf16_f32 v31, v94, v95
s_waitcnt lgkmcnt(2)
v_mfma_f32_32x32x16_bf16 v[80:95], v[104:107], v[16:19], v[48:63]
ds_read_b128 v[96:99], v2 offset:24576
v_exp_f32 v64, v64
v_exp_f32 v65, v65
v_exp_f32 v66, v66
v_exp_f32 v67, v67
v_mfma_f32_32x32x16_bf16 v[80:95], v[108:111], v[20:23], v[80:95]
ds_read_b128 v[100:103], v2 offset:25600
v_exp_f32 v72, v72
v_exp_f32 v73, v73
v_exp_f32 v74, v74
v_exp_f32 v75, v75
v_mfma_f32_32x32x16_bf16 v[32:47], v[136:139], v[24:27], v[32:47]
ds_read_b128 v[120:123], v2 offset:22528
v_cvt_pk_bf16_f32 v24, v64, v65
v_cvt_pk_bf16_f32 v25, v66, v67
v_cvt_pk_bf16_f32 v26, v72, v73
v_cvt_pk_bf16_f32 v27, v74, v75
v_exp_f32 v68, v68
v_exp_f32 v69, v69
v_exp_f32 v70, v70
v_exp_f32 v71, v71
v_mfma_f32_32x32x16_bf16 v[32:47], v[140:143], v[28:31], v[32:47]
ds_read_b128 v[124:127], v2 offset:23552
v_exp_f32 v76, v76
v_exp_f32 v77, v77
v_exp_f32 v78, v78
v_exp_f32 v79, v79
v_cvt_pk_bf16_f32 v28, v68, v69
v_cvt_pk_bf16_f32 v29, v70, v71
v_cvt_pk_bf16_f32 v30, v76, v77
v_cvt_pk_bf16_f32 v31, v78, v79
s_waitcnt lgkmcnt(2)
v_mfma_f32_32x32x16_bf16 v[64:79], v[96:99], v[16:19], v[48:63]
ds_read_b128 v[104:107], v2 offset:28672
v_exp_f32 v80, v80
v_exp_f32 v81, v81
v_exp_f32 v82, v82
v_exp_f32 v83, v83
v_mfma_f32_32x32x16_bf16 v[64:79], v[100:103], v[20:23], v[64:79]
ds_read_b128 v[108:111], v2 offset:29696
v_exp_f32 v88, v88
v_exp_f32 v89, v89
v_exp_f32 v90, v90
v_exp_f32 v91, v91
s_cmp_lg_u32 s56, 0
s_cbranch_scc1 LA_ren2L
LA_ren2retL:
v_mfma_f32_32x32x16_bf16 v[32:47], v[112:115], v[24:27], v[32:47]
ds_read_b128 v[128:131], v2 offset:26624
v_cvt_pk_bf16_f32 v24, v80, v81
v_cvt_pk_bf16_f32 v25, v82, v83
v_cvt_pk_bf16_f32 v26, v88, v89
v_cvt_pk_bf16_f32 v27, v90, v91
v_exp_f32 v84, v84
v_exp_f32 v85, v85
v_exp_f32 v86, v86
v_exp_f32 v87, v87
v_mfma_f32_32x32x16_bf16 v[32:47], v[116:119], v[28:31], v[32:47]
ds_read_b128 v[132:135], v2 offset:27648
v_exp_f32 v92, v92
v_exp_f32 v93, v93
v_exp_f32 v94, v94
v_exp_f32 v95, v95
v_cvt_pk_bf16_f32 v28, v84, v85
v_cvt_pk_bf16_f32 v29, v86, v87
v_cvt_pk_bf16_f32 v30, v92, v93
v_cvt_pk_bf16_f32 v31, v94, v95
s_waitcnt lgkmcnt(2)
v_mfma_f32_32x32x16_bf16 v[80:95], v[104:107], v[16:19], v[48:63]
v_exp_f32 v64, v64
v_exp_f32 v65, v65
v_exp_f32 v66, v66
v_exp_f32 v67, v67
v_mfma_f32_32x32x16_bf16 v[80:95], v[108:111], v[20:23], v[80:95]
v_exp_f32 v72, v72
v_exp_f32 v73, v73
v_exp_f32 v74, v74
v_exp_f32 v75, v75
v_mfma_f32_32x32x16_bf16 v[32:47], v[120:123], v[24:27], v[32:47]
ds_read_b128 v[136:139], v2 offset:30720
v_cvt_pk_bf16_f32 v24, v64, v65
v_cvt_pk_bf16_f32 v25, v66, v67
v_cvt_pk_bf16_f32 v26, v72, v73
v_cvt_pk_bf16_f32 v27, v74, v75
v_exp_f32 v68, v68
v_exp_f32 v69, v69
v_exp_f32 v70, v70
v_exp_f32 v71, v71
v_mfma_f32_32x32x16_bf16 v[32:47], v[124:127], v[28:31], v[32:47]
ds_read_b128 v[140:143], v2 offset:31744
v_exp_f32 v76, v76
v_exp_f32 v77, v77
v_exp_f32 v78, v78
v_exp_f32 v79, v79
v_cvt_pk_bf16_f32 v28, v68, v69
v_cvt_pk_bf16_f32 v29, v70, v71
v_cvt_pk_bf16_f32 v30, v76, v77
v_cvt_pk_bf16_f32 v31, v78, v79
s_waitcnt lgkmcnt(0)
v_exp_f32 v80, v80
v_exp_f32 v81, v81
v_exp_f32 v82, v82
v_exp_f32 v83, v83
v_exp_f32 v88, v88
v_exp_f32 v89, v89
v_exp_f32 v90, v90
v_exp_f32 v91, v91
v_mfma_f32_32x32x16_bf16 v[32:47], v[128:131], v[24:27], v[32:47]
v_cvt_pk_bf16_f32 v24, v80, v81
v_cvt_pk_bf16_f32 v25, v82, v83
v_cvt_pk_bf16_f32 v26, v88, v89
v_cvt_pk_bf16_f32 v27, v90, v91
v_exp_f32 v84, v84
v_exp_f32 v85, v85
v_exp_f32 v86, v86
v_exp_f32 v87, v87
v_mfma_f32_32x32x16_bf16 v[32:47], v[132:135], v[28:31], v[32:47]
v_exp_f32 v92, v92
v_exp_f32 v93, v93
v_exp_f32 v94, v94
v_exp_f32 v95, v95
v_cvt_pk_bf16_f32 v28, v84, v85
v_cvt_pk_bf16_f32 v29, v86, v87
v_cvt_pk_bf16_f32 v30, v92, v93
v_cvt_pk_bf16_f32 v31, v94, v95
LA_done:
s_nop 1
v_mfma_f32_32x32x16_bf16 v[32:47], v[136:139], v[24:27], v[32:47]
v_mfma_f32_32x32x16_bf16 v[32:47], v[140:143], v[28:31], v[32:47]
s_nop 11
v_mov_b32 v7, v44
v_mov_b32 v6, v44
s_nop 1
v_permlane32_swap_b32 v7, v6
v_mul_f32 v8, 0, v32
v_fmac_f32 v8, 0, v33
v_fmac_f32 v8, 0, v34
v_fmac_f32 v8, 0, v35
v_fmac_f32 v8, 0, v36
v_fmac_f32 v8, 0, v37
v_fmac_f32 v8, 0, v38
v_fmac_f32 v8, 0, v39
v_fmac_f32 v8, 0, v40
v_fmac_f32 v8, 0, v41
v_fmac_f32 v8, 0, v42
v_fmac_f32 v8, 0, v43
v_fmac_f32 v8, 0, v44
v_fmac_f32 v8, 0, v45
v_fmac_f32 v8, 0, v46
v_fmac_f32 v8, 0, v47
v_cmp_u_f32 vcc, v8, v8
s_cbranch_vccnz LA_slow
LA_fin:
v_rcp_f32 v6, v6
v_cmp_gt_u32 vcc, 32, v15
v_mul_f32 v32, v32, v6
v_mul_f32 v33, v33, v6
v_mul_f32 v34, v34, v6
v_mul_f32 v35, v35, v6
v_mul_f32 v36, v36, v6
v_mul_f32 v37, v37, v6
v_mul_f32 v38, v38, v6
v_mul_f32 v39, v39, v6
v_mul_f32 v40, v40, v6
v_mul_f32 v41, v41, v6
v_mul_f32 v42, v42, v6
v_mul_f32 v43, v43, v6
v_cndmask_b32 v7, 0, v6, vcc
v_mul_f32 v44, v44, v7
v_mul_f32 v45, v45, v7
v_mul_f32 v46, v46, v7
v_mul_f32 v47, v47, v7
v_cvt_pk_bf16_f32 v24, v32, v33
v_cvt_pk_bf16_f32 v25, v34, v35
v_cvt_pk_bf16_f32 v26, v40, v41
v_cvt_pk_bf16_f32 v27, v42, v43
v_cvt_pk_bf16_f32 v28, v36, v37
v_cvt_pk_bf16_f32 v29, v38, v39
v_cvt_pk_bf16_f32 v30, v44, v45
v_cvt_pk_bf16_f32 v31, v46, v47
v_and_b32 v9, 15, v15
v_lshrrev_b32 v10, 5, v15
v_lshl_add_u32 v9, v10, 4, v9
v_lshlrev_b32 v9, 4, v9
v_bfe_u32 v10, v15, 4, 1
v_lshl_add_u32 v9, v10, 14, v9
s_lshl_b32 s26, s50, 2
s_add_u32 s26, s26, s48
s_lshl_b32 s26, s26, 15
s_lshl_b32 s27, s49, 10
s_add_u32 s26, s26, s27
s_add_u32 s26, s26, 73400320
buffer_store_dwordx4 v[24:27], v9, s[20:23], s26 offen offset:0 sc0 sc1
buffer_store_dwordx4 v[28:31], v9, s[20:23], s26 offen offset:512 sc0 sc1
s_lshl_b32 s58, s50, 7
s_lshl_b32 s27, s49, 2
s_add_u32 s58, s58, s27
s_add_u32 s58, s58, 109101056
s_branch LP_start
LA_ren1L:
v_mov_b32 v7, v44
v_mov_b32 v6, v44
s_nop 1
v_permlane32_swap_b32 v7, v6
v_frexp_exp_i32_f32 v6, v6
v_max_i32 v6, 0, v6
v_sub_u32 v7, 0, v6
v_ldexp_f32 v4, 1.0, v7
v_cvt_f32_i32 v6, v6
v_sub_f32 v48, v48, v6
v_sub_f32 v49, v49, v6
v_sub_f32 v50, v50, v6
v_sub_f32 v51, v51, v6
v_sub_f32 v52, v52, v6
v_sub_f32 v53, v53, v6
v_sub_f32 v54, v54, v6
v_sub_f32 v55, v55, v6
v_sub_f32 v56, v56, v6
v_sub_f32 v57, v57, v6
v_sub_f32 v58, v58, v6
v_sub_f32 v59, v59, v6
v_sub_f32 v60, v60, v6
v_sub_f32 v61, v61, v6
v_sub_f32 v62, v62, v6
v_sub_f32 v63, v63, v6
s_mov_b32 s56, 1
s_branch LA_ren1retL
LA_ren2L:
v_mul_f32 v32, v32, v4
v_mul_f32 v33, v33, v4
v_mul_f32 v34, v34, v4
v_mul_f32 v35, v35, v4
v_mul_f32 v36, v36, v4
v_mul_f32 v37, v37, v4
v_mul_f32 v38, v38, v4
v_mul_f32 v39, v39, v4
v_mul_f32 v40, v40, v4
v_mul_f32 v41, v41, v4
v_mul_f32 v42, v42, v4
v_mul_f32 v43, v43, v4
v_mul_f32 v44, v44, v4
v_mul_f32 v45, v45, v4
v_mul_f32 v46, v46, v4
v_mul_f32 v47, v47, v4
s_mov_b32 s56, 0
s_nop 0
s_branch LA_ren2retL
LA_ren1E:
v_mov_b32 v7, v44
v_mov_b32 v6, v44
s_nop 1
v_permlane32_swap_b32 v7, v6
v_frexp_exp_i32_f32 v6, v6
v_max_i32 v6, 0, v6
v_sub_u32 v7, 0, v6
v_ldexp_f32 v4, 1.0, v7
v_cvt_f32_i32 v6, v6
v_sub_f32 v48, v48, v6
v_sub_f32 v49, v49, v6
v_sub_f32 v50, v50, v6
v_sub_f32 v51, v51, v6
v_sub_f32 v52, v52, v6
v_sub_f32 v53, v53, v6
v_sub_f32 v54, v54, v6
v_sub_f32 v55, v55, v6
v_sub_f32 v56, v56, v6
v_sub_f32 v57, v57, v6
v_sub_f32 v58, v58, v6
v_sub_f32 v59, v59, v6
v_sub_f32 v60, v60, v6
v_sub_f32 v61, v61, v6
v_sub_f32 v62, v62, v6
v_sub_f32 v63, v63, v6
s_mov_b32 s56, 1
s_branch LA_ren1retE
LA_ren2E:
v_mul_f32 v32, v32, v4
v_mul_f32 v33, v33, v4
v_mul_f32 v34, v34, v4
v_mul_f32 v35, v35, v4
v_mul_f32 v36, v36, v4
v_mul_f32 v37, v37, v4
v_mul_f32 v38, v38, v4
v_mul_f32 v39, v39, v4
v_mul_f32 v40, v40, v4
v_mul_f32 v41, v41, v4
v_mul_f32 v42, v42, v4
v_mul_f32 v43, v43, v4
v_mul_f32 v44, v44, v4
v_mul_f32 v45, v45, v4
v_mul_f32 v46, v46, v4
v_mul_f32 v47, v47, v4
s_mov_b32 s56, 0
s_nop 0
s_branch LA_ren2retE
LA_ren1F:
v_mov_b32 v7, v44
v_mov_b32 v6, v44
s_nop 1
v_permlane32_swap_b32 v7, v6
v_frexp_exp_i32_f32 v6, v6
v_max_i32 v6, 0, v6
v_sub_u32 v7, 0, v6
v_ldexp_f32 v4, 1.0, v7
v_cvt_f32_i32 v6, v6
v_sub_f32 v48, v48, v6
v_sub_f32 v49, v49, v6
v_sub_f32 v50, v50, v6
v_sub_f32 v51, v51, v6
v_sub_f32 v52, v52, v6
v_sub_f32 v53, v53, v6
v_sub_f32 v54, v54, v6
v_sub_f32 v55, v55, v6
v_sub_f32 v56, v56, v6
v_sub_f32 v57, v57, v6
v_sub_f32 v58, v58, v6
v_sub_f32 v59, v59, v6
v_sub_f32 v60, v60, v6
v_sub_f32 v61, v61, v6
v_sub_f32 v62, v62, v6
v_sub_f32 v63, v63, v6
s_mov_b32 s56, 1
s_branch LA_ren1retF
LA_ren2F:
v_mul_f32 v32, v32, v4
v_mul_f32 v33, v33, v4
v_mul_f32 v34, v34, v4
v_mul_f32 v35, v35, v4
v_mul_f32 v36, v36, v4
v_mul_f32 v37, v37, v4
v_mul_f32 v38, v38, v4
v_mul_f32 v39, v39, v4
v_mul_f32 v40, v40, v4
v_mul_f32 v41, v41, v4
v_mul_f32 v42, v42, v4
v_mul_f32 v43, v43, v4
v_mul_f32 v44, v44, v4
v_mul_f32 v45, v45, v4
v_mul_f32 v46, v46, v4
v_mul_f32 v47, v47, v4
s_mov_b32 s56, 0
s_nop 0
s_branch LA_ren2retF
LA_ren1G:
v_mov_b32 v7, v44
v_mov_b32 v6, v44
s_nop 1
v_permlane32_swap_b32 v7, v6
v_frexp_exp_i32_f32 v6, v6
v_max_i32 v6, 0, v6
v_sub_u32 v7, 0, v6
v_ldexp_f32 v4, 1.0, v7
v_cvt_f32_i32 v6, v6
v_sub_f32 v48, v48, v6
v_sub_f32 v49, v49, v6
v_sub_f32 v50, v50, v6
v_sub_f32 v51, v51, v6
v_sub_f32 v52, v52, v6
v_sub_f32 v53, v53, v6
v_sub_f32 v54, v54, v6
v_sub_f32 v55, v55, v6
v_sub_f32 v56, v56, v6
v_sub_f32 v57, v57, v6
v_sub_f32 v58, v58, v6
v_sub_f32 v59, v59, v6
v_sub_f32 v60, v60, v6
v_sub_f32 v61, v61, v6
v_sub_f32 v62, v62, v6
v_sub_f32 v63, v63, v6
s_mov_b32 s56, 1
s_branch LA_ren1retG
LA_ren2G:
v_mul_f32 v32, v32, v4
v_mul_f32 v33, v33, v4
v_mul_f32 v34, v34, v4
v_mul_f32 v35, v35, v4
v_mul_f32 v36, v36, v4
v_mul_f32 v37, v37, v4
v_mul_f32 v38, v38, v4
v_mul_f32 v39, v39, v4
v_mul_f32 v40, v40, v4
v_mul_f32 v41, v41, v4
v_mul_f32 v42, v42, v4
v_mul_f32 v43, v43, v4
v_mul_f32 v44, v44, v4
v_mul_f32 v45, v45, v4
v_mul_f32 v46, v46, v4
v_mul_f32 v47, v47, v4
s_mov_b32 s56, 0
s_nop 0
s_branch LA_ren2retG
LA_ren1H:
v_mov_b32 v7, v44
v_mov_b32 v6, v44
s_nop 1
v_permlane32_swap_b32 v7, v6
v_frexp_exp_i32_f32 v6, v6
v_max_i32 v6, 0, v6
v_sub_u32 v7, 0, v6
v_ldexp_f32 v4, 1.0, v7
v_cvt_f32_i32 v6, v6
v_sub_f32 v48, v48, v6
v_sub_f32 v49, v49, v6
v_sub_f32 v50, v50, v6
v_sub_f32 v51, v51, v6
v_sub_f32 v52, v52, v6
v_sub_f32 v53, v53, v6
v_sub_f32 v54, v54, v6
v_sub_f32 v55, v55, v6
v_sub_f32 v56, v56, v6
v_sub_f32 v57, v57, v6
v_sub_f32 v58, v58, v6
v_sub_f32 v59, v59, v6
v_sub_f32 v60, v60, v6
v_sub_f32 v61, v61, v6
v_sub_f32 v62, v62, v6
v_sub_f32 v63, v63, v6
s_mov_b32 s56, 1
s_branch LA_ren1retH
LA_ren2H:
v_mul_f32 v32, v32, v4
v_mul_f32 v33, v33, v4
v_mul_f32 v34, v34, v4
v_mul_f32 v35, v35, v4
v_mul_f32 v36, v36, v4
v_mul_f32 v37, v37, v4
v_mul_f32 v38, v38, v4
v_mul_f32 v39, v39, v4
v_mul_f32 v40, v40, v4
v_mul_f32 v41, v41, v4
v_mul_f32 v42, v42, v4
v_mul_f32 v43, v43, v4
v_mul_f32 v44, v44, v4
v_mul_f32 v45, v45, v4
v_mul_f32 v46, v46, v4
v_mul_f32 v47, v47, v4
s_mov_b32 s56, 0
s_nop 0
s_branch LA_ren2retH
LA_slow:
s_lshl_b32 s51, s49, 18
s_add_u32 s51, s51, 69206016
s_mov_b32 s54, 64
v_mov_b32 v32, 0
v_mov_b32 v33, 0
v_mov_b32 v34, 0
v_mov_b32 v35, 0
v_mov_b32 v36, 0
v_mov_b32 v37, 0
v_mov_b32 v38, 0
v_mov_b32 v39, 0
v_mov_b32 v40, 0
v_mov_b32 v41, 0
v_mov_b32 v42, 0
v_mov_b32 v43, 0
v_mov_b32 v44, 0
v_mov_b32 v45, 0
v_mov_b32 v46, 0
v_mov_b32 v47, 0
v_mov_b32 v4, 0xf149f2ca
LA_sloop:
buffer_load_dwordx4 v[96:99], v1, s[20:23], s51 offen offset:0 sc1
buffer_load_dwordx4 v[100:103], v1, s[20:23], s51 offen offset:1024 sc1
buffer_load_dwordx4 v[112:115], v1, s[20:23], s51 offen offset:2048 sc1
buffer_load_dwordx4 v[116:119], v1, s[20:23], s51 offen offset:3072 sc1
s_add_u32 s51, s51, 4096
s_waitcnt vmcnt(0)
v_mfma_f32_32x32x16_bf16 v[64:79], v[96:99], v[16:19], 0
v_mfma_f32_32x32x16_bf16 v[64:79], v[100:103], v[20:23], v[64:79]
s_nop 11
v_max3_f32 v6, v64, v65, v66
v_max3_f32 v6, v6, v67, v68
v_max3_f32 v6, v6, v69, v70
v_max3_f32 v6, v6, v71, v72
v_max3_f32 v6, v6, v73, v74
v_max3_f32 v6, v6, v75, v76
v_max3_f32 v6, v6, v77, v78
v_max_f32 v6, v6, v79
v_mov_b32 v7, v6
s_nop 1
v_permlane32_swap_b32 v6, v7
v_max_f32 v6, v6, v7
v_max_f32 v6, v6, v4
v_sub_f32 v7, v4, v6
v_exp_f32 v7, v7
v_mov_b32 v4, v6
v_sub_f32 v64, v64, v6
v_sub_f32 v65, v65, v6
v_sub_f32 v66, v66, v6
v_sub_f32 v67, v67, v6
v_sub_f32 v68, v68, v6
v_sub_f32 v69, v69, v6
v_sub_f32 v70, v70, v6
v_sub_f32 v71, v71, v6
v_sub_f32 v72, v72, v6
v_sub_f32 v73, v73, v6
v_sub_f32 v74, v74, v6
v_sub_f32 v75, v75, v6
v_sub_f32 v76, v76, v6
v_sub_f32 v77, v77, v6
v_sub_f32 v78, v78, v6
v_sub_f32 v79, v79, v6
v_mul_f32 v32, v32, v7
v_mul_f32 v33, v33, v7
v_mul_f32 v34, v34, v7
v_mul_f32 v35, v35, v7
v_mul_f32 v36, v36, v7
v_mul_f32 v37, v37, v7
v_mul_f32 v38, v38, v7
v_mul_f32 v39, v39, v7
v_mul_f32 v40, v40, v7
v_mul_f32 v41, v41, v7
v_mul_f32 v42, v42, v7
v_mul_f32 v43, v43, v7
v_mul_f32 v44, v44, v7
v_mul_f32 v45, v45, v7
v_mul_f32 v46, v46, v7
v_mul_f32 v47, v47, v7
v_exp_f32 v64, v64
v_exp_f32 v65, v65
v_exp_f32 v66, v66
v_exp_f32 v67, v67
v_exp_f32 v68, v68
v_exp_f32 v69, v69
v_exp_f32 v70, v70
v_exp_f32 v71, v71
v_exp_f32 v72, v72
v_exp_f32 v73, v73
v_exp_f32 v74, v74
v_exp_f32 v75, v75
v_exp_f32 v76, v76
v_exp_f32 v77, v77
v_exp_f32 v78, v78
v_exp_f32 v79, v79
s_nop 0
v_cvt_pk_bf16_f32 v24, v64, v65
v_cvt_pk_bf16_f32 v25, v66, v67
v_cvt_pk_bf16_f32 v26, v72, v73
v_cvt_pk_bf16_f32 v27, v74, v75
v_cvt_pk_bf16_f32 v28, v68, v69
v_cvt_pk_bf16_f32 v29, v70, v71
v_cvt_pk_bf16_f32 v30, v76, v77
v_cvt_pk_bf16_f32 v31, v78, v79
s_nop 1
v_mfma_f32_32x32x16_bf16 v[32:47], v[112:115], v[24:27], v[32:47]
v_mfma_f32_32x32x16_bf16 v[32:47], v[116:119], v[28:31], v[32:47]
s_sub_u32 s54, s54, 1
s_cmp_lg_u32 s54, 0
s_nop 9
s_cbranch_scc1 LA_sloop
v_mov_b32 v7, v44
v_mov_b32 v6, v44
s_nop 1
v_permlane32_swap_b32 v7, v6
s_branch LA_fin
LP_start:
s_cmp_eq_u32 s60, 1
s_cbranch_scc1 LP_go
buffer_load_dword v13, v14, s[20:23], s62 offen sc0 sc1
buffer_load_dwordx4 v[148:151], v152, s[20:23], s65 offen sc0 sc1
s_waitcnt vmcnt(0)
s_mov_b32 s26, 0
LT_chkP:
v_xor_b32 v148, s89, v148
v_xor_b32 v149, s89, v149
v_xor_b32 v150, s89, v150
v_xor_b32 v151, s89, v151
v_xor_b32 v13, s89, v13
v_or3_b32 v13, v13, v148, v149
v_or3_b32 v13, v13, v150, v151
v_cmp_ne_u32 vcc, 0, v13
s_cbranch_vccz LT_okP
s_cmp_gt_u32 s26, 200000
s_cbranch_scc1 LT_okP
s_sleep 1
buffer_load_dword v13, v14, s[20:23], s62 offen sc0 sc1
buffer_load_dwordx4 v[148:151], v152, s[20:23], s65 offen sc0 sc1
s_add_u32 s26, s26, 1
s_waitcnt vmcnt(0)
s_branch LT_chkP
LT_okP:
s_add_u32 m0, s35, 131072
s_nop 0
buffer_load_dwordx4 v1, s[20:23], s34 offen offset:0 sc1 lds
buffer_load_dwordx4 v1, s[20:23], s34 offen offset:1024 sc1 lds
buffer_load_dwordx4 v1, s[20:23], s34 offen offset:2048 sc1 lds
buffer_load_dwordx4 v1, s[20:23], s34 offen offset:3072 sc1 lds
s_add_u32 s34, s34, 4096
s_add_u32 m0, s35, 135168
s_nop 0
buffer_load_dwordx4 v1, s[20:23], s34 offen offset:0 sc1 lds
buffer_load_dwordx4 v1, s[20:23], s34 offen offset:1024 sc1 lds
buffer_load_dwordx4 v1, s[20:23], s34 offen offset:2048 sc1 lds
s_add_u32 s34, s34, 110592
buffer_load_dwordx4 a[0:3], v1, s[20:23], s32 offen offset:0 sc1
buffer_load_dwordx4 a[4:7], v1, s[20:23], s33 offen offset:0 sc1
buffer_load_dwordx4 a[8:11], v1, s[20:23], s32 offen offset:1024 sc1
buffer_load_dwordx4 a[12:15], v1, s[20:23], s33 offen offset:1024 sc1
buffer_load_dwordx4 a[16:19], v1, s[20:23], s32 offen offset:2048 sc1
buffer_load_dwordx4 a[20:23], v1, s[20:23], s33 offen offset:2048 sc1
buffer_load_dwordx4 a[24:27], v1, s[20:23], s32 offen offset:3072 sc1
s_add_u32 s32, s32, 4096
buffer_load_dwordx4 a[28:31], v1, s[20:23], s33 offen offset:3072 sc1
s_add_u32 s33, s33, 4096
s_add_u32 m0, s35, 0
s_nop 0
buffer_load_dwordx4 v1, s[20:23], s34 offen offset:0 sc1 lds
buffer_load_dwordx4 v1, s[20:23], s34 offen offset:1024 sc1 lds
buffer_load_dwordx4 v1, s[20:23], s34 offen offset:2048 sc1 lds
buffer_load_dwordx4 v1, s[20:23], s34 offen offset:3072 sc1 lds
s_add_u32 s34, s34, 4096
s_add_u32 m0, s35, 4096
s_nop 0
buffer_load_dwordx4 v1, s[20:23], s34 offen offset:0 sc1 lds
buffer_load_dwordx4 v1, s[20:23], s34 offen offset:1024 sc1 lds
buffer_load_dwordx4 v1, s[20:23], s34 offen offset:2048 sc1 lds
s_add_u32 s34, s34, 110592
buffer_load_dwordx4 a[32:35], v1, s[20:23], s32 offen offset:0 sc1
buffer_load_dwordx4 a[36:39], v1, s[20:23], s33 offen offset:0 sc1
buffer_load_dwordx4 a[40:43], v1, s[20:23], s32 offen offset:1024 sc1
buffer_load_dwordx4 a[44:47], v1, s[20:23], s33 offen offset:1024 sc1
buffer_load_dwordx4 a[48:51], v1, s[20:23], s32 offen offset:2048 sc1
buffer_load_dwordx4 a[52:55], v1, s[20:23], s33 offen offset:2048 sc1
buffer_load_dwordx4 a[56:59], v1, s[20:23], s32 offen offset:3072 sc1
s_add_u32 s32, s32, 4096
buffer_load_dwordx4 a[60:63], v1, s[20:23], s33 offen offset:3072 sc1
s_add_u32 s33, s33, 4096
s_add_u32 m0, s35, 32768
s_nop 0
buffer_load_dwordx4 v1, s[20:23], s34 offen offset:0 sc1 lds
buffer_load_dwordx4 v1, s[20:23], s34 offen offset:1024 sc1 lds
buffer_load_dwordx4 v1, s[20:23], s34 offen offset:2048 sc1 lds
buffer_load_dwordx4 v1, s[20:23], s34 offen offset:3072 sc1 lds
s_add_u32 s34, s34, 4096
s_add_u32 m0, s35, 36864
s_nop 0
buffer_load_dwordx4 v1, s[20:23], s34 offen offset:0 sc1 lds
buffer_load_dwordx4 v1, s[20:23], s34 offen offset:1024 sc1 lds
buffer_load_dwordx4 v1, s[20:23], s34 offen offset:2048 sc1 lds
s_add_u32 s34, s34, 110592
buffer_load_dwordx4 a[64:67], v1, s[20:23], s32 offen offset:0 sc1
buffer_load_dwordx4 a[68:71], v1, s[20:23], s33 offen offset:0 sc1
buffer_load_dwordx4 a[72:75], v1, s[20:23], s32 offen offset:1024 sc1
buffer_load_dwordx4 a[76:79], v1, s[20:23], s33 offen offset:1024 sc1
buffer_load_dwordx4 a[80:83], v1, s[20:23], s32 offen offset:2048 sc1
buffer_load_dwordx4 a[84:87], v1, s[20:23], s33 offen offset:2048 sc1
buffer_load_dwordx4 a[88:91], v1, s[20:23], s32 offen offset:3072 sc1
s_add_u32 s32, s32, 4096
buffer_load_dwordx4 a[92:95], v1, s[20:23], s33 offen offset:3072 sc1
s_add_u32 s33, s33, 4096
buffer_load_dwordx4 v[148:151], v152, s[20:23], s65 offen sc0 sc1
buffer_load_dwordx4 v[148:151], v152, s[20:23], s65 offen sc0 sc1
LP_go:
s_waitcnt vmcnt(40)
s_barrier
ds_read_b128 v[16:19], v146 offset:0
ds_read_b128 v[20:23], v146 offset:1024
ds_read_b128 v[24:27], v146 offset:2048
ds_read_b128 v[28:31], v146 offset:3072
ds_read_b128 v[32:35], v146 offset:4096
ds_read_b128 v[36:39], v146 offset:5120
ds_read_b128 v[40:43], v146 offset:6144
s_add_u32 m0, s35, 65536
s_nop 0
buffer_load_dwordx4 v1, s[20:23], s34 offen offset:0 sc1 lds
buffer_load_dwordx4 v1, s[20:23], s34 offen offset:1024 sc1 lds
buffer_load_dwordx4 v1, s[20:23], s34 offen offset:2048 sc1 lds
buffer_load_dwordx4 v1, s[20:23], s34 offen offset:3072 sc1 lds
s_add_u32 s34, s34, 4096
s_add_u32 m0, s35, 69632
s_nop 0
buffer_load_dwordx4 v1, s[20:23], s34 offen offset:0 sc1 lds
buffer_load_dwordx4 v1, s[20:23], s34 offen offset:1024 sc1 lds
buffer_load_dwordx4 v1, s[20:23], s34 offen offset:2048 sc1 lds
s_add_u32 s34, s34, 110592
s_add_u32 m0, s35, 98304
s_nop 0
buffer_load_dwordx4 v1, s[20:23], s34 offen offset:0 sc1 lds
buffer_load_dwordx4 v1, s[20:23], s34 offen offset:1024 sc1 lds
buffer_load_dwordx4 v1, s[20:23], s34 offen offset:2048 sc1 lds
buffer_load_dwordx4 v1, s[20:23], s34 offen offset:3072 sc1 lds
s_add_u32 s34, s34, 4096
s_add_u32 m0, s35, 102400
s_nop 0
buffer_load_dwordx4 v1, s[20:23], s34 offen offset:0 sc1 lds
buffer_load_dwordx4 v1, s[20:23], s34 offen offset:1024 sc1 lds
buffer_load_dwordx4 v1, s[20:23], s34 offen offset:2048 sc1 lds
s_add_u32 s34, s34, 110592
v_and_b32 v14, 15, v15
v_lshlrev_b32 v14, 2, v14
s_waitcnt vmcnt(52) lgkmcnt(0)
v_mfma_f32_16x16x32_bf16 v[160:163], v[16:19], a[0:3], 0
ds_read_b128 v[44:47], v146 offset:7168
v_mfma_f32_16x16x32_bf16 v[164:167], v[16:19], a[4:7], 0
ds_read_b128 v[48:51], v146 offset:8192
v_mfma_f32_16x16x32_bf16 v[168:171], v[20:23], a[0:3], 0
ds_read_b128 v[52:55], v146 offset:9216
v_mfma_f32_16x16x32_bf16 v[172:175], v[20:23], a[4:7], 0
ds_read_b128 v[56:59], v146 offset:10240
v_mfma_f32_16x16x32_bf16 v[176:179], v[24:27], a[0:3], 0
ds_read_b128 v[60:63], v146 offset:11264
v_mfma_f32_16x16x32_bf16 v[180:183], v[24:27], a[4:7], 0
ds_read_b128 v[64:67], v146 offset:12288
v_mfma_f32_16x16x32_bf16 v[184:187], v[28:31], a[0:3], 0
ds_read_b128 v[68:71], v146 offset:13312
v_mfma_f32_16x16x32_bf16 v[188:191], v[28:31], a[4:7], 0
buffer_load_dwordx4 a[96:99], v1, s[20:23], s32 offen offset:0 sc1
v_mfma_f32_16x16x32_bf16 v[192:195], v[32:35], a[0:3], 0
buffer_load_dwordx4 a[100:103], v1, s[20:23], s33 offen offset:0 sc1
v_mfma_f32_16x16x32_bf16 v[196:199], v[32:35], a[4:7], 0
v_mfma_f32_16x16x32_bf16 v[200:203], v[36:39], a[0:3], 0
v_mfma_f32_16x16x32_bf16 v[204:207], v[36:39], a[4:7], 0
v_mfma_f32_16x16x32_bf16 v[208:211], v[40:43], a[0:3], 0
v_mfma_f32_16x16x32_bf16 v[212:215], v[40:43], a[4:7], 0
s_waitcnt vmcnt(52) lgkmcnt(0)
v_mfma_f32_16x16x32_bf16 v[160:163], v[44:47], a[8:11], v[160:163]
ds_read_b128 v[16:19], v146 offset:14336
v_mfma_f32_16x16x32_bf16 v[164:167], v[44:47], a[12:15], v[164:167]
ds_read_b128 v[20:23], v146 offset:15360
v_mfma_f32_16x16x32_bf16 v[168:171], v[48:51], a[8:11], v[168:171]
ds_read_b128 v[24:27], v146 offset:16384
v_mfma_f32_16x16x32_bf16 v[172:175], v[48:51], a[12:15], v[172:175]
ds_read_b128 v[28:31], v146 offset:17408
v_mfma_f32_16x16x32_bf16 v[176:179], v[52:55], a[8:11], v[176:179]
ds_read_b128 v[32:35], v146 offset:18432
v_mfma_f32_16x16x32_bf16 v[180:183], v[52:55], a[12:15], v[180:183]
ds_read_b128 v[36:39], v146 offset:19456
v_mfma_f32_16x16x32_bf16 v[184:187], v[56:59], a[8:11], v[184:187]
ds_read_b128 v[40:43], v146 offset:20480
v_mfma_f32_16x16x32_bf16 v[188:191], v[56:59], a[12:15], v[188:191]
buffer_load_dwordx4 a[104:107], v1, s[20:23], s32 offen offset:1024 sc1
v_mfma_f32_16x16x32_bf16 v[192:195], v[60:63], a[8:11], v[192:195]
buffer_load_dwordx4 a[108:111], v1, s[20:23], s33 offen offset:1024 sc1
v_mfma_f32_16x16x32_bf16 v[196:199], v[60:63], a[12:15], v[196:199]
v_mfma_f32_16x16x32_bf16 v[200:203], v[64:67], a[8:11], v[200:203]
v_mfma_f32_16x16x32_bf16 v[204:207], v[64:67], a[12:15], v[204:207]
v_mfma_f32_16x16x32_bf16 v[208:211], v[68:71], a[8:11], v[208:211]
v_mfma_f32_16x16x32_bf16 v[212:215], v[68:71], a[12:15], v[212:215]
s_waitcnt vmcnt(52) lgkmcnt(0)
v_mfma_f32_16x16x32_bf16 v[160:163], v[16:19], a[16:19], v[160:163]
ds_read_b128 v[44:47], v146 offset:21504
v_mfma_f32_16x16x32_bf16 v[164:167], v[16:19], a[20:23], v[164:167]
ds_read_b128 v[48:51], v146 offset:22528
v_mfma_f32_16x16x32_bf16 v[168:171], v[20:23], a[16:19], v[168:171]
ds_read_b128 v[52:55], v146 offset:23552
v_mfma_f32_16x16x32_bf16 v[172:175], v[20:23], a[20:23], v[172:175]
ds_read_b128 v[56:59], v146 offset:24576
v_mfma_f32_16x16x32_bf16 v[176:179], v[24:27], a[16:19], v[176:179]
ds_read_b128 v[60:63], v146 offset:25600
v_mfma_f32_16x16x32_bf16 v[180:183], v[24:27], a[20:23], v[180:183]
ds_read_b128 v[64:67], v146 offset:26624
v_mfma_f32_16x16x32_bf16 v[184:187], v[28:31], a[16:19], v[184:187]
ds_read_b128 v[68:71], v146 offset:27648
v_mfma_f32_16x16x32_bf16 v[188:191], v[28:31], a[20:23], v[188:191]
buffer_load_dwordx4 a[112:115], v1, s[20:23], s32 offen offset:2048 sc1
v_mfma_f32_16x16x32_bf16 v[192:195], v[32:35], a[16:19], v[192:195]
buffer_load_dwordx4 a[116:119], v1, s[20:23], s33 offen offset:2048 sc1
v_mfma_f32_16x16x32_bf16 v[196:199], v[32:35], a[20:23], v[196:199]
v_mfma_f32_16x16x32_bf16 v[200:203], v[36:39], a[16:19], v[200:203]
v_mfma_f32_16x16x32_bf16 v[204:207], v[36:39], a[20:23], v[204:207]
v_mfma_f32_16x16x32_bf16 v[208:211], v[40:43], a[16:19], v[208:211]
v_mfma_f32_16x16x32_bf16 v[212:215], v[40:43], a[20:23], v[212:215]
s_waitcnt vmcnt(20) lgkmcnt(0)
s_barrier
s_cmp_lg_u32 s48, 0
s_cbranch_scc1 LT_npA
v_mov_b32 v10, s89
v_mov_b32 v11, 0
s_mov_b64 exec, 1
buffer_store_dword v10, v11, s[20:23], s58 offen sc0 sc1
s_mov_b64 exec, -1
LT_npA:
v_mfma_f32_16x16x32_bf16 v[160:163], v[44:47], a[24:27], v[160:163]
ds_read_b128 v[16:19], v144 offset:0
v_mfma_f32_16x16x32_bf16 v[164:167], v[44:47], a[28:31], v[164:167]
ds_read_b128 v[20:23], v144 offset:1024
v_mfma_f32_16x16x32_bf16 v[168:171], v[48:51], a[24:27], v[168:171]
ds_read_b128 v[24:27], v144 offset:2048
v_mfma_f32_16x16x32_bf16 v[172:175], v[48:51], a[28:31], v[172:175]
ds_read_b128 v[28:31], v144 offset:3072
v_mfma_f32_16x16x32_bf16 v[176:179], v[52:55], a[24:27], v[176:179]
ds_read_b128 v[32:35], v144 offset:4096
v_mfma_f32_16x16x32_bf16 v[180:183], v[52:55], a[28:31], v[180:183]
ds_read_b128 v[36:39], v144 offset:5120
v_mfma_f32_16x16x32_bf16 v[184:187], v[56:59], a[24:27], v[184:187]
ds_read_b128 v[40:43], v144 offset:6144
v_mfma_f32_16x16x32_bf16 v[188:191], v[56:59], a[28:31], v[188:191]
buffer_load_dwordx4 a[120:123], v1, s[20:23], s32 offen offset:3072 sc1
v_mfma_f32_16x16x32_bf16 v[192:195], v[60:63], a[24:27], v[192:195]
s_add_u32 s32, s32, 4096
buffer_load_dwordx4 a[124:127], v1, s[20:23], s33 offen offset:3072 sc1
v_mfma_f32_16x16x32_bf16 v[196:199], v[60:63], a[28:31], v[196:199]
s_add_u32 s33, s33, 4096
v_mfma_f32_16x16x32_bf16 v[200:203], v[64:67], a[24:27], v[200:203]
v_mfma_f32_16x16x32_bf16 v[204:207], v[64:67], a[28:31], v[204:207]
v_mfma_f32_16x16x32_bf16 v[208:211], v[68:71], a[24:27], v[208:211]
v_mfma_f32_16x16x32_bf16 v[212:215], v[68:71], a[28:31], v[212:215]
s_waitcnt vmcnt(22) lgkmcnt(0)
v_mfma_f32_16x16x32_bf16 v[160:163], v[16:19], a[32:35], v[160:163]
ds_read_b128 v[44:47], v144 offset:7168
v_mfma_f32_16x16x32_bf16 v[164:167], v[16:19], a[36:39], v[164:167]
ds_read_b128 v[48:51], v144 offset:8192
v_mfma_f32_16x16x32_bf16 v[168:171], v[20:23], a[32:35], v[168:171]
ds_read_b128 v[52:55], v144 offset:9216
v_mfma_f32_16x16x32_bf16 v[172:175], v[20:23], a[36:39], v[172:175]
ds_read_b128 v[56:59], v144 offset:10240
v_mfma_f32_16x16x32_bf16 v[176:179], v[24:27], a[32:35], v[176:179]
ds_read_b128 v[60:63], v144 offset:11264
v_mfma_f32_16x16x32_bf16 v[180:183], v[24:27], a[36:39], v[180:183]
ds_read_b128 v[64:67], v144 offset:12288
v_mfma_f32_16x16x32_bf16 v[184:187], v[28:31], a[32:35], v[184:187]
ds_read_b128 v[68:71], v144 offset:13312
v_mfma_f32_16x16x32_bf16 v[188:191], v[28:31], a[36:39], v[188:191]
buffer_load_dwordx4 a[128:131], v1, s[20:23], s32 offen offset:0 sc1
v_mfma_f32_16x16x32_bf16 v[192:195], v[32:35], a[32:35], v[192:195]
buffer_load_dwordx4 a[132:135], v1, s[20:23], s33 offen offset:0 sc1
v_mfma_f32_16x16x32_bf16 v[196:199], v[32:35], a[36:39], v[196:199]
v_mfma_f32_16x16x32_bf16 v[200:203], v[36:39], a[32:35], v[200:203]
v_mfma_f32_16x16x32_bf16 v[204:207], v[36:39], a[36:39], v[204:207]
v_mfma_f32_16x16x32_bf16 v[208:211], v[40:43], a[32:35], v[208:211]
v_mfma_f32_16x16x32_bf16 v[212:215], v[40:43], a[36:39], v[212:215]
s_waitcnt vmcnt(24) lgkmcnt(0)
v_mfma_f32_16x16x32_bf16 v[160:163], v[44:47], a[40:43], v[160:163]
ds_read_b128 v[16:19], v144 offset:14336
v_mfma_f32_16x16x32_bf16 v[164:167], v[44:47], a[44:47], v[164:167]
ds_read_b128 v[20:23], v144 offset:15360
v_mfma_f32_16x16x32_bf16 v[168:171], v[48:51], a[40:43], v[168:171]
ds_read_b128 v[24:27], v144 offset:16384
v_mfma_f32_16x16x32_bf16 v[172:175], v[48:51], a[44:47], v[172:175]
ds_read_b128 v[28:31], v144 offset:17408
v_mfma_f32_16x16x32_bf16 v[176:179], v[52:55], a[40:43], v[176:179]
ds_read_b128 v[32:35], v144 offset:18432
v_mfma_f32_16x16x32_bf16 v[180:183], v[52:55], a[44:47], v[180:183]
ds_read_b128 v[36:39], v144 offset:19456
v_mfma_f32_16x16x32_bf16 v[184:187], v[56:59], a[40:43], v[184:187]
ds_read_b128 v[40:43], v144 offset:20480
v_mfma_f32_16x16x32_bf16 v[188:191], v[56:59], a[44:47], v[188:191]
buffer_load_dwordx4 a[136:139], v1, s[20:23], s32 offen offset:1024 sc1
v_mfma_f32_16x16x32_bf16 v[192:195], v[60:63], a[40:43], v[192:195]
buffer_load_dwordx4 a[140:143], v1, s[20:23], s33 offen offset:1024 sc1
v_mfma_f32_16x16x32_bf16 v[196:199], v[60:63], a[44:47], v[196:199]
v_mfma_f32_16x16x32_bf16 v[200:203], v[64:67], a[40:43], v[200:203]
v_mfma_f32_16x16x32_bf16 v[204:207], v[64:67], a[44:47], v[204:207]
v_mfma_f32_16x16x32_bf16 v[208:211], v[68:71], a[40:43], v[208:211]
v_mfma_f32_16x16x32_bf16 v[212:215], v[68:71], a[44:47], v[212:215]
s_waitcnt vmcnt(26) lgkmcnt(0)
v_mfma_f32_16x16x32_bf16 v[160:163], v[16:19], a[48:51], v[160:163]
ds_read_b128 v[44:47], v144 offset:21504
v_mfma_f32_16x16x32_bf16 v[164:167], v[16:19], a[52:55], v[164:167]
ds_read_b128 v[48:51], v144 offset:22528
v_mfma_f32_16x16x32_bf16 v[168:171], v[20:23], a[48:51], v[168:171]
ds_read_b128 v[52:55], v144 offset:23552
v_mfma_f32_16x16x32_bf16 v[172:175], v[20:23], a[52:55], v[172:175]
ds_read_b128 v[56:59], v144 offset:24576
v_mfma_f32_16x16x32_bf16 v[176:179], v[24:27], a[48:51], v[176:179]
ds_read_b128 v[60:63], v144 offset:25600
v_mfma_f32_16x16x32_bf16 v[180:183], v[24:27], a[52:55], v[180:183]
ds_read_b128 v[64:67], v144 offset:26624
v_mfma_f32_16x16x32_bf16 v[184:187], v[28:31], a[48:51], v[184:187]
ds_read_b128 v[68:71], v144 offset:27648
v_mfma_f32_16x16x32_bf16 v[188:191], v[28:31], a[52:55], v[188:191]
buffer_load_dwordx4 a[144:147], v1, s[20:23], s32 offen offset:2048 sc1
v_mfma_f32_16x16x32_bf16 v[192:195], v[32:35], a[48:51], v[192:195]
buffer_load_dwordx4 a[148:151], v1, s[20:23], s33 offen offset:2048 sc1
v_mfma_f32_16x16x32_bf16 v[196:199], v[32:35], a[52:55], v[196:199]
v_mfma_f32_16x16x32_bf16 v[200:203], v[36:39], a[48:51], v[200:203]
v_mfma_f32_16x16x32_bf16 v[204:207], v[36:39], a[52:55], v[204:207]
v_mfma_f32_16x16x32_bf16 v[208:211], v[40:43], a[48:51], v[208:211]
v_mfma_f32_16x16x32_bf16 v[212:215], v[40:43], a[52:55], v[212:215]
s_waitcnt vmcnt(28) lgkmcnt(0)
s_barrier
v_mfma_f32_16x16x32_bf16 v[160:163], v[44:47], a[56:59], v[160:163]
ds_read_b128 v[16:19], v144 offset:32768
v_mfma_f32_16x16x32_bf16 v[164:167], v[44:47], a[60:63], v[164:167]
ds_read_b128 v[20:23], v144 offset:33792
v_mfma_f32_16x16x32_bf16 v[168:171], v[48:51], a[56:59], v[168:171]
ds_read_b128 v[24:27], v144 offset:34816
v_mfma_f32_16x16x32_bf16 v[172:175], v[48:51], a[60:63], v[172:175]
ds_read_b128 v[28:31], v144 offset:35840
v_mfma_f32_16x16x32_bf16 v[176:179], v[52:55], a[56:59], v[176:179]
ds_read_b128 v[32:35], v144 offset:36864
v_mfma_f32_16x16x32_bf16 v[180:183], v[52:55], a[60:63], v[180:183]
ds_read_b128 v[36:39], v144 offset:37888
v_mfma_f32_16x16x32_bf16 v[184:187], v[56:59], a[56:59], v[184:187]
ds_read_b128 v[40:43], v144 offset:38912
v_mfma_f32_16x16x32_bf16 v[188:191], v[56:59], a[60:63], v[188:191]
buffer_load_dwordx4 a[152:155], v1, s[20:23], s32 offen offset:3072 sc1
v_mfma_f32_16x16x32_bf16 v[192:195], v[60:63], a[56:59], v[192:195]
s_add_u32 s32, s32, 4096
buffer_load_dwordx4 a[156:159], v1, s[20:23], s33 offen offset:3072 sc1
s_add_u32 m0, s35, 131072
v_mfma_f32_16x16x32_bf16 v[196:199], v[60:63], a[60:63], v[196:199]
s_add_u32 s33, s33, 4096
buffer_load_dwordx4 v1, s[20:23], s34 offen offset:0 sc1 lds
v_mfma_f32_16x16x32_bf16 v[200:203], v[64:67], a[56:59], v[200:203]
buffer_load_dwordx4 v1, s[20:23], s34 offen offset:1024 sc1 lds
v_mfma_f32_16x16x32_bf16 v[204:207], v[64:67], a[60:63], v[204:207]
buffer_load_dwordx4 v1, s[20:23], s34 offen offset:2048 sc1 lds
v_mfma_f32_16x16x32_bf16 v[208:211], v[68:71], a[56:59], v[208:211]
buffer_load_dwordx4 v1, s[20:23], s34 offen offset:3072 sc1 lds
v_mfma_f32_16x16x32_bf16 v[212:215], v[68:71], a[60:63], v[212:215]
s_add_u32 s34, s34, 4096
s_waitcnt vmcnt(34) lgkmcnt(0)
v_mfma_f32_16x16x32_bf16 v[160:163], v[16:19], a[64:67], v[160:163]
ds_read_b128 v[44:47], v144 offset:39936
v_mfma_f32_16x16x32_bf16 v[164:167], v[16:19], a[68:71], v[164:167]
ds_read_b128 v[48:51], v144 offset:40960
v_mfma_f32_16x16x32_bf16 v[168:171], v[20:23], a[64:67], v[168:171]
ds_read_b128 v[52:55], v144 offset:41984
v_mfma_f32_16x16x32_bf16 v[172:175], v[20:23], a[68:71], v[172:175]
ds_read_b128 v[56:59], v144 offset:43008
v_mfma_f32_16x16x32_bf16 v[176:179], v[24:27], a[64:67], v[176:179]
ds_read_b128 v[60:63], v144 offset:44032
v_mfma_f32_16x16x32_bf16 v[180:183], v[24:27], a[68:71], v[180:183]
ds_read_b128 v[64:67], v144 offset:45056
v_mfma_f32_16x16x32_bf16 v[184:187], v[28:31], a[64:67], v[184:187]
ds_read_b128 v[68:71], v144 offset:46080
v_mfma_f32_16x16x32_bf16 v[188:191], v[28:31], a[68:71], v[188:191]
buffer_load_dwordx4 a[160:163], v1, s[20:23], s32 offen offset:0 sc1
v_mfma_f32_16x16x32_bf16 v[192:195], v[32:35], a[64:67], v[192:195]
buffer_load_dwordx4 a[164:167], v1, s[20:23], s33 offen offset:0 sc1
s_add_u32 m0, s35, 135168
v_mfma_f32_16x16x32_bf16 v[196:199], v[32:35], a[68:71], v[196:199]
buffer_load_dwordx4 v1, s[20:23], s34 offen offset:0 sc1 lds
v_mfma_f32_16x16x32_bf16 v[200:203], v[36:39], a[64:67], v[200:203]
buffer_load_dwordx4 v1, s[20:23], s34 offen offset:1024 sc1 lds
v_mfma_f32_16x16x32_bf16 v[204:207], v[36:39], a[68:71], v[204:207]
buffer_load_dwordx4 v1, s[20:23], s34 offen offset:2048 sc1 lds
v_mfma_f32_16x16x32_bf16 v[208:211], v[40:43], a[64:67], v[208:211]
s_add_u32 s34, s34, 110592
v_mfma_f32_16x16x32_bf16 v[212:215], v[40:43], a[68:71], v[212:215]
s_waitcnt vmcnt(39) lgkmcnt(0)
v_mfma_f32_16x16x32_bf16 v[160:163], v[44:47], a[72:75], v[160:163]
ds_read_b128 v[16:19], v144 offset:47104
v_mfma_f32_16x16x32_bf16 v[164:167], v[44:47], a[76:79], v[164:167]
ds_read_b128 v[20:23], v144 offset:48128
v_mfma_f32_16x16x32_bf16 v[168:171], v[48:51], a[72:75], v[168:171]
ds_read_b128 v[24:27], v144 offset:49152
v_mfma_f32_16x16x32_bf16 v[172:175], v[48:51], a[76:79], v[172:175]
ds_read_b128 v[28:31], v144 offset:50176
v_mfma_f32_16x16x32_bf16 v[176:179], v[52:55], a[72:75], v[176:179]
ds_read_b128 v[32:35], v144 offset:51200
v_mfma_f32_16x16x32_bf16 v[180:183], v[52:55], a[76:79], v[180:183]
ds_read_b128 v[36:39], v144 offset:52224
v_mfma_f32_16x16x32_bf16 v[184:187], v[56:59], a[72:75], v[184:187]
ds_read_b128 v[40:43], v144 offset:53248
v_mfma_f32_16x16x32_bf16 v[188:191], v[56:59], a[76:79], v[188:191]
buffer_load_dwordx4 a[168:171], v1, s[20:23], s32 offen offset:1024 sc1
v_mfma_f32_16x16x32_bf16 v[192:195], v[60:63], a[72:75], v[192:195]
buffer_load_dwordx4 a[172:175], v1, s[20:23], s33 offen offset:1024 sc1
v_mfma_f32_16x16x32_bf16 v[196:199], v[60:63], a[76:79], v[196:199]
v_mfma_f32_16x16x32_bf16 v[200:203], v[64:67], a[72:75], v[200:203]
v_mfma_f32_16x16x32_bf16 v[204:207], v[64:67], a[76:79], v[204:207]
v_mfma_f32_16x16x32_bf16 v[208:211], v[68:71], a[72:75], v[208:211]
v_mfma_f32_16x16x32_bf16 v[212:215], v[68:71], a[76:79], v[212:215]
s_waitcnt vmcnt(41) lgkmcnt(0)
v_mfma_f32_16x16x32_bf16 v[160:163], v[16:19], a[80:83], v[160:163]
ds_read_b128 v[44:47], v144 offset:54272
v_mfma_f32_16x16x32_bf16 v[164:167], v[16:19], a[84:87], v[164:167]
ds_read_b128 v[48:51], v144 offset:55296
v_mfma_f32_16x16x32_bf16 v[168:171], v[20:23], a[80:83], v[168:171]
ds_read_b128 v[52:55], v144 offset:56320
v_mfma_f32_16x16x32_bf16 v[172:175], v[20:23], a[84:87], v[172:175]
ds_read_b128 v[56:59], v144 offset:57344
v_mfma_f32_16x16x32_bf16 v[176:179], v[24:27], a[80:83], v[176:179]
ds_read_b128 v[60:63], v144 offset:58368
v_mfma_f32_16x16x32_bf16 v[180:183], v[24:27], a[84:87], v[180:183]
ds_read_b128 v[64:67], v144 offset:59392
v_mfma_f32_16x16x32_bf16 v[184:187], v[28:31], a[80:83], v[184:187]
ds_read_b128 v[68:71], v144 offset:60416
v_mfma_f32_16x16x32_bf16 v[188:191], v[28:31], a[84:87], v[188:191]
buffer_load_dwordx4 a[176:179], v1, s[20:23], s32 offen offset:2048 sc1
v_mfma_f32_16x16x32_bf16 v[192:195], v[32:35], a[80:83], v[192:195]
buffer_load_dwordx4 a[180:183], v1, s[20:23], s33 offen offset:2048 sc1
v_mfma_f32_16x16x32_bf16 v[196:199], v[32:35], a[84:87], v[196:199]
v_mfma_f32_16x16x32_bf16 v[200:203], v[36:39], a[80:83], v[200:203]
v_mfma_f32_16x16x32_bf16 v[204:207], v[36:39], a[84:87], v[204:207]
v_mfma_f32_16x16x32_bf16 v[208:211], v[40:43], a[80:83], v[208:211]
v_mfma_f32_16x16x32_bf16 v[212:215], v[40:43], a[84:87], v[212:215]
s_waitcnt vmcnt(36) lgkmcnt(0)
s_barrier
v_mfma_f32_16x16x32_bf16 v[160:163], v[44:47], a[88:91], v[160:163]
ds_read_b128 v[16:19], v145 offset:0
v_mfma_f32_16x16x32_bf16 v[164:167], v[44:47], a[92:95], v[164:167]
ds_read_b128 v[20:23], v145 offset:1024
v_mfma_f32_16x16x32_bf16 v[168:171], v[48:51], a[88:91], v[168:171]
ds_read_b128 v[24:27], v145 offset:2048
v_mfma_f32_16x16x32_bf16 v[172:175], v[48:51], a[92:95], v[172:175]
ds_read_b128 v[28:31], v145 offset:3072
v_mfma_f32_16x16x32_bf16 v[176:179], v[52:55], a[88:91], v[176:179]
ds_read_b128 v[32:35], v145 offset:4096
v_mfma_f32_16x16x32_bf16 v[180:183], v[52:55], a[92:95], v[180:183]
ds_read_b128 v[36:39], v145 offset:5120
v_mfma_f32_16x16x32_bf16 v[184:187], v[56:59], a[88:91], v[184:187]
ds_read_b128 v[40:43], v145 offset:6144
v_mfma_f32_16x16x32_bf16 v[188:191], v[56:59], a[92:95], v[188:191]
buffer_load_dwordx4 a[184:187], v1, s[20:23], s32 offen offset:3072 sc1
v_mfma_f32_16x16x32_bf16 v[192:195], v[60:63], a[88:91], v[192:195]
s_add_u32 s32, s32, 4096
buffer_load_dwordx4 a[188:191], v1, s[20:23], s33 offen offset:3072 sc1
s_add_u32 m0, s35, 0
v_mfma_f32_16x16x32_bf16 v[196:199], v[60:63], a[92:95], v[196:199]
s_add_u32 s33, s33, 4096
buffer_load_dwordx4 v1, s[20:23], s34 offen offset:0 sc1 lds
v_mfma_f32_16x16x32_bf16 v[200:203], v[64:67], a[88:91], v[200:203]
buffer_load_dwordx4 v1, s[20:23], s34 offen offset:1024 sc1 lds
v_mfma_f32_16x16x32_bf16 v[204:207], v[64:67], a[92:95], v[204:207]
buffer_load_dwordx4 v1, s[20:23], s34 offen offset:2048 sc1 lds
v_mfma_f32_16x16x32_bf16 v[208:211], v[68:71], a[88:91], v[208:211]
buffer_load_dwordx4 v1, s[20:23], s34 offen offset:3072 sc1 lds
v_mfma_f32_16x16x32_bf16 v[212:215], v[68:71], a[92:95], v[212:215]
s_add_u32 s34, s34, 4096
s_waitcnt vmcnt(33) lgkmcnt(0)
v_mfma_f32_16x16x32_bf16 v[160:163], v[16:19], a[96:99], v[160:163]
ds_read_b128 v[44:47], v145 offset:7168
v_mfma_f32_16x16x32_bf16 v[164:167], v[16:19], a[100:103], v[164:167]
ds_read_b128 v[48:51], v145 offset:8192
v_mfma_f32_16x16x32_bf16 v[168:171], v[20:23], a[96:99], v[168:171]
ds_read_b128 v[52:55], v145 offset:9216
v_mfma_f32_16x16x32_bf16 v[172:175], v[20:23], a[100:103], v[172:175]
ds_read_b128 v[56:59], v145 offset:10240
v_mfma_f32_16x16x32_bf16 v[176:179], v[24:27], a[96:99], v[176:179]
ds_read_b128 v[60:63], v145 offset:11264
v_mfma_f32_16x16x32_bf16 v[180:183], v[24:27], a[100:103], v[180:183]
ds_read_b128 v[64:67], v145 offset:12288
v_mfma_f32_16x16x32_bf16 v[184:187], v[28:31], a[96:99], v[184:187]
ds_read_b128 v[68:71], v145 offset:13312
v_mfma_f32_16x16x32_bf16 v[188:191], v[28:31], a[100:103], v[188:191]
buffer_load_dwordx4 a[192:195], v1, s[20:23], s32 offen offset:0 sc1
v_mfma_f32_16x16x32_bf16 v[192:195], v[32:35], a[96:99], v[192:195]
buffer_load_dwordx4 a[196:199], v1, s[20:23], s33 offen offset:0 sc1
s_add_u32 m0, s35, 4096
v_mfma_f32_16x16x32_bf16 v[196:199], v[32:35], a[100:103], v[196:199]
buffer_load_dwordx4 v1, s[20:23], s34 offen offset:0 sc1 lds
v_mfma_f32_16x16x32_bf16 v[200:203], v[36:39], a[96:99], v[200:203]
buffer_load_dwordx4 v1, s[20:23], s34 offen offset:1024 sc1 lds
v_mfma_f32_16x16x32_bf16 v[204:207], v[36:39], a[100:103], v[204:207]
buffer_load_dwordx4 v1, s[20:23], s34 offen offset:2048 sc1 lds
v_mfma_f32_16x16x32_bf16 v[208:211], v[40:43], a[96:99], v[208:211]
s_add_u32 s34, s34, 110592
v_mfma_f32_16x16x32_bf16 v[212:215], v[40:43], a[100:103], v[212:215]
s_waitcnt vmcnt(36) lgkmcnt(0)
v_mfma_f32_16x16x32_bf16 v[160:163], v[44:47], a[104:107], v[160:163]
ds_read_b128 v[16:19], v145 offset:14336
v_mfma_f32_16x16x32_bf16 v[164:167], v[44:47], a[108:111], v[164:167]
ds_read_b128 v[20:23], v145 offset:15360
v_mfma_f32_16x16x32_bf16 v[168:171], v[48:51], a[104:107], v[168:171]
ds_read_b128 v[24:27], v145 offset:16384
v_mfma_f32_16x16x32_bf16 v[172:175], v[48:51], a[108:111], v[172:175]
ds_read_b128 v[28:31], v145 offset:17408
v_mfma_f32_16x16x32_bf16 v[176:179], v[52:55], a[104:107], v[176:179]
ds_read_b128 v[32:35], v145 offset:18432
v_mfma_f32_16x16x32_bf16 v[180:183], v[52:55], a[108:111], v[180:183]
ds_read_b128 v[36:39], v145 offset:19456
v_mfma_f32_16x16x32_bf16 v[184:187], v[56:59], a[104:107], v[184:187]
ds_read_b128 v[40:43], v145 offset:20480
v_mfma_f32_16x16x32_bf16 v[188:191], v[56:59], a[108:111], v[188:191]
buffer_load_dwordx4 a[200:203], v1, s[20:23], s32 offen offset:1024 sc1
v_mfma_f32_16x16x32_bf16 v[192:195], v[60:63], a[104:107], v[192:195]
buffer_load_dwordx4 a[204:207], v1, s[20:23], s33 offen offset:1024 sc1
v_mfma_f32_16x16x32_bf16 v[196:199], v[60:63], a[108:111], v[196:199]
v_mfma_f32_16x16x32_bf16 v[200:203], v[64:67], a[104:107], v[200:203]
v_mfma_f32_16x16x32_bf16 v[204:207], v[64:67], a[108:111], v[204:207]
v_mfma_f32_16x16x32_bf16 v[208:211], v[68:71], a[104:107], v[208:211]
v_mfma_f32_16x16x32_bf16 v[212:215], v[68:71], a[108:111], v[212:215]
s_waitcnt vmcnt(36) lgkmcnt(0)
v_mfma_f32_16x16x32_bf16 v[160:163], v[16:19], a[112:115], v[160:163]
ds_read_b128 v[44:47], v145 offset:21504
v_mfma_f32_16x16x32_bf16 v[164:167], v[16:19], a[116:119], v[164:167]
ds_read_b128 v[48:51], v145 offset:22528
v_mfma_f32_16x16x32_bf16 v[168:171], v[20:23], a[112:115], v[168:171]
ds_read_b128 v[52:55], v145 offset:23552
v_mfma_f32_16x16x32_bf16 v[172:175], v[20:23], a[116:119], v[172:175]
ds_read_b128 v[56:59], v145 offset:24576
v_mfma_f32_16x16x32_bf16 v[176:179], v[24:27], a[112:115], v[176:179]
ds_read_b128 v[60:63], v145 offset:25600
v_mfma_f32_16x16x32_bf16 v[180:183], v[24:27], a[116:119], v[180:183]
ds_read_b128 v[64:67], v145 offset:26624
v_mfma_f32_16x16x32_bf16 v[184:187], v[28:31], a[112:115], v[184:187]
ds_read_b128 v[68:71], v145 offset:27648
v_mfma_f32_16x16x32_bf16 v[188:191], v[28:31], a[116:119], v[188:191]
buffer_load_dwordx4 a[208:211], v1, s[20:23], s32 offen offset:2048 sc1
v_mfma_f32_16x16x32_bf16 v[192:195], v[32:35], a[112:115], v[192:195]
buffer_load_dwordx4 a[212:215], v1, s[20:23], s33 offen offset:2048 sc1
v_mfma_f32_16x16x32_bf16 v[196:199], v[32:35], a[116:119], v[196:199]
v_mfma_f32_16x16x32_bf16 v[200:203], v[36:39], a[112:115], v[200:203]
v_mfma_f32_16x16x32_bf16 v[204:207], v[36:39], a[116:119], v[204:207]
v_mfma_f32_16x16x32_bf16 v[208:211], v[40:43], a[112:115], v[208:211]
v_mfma_f32_16x16x32_bf16 v[212:215], v[40:43], a[116:119], v[212:215]
s_waitcnt vmcnt(36) lgkmcnt(0)
s_barrier
v_mfma_f32_16x16x32_bf16 v[160:163], v[44:47], a[120:123], v[160:163]
ds_read_b128 v[16:19], v145 offset:32768
v_mfma_f32_16x16x32_bf16 v[164:167], v[44:47], a[124:127], v[164:167]
ds_read_b128 v[20:23], v145 offset:33792
v_mfma_f32_16x16x32_bf16 v[168:171], v[48:51], a[120:123], v[168:171]
ds_read_b128 v[24:27], v145 offset:34816
v_mfma_f32_16x16x32_bf16 v[172:175], v[48:51], a[124:127], v[172:175]
ds_read_b128 v[28:31], v145 offset:35840
v_mfma_f32_16x16x32_bf16 v[176:179], v[52:55], a[120:123], v[176:179]
ds_read_b128 v[32:35], v145 offset:36864
v_mfma_f32_16x16x32_bf16 v[180:183], v[52:55], a[124:127], v[180:183]
ds_read_b128 v[36:39], v145 offset:37888
v_mfma_f32_16x16x32_bf16 v[184:187], v[56:59], a[120:123], v[184:187]
ds_read_b128 v[40:43], v145 offset:38912
v_mfma_f32_16x16x32_bf16 v[188:191], v[56:59], a[124:127], v[188:191]
buffer_load_dwordx4 a[216:219], v1, s[20:23], s32 offen offset:3072 sc1
v_mfma_f32_16x16x32_bf16 v[192:195], v[60:63], a[120:123], v[192:195]
s_add_u32 s32, s32, 4096
buffer_load_dwordx4 a[220:223], v1, s[20:23], s33 offen offset:3072 sc1
s_add_u32 m0, s35, 32768
v_mfma_f32_16x16x32_bf16 v[196:199], v[60:63], a[124:127], v[196:199]
s_add_u32 s33, s33, 4096
buffer_load_dwordx4 v1, s[20:23], s34 offen offset:0 sc1 lds
v_mfma_f32_16x16x32_bf16 v[200:203], v[64:67], a[120:123], v[200:203]
buffer_load_dwordx4 v1, s[20:23], s34 offen offset:1024 sc1 lds
v_mfma_f32_16x16x32_bf16 v[204:207], v[64:67], a[124:127], v[204:207]
buffer_load_dwordx4 v1, s[20:23], s34 offen offset:2048 sc1 lds
v_mfma_f32_16x16x32_bf16 v[208:211], v[68:71], a[120:123], v[208:211]
buffer_load_dwordx4 v1, s[20:23], s34 offen offset:3072 sc1 lds
v_mfma_f32_16x16x32_bf16 v[212:215], v[68:71], a[124:127], v[212:215]
s_add_u32 s34, s34, 4096
s_waitcnt vmcnt(40) lgkmcnt(0)
v_mfma_f32_16x16x32_bf16 v[160:163], v[16:19], a[128:131], v[160:163]
ds_read_b128 v[44:47], v145 offset:39936
v_mfma_f32_16x16x32_bf16 v[164:167], v[16:19], a[132:135], v[164:167]
ds_read_b128 v[48:51], v145 offset:40960
v_mfma_f32_16x16x32_bf16 v[168:171], v[20:23], a[128:131], v[168:171]
ds_read_b128 v[52:55], v145 offset:41984
v_mfma_f32_16x16x32_bf16 v[172:175], v[20:23], a[132:135], v[172:175]
ds_read_b128 v[56:59], v145 offset:43008
v_mfma_f32_16x16x32_bf16 v[176:179], v[24:27], a[128:131], v[176:179]
ds_read_b128 v[60:63], v145 offset:44032
v_mfma_f32_16x16x32_bf16 v[180:183], v[24:27], a[132:135], v[180:183]
ds_read_b128 v[64:67], v145 offset:45056
v_mfma_f32_16x16x32_bf16 v[184:187], v[28:31], a[128:131], v[184:187]
ds_read_b128 v[68:71], v145 offset:46080
v_mfma_f32_16x16x32_bf16 v[188:191], v[28:31], a[132:135], v[188:191]
buffer_load_dwordx4 a[224:227], v1, s[20:23], s32 offen offset:0 sc1
v_mfma_f32_16x16x32_bf16 v[192:195], v[32:35], a[128:131], v[192:195]
buffer_load_dwordx4 a[228:231], v1, s[20:23], s33 offen offset:0 sc1
s_add_u32 m0, s35, 36864
v_mfma_f32_16x16x32_bf16 v[196:199], v[32:35], a[132:135], v[196:199]
buffer_load_dwordx4 v1, s[20:23], s34 offen offset:0 sc1 lds
v_mfma_f32_16x16x32_bf16 v[200:203], v[36:39], a[128:131], v[200:203]
buffer_load_dwordx4 v1, s[20:23], s34 offen offset:1024 sc1 lds
v_mfma_f32_16x16x32_bf16 v[204:207], v[36:39], a[132:135], v[204:207]
buffer_load_dwordx4 v1, s[20:23], s34 offen offset:2048 sc1 lds
v_mfma_f32_16x16x32_bf16 v[208:211], v[40:43], a[128:131], v[208:211]
s_add_u32 s34, s34, 110592
v_mfma_f32_16x16x32_bf16 v[212:215], v[40:43], a[132:135], v[212:215]
s_waitcnt vmcnt(43) lgkmcnt(0)
v_mfma_f32_16x16x32_bf16 v[160:163], v[44:47], a[136:139], v[160:163]
ds_read_b128 v[16:19], v145 offset:47104
v_mfma_f32_16x16x32_bf16 v[164:167], v[44:47], a[140:143], v[164:167]
ds_read_b128 v[20:23], v145 offset:48128
v_mfma_f32_16x16x32_bf16 v[168:171], v[48:51], a[136:139], v[168:171]
ds_read_b128 v[24:27], v145 offset:49152
v_mfma_f32_16x16x32_bf16 v[172:175], v[48:51], a[140:143], v[172:175]
ds_read_b128 v[28:31], v145 offset:50176
v_mfma_f32_16x16x32_bf16 v[176:179], v[52:55], a[136:139], v[176:179]
ds_read_b128 v[32:35], v145 offset:51200
v_mfma_f32_16x16x32_bf16 v[180:183], v[52:55], a[140:143], v[180:183]
ds_read_b128 v[36:39], v145 offset:52224
v_mfma_f32_16x16x32_bf16 v[184:187], v[56:59], a[136:139], v[184:187]
ds_read_b128 v[40:43], v145 offset:53248
v_mfma_f32_16x16x32_bf16 v[188:191], v[56:59], a[140:143], v[188:191]
buffer_load_dwordx4 a[232:235], v1, s[20:23], s32 offen offset:1024 sc1
v_mfma_f32_16x16x32_bf16 v[192:195], v[60:63], a[136:139], v[192:195]
buffer_load_dwordx4 a[236:239], v1, s[20:23], s33 offen offset:1024 sc1
v_mfma_f32_16x16x32_bf16 v[196:199], v[60:63], a[140:143], v[196:199]
v_mfma_f32_16x16x32_bf16 v[200:203], v[64:67], a[136:139], v[200:203]
v_mfma_f32_16x16x32_bf16 v[204:207], v[64:67], a[140:143], v[204:207]
v_mfma_f32_16x16x32_bf16 v[208:211], v[68:71], a[136:139], v[208:211]
v_mfma_f32_16x16x32_bf16 v[212:215], v[68:71], a[140:143], v[212:215]
s_waitcnt vmcnt(43) lgkmcnt(0)
v_mfma_f32_16x16x32_bf16 v[160:163], v[16:19], a[144:147], v[160:163]
ds_read_b128 v[44:47], v145 offset:54272
v_mfma_f32_16x16x32_bf16 v[164:167], v[16:19], a[148:151], v[164:167]
ds_read_b128 v[48:51], v145 offset:55296
v_mfma_f32_16x16x32_bf16 v[168:171], v[20:23], a[144:147], v[168:171]
ds_read_b128 v[52:55], v145 offset:56320
v_mfma_f32_16x16x32_bf16 v[172:175], v[20:23], a[148:151], v[172:175]
ds_read_b128 v[56:59], v145 offset:57344
v_mfma_f32_16x16x32_bf16 v[176:179], v[24:27], a[144:147], v[176:179]
ds_read_b128 v[60:63], v145 offset:58368
v_mfma_f32_16x16x32_bf16 v[180:183], v[24:27], a[148:151], v[180:183]
ds_read_b128 v[64:67], v145 offset:59392
v_mfma_f32_16x16x32_bf16 v[184:187], v[28:31], a[144:147], v[184:187]
ds_read_b128 v[68:71], v145 offset:60416
v_mfma_f32_16x16x32_bf16 v[188:191], v[28:31], a[148:151], v[188:191]
buffer_load_dwordx4 a[240:243], v1, s[20:23], s32 offen offset:2048 sc1
v_mfma_f32_16x16x32_bf16 v[192:195], v[32:35], a[144:147], v[192:195]
buffer_load_dwordx4 a[244:247], v1, s[20:23], s33 offen offset:2048 sc1
v_mfma_f32_16x16x32_bf16 v[196:199], v[32:35], a[148:151], v[196:199]
buffer_load_dword v13, v14, s[20:23], s70 offen sc0 sc1
v_mfma_f32_16x16x32_bf16 v[200:203], v[36:39], a[144:147], v[200:203]
v_mfma_f32_16x16x32_bf16 v[204:207], v[36:39], a[148:151], v[204:207]
v_mfma_f32_16x16x32_bf16 v[208:211], v[40:43], a[144:147], v[208:211]
v_mfma_f32_16x16x32_bf16 v[212:215], v[40:43], a[148:151], v[212:215]
s_waitcnt vmcnt(35) lgkmcnt(0)
s_barrier
v_mfma_f32_16x16x32_bf16 v[160:163], v[44:47], a[152:155], v[160:163]
ds_read_b128 v[16:19], v146 offset:0
v_mfma_f32_16x16x32_bf16 v[164:167], v[44:47], a[156:159], v[164:167]
ds_read_b128 v[20:23], v146 offset:1024
v_mfma_f32_16x16x32_bf16 v[168:171], v[48:51], a[152:155], v[168:171]
ds_read_b128 v[24:27], v146 offset:2048
v_mfma_f32_16x16x32_bf16 v[172:175], v[48:51], a[156:159], v[172:175]
ds_read_b128 v[28:31], v146 offset:3072
v_mfma_f32_16x16x32_bf16 v[176:179], v[52:55], a[152:155], v[176:179]
ds_read_b128 v[32:35], v146 offset:4096
v_mfma_f32_16x16x32_bf16 v[180:183], v[52:55], a[156:159], v[180:183]
ds_read_b128 v[36:39], v146 offset:5120
v_mfma_f32_16x16x32_bf16 v[184:187], v[56:59], a[152:155], v[184:187]
ds_read_b128 v[40:43], v146 offset:6144
v_mfma_f32_16x16x32_bf16 v[188:191], v[56:59], a[156:159], v[188:191]
buffer_load_dwordx4 a[248:251], v1, s[20:23], s32 offen offset:3072 sc1
v_mfma_f32_16x16x32_bf16 v[192:195], v[60:63], a[152:155], v[192:195]
s_add_u32 s32, s32, 4096
buffer_load_dwordx4 a[252:255], v1, s[20:23], s33 offen offset:3072 sc1
v_mfma_f32_16x16x32_bf16 v[196:199], v[60:63], a[156:159], v[196:199]
s_add_u32 s33, s33, 4096
v_mfma_f32_16x16x32_bf16 v[200:203], v[64:67], a[152:155], v[200:203]
v_mfma_f32_16x16x32_bf16 v[204:207], v[64:67], a[156:159], v[204:207]
v_mfma_f32_16x16x32_bf16 v[208:211], v[68:71], a[152:155], v[208:211]
v_mfma_f32_16x16x32_bf16 v[212:215], v[68:71], a[156:159], v[212:215]
s_waitcnt vmcnt(37) lgkmcnt(0)
v_mfma_f32_16x16x32_bf16 v[160:163], v[16:19], a[160:163], v[160:163]
ds_read_b128 v[44:47], v146 offset:7168
v_mfma_f32_16x16x32_bf16 v[164:167], v[16:19], a[164:167], v[164:167]
ds_read_b128 v[48:51], v146 offset:8192
v_mfma_f32_16x16x32_bf16 v[168:171], v[20:23], a[160:163], v[168:171]
ds_read_b128 v[52:55], v146 offset:9216
v_mfma_f32_16x16x32_bf16 v[172:175], v[20:23], a[164:167], v[172:175]
ds_read_b128 v[56:59], v146 offset:10240
v_mfma_f32_16x16x32_bf16 v[176:179], v[24:27], a[160:163], v[176:179]
ds_read_b128 v[60:63], v146 offset:11264
v_mfma_f32_16x16x32_bf16 v[180:183], v[24:27], a[164:167], v[180:183]
ds_read_b128 v[64:67], v146 offset:12288
v_mfma_f32_16x16x32_bf16 v[184:187], v[28:31], a[160:163], v[184:187]
ds_read_b128 v[68:71], v146 offset:13312
v_mfma_f32_16x16x32_bf16 v[188:191], v[28:31], a[164:167], v[188:191]
v_mfma_f32_16x16x32_bf16 v[192:195], v[32:35], a[160:163], v[192:195]
v_mfma_f32_16x16x32_bf16 v[196:199], v[32:35], a[164:167], v[196:199]
v_mfma_f32_16x16x32_bf16 v[200:203], v[36:39], a[160:163], v[200:203]
v_mfma_f32_16x16x32_bf16 v[204:207], v[36:39], a[164:167], v[204:207]
v_mfma_f32_16x16x32_bf16 v[208:211], v[40:43], a[160:163], v[208:211]
v_mfma_f32_16x16x32_bf16 v[212:215], v[40:43], a[164:167], v[212:215]
s_waitcnt vmcnt(35) lgkmcnt(0)
v_mfma_f32_16x16x32_bf16 v[160:163], v[44:47], a[168:171], v[160:163]
ds_read_b128 v[16:19], v146 offset:14336
v_mfma_f32_16x16x32_bf16 v[164:167], v[44:47], a[172:175], v[164:167]
ds_read_b128 v[20:23], v146 offset:15360
v_mfma_f32_16x16x32_bf16 v[168:171], v[48:51], a[168:171], v[168:171]
ds_read_b128 v[24:27], v146 offset:16384
v_mfma_f32_16x16x32_bf16 v[172:175], v[48:51], a[172:175], v[172:175]
ds_read_b128 v[28:31], v146 offset:17408
v_mfma_f32_16x16x32_bf16 v[176:179], v[52:55], a[168:171], v[176:179]
ds_read_b128 v[32:35], v146 offset:18432
v_mfma_f32_16x16x32_bf16 v[180:183], v[52:55], a[172:175], v[180:183]
ds_read_b128 v[36:39], v146 offset:19456
v_mfma_f32_16x16x32_bf16 v[184:187], v[56:59], a[168:171], v[184:187]
ds_read_b128 v[40:43], v146 offset:20480
v_mfma_f32_16x16x32_bf16 v[188:191], v[56:59], a[172:175], v[188:191]
v_mfma_f32_16x16x32_bf16 v[192:195], v[60:63], a[168:171], v[192:195]
v_mfma_f32_16x16x32_bf16 v[196:199], v[60:63], a[172:175], v[196:199]
v_mfma_f32_16x16x32_bf16 v[200:203], v[64:67], a[168:171], v[200:203]
v_mfma_f32_16x16x32_bf16 v[204:207], v[64:67], a[172:175], v[204:207]
v_mfma_f32_16x16x32_bf16 v[208:211], v[68:71], a[168:171], v[208:211]
v_mfma_f32_16x16x32_bf16 v[212:215], v[68:71], a[172:175], v[212:215]
s_waitcnt vmcnt(33) lgkmcnt(0)
s_waitcnt vmcnt(2)
s_mov_b32 s26, 0
LT_chkA:
v_cmp_ne_u32 vcc, s89, v13
s_cbranch_vccz LT_okA
s_cmp_gt_u32 s26, 200000
s_cbranch_scc1 LT_okA
s_sleep 1
buffer_load_dword v13, v14, s[20:23], s70 offen sc0 sc1
s_add_u32 s26, s26, 1
s_waitcnt vmcnt(0)
s_branch LT_chkA
LT_okA:
v_mfma_f32_16x16x32_bf16 v[160:163], v[16:19], a[176:179], v[160:163]
ds_read_b128 v[44:47], v146 offset:21504
v_mfma_f32_16x16x32_bf16 v[164:167], v[16:19], a[180:183], v[164:167]
ds_read_b128 v[48:51], v146 offset:22528
v_mfma_f32_16x16x32_bf16 v[168:171], v[20:23], a[176:179], v[168:171]
ds_read_b128 v[52:55], v146 offset:23552
v_mfma_f32_16x16x32_bf16 v[172:175], v[20:23], a[180:183], v[172:175]
ds_read_b128 v[56:59], v146 offset:24576
v_mfma_f32_16x16x32_bf16 v[176:179], v[24:27], a[176:179], v[176:179]
ds_read_b128 v[60:63], v146 offset:25600
v_mfma_f32_16x16x32_bf16 v[180:183], v[24:27], a[180:183], v[180:183]
ds_read_b128 v[64:67], v146 offset:26624
v_mfma_f32_16x16x32_bf16 v[184:187], v[28:31], a[176:179], v[184:187]
ds_read_b128 v[68:71], v146 offset:27648
v_mfma_f32_16x16x32_bf16 v[188:191], v[28:31], a[180:183], v[188:191]
buffer_load_dwordx4 a[64:67], v1, s[20:23], s64 offen offset:0 sc1
v_mfma_f32_16x16x32_bf16 v[192:195], v[32:35], a[176:179], v[192:195]
buffer_load_dwordx4 a[68:71], v1, s[20:23], s64 offen offset:1024 sc1
v_mfma_f32_16x16x32_bf16 v[196:199], v[32:35], a[180:183], v[196:199]
buffer_load_dwordx4 a[72:75], v1, s[20:23], s64 offen offset:2048 sc1
v_mfma_f32_16x16x32_bf16 v[200:203], v[36:39], a[176:179], v[200:203]
buffer_load_dwordx4 a[76:79], v1, s[20:23], s64 offen offset:3072 sc1
v_mfma_f32_16x16x32_bf16 v[204:207], v[36:39], a[180:183], v[204:207]
s_add_u32 s64, s64, 4096
v_mfma_f32_16x16x32_bf16 v[208:211], v[40:43], a[176:179], v[208:211]
v_mfma_f32_16x16x32_bf16 v[212:215], v[40:43], a[180:183], v[212:215]
s_waitcnt vmcnt(6) lgkmcnt(0)
s_barrier
v_mfma_f32_16x16x32_bf16 v[160:163], v[44:47], a[184:187], v[160:163]
ds_read_b128 v[16:19], v144 offset:0
v_mfma_f32_16x16x32_bf16 v[164:167], v[44:47], a[188:191], v[164:167]
ds_read_b128 v[20:23], v144 offset:1024
v_mfma_f32_16x16x32_bf16 v[168:171], v[48:51], a[184:187], v[168:171]
ds_read_b128 v[24:27], v144 offset:2048
v_mfma_f32_16x16x32_bf16 v[172:175], v[48:51], a[188:191], v[172:175]
ds_read_b128 v[28:31], v144 offset:3072
v_mfma_f32_16x16x32_bf16 v[176:179], v[52:55], a[184:187], v[176:179]
ds_read_b128 v[32:35], v144 offset:4096
v_mfma_f32_16x16x32_bf16 v[180:183], v[52:55], a[188:191], v[180:183]
ds_read_b128 v[36:39], v144 offset:5120
v_mfma_f32_16x16x32_bf16 v[184:187], v[56:59], a[184:187], v[184:187]
ds_read_b128 v[40:43], v144 offset:6144
v_mfma_f32_16x16x32_bf16 v[188:191], v[56:59], a[188:191], v[188:191]
buffer_load_dwordx4 a[80:83], v1, s[20:23], s64 offen offset:0 sc1
v_mfma_f32_16x16x32_bf16 v[192:195], v[60:63], a[184:187], v[192:195]
buffer_load_dwordx4 a[84:87], v1, s[20:23], s64 offen offset:1024 sc1
v_mfma_f32_16x16x32_bf16 v[196:199], v[60:63], a[188:191], v[196:199]
buffer_load_dwordx4 a[88:91], v1, s[20:23], s64 offen offset:2048 sc1
v_mfma_f32_16x16x32_bf16 v[200:203], v[64:67], a[184:187], v[200:203]
buffer_load_dwordx4 a[92:95], v1, s[20:23], s64 offen offset:3072 sc1
v_mfma_f32_16x16x32_bf16 v[204:207], v[64:67], a[188:191], v[204:207]
s_add_u32 s64, s64, 4096
v_mfma_f32_16x16x32_bf16 v[208:211], v[68:71], a[184:187], v[208:211]
v_mfma_f32_16x16x32_bf16 v[212:215], v[68:71], a[188:191], v[212:215]
s_waitcnt vmcnt(10) lgkmcnt(0)
v_mfma_f32_16x16x32_bf16 v[160:163], v[16:19], a[192:195], v[160:163]
ds_read_b128 v[44:47], v144 offset:7168
v_mfma_f32_16x16x32_bf16 v[164:167], v[16:19], a[196:199], v[164:167]
ds_read_b128 v[48:51], v144 offset:8192
v_mfma_f32_16x16x32_bf16 v[168:171], v[20:23], a[192:195], v[168:171]
ds_read_b128 v[52:55], v144 offset:9216
v_mfma_f32_16x16x32_bf16 v[172:175], v[20:23], a[196:199], v[172:175]
ds_read_b128 v[56:59], v144 offset:10240
v_mfma_f32_16x16x32_bf16 v[176:179], v[24:27], a[192:195], v[176:179]
ds_read_b128 v[60:63], v144 offset:11264
v_mfma_f32_16x16x32_bf16 v[180:183], v[24:27], a[196:199], v[180:183]
ds_read_b128 v[64:67], v144 offset:12288
v_mfma_f32_16x16x32_bf16 v[184:187], v[28:31], a[192:195], v[184:187]
ds_read_b128 v[68:71], v144 offset:13312
v_mfma_f32_16x16x32_bf16 v[188:191], v[28:31], a[196:199], v[188:191]
buffer_load_dwordx4 a[96:99], v1, s[20:23], s64 offen offset:0 sc1
v_mfma_f32_16x16x32_bf16 v[192:195], v[32:35], a[192:195], v[192:195]
buffer_load_dwordx4 a[100:103], v1, s[20:23], s64 offen offset:1024 sc1
v_mfma_f32_16x16x32_bf16 v[196:199], v[32:35], a[196:199], v[196:199]
buffer_load_dwordx4 a[104:107], v1, s[20:23], s64 offen offset:2048 sc1
v_mfma_f32_16x16x32_bf16 v[200:203], v[36:39], a[192:195], v[200:203]
buffer_load_dwordx4 a[108:111], v1, s[20:23], s64 offen offset:3072 sc1
v_mfma_f32_16x16x32_bf16 v[204:207], v[36:39], a[196:199], v[204:207]
s_add_u32 s64, s64, 4096
v_mfma_f32_16x16x32_bf16 v[208:211], v[40:43], a[192:195], v[208:211]
v_mfma_f32_16x16x32_bf16 v[212:215], v[40:43], a[196:199], v[212:215]
s_waitcnt vmcnt(14) lgkmcnt(0)
v_mfma_f32_16x16x32_bf16 v[160:163], v[44:47], a[200:203], v[160:163]
ds_read_b128 v[16:19], v144 offset:14336
v_mfma_f32_16x16x32_bf16 v[164:167], v[44:47], a[204:207], v[164:167]
ds_read_b128 v[20:23], v144 offset:15360
v_mfma_f32_16x16x32_bf16 v[168:171], v[48:51], a[200:203], v[168:171]
ds_read_b128 v[24:27], v144 offset:16384
v_mfma_f32_16x16x32_bf16 v[172:175], v[48:51], a[204:207], v[172:175]
ds_read_b128 v[28:31], v144 offset:17408
v_mfma_f32_16x16x32_bf16 v[176:179], v[52:55], a[200:203], v[176:179]
ds_read_b128 v[32:35], v144 offset:18432
v_mfma_f32_16x16x32_bf16 v[180:183], v[52:55], a[204:207], v[180:183]
ds_read_b128 v[36:39], v144 offset:19456
v_mfma_f32_16x16x32_bf16 v[184:187], v[56:59], a[200:203], v[184:187]
ds_read_b128 v[40:43], v144 offset:20480
v_mfma_f32_16x16x32_bf16 v[188:191], v[56:59], a[204:207], v[188:191]
buffer_load_dwordx4 a[112:115], v1, s[20:23], s64 offen offset:0 sc1
v_mfma_f32_16x16x32_bf16 v[192:195], v[60:63], a[200:203], v[192:195]
buffer_load_dwordx4 a[116:119], v1, s[20:23], s64 offen offset:1024 sc1
v_mfma_f32_16x16x32_bf16 v[196:199], v[60:63], a[204:207], v[196:199]
buffer_load_dwordx4 a[120:123], v1, s[20:23], s64 offen offset:2048 sc1
v_mfma_f32_16x16x32_bf16 v[200:203], v[64:67], a[200:203], v[200:203]
buffer_load_dwordx4 a[124:127], v1, s[20:23], s64 offen offset:3072 sc1
v_mfma_f32_16x16x32_bf16 v[204:207], v[64:67], a[204:207], v[204:207]
s_add_u32 s64, s64, 4096
v_mfma_f32_16x16x32_bf16 v[208:211], v[68:71], a[200:203], v[208:211]
v_mfma_f32_16x16x32_bf16 v[212:215], v[68:71], a[204:207], v[212:215]
s_waitcnt vmcnt(18) lgkmcnt(0)
v_mfma_f32_16x16x32_bf16 v[160:163], v[16:19], a[208:211], v[160:163]
ds_read_b128 v[44:47], v144 offset:21504
v_mfma_f32_16x16x32_bf16 v[164:167], v[16:19], a[212:215], v[164:167]
ds_read_b128 v[48:51], v144 offset:22528
v_mfma_f32_16x16x32_bf16 v[168:171], v[20:23], a[208:211], v[168:171]
ds_read_b128 v[52:55], v144 offset:23552
v_mfma_f32_16x16x32_bf16 v[172:175], v[20:23], a[212:215], v[172:175]
ds_read_b128 v[56:59], v144 offset:24576
v_mfma_f32_16x16x32_bf16 v[176:179], v[24:27], a[208:211], v[176:179]
ds_read_b128 v[60:63], v144 offset:25600
v_mfma_f32_16x16x32_bf16 v[180:183], v[24:27], a[212:215], v[180:183]
ds_read_b128 v[64:67], v144 offset:26624
v_mfma_f32_16x16x32_bf16 v[184:187], v[28:31], a[208:211], v[184:187]
ds_read_b128 v[68:71], v144 offset:27648
v_mfma_f32_16x16x32_bf16 v[188:191], v[28:31], a[212:215], v[188:191]
buffer_load_dwordx4 a[0:3], v1, s[20:23], s36 offen offset:0 sc1
v_mfma_f32_16x16x32_bf16 v[192:195], v[32:35], a[208:211], v[192:195]
buffer_load_dwordx4 a[4:7], v1, s[20:23], s37 offen offset:0 sc1
v_mfma_f32_16x16x32_bf16 v[196:199], v[32:35], a[212:215], v[196:199]
buffer_load_dwordx4 a[8:11], v1, s[20:23], s38 offen offset:0 sc1
v_mfma_f32_16x16x32_bf16 v[200:203], v[36:39], a[208:211], v[200:203]
buffer_load_dwordx4 a[12:15], v1, s[20:23], s39 offen offset:0 sc1
v_mfma_f32_16x16x32_bf16 v[204:207], v[36:39], a[212:215], v[204:207]
v_mfma_f32_16x16x32_bf16 v[208:211], v[40:43], a[208:211], v[208:211]
v_mfma_f32_16x16x32_bf16 v[212:215], v[40:43], a[212:215], v[212:215]
s_waitcnt vmcnt(22) lgkmcnt(0)
s_barrier
v_mfma_f32_16x16x32_bf16 v[160:163], v[44:47], a[216:219], v[160:163]
ds_read_b128 v[16:19], v144 offset:32768
v_mfma_f32_16x16x32_bf16 v[164:167], v[44:47], a[220:223], v[164:167]
ds_read_b128 v[20:23], v144 offset:33792
v_mfma_f32_16x16x32_bf16 v[168:171], v[48:51], a[216:219], v[168:171]
ds_read_b128 v[24:27], v144 offset:34816
v_mfma_f32_16x16x32_bf16 v[172:175], v[48:51], a[220:223], v[172:175]
ds_read_b128 v[28:31], v144 offset:35840
v_mfma_f32_16x16x32_bf16 v[176:179], v[52:55], a[216:219], v[176:179]
ds_read_b128 v[32:35], v144 offset:36864
v_mfma_f32_16x16x32_bf16 v[180:183], v[52:55], a[220:223], v[180:183]
ds_read_b128 v[36:39], v144 offset:37888
v_mfma_f32_16x16x32_bf16 v[184:187], v[56:59], a[216:219], v[184:187]
ds_read_b128 v[40:43], v144 offset:38912
v_mfma_f32_16x16x32_bf16 v[188:191], v[56:59], a[220:223], v[188:191]
buffer_load_dwordx4 a[16:19], v1, s[20:23], s36 offen offset:1024 sc1
v_mfma_f32_16x16x32_bf16 v[192:195], v[60:63], a[216:219], v[192:195]
buffer_load_dwordx4 a[20:23], v1, s[20:23], s37 offen offset:1024 sc1
v_mfma_f32_16x16x32_bf16 v[196:199], v[60:63], a[220:223], v[196:199]
buffer_load_dwordx4 a[24:27], v1, s[20:23], s38 offen offset:1024 sc1
v_mfma_f32_16x16x32_bf16 v[200:203], v[64:67], a[216:219], v[200:203]
buffer_load_dwordx4 a[28:31], v1, s[20:23], s39 offen offset:1024 sc1
v_mfma_f32_16x16x32_bf16 v[204:207], v[64:67], a[220:223], v[204:207]
v_mfma_f32_16x16x32_bf16 v[208:211], v[68:71], a[216:219], v[208:211]
v_mfma_f32_16x16x32_bf16 v[212:215], v[68:71], a[220:223], v[212:215]
s_waitcnt vmcnt(26) lgkmcnt(0)
v_mfma_f32_16x16x32_bf16 v[160:163], v[16:19], a[224:227], v[160:163]
ds_read_b128 v[44:47], v144 offset:39936
v_mfma_f32_16x16x32_bf16 v[164:167], v[16:19], a[228:231], v[164:167]
ds_read_b128 v[48:51], v144 offset:40960
v_mfma_f32_16x16x32_bf16 v[168:171], v[20:23], a[224:227], v[168:171]
ds_read_b128 v[52:55], v144 offset:41984
v_mfma_f32_16x16x32_bf16 v[172:175], v[20:23], a[228:231], v[172:175]
ds_read_b128 v[56:59], v144 offset:43008
v_mfma_f32_16x16x32_bf16 v[176:179], v[24:27], a[224:227], v[176:179]
ds_read_b128 v[60:63], v144 offset:44032
v_mfma_f32_16x16x32_bf16 v[180:183], v[24:27], a[228:231], v[180:183]
ds_read_b128 v[64:67], v144 offset:45056
v_mfma_f32_16x16x32_bf16 v[184:187], v[28:31], a[224:227], v[184:187]
ds_read_b128 v[68:71], v144 offset:46080
v_mfma_f32_16x16x32_bf16 v[188:191], v[28:31], a[228:231], v[188:191]
buffer_load_dwordx4 a[32:35], v1, s[20:23], s36 offen offset:2048 sc1
v_mfma_f32_16x16x32_bf16 v[192:195], v[32:35], a[224:227], v[192:195]
buffer_load_dwordx4 a[36:39], v1, s[20:23], s37 offen offset:2048 sc1
v_mfma_f32_16x16x32_bf16 v[196:199], v[32:35], a[228:231], v[196:199]
buffer_load_dwordx4 a[40:43], v1, s[20:23], s38 offen offset:2048 sc1
v_mfma_f32_16x16x32_bf16 v[200:203], v[36:39], a[224:227], v[200:203]
buffer_load_dwordx4 a[44:47], v1, s[20:23], s39 offen offset:2048 sc1
v_mfma_f32_16x16x32_bf16 v[204:207], v[36:39], a[228:231], v[204:207]
v_mfma_f32_16x16x32_bf16 v[208:211], v[40:43], a[224:227], v[208:211]
v_mfma_f32_16x16x32_bf16 v[212:215], v[40:43], a[228:231], v[212:215]
s_waitcnt vmcnt(30) lgkmcnt(0)
v_mfma_f32_16x16x32_bf16 v[160:163], v[44:47], a[232:235], v[160:163]
ds_read_b128 v[16:19], v144 offset:47104
v_mfma_f32_16x16x32_bf16 v[164:167], v[44:47], a[236:239], v[164:167]
ds_read_b128 v[20:23], v144 offset:48128
v_mfma_f32_16x16x32_bf16 v[168:171], v[48:51], a[232:235], v[168:171]
ds_read_b128 v[24:27], v144 offset:49152
v_mfma_f32_16x16x32_bf16 v[172:175], v[48:51], a[236:239], v[172:175]
ds_read_b128 v[28:31], v144 offset:50176
v_mfma_f32_16x16x32_bf16 v[176:179], v[52:55], a[232:235], v[176:179]
ds_read_b128 v[32:35], v144 offset:51200
v_mfma_f32_16x16x32_bf16 v[180:183], v[52:55], a[236:239], v[180:183]
ds_read_b128 v[36:39], v144 offset:52224
v_mfma_f32_16x16x32_bf16 v[184:187], v[56:59], a[232:235], v[184:187]
ds_read_b128 v[40:43], v144 offset:53248
v_mfma_f32_16x16x32_bf16 v[188:191], v[56:59], a[236:239], v[188:191]
buffer_load_dwordx4 a[48:51], v1, s[20:23], s36 offen offset:3072 sc1
v_mfma_f32_16x16x32_bf16 v[192:195], v[60:63], a[232:235], v[192:195]
buffer_load_dwordx4 a[52:55], v1, s[20:23], s37 offen offset:3072 sc1
v_mfma_f32_16x16x32_bf16 v[196:199], v[60:63], a[236:239], v[196:199]
buffer_load_dwordx4 a[56:59], v1, s[20:23], s38 offen offset:3072 sc1
v_mfma_f32_16x16x32_bf16 v[200:203], v[64:67], a[232:235], v[200:203]
buffer_load_dwordx4 a[60:63], v1, s[20:23], s39 offen offset:3072 sc1
v_mfma_f32_16x16x32_bf16 v[204:207], v[64:67], a[236:239], v[204:207]
v_mfma_f32_16x16x32_bf16 v[208:211], v[68:71], a[232:235], v[208:211]
v_mfma_f32_16x16x32_bf16 v[212:215], v[68:71], a[236:239], v[212:215]
s_waitcnt vmcnt(34) lgkmcnt(0)
v_mfma_f32_16x16x32_bf16 v[160:163], v[16:19], a[240:243], v[160:163]
ds_read_b128 v[44:47], v144 offset:54272
v_mfma_f32_16x16x32_bf16 v[164:167], v[16:19], a[244:247], v[164:167]
ds_read_b128 v[48:51], v144 offset:55296
v_mfma_f32_16x16x32_bf16 v[168:171], v[20:23], a[240:243], v[168:171]
ds_read_b128 v[52:55], v144 offset:56320
v_mfma_f32_16x16x32_bf16 v[172:175], v[20:23], a[244:247], v[172:175]
ds_read_b128 v[56:59], v144 offset:57344
v_mfma_f32_16x16x32_bf16 v[176:179], v[24:27], a[240:243], v[176:179]
ds_read_b128 v[60:63], v144 offset:58368
v_mfma_f32_16x16x32_bf16 v[180:183], v[24:27], a[244:247], v[180:183]
ds_read_b128 v[64:67], v144 offset:59392
v_mfma_f32_16x16x32_bf16 v[184:187], v[28:31], a[240:243], v[184:187]
ds_read_b128 v[68:71], v144 offset:60416
v_mfma_f32_16x16x32_bf16 v[188:191], v[28:31], a[244:247], v[188:191]
v_mfma_f32_16x16x32_bf16 v[192:195], v[32:35], a[240:243], v[192:195]
v_mfma_f32_16x16x32_bf16 v[196:199], v[32:35], a[244:247], v[196:199]
v_mfma_f32_16x16x32_bf16 v[200:203], v[36:39], a[240:243], v[200:203]
v_mfma_f32_16x16x32_bf16 v[204:207], v[36:39], a[244:247], v[204:207]
v_mfma_f32_16x16x32_bf16 v[208:211], v[40:43], a[240:243], v[208:211]
v_mfma_f32_16x16x32_bf16 v[212:215], v[40:43], a[244:247], v[212:215]
s_waitcnt vmcnt(32) lgkmcnt(0)
v_mfma_f32_16x16x32_bf16 v[160:163], v[44:47], a[248:251], v[160:163]
v_mfma_f32_16x16x32_bf16 v[164:167], v[44:47], a[252:255], v[164:167]
v_mfma_f32_16x16x32_bf16 v[168:171], v[48:51], a[248:251], v[168:171]
v_mfma_f32_16x16x32_bf16 v[172:175], v[48:51], a[252:255], v[172:175]
v_mfma_f32_16x16x32_bf16 v[176:179], v[52:55], a[248:251], v[176:179]
v_mfma_f32_16x16x32_bf16 v[180:183], v[52:55], a[252:255], v[180:183]
v_mfma_f32_16x16x32_bf16 v[184:187], v[56:59], a[248:251], v[184:187]
v_mfma_f32_16x16x32_bf16 v[188:191], v[56:59], a[252:255], v[188:191]
v_mfma_f32_16x16x32_bf16 v[192:195], v[60:63], a[248:251], v[192:195]
v_mfma_f32_16x16x32_bf16 v[196:199], v[60:63], a[252:255], v[196:199]
v_mfma_f32_16x16x32_bf16 v[200:203], v[64:67], a[248:251], v[200:203]
v_mfma_f32_16x16x32_bf16 v[204:207], v[64:67], a[252:255], v[204:207]
v_mfma_f32_16x16x32_bf16 v[208:211], v[68:71], a[248:251], v[208:211]
v_mfma_f32_16x16x32_bf16 v[212:215], v[68:71], a[252:255], v[212:215]
s_nop 7
v_cvt_pk_bf16_f32 v160, v160, v161
v_cvt_pk_bf16_f32 v161, v162, v163
v_cvt_pk_bf16_f32 v162, v164, v165
v_cvt_pk_bf16_f32 v163, v166, v167
buffer_store_dwordx4 v[160:163], v1, s[20:23], s66 offen sc0 sc1
s_add_u32 s66, s66, 4096
v_cvt_pk_bf16_f32 v168, v168, v169
v_cvt_pk_bf16_f32 v169, v170, v171
v_cvt_pk_bf16_f32 v170, v172, v173
v_cvt_pk_bf16_f32 v171, v174, v175
buffer_store_dwordx4 v[168:171], v1, s[20:23], s66 offen sc0 sc1
s_add_u32 s66, s66, 4096
v_cvt_pk_bf16_f32 v176, v176, v177
v_cvt_pk_bf16_f32 v177, v178, v179
v_cvt_pk_bf16_f32 v178, v180, v181
v_cvt_pk_bf16_f32 v179, v182, v183
buffer_store_dwordx4 v[176:179], v1, s[20:23], s66 offen sc0 sc1
s_add_u32 s66, s66, 4096
v_cvt_pk_bf16_f32 v184, v184, v185
v_cvt_pk_bf16_f32 v185, v186, v187
v_cvt_pk_bf16_f32 v186, v188, v189
v_cvt_pk_bf16_f32 v187, v190, v191
buffer_store_dwordx4 v[184:187], v1, s[20:23], s66 offen sc0 sc1
s_add_u32 s66, s66, 4096
v_cvt_pk_bf16_f32 v192, v192, v193
v_cvt_pk_bf16_f32 v193, v194, v195
v_cvt_pk_bf16_f32 v194, v196, v197
v_cvt_pk_bf16_f32 v195, v198, v199
buffer_store_dwordx4 v[192:195], v1, s[20:23], s66 offen sc0 sc1
s_add_u32 s66, s66, 4096
v_cvt_pk_bf16_f32 v200, v200, v201
v_cvt_pk_bf16_f32 v201, v202, v203
v_cvt_pk_bf16_f32 v202, v204, v205
v_cvt_pk_bf16_f32 v203, v206, v207
buffer_store_dwordx4 v[200:203], v1, s[20:23], s66 offen sc0 sc1
s_add_u32 s66, s66, 4096
v_cvt_pk_bf16_f32 v208, v208, v209
v_cvt_pk_bf16_f32 v209, v210, v211
v_cvt_pk_bf16_f32 v210, v212, v213
v_cvt_pk_bf16_f32 v211, v214, v215
buffer_store_dwordx4 v[208:211], v1, s[20:23], s66 offen sc0 sc1
s_add_u32 s66, s66, 4096
s_waitcnt vmcnt(7)
v_mfma_f32_16x16x32_bf16 v[72:75], a[64:67], a[0:3], 0
v_mfma_f32_16x16x32_bf16 v[76:79], a[64:67], a[4:7], 0
v_mfma_f32_16x16x32_bf16 v[80:83], a[64:67], a[8:11], 0
v_mfma_f32_16x16x32_bf16 v[84:87], a[64:67], a[12:15], 0
v_mfma_f32_16x16x32_bf16 v[88:91], a[68:71], a[0:3], 0
v_mfma_f32_16x16x32_bf16 v[92:95], a[68:71], a[4:7], 0
v_mfma_f32_16x16x32_bf16 v[96:99], a[68:71], a[8:11], 0
v_mfma_f32_16x16x32_bf16 v[100:103], a[68:71], a[12:15], 0
v_mfma_f32_16x16x32_bf16 v[104:107], a[72:75], a[0:3], 0
v_mfma_f32_16x16x32_bf16 v[108:111], a[72:75], a[4:7], 0
v_mfma_f32_16x16x32_bf16 v[112:115], a[72:75], a[8:11], 0
v_mfma_f32_16x16x32_bf16 v[116:119], a[72:75], a[12:15], 0
v_mfma_f32_16x16x32_bf16 v[120:123], a[76:79], a[0:3], 0
v_mfma_f32_16x16x32_bf16 v[124:127], a[76:79], a[4:7], 0
v_mfma_f32_16x16x32_bf16 v[128:131], a[76:79], a[8:11], 0
v_mfma_f32_16x16x32_bf16 v[132:135], a[76:79], a[12:15], 0
v_mfma_f32_16x16x32_bf16 v[72:75], a[80:83], a[16:19], v[72:75]
v_mfma_f32_16x16x32_bf16 v[76:79], a[80:83], a[20:23], v[76:79]
v_mfma_f32_16x16x32_bf16 v[80:83], a[80:83], a[24:27], v[80:83]
v_mfma_f32_16x16x32_bf16 v[84:87], a[80:83], a[28:31], v[84:87]
v_mfma_f32_16x16x32_bf16 v[88:91], a[84:87], a[16:19], v[88:91]
v_mfma_f32_16x16x32_bf16 v[92:95], a[84:87], a[20:23], v[92:95]
v_mfma_f32_16x16x32_bf16 v[96:99], a[84:87], a[24:27], v[96:99]
v_mfma_f32_16x16x32_bf16 v[100:103], a[84:87], a[28:31], v[100:103]
v_mfma_f32_16x16x32_bf16 v[104:107], a[88:91], a[16:19], v[104:107]
v_mfma_f32_16x16x32_bf16 v[108:111], a[88:91], a[20:23], v[108:111]
v_mfma_f32_16x16x32_bf16 v[112:115], a[88:91], a[24:27], v[112:115]
v_mfma_f32_16x16x32_bf16 v[116:119], a[88:91], a[28:31], v[116:119]
v_mfma_f32_16x16x32_bf16 v[120:123], a[92:95], a[16:19], v[120:123]
v_mfma_f32_16x16x32_bf16 v[124:127], a[92:95], a[20:23], v[124:127]
v_mfma_f32_16x16x32_bf16 v[128:131], a[92:95], a[24:27], v[128:131]
v_mfma_f32_16x16x32_bf16 v[132:135], a[92:95], a[28:31], v[132:135]
v_mfma_f32_16x16x32_bf16 v[72:75], a[96:99], a[32:35], v[72:75]
v_mfma_f32_16x16x32_bf16 v[76:79], a[96:99], a[36:39], v[76:79]
v_mfma_f32_16x16x32_bf16 v[80:83], a[96:99], a[40:43], v[80:83]
v_mfma_f32_16x16x32_bf16 v[84:87], a[96:99], a[44:47], v[84:87]
v_mfma_f32_16x16x32_bf16 v[88:91], a[100:103], a[32:35], v[88:91]
v_mfma_f32_16x16x32_bf16 v[92:95], a[100:103], a[36:39], v[92:95]
v_mfma_f32_16x16x32_bf16 v[96:99], a[100:103], a[40:43], v[96:99]
v_mfma_f32_16x16x32_bf16 v[100:103], a[100:103], a[44:47], v[100:103]
v_mfma_f32_16x16x32_bf16 v[104:107], a[104:107], a[32:35], v[104:107]
v_mfma_f32_16x16x32_bf16 v[108:111], a[104:107], a[36:39], v[108:111]
v_mfma_f32_16x16x32_bf16 v[112:115], a[104:107], a[40:43], v[112:115]
v_mfma_f32_16x16x32_bf16 v[116:119], a[104:107], a[44:47], v[116:119]
v_mfma_f32_16x16x32_bf16 v[120:123], a[108:111], a[32:35], v[120:123]
v_mfma_f32_16x16x32_bf16 v[124:127], a[108:111], a[36:39], v[124:127]
v_mfma_f32_16x16x32_bf16 v[128:131], a[108:111], a[40:43], v[128:131]
v_mfma_f32_16x16x32_bf16 v[132:135], a[108:111], a[44:47], v[132:135]
v_mfma_f32_16x16x32_bf16 v[72:75], a[112:115], a[48:51], v[72:75]
v_mfma_f32_16x16x32_bf16 v[76:79], a[112:115], a[52:55], v[76:79]
v_mfma_f32_16x16x32_bf16 v[80:83], a[112:115], a[56:59], v[80:83]
v_mfma_f32_16x16x32_bf16 v[84:87], a[112:115], a[60:63], v[84:87]
v_mfma_f32_16x16x32_bf16 v[88:91], a[116:119], a[48:51], v[88:91]
v_mfma_f32_16x16x32_bf16 v[92:95], a[116:119], a[52:55], v[92:95]
v_mfma_f32_16x16x32_bf16 v[96:99], a[116:119], a[56:59], v[96:99]
v_mfma_f32_16x16x32_bf16 v[100:103], a[116:119], a[60:63], v[100:103]
v_mfma_f32_16x16x32_bf16 v[104:107], a[120:123], a[48:51], v[104:107]
v_mfma_f32_16x16x32_bf16 v[108:111], a[120:123], a[52:55], v[108:111]
v_mfma_f32_16x16x32_bf16 v[112:115], a[120:123], a[56:59], v[112:115]
v_mfma_f32_16x16x32_bf16 v[116:119], a[120:123], a[60:63], v[116:119]
v_mfma_f32_16x16x32_bf16 v[120:123], a[124:127], a[48:51], v[120:123]
v_mfma_f32_16x16x32_bf16 v[124:127], a[124:127], a[52:55], v[124:127]
v_mfma_f32_16x16x32_bf16 v[128:131], a[124:127], a[56:59], v[128:131]
v_mfma_f32_16x16x32_bf16 v[132:135], a[124:127], a[60:63], v[132:135]
v_and_b32 v8, 15, v15
v_mul_u32_u24 v8, 1792, v8
v_bfe_u32 v9, v15, 4, 1
v_lshl_add_u32 v8, v9, 5, v8
v_lshrrev_b32 v9, 5, v15
v_lshl_add_u32 v8, v9, 4, v8
s_lshl_b32 s26, s48, 12
v_add_u32 v9, s26, v145
s_lshl_b32 s26, s48, 14
v_add_u32 v10, s26, v145
v_and_b32 v14, 3, v15
v_lshlrev_b32 v14, 2, v14
v_mov_b32 v6, s89
v_mov_b32 v7, 0
s_waitcnt vmcnt(0)
s_mov_b64 exec, 1
buffer_store_dword v6, v7, s[20:23], s68 offen sc0 sc1
s_mov_b64 exec, -1
s_cmp_eq_u32 s63, 0
s_cbranch_scc1 LT_noA
ds_write_b128 v9, v[72:75] offset:0
ds_write_b128 v9, v[76:79] offset:16384
ds_write_b128 v9, v[80:83] offset:32768
ds_write_b128 v9, v[84:87] offset:49152
ds_write_b128 v9, v[88:91] offset:1024
ds_write_b128 v9, v[92:95] offset:17408
ds_write_b128 v9, v[96:99] offset:33792
ds_write_b128 v9, v[100:103] offset:50176
ds_write_b128 v9, v[104:107] offset:2048
ds_write_b128 v9, v[108:111] offset:18432
ds_write_b128 v9, v[112:115] offset:34816
ds_write_b128 v9, v[116:119] offset:51200
ds_write_b128 v9, v[120:123] offset:3072
ds_write_b128 v9, v[124:127] offset:19456
ds_write_b128 v9, v[128:131] offset:35840
ds_write_b128 v9, v[132:135] offset:52224
s_waitcnt lgkmcnt(0)
s_barrier
ds_read_b128 v[16:19], v10 offset:0
ds_read_b128 v[20:23], v10 offset:4096
ds_read_b128 v[24:27], v10 offset:8192
ds_read_b128 v[28:31], v10 offset:12288
ds_read_b128 v[32:35], v10 offset:1024
ds_read_b128 v[36:39], v10 offset:5120
ds_read_b128 v[40:43], v10 offset:9216
ds_read_b128 v[44:47], v10 offset:13312
ds_read_b128 v[48:51], v10 offset:2048
ds_read_b128 v[52:55], v10 offset:6144
ds_read_b128 v[56:59], v10 offset:10240
ds_read_b128 v[60:63], v10 offset:14336
ds_read_b128 v[64:67], v10 offset:3072
ds_read_b128 v[68:71], v10 offset:7168
ds_read_b128 v[72:75], v10 offset:11264
ds_read_b128 v[76:79], v10 offset:15360
buffer_load_dword v13, v14, s[20:23], s72 offen sc0 sc1
s_mul_i32 s26, s48, 28672
s_add_u32 s26, s26, s61
s_waitcnt lgkmcnt(12)
v_add_f32 v16, v16, v20
v_add_f32 v24, v24, v28
v_add_f32 v17, v17, v21
v_add_f32 v25, v25, v29
v_add_f32 v18, v18, v22
v_add_f32 v26, v26, v30
v_add_f32 v19, v19, v23
v_add_f32 v27, v27, v31
v_add_f32 v16, v16, v24
v_add_f32 v17, v17, v25
v_add_f32 v18, v18, v26
v_add_f32 v19, v19, v27
v_cvt_pk_bf16_f32 v16, v16, v17
v_cvt_pk_bf16_f32 v17, v18, v19
s_waitcnt lgkmcnt(8)
v_add_f32 v32, v32, v36
v_add_f32 v40, v40, v44
v_add_f32 v33, v33, v37
v_add_f32 v41, v41, v45
v_add_f32 v34, v34, v38
v_add_f32 v42, v42, v46
v_add_f32 v35, v35, v39
v_add_f32 v43, v43, v47
v_add_f32 v32, v32, v40
v_add_f32 v33, v33, v41
v_add_f32 v34, v34, v42
v_add_f32 v35, v35, v43
v_cvt_pk_bf16_f32 v18, v32, v33
v_cvt_pk_bf16_f32 v19, v34, v35
s_nop 1
v_permlane16_swap_b32 v16, v18
v_permlane16_swap_b32 v17, v19
buffer_store_dwordx4 v[16:19], v8, s[12:15], s26 offen offset:0 sc0 sc1
s_waitcnt lgkmcnt(4)
v_add_f32 v48, v48, v52
v_add_f32 v56, v56, v60
v_add_f32 v49, v49, v53
v_add_f32 v57, v57, v61
v_add_f32 v50, v50, v54
v_add_f32 v58, v58, v62
v_add_f32 v51, v51, v55
v_add_f32 v59, v59, v63
v_add_f32 v48, v48, v56
v_add_f32 v49, v49, v57
v_add_f32 v50, v50, v58
v_add_f32 v51, v51, v59
v_cvt_pk_bf16_f32 v48, v48, v49
v_cvt_pk_bf16_f32 v49, v50, v51
s_waitcnt lgkmcnt(0)
v_add_f32 v64, v64, v68
v_add_f32 v72, v72, v76
v_add_f32 v65, v65, v69
v_add_f32 v73, v73, v77
v_add_f32 v66, v66, v70
v_add_f32 v74, v74, v78
v_add_f32 v67, v67, v71
v_add_f32 v75, v75, v79
v_add_f32 v64, v64, v72
v_add_f32 v65, v65, v73
v_add_f32 v66, v66, v74
v_add_f32 v67, v67, v75
v_cvt_pk_bf16_f32 v50, v64, v65
v_cvt_pk_bf16_f32 v51, v66, v67
s_nop 1
v_permlane16_swap_b32 v48, v50
v_permlane16_swap_b32 v49, v51
buffer_store_dwordx4 v[48:51], v8, s[12:15], s26 offen offset:64 sc0 sc1
s_waitcnt vmcnt(2)
s_branch LT_sum
LT_noA:
buffer_load_dword v13, v14, s[20:23], s72 offen sc0 sc1
s_waitcnt vmcnt(0)
LT_sum:
s_mov_b32 s26, 0
LT_chkR:
v_cmp_ne_u32 vcc, s89, v13
s_cbranch_vccz LT_okR
s_cmp_gt_u32 s26, 200000
s_cbranch_scc1 LT_okR
s_sleep 1
buffer_load_dword v13, v14, s[20:23], s72 offen sc0 sc1
s_add_u32 s26, s26, 1
s_waitcnt vmcnt(0)
s_branch LT_chkR
LT_okR:
buffer_load_dwordx4 v[96:99], v1, s[20:23], s71 offen offset:0 sc1
buffer_load_dwordx4 v[100:103], v1, s[20:23], s71 offen offset:1024 sc1
buffer_load_dwordx4 v[104:107], v1, s[20:23], s71 offen offset:2048 sc1
buffer_load_dwordx4 v[108:111], v1, s[20:23], s71 offen offset:3072 sc1
s_add_u32 s71, s71, 4096
buffer_load_dwordx4 v[112:115], v1, s[20:23], s71 offen offset:0 sc1
buffer_load_dwordx4 v[116:119], v1, s[20:23], s71 offen offset:1024 sc1
buffer_load_dwordx4 v[120:123], v1, s[20:23], s71 offen offset:2048 sc1
buffer_load_dwordx4 v[124:127], v1, s[20:23], s71 offen offset:3072 sc1
s_mov_b32 s26, 0x3f80
s_mov_b32 s27, 0x3f800000
s_add_u32 s28, s69, 28672
s_waitcnt vmcnt(4)
v_dot2_f32_bf16 v128, v96, s26, 0
v_dot2_f32_bf16 v129, v96, s27, 0
v_dot2_f32_bf16 v130, v97, s26, 0
v_dot2_f32_bf16 v131, v97, s27, 0
v_dot2_f32_bf16 v132, v98, s26, 0
v_dot2_f32_bf16 v133, v98, s27, 0
v_dot2_f32_bf16 v134, v99, s26, 0
v_dot2_f32_bf16 v135, v99, s27, 0
v_dot2_f32_bf16 v128, v100, s26, v128
v_dot2_f32_bf16 v129, v100, s27, v129
v_dot2_f32_bf16 v130, v101, s26, v130
v_dot2_f32_bf16 v131, v101, s27, v131
v_dot2_f32_bf16 v132, v102, s26, v132
v_dot2_f32_bf16 v133, v102, s27, v133
v_dot2_f32_bf16 v134, v103, s26, v134
v_dot2_f32_bf16 v135, v103, s27, v135
v_dot2_f32_bf16 v128, v104, s26, v128
v_dot2_f32_bf16 v129, v104, s27, v129
v_dot2_f32_bf16 v130, v105, s26, v130
v_dot2_f32_bf16 v131, v105, s27, v131
v_dot2_f32_bf16 v132, v106, s26, v132
v_dot2_f32_bf16 v133, v106, s27, v133
v_dot2_f32_bf16 v134, v107, s26, v134
v_dot2_f32_bf16 v135, v107, s27, v135
v_dot2_f32_bf16 v128, v108, s26, v128
v_dot2_f32_bf16 v129, v108, s27, v129
v_dot2_f32_bf16 v130, v109, s26, v130
v_dot2_f32_bf16 v131, v109, s27, v131
v_dot2_f32_bf16 v132, v110, s26, v132
v_dot2_f32_bf16 v133, v110, s27, v133
v_dot2_f32_bf16 v134, v111, s26, v134
v_dot2_f32_bf16 v135, v111, s27, v135
s_nop 2
v_cvt_pk_bf16_f32 v88, v128, v129
v_cvt_pk_bf16_f32 v89, v130, v131
v_cvt_pk_bf16_f32 v92, v132, v133
v_cvt_pk_bf16_f32 v93, v134, v135
s_cmp_lg_u32 s48, 3
s_cbranch_scc1 LT_pair
buffer_store_dwordx2 v[88:89], v147, s[12:15], s69 offen sc0 sc1
buffer_store_dwordx2 v[92:93], v147, s[12:15], s28 offen sc0 sc1
s_branch LP_end
LT_pair:
s_waitcnt vmcnt(0)
v_dot2_f32_bf16 v136, v112, s26, 0
v_dot2_f32_bf16 v137, v112, s27, 0
v_dot2_f32_bf16 v138, v113, s26, 0
v_dot2_f32_bf16 v139, v113, s27, 0
v_dot2_f32_bf16 v140, v114, s26, 0
v_dot2_f32_bf16 v141, v114, s27, 0
v_dot2_f32_bf16 v142, v115, s26, 0
v_dot2_f32_bf16 v143, v115, s27, 0
v_dot2_f32_bf16 v136, v116, s26, v136
v_dot2_f32_bf16 v137, v116, s27, v137
v_dot2_f32_bf16 v138, v117, s26, v138
v_dot2_f32_bf16 v139, v117, s27, v139
v_dot2_f32_bf16 v140, v118, s26, v140
v_dot2_f32_bf16 v141, v118, s27, v141
v_dot2_f32_bf16 v142, v119, s26, v142
v_dot2_f32_bf16 v143, v119, s27, v143
v_dot2_f32_bf16 v136, v120, s26, v136
v_dot2_f32_bf16 v137, v120, s27, v137
v_dot2_f32_bf16 v138, v121, s26, v138
v_dot2_f32_bf16 v139, v121, s27, v139
v_dot2_f32_bf16 v140, v122, s26, v140
v_dot2_f32_bf16 v141, v122, s27, v141
v_dot2_f32_bf16 v142, v123, s26, v142
v_dot2_f32_bf16 v143, v123, s27, v143
v_dot2_f32_bf16 v136, v124, s26, v136
v_dot2_f32_bf16 v137, v124, s27, v137
v_dot2_f32_bf16 v138, v125, s26, v138
v_dot2_f32_bf16 v139, v125, s27, v139
v_dot2_f32_bf16 v140, v126, s26, v140
v_dot2_f32_bf16 v141, v126, s27, v141
v_dot2_f32_bf16 v142, v127, s26, v142
v_dot2_f32_bf16 v143, v127, s27, v143
s_nop 2
v_cvt_pk_bf16_f32 v90, v136, v137
v_cvt_pk_bf16_f32 v91, v138, v139
v_cvt_pk_bf16_f32 v94, v140, v141
v_cvt_pk_bf16_f32 v95, v142, v143
s_nop 1
v_permlane16_swap_b32 v88, v90
v_permlane16_swap_b32 v89, v91
buffer_store_dwordx4 v[88:91], v8, s[12:15], s69 offen sc0 sc1
v_permlane16_swap_b32 v92, v94
v_permlane16_swap_b32 v93, v95
buffer_store_dwordx4 v[92:95], v8, s[12:15], s28 offen sc0 sc1
LP_end:
L2_end:
s_endpgm
L_text_end:
.section .rodata,"a"
.p2align 6
.amdhsa_kernel concat_heads__softmax_full_mha__compressed_kv_cla__prompt_kernel
  .amdhsa_next_free_vgpr 512
  .amdhsa_next_free_sgpr 102
  .amdhsa_accum_offset 256
  .amdhsa_group_segment_fixed_size 0
  .amdhsa_kernarg_size 96
  .amdhsa_user_sgpr_count 2
  .amdhsa_user_sgpr_kernarg_segment_ptr 1
  .amdhsa_system_sgpr_workgroup_id_x 1
.end_amdhsa_kernel
```
